```python
import torch

def _softmax(x, axis=-1):
    return torch.softmax(x, dim=axis)
def _gelu(x):
    return torch.nn.functional.gelu(x, approximate="tanh")
def _silu(x):
    return torch.nn.functional.silu(x)
def _sigmoid(x):
    return torch.sigmoid(x)
def _layernorm(x, axis=-1, eps=1e-5):
    m = x.mean(dim=axis, keepdim=True)
    v = x.var(dim=axis, keepdim=True, unbiased=False)
    return (x - m) / torch.sqrt(v + eps)
def _scatter_add(tgt, idx, src, axis=0):
    return tgt.clone().index_add_(axis, idx, src)
def _segment_sum(src, seg, n):
    out = torch.zeros((n,) + src.shape[1:], dtype=src.dtype)
    return out.index_add_(0, seg, src)
def _pad(x, pw):
    flat = tuple(v for pair in reversed(pw) for v in pair)
    return torch.nn.functional.pad(x, flat)

kernel_name = 'interleave_layers__mha_block_cached__glu_gated_geglu__decode'

def setup_inputs():

    _w = (lambda a: (lambda t: t.to(torch.bfloat16) if t.is_floating_point() else t)(torch.as_tensor(a)))
    def _A_setup():
        B, Sq, D = 4, 1, 640
        H, Sk, Dh = 32, 8192, 192
        return {
            "x": _w((lambda *s: torch.randn(*s, dtype=torch.bfloat16) * 0.05)(B, Sq, D)),
            "k_cache": _w((lambda *s: torch.randn(*s, dtype=torch.bfloat16) * 0.4)(B, H, Sk, Dh)),
            "v_cache": _w((lambda *s: torch.randn(*s, dtype=torch.bfloat16) * 1.6)(B, H, Sk, Dh)),
            "wq": _w((lambda *s: torch.randn(*s, dtype=torch.bfloat16) * 0.4)(D, H * Dh) * (D ** -0.5)),
            "wo": _w((lambda *s: torch.randn(*s, dtype=torch.bfloat16) * 1.6)(H * Dh, D) * ((H * Dh) ** -0.5)),
        }
    _A_in = _A_setup()

    def _B_setup():
        B, S, Dm, Df = 4, 1, 640, 1536
        return {
            "x": _w((lambda *s: torch.randn(*s, dtype=torch.bfloat16) * 0.05)(B, S, Dm)),
            "w_gate": _w((lambda *s: torch.randn(*s, dtype=torch.bfloat16) * 0.4)(Dm, Df) * (Dm ** -0.5)),
            "w_up": _w((lambda *s: torch.randn(*s, dtype=torch.bfloat16) * 0.4)(Dm, Df) * (Dm ** -0.5)),
            "w_down": _w((lambda *s: torch.randn(*s, dtype=torch.bfloat16) * 0.4)(Df, Dm) * (Df ** -0.5)),
        }
    _B_in = _B_setup()

    return {
        "A_x": _A_in["x"],
        "A_k_cache": _A_in["k_cache"],
        "A_v_cache": _A_in["v_cache"],
        "A_wq": _A_in["wq"],
        "A_wo": _A_in["wo"],
        "B_x": _B_in["x"],
        "B_w_gate": _B_in["w_gate"],
        "B_w_up": _B_in["w_up"],
        "B_w_down": _B_in["w_down"],
    }

def reference(A_x, A_k_cache, A_v_cache, A_wq, A_wo, B_x, B_w_gate, B_w_up, B_w_down):
    def _A_ref(x, k_cache, v_cache, wq, wo):
        B, Sq, D = x.shape
        H, Dh = 32, 192
        q = (lambda x, *d: x.permute(*d))((x @ wq).reshape(B, Sq, H, Dh), 0, 2, 1, 3)
        scores = torch.einsum("bhqd,bhkd->bhqk", q, k_cache) * (Dh ** -0.5)
        p = _softmax(scores, axis=-1)
        o = torch.einsum("bhqk,bhkd->bhqd", p, v_cache)
        return (lambda x, *d: x.permute(*d))(o, 0, 2, 1, 3).reshape(B, Sq, H * Dh) @ wo

    def _B_ref(x, w_gate, w_up, w_down):
        g = torch.einsum("bsd,df->bsf", x, w_gate)
        u = torch.einsum("bsd,df->bsf", x, w_up)
        h = _gelu(g) * u
        return torch.einsum("bsf,fd->bsd", h, w_down)

    x = A_x
    x = x + _A_ref(_layernorm(x, axis=-1), A_k_cache, A_v_cache, A_wq, A_wo)
    x = x + _B_ref(_layernorm(x, axis=-1), B_w_gate, B_w_up, B_w_down)
    x = x + _A_ref(_layernorm(x, axis=-1), A_k_cache, A_v_cache, A_wq, A_wo)
    x = x + _B_ref(_layernorm(x, axis=-1), B_w_gate, B_w_up, B_w_down)
    return x
```

```asm
; @launch grid=(256,1,1) block=(256,1,1) lds=163840
.amdgcn_target "amdgcn-amd-amdhsa--gfx950"
.text

.macro QK2 ta, tb, q, s
  v_dot2_f32_bf16 v[\s+0], v[\ta+0], v[\q+0], 0
  v_dot2_f32_bf16 v[\s+1], v[\ta+4], v[\q+4], 0
  v_dot2_f32_bf16 v[\s+2], v[\ta+8], v[\q+8], 0
  v_dot2_f32_bf16 v[\s+3], v[\tb+0], v[\q+0], 0
  v_dot2_f32_bf16 v[\s+4], v[\tb+4], v[\q+4], 0
  v_dot2_f32_bf16 v[\s+5], v[\tb+8], v[\q+8], 0
  .irp k, 1, 2, 3
  v_dot2c_f32_bf16 v[\s+0], v[\ta+\k], v[\q+\k]
  v_dot2c_f32_bf16 v[\s+1], v[\ta+4+\k], v[\q+4+\k]
  v_dot2c_f32_bf16 v[\s+2], v[\ta+8+\k], v[\q+8+\k]
  v_dot2c_f32_bf16 v[\s+3], v[\tb+\k], v[\q+\k]
  v_dot2c_f32_bf16 v[\s+4], v[\tb+4+\k], v[\q+4+\k]
  v_dot2c_f32_bf16 v[\s+5], v[\tb+8+\k], v[\q+8+\k]
  .endr
.endm
.macro PV t, p, acc
  .irp k, 0, 1, 2, 3, 4, 5, 6, 7, 8, 9, 10, 11
  v_dot2c_f32_bf16 v[\acc+2*\k], v[\t+\k], v[\p]
  v_dot2c_f32_bf16 v[\acc+2*\k+1], v[\t+\k], v[\p+1]
  .endr
.endm
.macro ACR t, s
  .irp k, 0, 1, 2, 3, 4, 5, 6, 7, 8, 9, 10, 11
  v_accvgpr_read_b32 v[\t+\k], a[\s+\k]
  .endr
.endm
.macro LDT k, d, srd
  buffer_load_dwordx4 \k[\d:\d+3], v1, s[\srd:\srd+3], s76 offen nt
  buffer_load_dwordx4 \k[\d+4:\d+7], v1, s[\srd:\srd+3], s76 offen offset:128 nt
  buffer_load_dwordx4 \k[\d+8:\d+11], v1, s[\srd:\srd+3], s76 offen offset:256 nt
.endm
.macro LDC k, d, srd
  buffer_load_dwordx4 \k[\d:\d+3], v1, s[\srd:\srd+3], s76 offen
  buffer_load_dwordx4 \k[\d+4:\d+7], v1, s[\srd:\srd+3], s76 offen offset:128
  buffer_load_dwordx4 \k[\d+8:\d+11], v1, s[\srd:\srd+3], s76 offen offset:256
.endm
.macro RESC acc, al
  .irp k, 0, 1, 2, 3, 4, 5, 6, 7, 8, 9, 10, 11, 12, 13, 14, 15, 16, 17, 18, 19, 20, 21, 22, 23
  v_mul_f32 v[\acc+\k], v[\al], v[\acc+\k]
  .endr
.endm
.macro GV8 w, x, acc
  .irp k, 0, 1, 2, 3
  v_dot2c_f32_bf16 v[\acc+2*\k], v[\w+\k], v[\x]
  v_dot2c_f32_bf16 v[\acc+2*\k+1], v[\w+\k], v[\x+1]
  .endr
.endm
.macro AC4 t, s
  .irp k, 0, 1, 2, 3
  v_accvgpr_read_b32 v[\t+\k], a[\s+\k]
  .endr
.endm

.globl interleave_layers__mha_block_cached__glu_gated_geglu__decode_kernel
.p2align 8
.type interleave_layers__mha_block_cached__glu_gated_geglu__decode_kernel,@function
interleave_layers__mha_block_cached__glu_gated_geglu__decode_kernel:
  s_cmp_ge_u32 s2, 256
  s_cbranch_scc1 L_exit
  s_load_dwordx16 s[8:23], s[0:1], 0
  s_load_dwordx8 s[24:31], s[0:1], 64
  v_lshrrev_b32 v1, 6, v0
  v_and_b32 v0, 63, v0
  v_readfirstlane_b32 s3, v1
  s_waitcnt lgkmcnt(0)
  s_mov_b32 s64, s30
  s_and_b32 s65, s31, 0xffff
  s_mov_b32 s66, 0xc90000
  s_mov_b32 s67, 0x20000
  s_cmp_ge_u32 s2, 208
  s_cbranch_scc1 L_chain
  s_branch L_stream
L_exit:
  s_endpgm
L_chain:
  s_cmp_ge_u32 s2, 240
  s_cbranch_scc1 L_qcu
  s_nop 4
L_acu:
  s_lshl_b32 s4, s3, 6
  v_add_u32 v15, s4, v0
  v_lshlrev_b32 v15, 4, v15
  v_mov_b32 v16, -1
  v_mov_b32 v17, -1
  v_mov_b32 v18, -1
  v_mov_b32 v19, -1
  s_mov_b32 s96, s8
  s_and_b32 s97, s9, 0xffff
  s_mov_b32 s98, 0x1400
  s_mov_b32 s99, 0x20000
  v_lshlrev_b32 v254, 2, v0
  s_mul_i32 s76, s3, 1280
  buffer_load_dword v226, v254, s[96:99], s76 offen offset:0
  buffer_load_dword v227, v254, s[96:99], s76 offen offset:256
  buffer_load_dword v228, v254, s[96:99], s76 offen offset:512
  buffer_load_dword v229, v254, s[96:99], s76 offen offset:768
  buffer_load_dword v230, v254, s[96:99], s76 offen offset:1024
  s_mul_i32 s4, s2, 48
  s_sub_u32 s5, 7864320, s4
  s_add_u32 s92, s14, s4
  s_addc_u32 s93, s15, 0
  s_and_b32 s93, s93, 0xffff
  s_mov_b32 s94, s5
  s_mov_b32 s95, 0x20000
  v_and_b32 v255, 15, v0
  v_mul_u32_u24 v255, 122880, v255
  v_lshrrev_b32 v128, 4, v0
  v_min_u32 v128, 2, v128
  v_lshl_add_u32 v255, v128, 4, v255
  s_mul_i32 s4, s3, 1966080
  s_add_u32 s76, s4, 0
  buffer_load_dwordx4 v[56:59], v255, s[92:95], s76 offen
  s_add_u32 s76, s4, 12288
  buffer_load_dwordx4 v[60:63], v255, s[92:95], s76 offen
  s_add_u32 s76, s4, 24576
  buffer_load_dwordx4 v[64:67], v255, s[92:95], s76 offen
  s_add_u32 s76, s4, 36864
  buffer_load_dwordx4 v[68:71], v255, s[92:95], s76 offen
  s_add_u32 s76, s4, 49152
  buffer_load_dwordx4 v[72:75], v255, s[92:95], s76 offen
  s_add_u32 s76, s4, 61440
  buffer_load_dwordx4 v[76:79], v255, s[92:95], s76 offen
  s_add_u32 s76, s4, 73728
  buffer_load_dwordx4 v[80:83], v255, s[92:95], s76 offen
  s_add_u32 s76, s4, 86016
  buffer_load_dwordx4 v[84:87], v255, s[92:95], s76 offen
  s_add_u32 s76, s4, 98304
  buffer_load_dwordx4 v[88:91], v255, s[92:95], s76 offen
  s_add_u32 s76, s4, 110592
  buffer_load_dwordx4 v[92:95], v255, s[92:95], s76 offen
  s_waitcnt vmcnt(10)
  v_lshlrev_b32 v231, 16, v226
  v_and_b32 v232, 0xffff0000, v226
  v_lshlrev_b32 v233, 16, v227
  v_and_b32 v234, 0xffff0000, v227
  v_lshlrev_b32 v235, 16, v228
  v_and_b32 v236, 0xffff0000, v228
  v_lshlrev_b32 v237, 16, v229
  v_and_b32 v238, 0xffff0000, v229
  v_lshlrev_b32 v239, 16, v230
  v_and_b32 v240, 0xffff0000, v230
  v_add_f32 v96, v231, v232
  v_add_f32 v96, v96, v233
  v_add_f32 v96, v96, v234
  v_add_f32 v96, v96, v235
  v_add_f32 v96, v96, v236
  v_add_f32 v96, v96, v237
  v_add_f32 v96, v96, v238
  v_add_f32 v96, v96, v239
  v_add_f32 v96, v96, v240
  s_nop 1
  v_add_f32_dpp v96, v96, v96 quad_perm:[1,0,3,2] row_mask:0xf bank_mask:0xf
  s_nop 1
  v_add_f32_dpp v96, v96, v96 quad_perm:[2,3,0,1] row_mask:0xf bank_mask:0xf
  s_nop 1
  v_add_f32_dpp v96, v96, v96 row_half_mirror row_mask:0xf bank_mask:0xf
  s_nop 1
  v_add_f32_dpp v96, v96, v96 row_mirror row_mask:0xf bank_mask:0xf
  v_mov_b32 v97, v96
  s_nop 1
  v_permlane16_swap_b32 v96, v97
  v_add_f32 v96, v96, v97
  v_mov_b32 v97, v96
  s_nop 1
  v_permlane32_swap_b32 v96, v97
  v_add_f32 v96, v96, v97
  v_mul_f32 v98, 0x3acccccd, v96
  v_sub_f32 v100, v231, v98
  v_sub_f32 v101, v232, v98
  v_sub_f32 v102, v233, v98
  v_sub_f32 v103, v234, v98
  v_sub_f32 v104, v235, v98
  v_sub_f32 v105, v236, v98
  v_sub_f32 v106, v237, v98
  v_sub_f32 v107, v238, v98
  v_sub_f32 v108, v239, v98
  v_sub_f32 v109, v240, v98
  v_mul_f32 v96, v100, v100
  v_fmac_f32 v96, v101, v101
  v_fmac_f32 v96, v102, v102
  v_fmac_f32 v96, v103, v103
  v_fmac_f32 v96, v104, v104
  v_fmac_f32 v96, v105, v105
  v_fmac_f32 v96, v106, v106
  v_fmac_f32 v96, v107, v107
  v_fmac_f32 v96, v108, v108
  v_fmac_f32 v96, v109, v109
  s_nop 1
  v_add_f32_dpp v96, v96, v96 quad_perm:[1,0,3,2] row_mask:0xf bank_mask:0xf
  s_nop 1
  v_add_f32_dpp v96, v96, v96 quad_perm:[2,3,0,1] row_mask:0xf bank_mask:0xf
  s_nop 1
  v_add_f32_dpp v96, v96, v96 row_half_mirror row_mask:0xf bank_mask:0xf
  s_nop 1
  v_add_f32_dpp v96, v96, v96 row_mirror row_mask:0xf bank_mask:0xf
  v_mov_b32 v97, v96
  s_nop 1
  v_permlane16_swap_b32 v96, v97
  v_add_f32 v96, v96, v97
  v_mov_b32 v97, v96
  s_nop 1
  v_permlane32_swap_b32 v96, v97
  v_add_f32 v96, v96, v97
  v_mul_f32 v99, 0x3acccccd, v96
  v_cvt_pk_bf16_f32 v98, 0, v98
  v_cvt_pk_bf16_f32 v99, 0, v99
  v_add_f32 v99, 0x3727c5ac, v99
  v_cvt_pk_bf16_f32 v99, 0, v99
  v_sqrt_f32 v99, v99
  s_nop 0
  v_cvt_pk_bf16_f32 v99, 0, v99
  v_rcp_f32 v97, v99
  v_sub_f32 v100, v231, v98
  v_sub_f32 v101, v232, v98
  v_sub_f32 v102, v233, v98
  v_sub_f32 v103, v234, v98
  v_sub_f32 v104, v235, v98
  v_sub_f32 v105, v236, v98
  v_sub_f32 v106, v237, v98
  v_sub_f32 v107, v238, v98
  v_sub_f32 v108, v239, v98
  v_sub_f32 v109, v240, v98
  v_cvt_pk_bf16_f32 v100, 0, v100
  v_cvt_pk_bf16_f32 v101, 0, v101
  v_cvt_pk_bf16_f32 v102, 0, v102
  v_cvt_pk_bf16_f32 v103, 0, v103
  v_cvt_pk_bf16_f32 v104, 0, v104
  v_cvt_pk_bf16_f32 v105, 0, v105
  v_cvt_pk_bf16_f32 v106, 0, v106
  v_cvt_pk_bf16_f32 v107, 0, v107
  v_cvt_pk_bf16_f32 v108, 0, v108
  v_cvt_pk_bf16_f32 v109, 0, v109
  v_mul_f32 v110, v100, v97
  v_mul_f32 v111, v101, v97
  v_mul_f32 v112, v102, v97
  v_mul_f32 v113, v103, v97
  v_mul_f32 v114, v104, v97
  v_mul_f32 v115, v105, v97
  v_mul_f32 v116, v106, v97
  v_mul_f32 v117, v107, v97
  v_mul_f32 v118, v108, v97
  v_mul_f32 v119, v109, v97
  v_fma_f32 v241, -v110, v99, v100
  v_fma_f32 v242, -v111, v99, v101
  v_fma_f32 v243, -v112, v99, v102
  v_fma_f32 v244, -v113, v99, v103
  v_fma_f32 v245, -v114, v99, v104
  v_fma_f32 v246, -v115, v99, v105
  v_fma_f32 v247, -v116, v99, v106
  v_fma_f32 v248, -v117, v99, v107
  v_fma_f32 v249, -v118, v99, v108
  v_fma_f32 v250, -v119, v99, v109
  v_fma_f32 v110, v241, v97, v110
  v_fma_f32 v111, v242, v97, v111
  v_fma_f32 v112, v243, v97, v112
  v_fma_f32 v113, v244, v97, v113
  v_fma_f32 v114, v245, v97, v114
  v_fma_f32 v115, v246, v97, v115
  v_fma_f32 v116, v247, v97, v116
  v_fma_f32 v117, v248, v97, v117
  v_fma_f32 v118, v249, v97, v118
  v_fma_f32 v119, v250, v97, v119
  s_mul_i32 s4, s3, 5120
  v_lshlrev_b32 v254, 4, v0
  v_add_u32 v254, s4, v254
  v_cvt_pk_bf16_f32 v120, v110, 0
  v_cvt_pk_bf16_f32 v121, 0, v110
  v_cvt_pk_bf16_f32 v122, v111, 0
  v_cvt_pk_bf16_f32 v123, 0, v111
  ds_write_b128 v254, v[120:123] offset:0
  s_waitcnt lgkmcnt(0)
  v_cvt_pk_bf16_f32 v120, v112, 0
  v_cvt_pk_bf16_f32 v121, 0, v112
  v_cvt_pk_bf16_f32 v122, v113, 0
  v_cvt_pk_bf16_f32 v123, 0, v113
  ds_write_b128 v254, v[120:123] offset:1024
  s_waitcnt lgkmcnt(0)
  v_cvt_pk_bf16_f32 v120, v114, 0
  v_cvt_pk_bf16_f32 v121, 0, v114
  v_cvt_pk_bf16_f32 v122, v115, 0
  v_cvt_pk_bf16_f32 v123, 0, v115
  ds_write_b128 v254, v[120:123] offset:2048
  s_waitcnt lgkmcnt(0)
  v_cvt_pk_bf16_f32 v120, v116, 0
  v_cvt_pk_bf16_f32 v121, 0, v116
  v_cvt_pk_bf16_f32 v122, v117, 0
  v_cvt_pk_bf16_f32 v123, 0, v117
  ds_write_b128 v254, v[120:123] offset:3072
  s_waitcnt lgkmcnt(0)
  v_cvt_pk_bf16_f32 v120, v118, 0
  v_cvt_pk_bf16_f32 v121, 0, v118
  v_cvt_pk_bf16_f32 v122, v119, 0
  v_cvt_pk_bf16_f32 v123, 0, v119
  ds_write_b128 v254, v[120:123] offset:4096
  s_waitcnt lgkmcnt(0)
  s_waitcnt lgkmcnt(0)
  s_barrier
  v_and_b32 v254, 15, v0
  v_mul_u32_u24 v254, 80, v254
  s_mul_i32 s4, s3, 1280
  v_add_u32 v254, s4, v254
  v_mov_b32 v96, 0
  v_mov_b32 v97, 0
  v_mov_b32 v98, 0
  v_mov_b32 v99, 0
  v_mov_b32 v100, 0
  v_mov_b32 v101, 0
  v_mov_b32 v102, 0
  v_mov_b32 v103, 0
  v_mov_b32 v104, 0
  v_mov_b32 v105, 0
  v_mov_b32 v106, 0
  v_mov_b32 v107, 0
  v_mov_b32 v108, 0
  v_mov_b32 v109, 0
  v_mov_b32 v110, 0
  v_mov_b32 v111, 0
  v_mov_b32 v112, 0
  v_mov_b32 v113, 0
  v_mov_b32 v114, 0
  v_mov_b32 v115, 0
  v_mov_b32 v116, 0
  v_mov_b32 v117, 0
  v_mov_b32 v118, 0
  v_mov_b32 v119, 0
  v_mov_b32 v120, 0
  v_mov_b32 v121, 0
  v_mov_b32 v122, 0
  v_mov_b32 v123, 0
  v_mov_b32 v124, 0
  v_mov_b32 v125, 0
  v_mov_b32 v126, 0
  v_mov_b32 v127, 0
  s_waitcnt vmcnt(0)
  ds_read_b128 v[226:229], v254 offset:0
  ds_read_b128 v[230:233], v254 offset:16
  ds_read_b128 v[234:237], v254 offset:32
  ds_read_b128 v[238:241], v254 offset:48
  ds_read_b128 v[242:245], v254 offset:64
  s_waitcnt lgkmcnt(0)
  GV8 56, 226, 96
  GV8 60, 228, 96
  GV8 64, 230, 96
  GV8 68, 232, 96
  GV8 72, 234, 96
  GV8 76, 236, 96
  GV8 80, 238, 96
  GV8 84, 240, 96
  GV8 88, 242, 96
  GV8 92, 244, 96
  ds_read_b128 v[226:229], v254 offset:5120
  ds_read_b128 v[230:233], v254 offset:5136
  ds_read_b128 v[234:237], v254 offset:5152
  ds_read_b128 v[238:241], v254 offset:5168
  ds_read_b128 v[242:245], v254 offset:5184
  s_waitcnt lgkmcnt(0)
  GV8 56, 226, 104
  GV8 60, 228, 104
  GV8 64, 230, 104
  GV8 68, 232, 104
  GV8 72, 234, 104
  GV8 76, 236, 104
  GV8 80, 238, 104
  GV8 84, 240, 104
  GV8 88, 242, 104
  GV8 92, 244, 104
  ds_read_b128 v[226:229], v254 offset:10240
  ds_read_b128 v[230:233], v254 offset:10256
  ds_read_b128 v[234:237], v254 offset:10272
  ds_read_b128 v[238:241], v254 offset:10288
  ds_read_b128 v[242:245], v254 offset:10304
  s_waitcnt lgkmcnt(0)
  GV8 56, 226, 112
  GV8 60, 228, 112
  GV8 64, 230, 112
  GV8 68, 232, 112
  GV8 72, 234, 112
  GV8 76, 236, 112
  GV8 80, 238, 112
  GV8 84, 240, 112
  GV8 88, 242, 112
  GV8 92, 244, 112
  ds_read_b128 v[226:229], v254 offset:15360
  ds_read_b128 v[230:233], v254 offset:15376
  ds_read_b128 v[234:237], v254 offset:15392
  ds_read_b128 v[238:241], v254 offset:15408
  ds_read_b128 v[242:245], v254 offset:15424
  s_waitcnt lgkmcnt(0)
  GV8 56, 226, 120
  GV8 60, 228, 120
  GV8 64, 230, 120
  GV8 68, 232, 120
  GV8 72, 234, 120
  GV8 76, 236, 120
  GV8 80, 238, 120
  GV8 84, 240, 120
  GV8 88, 242, 120
  GV8 92, 244, 120
  v_add_f32_dpp v96, v96, v96 quad_perm:[1,0,3,2] row_mask:0xf bank_mask:0xf
  v_add_f32_dpp v97, v97, v97 quad_perm:[1,0,3,2] row_mask:0xf bank_mask:0xf
  v_add_f32_dpp v98, v98, v98 quad_perm:[1,0,3,2] row_mask:0xf bank_mask:0xf
  v_add_f32_dpp v99, v99, v99 quad_perm:[1,0,3,2] row_mask:0xf bank_mask:0xf
  v_add_f32_dpp v100, v100, v100 quad_perm:[1,0,3,2] row_mask:0xf bank_mask:0xf
  v_add_f32_dpp v101, v101, v101 quad_perm:[1,0,3,2] row_mask:0xf bank_mask:0xf
  v_add_f32_dpp v102, v102, v102 quad_perm:[1,0,3,2] row_mask:0xf bank_mask:0xf
  v_add_f32_dpp v103, v103, v103 quad_perm:[1,0,3,2] row_mask:0xf bank_mask:0xf
  v_add_f32_dpp v104, v104, v104 quad_perm:[1,0,3,2] row_mask:0xf bank_mask:0xf
  v_add_f32_dpp v105, v105, v105 quad_perm:[1,0,3,2] row_mask:0xf bank_mask:0xf
  v_add_f32_dpp v106, v106, v106 quad_perm:[1,0,3,2] row_mask:0xf bank_mask:0xf
  v_add_f32_dpp v107, v107, v107 quad_perm:[1,0,3,2] row_mask:0xf bank_mask:0xf
  v_add_f32_dpp v108, v108, v108 quad_perm:[1,0,3,2] row_mask:0xf bank_mask:0xf
  v_add_f32_dpp v109, v109, v109 quad_perm:[1,0,3,2] row_mask:0xf bank_mask:0xf
  v_add_f32_dpp v110, v110, v110 quad_perm:[1,0,3,2] row_mask:0xf bank_mask:0xf
  v_add_f32_dpp v111, v111, v111 quad_perm:[1,0,3,2] row_mask:0xf bank_mask:0xf
  v_add_f32_dpp v112, v112, v112 quad_perm:[1,0,3,2] row_mask:0xf bank_mask:0xf
  v_add_f32_dpp v113, v113, v113 quad_perm:[1,0,3,2] row_mask:0xf bank_mask:0xf
  v_add_f32_dpp v114, v114, v114 quad_perm:[1,0,3,2] row_mask:0xf bank_mask:0xf
  v_add_f32_dpp v115, v115, v115 quad_perm:[1,0,3,2] row_mask:0xf bank_mask:0xf
  v_add_f32_dpp v116, v116, v116 quad_perm:[1,0,3,2] row_mask:0xf bank_mask:0xf
  v_add_f32_dpp v117, v117, v117 quad_perm:[1,0,3,2] row_mask:0xf bank_mask:0xf
  v_add_f32_dpp v118, v118, v118 quad_perm:[1,0,3,2] row_mask:0xf bank_mask:0xf
  v_add_f32_dpp v119, v119, v119 quad_perm:[1,0,3,2] row_mask:0xf bank_mask:0xf
  v_add_f32_dpp v120, v120, v120 quad_perm:[1,0,3,2] row_mask:0xf bank_mask:0xf
  v_add_f32_dpp v121, v121, v121 quad_perm:[1,0,3,2] row_mask:0xf bank_mask:0xf
  v_add_f32_dpp v122, v122, v122 quad_perm:[1,0,3,2] row_mask:0xf bank_mask:0xf
  v_add_f32_dpp v123, v123, v123 quad_perm:[1,0,3,2] row_mask:0xf bank_mask:0xf
  v_add_f32_dpp v124, v124, v124 quad_perm:[1,0,3,2] row_mask:0xf bank_mask:0xf
  v_add_f32_dpp v125, v125, v125 quad_perm:[1,0,3,2] row_mask:0xf bank_mask:0xf
  v_add_f32_dpp v126, v126, v126 quad_perm:[1,0,3,2] row_mask:0xf bank_mask:0xf
  v_add_f32_dpp v127, v127, v127 quad_perm:[1,0,3,2] row_mask:0xf bank_mask:0xf
  v_add_f32_dpp v96, v96, v96 quad_perm:[2,3,0,1] row_mask:0xf bank_mask:0xf
  v_add_f32_dpp v97, v97, v97 quad_perm:[2,3,0,1] row_mask:0xf bank_mask:0xf
  v_add_f32_dpp v98, v98, v98 quad_perm:[2,3,0,1] row_mask:0xf bank_mask:0xf
  v_add_f32_dpp v99, v99, v99 quad_perm:[2,3,0,1] row_mask:0xf bank_mask:0xf
  v_add_f32_dpp v100, v100, v100 quad_perm:[2,3,0,1] row_mask:0xf bank_mask:0xf
  v_add_f32_dpp v101, v101, v101 quad_perm:[2,3,0,1] row_mask:0xf bank_mask:0xf
  v_add_f32_dpp v102, v102, v102 quad_perm:[2,3,0,1] row_mask:0xf bank_mask:0xf
  v_add_f32_dpp v103, v103, v103 quad_perm:[2,3,0,1] row_mask:0xf bank_mask:0xf
  v_add_f32_dpp v104, v104, v104 quad_perm:[2,3,0,1] row_mask:0xf bank_mask:0xf
  v_add_f32_dpp v105, v105, v105 quad_perm:[2,3,0,1] row_mask:0xf bank_mask:0xf
  v_add_f32_dpp v106, v106, v106 quad_perm:[2,3,0,1] row_mask:0xf bank_mask:0xf
  v_add_f32_dpp v107, v107, v107 quad_perm:[2,3,0,1] row_mask:0xf bank_mask:0xf
  v_add_f32_dpp v108, v108, v108 quad_perm:[2,3,0,1] row_mask:0xf bank_mask:0xf
  v_add_f32_dpp v109, v109, v109 quad_perm:[2,3,0,1] row_mask:0xf bank_mask:0xf
  v_add_f32_dpp v110, v110, v110 quad_perm:[2,3,0,1] row_mask:0xf bank_mask:0xf
  v_add_f32_dpp v111, v111, v111 quad_perm:[2,3,0,1] row_mask:0xf bank_mask:0xf
  v_add_f32_dpp v112, v112, v112 quad_perm:[2,3,0,1] row_mask:0xf bank_mask:0xf
  v_add_f32_dpp v113, v113, v113 quad_perm:[2,3,0,1] row_mask:0xf bank_mask:0xf
  v_add_f32_dpp v114, v114, v114 quad_perm:[2,3,0,1] row_mask:0xf bank_mask:0xf
  v_add_f32_dpp v115, v115, v115 quad_perm:[2,3,0,1] row_mask:0xf bank_mask:0xf
  v_add_f32_dpp v116, v116, v116 quad_perm:[2,3,0,1] row_mask:0xf bank_mask:0xf
  v_add_f32_dpp v117, v117, v117 quad_perm:[2,3,0,1] row_mask:0xf bank_mask:0xf
  v_add_f32_dpp v118, v118, v118 quad_perm:[2,3,0,1] row_mask:0xf bank_mask:0xf
  v_add_f32_dpp v119, v119, v119 quad_perm:[2,3,0,1] row_mask:0xf bank_mask:0xf
  v_add_f32_dpp v120, v120, v120 quad_perm:[2,3,0,1] row_mask:0xf bank_mask:0xf
  v_add_f32_dpp v121, v121, v121 quad_perm:[2,3,0,1] row_mask:0xf bank_mask:0xf
  v_add_f32_dpp v122, v122, v122 quad_perm:[2,3,0,1] row_mask:0xf bank_mask:0xf
  v_add_f32_dpp v123, v123, v123 quad_perm:[2,3,0,1] row_mask:0xf bank_mask:0xf
  v_add_f32_dpp v124, v124, v124 quad_perm:[2,3,0,1] row_mask:0xf bank_mask:0xf
  v_add_f32_dpp v125, v125, v125 quad_perm:[2,3,0,1] row_mask:0xf bank_mask:0xf
  v_add_f32_dpp v126, v126, v126 quad_perm:[2,3,0,1] row_mask:0xf bank_mask:0xf
  v_add_f32_dpp v127, v127, v127 quad_perm:[2,3,0,1] row_mask:0xf bank_mask:0xf
  v_add_f32_dpp v96, v96, v96 row_half_mirror row_mask:0xf bank_mask:0xf
  v_add_f32_dpp v97, v97, v97 row_half_mirror row_mask:0xf bank_mask:0xf
  v_add_f32_dpp v98, v98, v98 row_half_mirror row_mask:0xf bank_mask:0xf
  v_add_f32_dpp v99, v99, v99 row_half_mirror row_mask:0xf bank_mask:0xf
  v_add_f32_dpp v100, v100, v100 row_half_mirror row_mask:0xf bank_mask:0xf
  v_add_f32_dpp v101, v101, v101 row_half_mirror row_mask:0xf bank_mask:0xf
  v_add_f32_dpp v102, v102, v102 row_half_mirror row_mask:0xf bank_mask:0xf
  v_add_f32_dpp v103, v103, v103 row_half_mirror row_mask:0xf bank_mask:0xf
  v_add_f32_dpp v104, v104, v104 row_half_mirror row_mask:0xf bank_mask:0xf
  v_add_f32_dpp v105, v105, v105 row_half_mirror row_mask:0xf bank_mask:0xf
  v_add_f32_dpp v106, v106, v106 row_half_mirror row_mask:0xf bank_mask:0xf
  v_add_f32_dpp v107, v107, v107 row_half_mirror row_mask:0xf bank_mask:0xf
  v_add_f32_dpp v108, v108, v108 row_half_mirror row_mask:0xf bank_mask:0xf
  v_add_f32_dpp v109, v109, v109 row_half_mirror row_mask:0xf bank_mask:0xf
  v_add_f32_dpp v110, v110, v110 row_half_mirror row_mask:0xf bank_mask:0xf
  v_add_f32_dpp v111, v111, v111 row_half_mirror row_mask:0xf bank_mask:0xf
  v_add_f32_dpp v112, v112, v112 row_half_mirror row_mask:0xf bank_mask:0xf
  v_add_f32_dpp v113, v113, v113 row_half_mirror row_mask:0xf bank_mask:0xf
  v_add_f32_dpp v114, v114, v114 row_half_mirror row_mask:0xf bank_mask:0xf
  v_add_f32_dpp v115, v115, v115 row_half_mirror row_mask:0xf bank_mask:0xf
  v_add_f32_dpp v116, v116, v116 row_half_mirror row_mask:0xf bank_mask:0xf
  v_add_f32_dpp v117, v117, v117 row_half_mirror row_mask:0xf bank_mask:0xf
  v_add_f32_dpp v118, v118, v118 row_half_mirror row_mask:0xf bank_mask:0xf
  v_add_f32_dpp v119, v119, v119 row_half_mirror row_mask:0xf bank_mask:0xf
  v_add_f32_dpp v120, v120, v120 row_half_mirror row_mask:0xf bank_mask:0xf
  v_add_f32_dpp v121, v121, v121 row_half_mirror row_mask:0xf bank_mask:0xf
  v_add_f32_dpp v122, v122, v122 row_half_mirror row_mask:0xf bank_mask:0xf
  v_add_f32_dpp v123, v123, v123 row_half_mirror row_mask:0xf bank_mask:0xf
  v_add_f32_dpp v124, v124, v124 row_half_mirror row_mask:0xf bank_mask:0xf
  v_add_f32_dpp v125, v125, v125 row_half_mirror row_mask:0xf bank_mask:0xf
  v_add_f32_dpp v126, v126, v126 row_half_mirror row_mask:0xf bank_mask:0xf
  v_add_f32_dpp v127, v127, v127 row_half_mirror row_mask:0xf bank_mask:0xf
  v_add_f32_dpp v96, v96, v96 row_mirror row_mask:0xf bank_mask:0xf
  v_add_f32_dpp v97, v97, v97 row_mirror row_mask:0xf bank_mask:0xf
  v_add_f32_dpp v98, v98, v98 row_mirror row_mask:0xf bank_mask:0xf
  v_add_f32_dpp v99, v99, v99 row_mirror row_mask:0xf bank_mask:0xf
  v_add_f32_dpp v100, v100, v100 row_mirror row_mask:0xf bank_mask:0xf
  v_add_f32_dpp v101, v101, v101 row_mirror row_mask:0xf bank_mask:0xf
  v_add_f32_dpp v102, v102, v102 row_mirror row_mask:0xf bank_mask:0xf
  v_add_f32_dpp v103, v103, v103 row_mirror row_mask:0xf bank_mask:0xf
  v_add_f32_dpp v104, v104, v104 row_mirror row_mask:0xf bank_mask:0xf
  v_add_f32_dpp v105, v105, v105 row_mirror row_mask:0xf bank_mask:0xf
  v_add_f32_dpp v106, v106, v106 row_mirror row_mask:0xf bank_mask:0xf
  v_add_f32_dpp v107, v107, v107 row_mirror row_mask:0xf bank_mask:0xf
  v_add_f32_dpp v108, v108, v108 row_mirror row_mask:0xf bank_mask:0xf
  v_add_f32_dpp v109, v109, v109 row_mirror row_mask:0xf bank_mask:0xf
  v_add_f32_dpp v110, v110, v110 row_mirror row_mask:0xf bank_mask:0xf
  v_add_f32_dpp v111, v111, v111 row_mirror row_mask:0xf bank_mask:0xf
  v_add_f32_dpp v112, v112, v112 row_mirror row_mask:0xf bank_mask:0xf
  v_add_f32_dpp v113, v113, v113 row_mirror row_mask:0xf bank_mask:0xf
  v_add_f32_dpp v114, v114, v114 row_mirror row_mask:0xf bank_mask:0xf
  v_add_f32_dpp v115, v115, v115 row_mirror row_mask:0xf bank_mask:0xf
  v_add_f32_dpp v116, v116, v116 row_mirror row_mask:0xf bank_mask:0xf
  v_add_f32_dpp v117, v117, v117 row_mirror row_mask:0xf bank_mask:0xf
  v_add_f32_dpp v118, v118, v118 row_mirror row_mask:0xf bank_mask:0xf
  v_add_f32_dpp v119, v119, v119 row_mirror row_mask:0xf bank_mask:0xf
  v_add_f32_dpp v120, v120, v120 row_mirror row_mask:0xf bank_mask:0xf
  v_add_f32_dpp v121, v121, v121 row_mirror row_mask:0xf bank_mask:0xf
  v_add_f32_dpp v122, v122, v122 row_mirror row_mask:0xf bank_mask:0xf
  v_add_f32_dpp v123, v123, v123 row_mirror row_mask:0xf bank_mask:0xf
  v_add_f32_dpp v124, v124, v124 row_mirror row_mask:0xf bank_mask:0xf
  v_add_f32_dpp v125, v125, v125 row_mirror row_mask:0xf bank_mask:0xf
  v_add_f32_dpp v126, v126, v126 row_mirror row_mask:0xf bank_mask:0xf
  v_add_f32_dpp v127, v127, v127 row_mirror row_mask:0xf bank_mask:0xf
  v_lshrrev_b32 v254, 4, v0
  v_lshlrev_b32 v254, 7, v254
  s_mul_i32 s4, s3, 384
  s_add_u32 s4, s4, 20480
  v_add_u32 v254, s4, v254
  s_mov_b32 exec_lo, 0x10001
  s_mov_b32 exec_hi, 1
  ds_write_b128 v254, v[96:99] offset:0
  ds_write_b128 v254, v[100:103] offset:16
  ds_write_b128 v254, v[104:107] offset:32
  ds_write_b128 v254, v[108:111] offset:48
  ds_write_b128 v254, v[112:115] offset:64
  ds_write_b128 v254, v[116:119] offset:80
  ds_write_b128 v254, v[120:123] offset:96
  ds_write_b128 v254, v[124:127] offset:112
  s_mov_b64 exec, -1
  s_waitcnt lgkmcnt(0)
  s_barrier
  s_cmp_lg_u32 s3, 0
  s_cbranch_scc1 Lw01
  v_mul_u32_u24 v254, 171, v0
  v_lshrrev_b32 v254, 9, v254
  v_mul_u32_u24 v255, 3, v254
  v_sub_u32 v255, v0, v255
  v_lshlrev_b32 v128, 7, v255
  v_lshl_add_u32 v128, v254, 5, v128
  v_and_b32 v128, 0x1ff, v128
  ds_read_b128 v[56:59], v128 offset:20480
  ds_read_b128 v[60:63], v128 offset:20496
  ds_read_b128 v[64:67], v128 offset:20864
  ds_read_b128 v[68:71], v128 offset:20880
  ds_read_b128 v[72:75], v128 offset:21248
  ds_read_b128 v[76:79], v128 offset:21264
  ds_read_b128 v[80:83], v128 offset:21632
  ds_read_b128 v[84:87], v128 offset:21648
  s_waitcnt lgkmcnt(0)
  v_add_f32 v56, v56, v64
  v_add_f32 v57, v57, v65
  v_add_f32 v58, v58, v66
  v_add_f32 v59, v59, v67
  v_add_f32 v60, v60, v68
  v_add_f32 v61, v61, v69
  v_add_f32 v62, v62, v70
  v_add_f32 v63, v63, v71
  v_add_f32 v56, v56, v72
  v_add_f32 v57, v57, v73
  v_add_f32 v58, v58, v74
  v_add_f32 v59, v59, v75
  v_add_f32 v60, v60, v76
  v_add_f32 v61, v61, v77
  v_add_f32 v62, v62, v78
  v_add_f32 v63, v63, v79
  v_add_f32 v56, v56, v80
  v_add_f32 v57, v57, v81
  v_add_f32 v58, v58, v82
  v_add_f32 v59, v59, v83
  v_add_f32 v60, v60, v84
  v_add_f32 v61, v61, v85
  v_add_f32 v62, v62, v86
  v_add_f32 v63, v63, v87
  v_cvt_pk_bf16_f32 v96, v56, v57
  v_cvt_pk_bf16_f32 v97, v58, v59
  v_cvt_pk_bf16_f32 v98, v60, v61
  v_cvt_pk_bf16_f32 v99, v62, v63
  v_mul_u32_u24 v254, 12288, v254
  v_lshl_add_u32 v254, v255, 4, v254
  s_mov_b32 s75, 0x61a80
  v_min_u32 v252, 11, v0
  v_lshlrev_b32 v252, 2, v252
  global_load_dword v253, v252, s[28:29]
  s_waitcnt vmcnt(0)
  v_cmp_ne_u32 vcc, 1, v253
  s_cbranch_vccz Lad3
Lar2:
  global_load_dword v253, v252, s[28:29] sc1
  s_waitcnt vmcnt(0)
  v_cmp_ne_u32 vcc, 1, v253
  s_cbranch_vccz Lad3
  s_sleep 8
  s_sub_u32 s75, s75, 1
  s_cmp_lg_u32 s75, 0
  s_cbranch_scc1 Lar2
Lad3:
  s_nop 4
  s_mul_i32 s76, s2, 48
  s_add_u32 s76, s76, 0xc73000
  s_mov_b32 exec_lo, 0xfff
  s_mov_b32 exec_hi, 0
  buffer_store_dwordx4 v[96:99], v254, s[64:67], s76 offen sc1
  s_mov_b64 exec, -1
  s_waitcnt lgkmcnt(0)
Lw01:
  s_nop 4
  s_waitcnt lgkmcnt(0)
  s_barrier
  s_sub_u32 s2, s2, 208
  s_mul_i32 s4, s2, 274432
  s_add_u32 s76, s4, 0
  s_sub_u32 s5, s76, 0xc73000
  s_cmp_lt_u32 s5, 49152
  s_cbranch_scc1 Lsa4
  buffer_store_dwordx4 v[16:19], v15, s[64:67], s76 offen sc1
Lsa4:
  s_add_u32 s76, s4, 4096
  s_sub_u32 s5, s76, 0xc73000
  s_cmp_lt_u32 s5, 49152
  s_cbranch_scc1 Lsa5
  buffer_store_dwordx4 v[16:19], v15, s[64:67], s76 offen sc1
Lsa5:
  s_add_u32 s76, s4, 8192
  s_sub_u32 s5, s76, 0xc73000
  s_cmp_lt_u32 s5, 49152
  s_cbranch_scc1 Lsa6
  buffer_store_dwordx4 v[16:19], v15, s[64:67], s76 offen sc1
Lsa6:
  s_add_u32 s76, s4, 12288
  s_sub_u32 s5, s76, 0xc73000
  s_cmp_lt_u32 s5, 49152
  s_cbranch_scc1 Lsa7
  buffer_store_dwordx4 v[16:19], v15, s[64:67], s76 offen sc1
Lsa7:
  s_add_u32 s76, s4, 16384
  s_sub_u32 s5, s76, 0xc73000
  s_cmp_lt_u32 s5, 49152
  s_cbranch_scc1 Lsa8
  buffer_store_dwordx4 v[16:19], v15, s[64:67], s76 offen sc1
Lsa8:
  s_add_u32 s76, s4, 20480
  s_sub_u32 s5, s76, 0xc73000
  s_cmp_lt_u32 s5, 49152
  s_cbranch_scc1 Lsa9
  buffer_store_dwordx4 v[16:19], v15, s[64:67], s76 offen sc1
Lsa9:
  s_add_u32 s76, s4, 24576
  s_sub_u32 s5, s76, 0xc73000
  s_cmp_lt_u32 s5, 49152
  s_cbranch_scc1 Lsa10
  buffer_store_dwordx4 v[16:19], v15, s[64:67], s76 offen sc1
Lsa10:
  s_add_u32 s76, s4, 28672
  s_sub_u32 s5, s76, 0xc73000
  s_cmp_lt_u32 s5, 49152
  s_cbranch_scc1 Lsa11
  buffer_store_dwordx4 v[16:19], v15, s[64:67], s76 offen sc1
Lsa11:
  s_add_u32 s76, s4, 32768
  s_sub_u32 s5, s76, 0xc73000
  s_cmp_lt_u32 s5, 49152
  s_cbranch_scc1 Lsa12
  buffer_store_dwordx4 v[16:19], v15, s[64:67], s76 offen sc1
Lsa12:
  s_add_u32 s76, s4, 36864
  s_sub_u32 s5, s76, 0xc73000
  s_cmp_lt_u32 s5, 49152
  s_cbranch_scc1 Lsa13
  buffer_store_dwordx4 v[16:19], v15, s[64:67], s76 offen sc1
Lsa13:
  s_add_u32 s76, s4, 40960
  s_sub_u32 s5, s76, 0xc73000
  s_cmp_lt_u32 s5, 49152
  s_cbranch_scc1 Lsa14
  buffer_store_dwordx4 v[16:19], v15, s[64:67], s76 offen sc1
Lsa14:
  s_add_u32 s76, s4, 45056
  s_sub_u32 s5, s76, 0xc73000
  s_cmp_lt_u32 s5, 49152
  s_cbranch_scc1 Lsa15
  buffer_store_dwordx4 v[16:19], v15, s[64:67], s76 offen sc1
Lsa15:
  s_add_u32 s76, s4, 49152
  s_sub_u32 s5, s76, 0xc73000
  s_cmp_lt_u32 s5, 49152
  s_cbranch_scc1 Lsa16
  buffer_store_dwordx4 v[16:19], v15, s[64:67], s76 offen sc1
Lsa16:
  s_add_u32 s76, s4, 53248
  s_sub_u32 s5, s76, 0xc73000
  s_cmp_lt_u32 s5, 49152
  s_cbranch_scc1 Lsa17
  buffer_store_dwordx4 v[16:19], v15, s[64:67], s76 offen sc1
Lsa17:
  s_add_u32 s76, s4, 57344
  s_sub_u32 s5, s76, 0xc73000
  s_cmp_lt_u32 s5, 49152
  s_cbranch_scc1 Lsa18
  buffer_store_dwordx4 v[16:19], v15, s[64:67], s76 offen sc1
Lsa18:
  s_add_u32 s76, s4, 61440
  s_sub_u32 s5, s76, 0xc73000
  s_cmp_lt_u32 s5, 49152
  s_cbranch_scc1 Lsa19
  buffer_store_dwordx4 v[16:19], v15, s[64:67], s76 offen sc1
Lsa19:
  s_add_u32 s76, s4, 65536
  s_sub_u32 s5, s76, 0xc73000
  s_cmp_lt_u32 s5, 49152
  s_cbranch_scc1 Lsa20
  buffer_store_dwordx4 v[16:19], v15, s[64:67], s76 offen sc1
Lsa20:
  s_add_u32 s76, s4, 69632
  s_sub_u32 s5, s76, 0xc73000
  s_cmp_lt_u32 s5, 49152
  s_cbranch_scc1 Lsa21
  buffer_store_dwordx4 v[16:19], v15, s[64:67], s76 offen sc1
Lsa21:
  s_add_u32 s76, s4, 73728
  s_sub_u32 s5, s76, 0xc73000
  s_cmp_lt_u32 s5, 49152
  s_cbranch_scc1 Lsa22
  buffer_store_dwordx4 v[16:19], v15, s[64:67], s76 offen sc1
Lsa22:
  s_add_u32 s76, s4, 77824
  s_sub_u32 s5, s76, 0xc73000
  s_cmp_lt_u32 s5, 49152
  s_cbranch_scc1 Lsa23
  buffer_store_dwordx4 v[16:19], v15, s[64:67], s76 offen sc1
Lsa23:
  s_add_u32 s76, s4, 81920
  s_sub_u32 s5, s76, 0xc73000
  s_cmp_lt_u32 s5, 49152
  s_cbranch_scc1 Lsa24
  buffer_store_dwordx4 v[16:19], v15, s[64:67], s76 offen sc1
Lsa24:
  s_add_u32 s76, s4, 86016
  s_sub_u32 s5, s76, 0xc73000
  s_cmp_lt_u32 s5, 49152
  s_cbranch_scc1 Lsa25
  buffer_store_dwordx4 v[16:19], v15, s[64:67], s76 offen sc1
Lsa25:
  s_add_u32 s76, s4, 90112
  s_sub_u32 s5, s76, 0xc73000
  s_cmp_lt_u32 s5, 49152
  s_cbranch_scc1 Lsa26
  buffer_store_dwordx4 v[16:19], v15, s[64:67], s76 offen sc1
Lsa26:
  s_add_u32 s76, s4, 94208
  s_sub_u32 s5, s76, 0xc73000
  s_cmp_lt_u32 s5, 49152
  s_cbranch_scc1 Lsa27
  buffer_store_dwordx4 v[16:19], v15, s[64:67], s76 offen sc1
Lsa27:
  s_add_u32 s76, s4, 98304
  s_sub_u32 s5, s76, 0xc73000
  s_cmp_lt_u32 s5, 49152
  s_cbranch_scc1 Lsa28
  buffer_store_dwordx4 v[16:19], v15, s[64:67], s76 offen sc1
Lsa28:
  s_add_u32 s76, s4, 102400
  s_sub_u32 s5, s76, 0xc73000
  s_cmp_lt_u32 s5, 49152
  s_cbranch_scc1 Lsa29
  buffer_store_dwordx4 v[16:19], v15, s[64:67], s76 offen sc1
Lsa29:
  s_add_u32 s76, s4, 106496
  s_sub_u32 s5, s76, 0xc73000
  s_cmp_lt_u32 s5, 49152
  s_cbranch_scc1 Lsa30
  buffer_store_dwordx4 v[16:19], v15, s[64:67], s76 offen sc1
Lsa30:
  s_add_u32 s76, s4, 110592
  s_sub_u32 s5, s76, 0xc73000
  s_cmp_lt_u32 s5, 49152
  s_cbranch_scc1 Lsa31
  buffer_store_dwordx4 v[16:19], v15, s[64:67], s76 offen sc1
Lsa31:
  s_add_u32 s76, s4, 114688
  s_sub_u32 s5, s76, 0xc73000
  s_cmp_lt_u32 s5, 49152
  s_cbranch_scc1 Lsa32
  buffer_store_dwordx4 v[16:19], v15, s[64:67], s76 offen sc1
Lsa32:
  s_add_u32 s76, s4, 118784
  s_sub_u32 s5, s76, 0xc73000
  s_cmp_lt_u32 s5, 49152
  s_cbranch_scc1 Lsa33
  buffer_store_dwordx4 v[16:19], v15, s[64:67], s76 offen sc1
Lsa33:
  s_add_u32 s76, s4, 122880
  s_sub_u32 s5, s76, 0xc73000
  s_cmp_lt_u32 s5, 49152
  s_cbranch_scc1 Lsa34
  buffer_store_dwordx4 v[16:19], v15, s[64:67], s76 offen sc1
Lsa34:
  s_add_u32 s76, s4, 126976
  s_sub_u32 s5, s76, 0xc73000
  s_cmp_lt_u32 s5, 49152
  s_cbranch_scc1 Lsa35
  buffer_store_dwordx4 v[16:19], v15, s[64:67], s76 offen sc1
Lsa35:
  s_add_u32 s76, s4, 131072
  s_sub_u32 s5, s76, 0xc73000
  s_cmp_lt_u32 s5, 49152
  s_cbranch_scc1 Lsa36
  buffer_store_dwordx4 v[16:19], v15, s[64:67], s76 offen sc1
Lsa36:
  s_add_u32 s76, s4, 135168
  s_sub_u32 s5, s76, 0xc73000
  s_cmp_lt_u32 s5, 49152
  s_cbranch_scc1 Lsa37
  buffer_store_dwordx4 v[16:19], v15, s[64:67], s76 offen sc1
Lsa37:
  s_add_u32 s76, s4, 139264
  s_sub_u32 s5, s76, 0xc73000
  s_cmp_lt_u32 s5, 49152
  s_cbranch_scc1 Lsa38
  buffer_store_dwordx4 v[16:19], v15, s[64:67], s76 offen sc1
Lsa38:
  s_add_u32 s76, s4, 143360
  s_sub_u32 s5, s76, 0xc73000
  s_cmp_lt_u32 s5, 49152
  s_cbranch_scc1 Lsa39
  buffer_store_dwordx4 v[16:19], v15, s[64:67], s76 offen sc1
Lsa39:
  s_add_u32 s76, s4, 147456
  s_sub_u32 s5, s76, 0xc73000
  s_cmp_lt_u32 s5, 49152
  s_cbranch_scc1 Lsa40
  buffer_store_dwordx4 v[16:19], v15, s[64:67], s76 offen sc1
Lsa40:
  s_add_u32 s76, s4, 151552
  s_sub_u32 s5, s76, 0xc73000
  s_cmp_lt_u32 s5, 49152
  s_cbranch_scc1 Lsa41
  buffer_store_dwordx4 v[16:19], v15, s[64:67], s76 offen sc1
Lsa41:
  s_add_u32 s76, s4, 155648
  s_sub_u32 s5, s76, 0xc73000
  s_cmp_lt_u32 s5, 49152
  s_cbranch_scc1 Lsa42
  buffer_store_dwordx4 v[16:19], v15, s[64:67], s76 offen sc1
Lsa42:
  s_add_u32 s76, s4, 159744
  s_sub_u32 s5, s76, 0xc73000
  s_cmp_lt_u32 s5, 49152
  s_cbranch_scc1 Lsa43
  buffer_store_dwordx4 v[16:19], v15, s[64:67], s76 offen sc1
Lsa43:
  s_add_u32 s76, s4, 163840
  s_sub_u32 s5, s76, 0xc73000
  s_cmp_lt_u32 s5, 49152
  s_cbranch_scc1 Lsa44
  buffer_store_dwordx4 v[16:19], v15, s[64:67], s76 offen sc1
Lsa44:
  s_add_u32 s76, s4, 167936
  s_sub_u32 s5, s76, 0xc73000
  s_cmp_lt_u32 s5, 49152
  s_cbranch_scc1 Lsa45
  buffer_store_dwordx4 v[16:19], v15, s[64:67], s76 offen sc1
Lsa45:
  s_add_u32 s76, s4, 172032
  s_sub_u32 s5, s76, 0xc73000
  s_cmp_lt_u32 s5, 49152
  s_cbranch_scc1 Lsa46
  buffer_store_dwordx4 v[16:19], v15, s[64:67], s76 offen sc1
Lsa46:
  s_add_u32 s76, s4, 176128
  s_sub_u32 s5, s76, 0xc73000
  s_cmp_lt_u32 s5, 49152
  s_cbranch_scc1 Lsa47
  buffer_store_dwordx4 v[16:19], v15, s[64:67], s76 offen sc1
Lsa47:
  s_add_u32 s76, s4, 180224
  s_sub_u32 s5, s76, 0xc73000
  s_cmp_lt_u32 s5, 49152
  s_cbranch_scc1 Lsa48
  buffer_store_dwordx4 v[16:19], v15, s[64:67], s76 offen sc1
Lsa48:
  s_add_u32 s76, s4, 184320
  s_sub_u32 s5, s76, 0xc73000
  s_cmp_lt_u32 s5, 49152
  s_cbranch_scc1 Lsa49
  buffer_store_dwordx4 v[16:19], v15, s[64:67], s76 offen sc1
Lsa49:
  s_add_u32 s76, s4, 188416
  s_sub_u32 s5, s76, 0xc73000
  s_cmp_lt_u32 s5, 49152
  s_cbranch_scc1 Lsa50
  buffer_store_dwordx4 v[16:19], v15, s[64:67], s76 offen sc1
Lsa50:
  s_add_u32 s76, s4, 192512
  s_sub_u32 s5, s76, 0xc73000
  s_cmp_lt_u32 s5, 49152
  s_cbranch_scc1 Lsa51
  buffer_store_dwordx4 v[16:19], v15, s[64:67], s76 offen sc1
Lsa51:
  s_add_u32 s76, s4, 196608
  s_sub_u32 s5, s76, 0xc73000
  s_cmp_lt_u32 s5, 49152
  s_cbranch_scc1 Lsa52
  buffer_store_dwordx4 v[16:19], v15, s[64:67], s76 offen sc1
Lsa52:
  s_add_u32 s76, s4, 200704
  s_sub_u32 s5, s76, 0xc73000
  s_cmp_lt_u32 s5, 49152
  s_cbranch_scc1 Lsa53
  buffer_store_dwordx4 v[16:19], v15, s[64:67], s76 offen sc1
Lsa53:
  s_add_u32 s76, s4, 204800
  s_sub_u32 s5, s76, 0xc73000
  s_cmp_lt_u32 s5, 49152
  s_cbranch_scc1 Lsa54
  buffer_store_dwordx4 v[16:19], v15, s[64:67], s76 offen sc1
Lsa54:
  s_add_u32 s76, s4, 208896
  s_sub_u32 s5, s76, 0xc73000
  s_cmp_lt_u32 s5, 49152
  s_cbranch_scc1 Lsa55
  buffer_store_dwordx4 v[16:19], v15, s[64:67], s76 offen sc1
Lsa55:
  s_add_u32 s76, s4, 212992
  s_sub_u32 s5, s76, 0xc73000
  s_cmp_lt_u32 s5, 49152
  s_cbranch_scc1 Lsa56
  buffer_store_dwordx4 v[16:19], v15, s[64:67], s76 offen sc1
Lsa56:
  s_add_u32 s76, s4, 217088
  s_sub_u32 s5, s76, 0xc73000
  s_cmp_lt_u32 s5, 49152
  s_cbranch_scc1 Lsa57
  buffer_store_dwordx4 v[16:19], v15, s[64:67], s76 offen sc1
Lsa57:
  s_add_u32 s76, s4, 221184
  s_sub_u32 s5, s76, 0xc73000
  s_cmp_lt_u32 s5, 49152
  s_cbranch_scc1 Lsa58
  buffer_store_dwordx4 v[16:19], v15, s[64:67], s76 offen sc1
Lsa58:
  s_add_u32 s76, s4, 225280
  s_sub_u32 s5, s76, 0xc73000
  s_cmp_lt_u32 s5, 49152
  s_cbranch_scc1 Lsa59
  buffer_store_dwordx4 v[16:19], v15, s[64:67], s76 offen sc1
Lsa59:
  s_add_u32 s76, s4, 229376
  s_sub_u32 s5, s76, 0xc73000
  s_cmp_lt_u32 s5, 49152
  s_cbranch_scc1 Lsa60
  buffer_store_dwordx4 v[16:19], v15, s[64:67], s76 offen sc1
Lsa60:
  s_add_u32 s76, s4, 233472
  s_sub_u32 s5, s76, 0xc73000
  s_cmp_lt_u32 s5, 49152
  s_cbranch_scc1 Lsa61
  buffer_store_dwordx4 v[16:19], v15, s[64:67], s76 offen sc1
Lsa61:
  s_add_u32 s76, s4, 237568
  s_sub_u32 s5, s76, 0xc73000
  s_cmp_lt_u32 s5, 49152
  s_cbranch_scc1 Lsa62
  buffer_store_dwordx4 v[16:19], v15, s[64:67], s76 offen sc1
Lsa62:
  s_add_u32 s76, s4, 241664
  s_sub_u32 s5, s76, 0xc73000
  s_cmp_lt_u32 s5, 49152
  s_cbranch_scc1 Lsa63
  buffer_store_dwordx4 v[16:19], v15, s[64:67], s76 offen sc1
Lsa63:
  s_add_u32 s76, s4, 245760
  s_sub_u32 s5, s76, 0xc73000
  s_cmp_lt_u32 s5, 49152
  s_cbranch_scc1 Lsa64
  buffer_store_dwordx4 v[16:19], v15, s[64:67], s76 offen sc1
Lsa64:
  s_add_u32 s76, s4, 249856
  s_sub_u32 s5, s76, 0xc73000
  s_cmp_lt_u32 s5, 49152
  s_cbranch_scc1 Lsa65
  buffer_store_dwordx4 v[16:19], v15, s[64:67], s76 offen sc1
Lsa65:
  s_add_u32 s76, s4, 253952
  s_sub_u32 s5, s76, 0xc73000
  s_cmp_lt_u32 s5, 49152
  s_cbranch_scc1 Lsa66
  buffer_store_dwordx4 v[16:19], v15, s[64:67], s76 offen sc1
Lsa66:
  s_add_u32 s76, s4, 258048
  s_sub_u32 s5, s76, 0xc73000
  s_cmp_lt_u32 s5, 49152
  s_cbranch_scc1 Lsa67
  buffer_store_dwordx4 v[16:19], v15, s[64:67], s76 offen sc1
Lsa67:
  s_add_u32 s76, s4, 262144
  s_sub_u32 s5, s76, 0xc73000
  s_cmp_lt_u32 s5, 49152
  s_cbranch_scc1 Lsa68
  buffer_store_dwordx4 v[16:19], v15, s[64:67], s76 offen sc1
Lsa68:
  s_add_u32 s76, s4, 266240
  s_sub_u32 s5, s76, 0xc73000
  s_cmp_lt_u32 s5, 49152
  s_cbranch_scc1 Lsa69
  buffer_store_dwordx4 v[16:19], v15, s[64:67], s76 offen sc1
Lsa69:
  s_add_u32 s76, s4, 270336
  s_sub_u32 s5, s76, 0xc73000
  s_cmp_lt_u32 s5, 49152
  s_cbranch_scc1 Lsa70
  buffer_store_dwordx4 v[16:19], v15, s[64:67], s76 offen sc1
Lsa70:
  s_waitcnt vmcnt(0)
  s_barrier
  s_cmp_lg_u32 s3, 0
  s_cbranch_scc1 Lw071
  s_lshl_b32 s4, s2, 1
  s_add_u32 s4, s4, 128
  v_mov_b32 v150, s4
  v_mov_b32 v151, 1
  s_mov_b32 exec_lo, 0x1
  s_mov_b32 exec_hi, 0
  global_store_short v150, v151, s[28:29] sc1
  s_mov_b64 exec, -1
Lw071:
  s_nop 4
  s_lshl_b32 s4, s3, 6
  v_add_u32 v1, s4, v0
  v_lshlrev_b32 v15, 4, v1
  v_min_u32 v2, 59, v0
  s_mul_i32 s4, s3, 60
  v_add_u32 v2, s4, v2
  v_lshlrev_b32 v14, 4, v2
  v_add_u32 v14, 38912, v14
  v_add_u32 v120, 61440, v14
  s_lshl_b32 s4, s3, 3
  v_add_u32 v8, s4, v0
  v_mul_u32_u24 v8, 2560, v8
  v_add_u32 v8, 2556, v8
  s_mul_i32 s4, s3, 20480
  v_lshlrev_b32 v13, 4, v0
  v_add_u32 v9, s4, v13
  s_mul_i32 s4, s3, 5120
  s_add_u32 s4, s4, 5120
  v_add_u32 v10, s4, v13
  v_lshlrev_b32 v12, 3, v0
  s_lshl_b32 s4, s2, 2
  s_add_u32 s4, s4, s3
  s_lshl_b32 s77, s4, 9
  s_add_u32 s77, s77, 0xcc4000
  s_mov_b32 s62, 0x5040100
  s_mov_b32 s63, 0x7060302
  v_and_b32 v3, 15, v0
  v_lshrrev_b32 v4, 4, v0
  v_lshlrev_b32 v112, 4, v4
  v_add_u32 v112, 0, v112
  s_lshl_b32 s4, s3, 6
  v_add_u32 v113, s4, v112
  s_mul_i32 s4, s3, 320
  v_add_u32 v114, s4, v112
  s_mul_i32 s70, s2, 2560
  v_lshlrev_b32 v119, 2, v0
  s_mul_i32 s4, s3, 24576
  s_add_u32 s4, s4, 38912
  v_add_u32 v14, s4, v13
  s_and_b32 s4, s3, 1
  s_lshl_b32 s4, s4, 13
  s_add_u32 s4, s4, 137216
  v_add_u32 v120, s4, v13
  v_mul_u32_u24 v125, 10240, v4
  v_lshl_add_u32 v125, v3, 4, v125
  v_subrev_u32 v127, 6, v3
  v_min_u32 v127, 5, v127
  v_cmp_gt_u32 vcc, 6, v3
  s_nop 1
  v_cndmask_b32 v127, v127, v3, vcc
  v_mul_u32_u24 v126, 24576, v4
  v_lshl_add_u32 v126, v127, 4, v126
  s_mov_b64 s[88:89], vcc
  s_not_b64 s[90:91], vcc
  s_mul_i32 s4, s2, 245760
  s_add_u32 s96, s16, s4
  s_addc_u32 s97, s17, 0
  s_and_b32 s97, s97, 0xffff
  s_mov_b32 s98, 0x3c000
  s_mov_b32 s99, 0x20000
  s_mul_i32 s4, s2, 96
  s_sub_u32 s5, 1966080, s4
  s_add_u32 s80, s20, s4
  s_addc_u32 s81, s21, 0
  s_and_b32 s81, s81, 0xffff
  s_mov_b32 s82, s5
  s_mov_b32 s83, 0x20000
  s_add_u32 s84, s22, s4
  s_addc_u32 s85, s23, 0
  s_and_b32 s85, s85, 0xffff
  s_mov_b32 s86, s5
  s_mov_b32 s87, 0x20000
  s_mul_i32 s4, s2, 61440
  s_add_u32 s92, s24, s4
  s_addc_u32 s93, s25, 0
  s_and_b32 s93, s93, 0xffff
  s_mov_b32 s94, 0xf000
  s_mov_b32 s95, 0x20000
  s_lshl_b32 s40, s3, 8
  s_mul_i32 s41, s3, 40960
  s_add_u32 s41, s41, 1024
  s_mul_i32 s42, s3, 491520
  s_add_u32 s76, s40, 0
  buffer_load_dwordx4 v[16:19], v125, s[96:99], s76 offen nt
  buffer_load_dwordx4 v[20:23], v125, s[96:99], s76 offen offset:1280 nt
  buffer_load_dwordx4 v[24:27], v125, s[96:99], s76 offen offset:2560 nt
  s_add_u32 s76, s40, 3840
  buffer_load_dwordx4 v[28:31], v125, s[96:99], s76 offen nt
  buffer_load_dwordx4 v[32:35], v125, s[96:99], s76 offen offset:1280 nt
  buffer_load_dwordx4 v[36:39], v125, s[96:99], s76 offen offset:2560 nt
  s_add_u32 s76, s40, 7680
  buffer_load_dwordx4 v[40:43], v125, s[96:99], s76 offen nt
  buffer_load_dwordx4 v[44:47], v125, s[96:99], s76 offen offset:1280 nt
  s_add_u32 s76, s40, 40960
  buffer_load_dwordx4 v[48:51], v125, s[96:99], s76 offen nt
  buffer_load_dwordx4 v[52:55], v125, s[96:99], s76 offen offset:1280 nt
  buffer_load_dwordx4 v[56:59], v125, s[96:99], s76 offen offset:2560 nt
  s_add_u32 s76, s40, 44800
  buffer_load_dwordx4 v[60:63], v125, s[96:99], s76 offen nt
  buffer_load_dwordx4 v[64:67], v125, s[96:99], s76 offen offset:1280 nt
  buffer_load_dwordx4 v[68:71], v125, s[96:99], s76 offen offset:2560 nt
  s_add_u32 s76, s40, 48640
  buffer_load_dwordx4 v[72:75], v125, s[96:99], s76 offen nt
  buffer_load_dwordx4 v[76:79], v125, s[96:99], s76 offen offset:1280 nt
  s_waitcnt vmcnt(8)
  v_perm_b32 v80, v20, v16, s62
  v_perm_b32 v81, v28, v24, s62
  v_perm_b32 v82, v36, v32, s62
  v_perm_b32 v83, v44, v40, s62
  v_perm_b32 v84, v20, v16, s63
  v_perm_b32 v85, v28, v24, s63
  v_perm_b32 v86, v36, v32, s63
  v_perm_b32 v87, v44, v40, s63
  v_perm_b32 v88, v21, v17, s62
  v_perm_b32 v89, v29, v25, s62
  v_perm_b32 v90, v37, v33, s62
  v_perm_b32 v91, v45, v41, s62
  v_perm_b32 v92, v21, v17, s63
  v_perm_b32 v93, v29, v25, s63
  v_perm_b32 v94, v37, v33, s63
  v_perm_b32 v95, v45, v41, s63
  v_perm_b32 v96, v22, v18, s62
  v_perm_b32 v97, v30, v26, s62
  v_perm_b32 v98, v38, v34, s62
  v_perm_b32 v99, v46, v42, s62
  v_perm_b32 v100, v22, v18, s63
  v_perm_b32 v101, v30, v26, s63
  v_perm_b32 v102, v38, v34, s63
  v_perm_b32 v103, v46, v42, s63
  v_perm_b32 v104, v23, v19, s62
  v_perm_b32 v105, v31, v27, s62
  v_perm_b32 v106, v39, v35, s62
  v_perm_b32 v107, v47, v43, s62
  v_perm_b32 v108, v23, v19, s63
  v_perm_b32 v109, v31, v27, s63
  v_perm_b32 v110, v39, v35, s63
  v_perm_b32 v111, v47, v43, s63
  v_accvgpr_write_b32 a0, v80
  v_accvgpr_write_b32 a1, v81
  v_accvgpr_write_b32 a2, v82
  v_accvgpr_write_b32 a3, v83
  v_accvgpr_write_b32 a4, v84
  v_accvgpr_write_b32 a5, v85
  v_accvgpr_write_b32 a6, v86
  v_accvgpr_write_b32 a7, v87
  v_accvgpr_write_b32 a8, v88
  v_accvgpr_write_b32 a9, v89
  v_accvgpr_write_b32 a10, v90
  v_accvgpr_write_b32 a11, v91
  v_accvgpr_write_b32 a12, v92
  v_accvgpr_write_b32 a13, v93
  v_accvgpr_write_b32 a14, v94
  v_accvgpr_write_b32 a15, v95
  v_accvgpr_write_b32 a16, v96
  v_accvgpr_write_b32 a17, v97
  v_accvgpr_write_b32 a18, v98
  v_accvgpr_write_b32 a19, v99
  v_accvgpr_write_b32 a20, v100
  v_accvgpr_write_b32 a21, v101
  v_accvgpr_write_b32 a22, v102
  v_accvgpr_write_b32 a23, v103
  v_accvgpr_write_b32 a24, v104
  v_accvgpr_write_b32 a25, v105
  v_accvgpr_write_b32 a26, v106
  v_accvgpr_write_b32 a27, v107
  v_accvgpr_write_b32 a28, v108
  v_accvgpr_write_b32 a29, v109
  v_accvgpr_write_b32 a30, v110
  v_accvgpr_write_b32 a31, v111
  s_add_u32 s76, s40, 81920
  buffer_load_dwordx4 v[16:19], v125, s[96:99], s76 offen nt
  buffer_load_dwordx4 v[20:23], v125, s[96:99], s76 offen offset:1280 nt
  buffer_load_dwordx4 v[24:27], v125, s[96:99], s76 offen offset:2560 nt
  s_add_u32 s76, s40, 85760
  buffer_load_dwordx4 v[28:31], v125, s[96:99], s76 offen nt
  buffer_load_dwordx4 v[32:35], v125, s[96:99], s76 offen offset:1280 nt
  buffer_load_dwordx4 v[36:39], v125, s[96:99], s76 offen offset:2560 nt
  s_add_u32 s76, s40, 89600
  buffer_load_dwordx4 v[40:43], v125, s[96:99], s76 offen nt
  buffer_load_dwordx4 v[44:47], v125, s[96:99], s76 offen offset:1280 nt
  s_waitcnt vmcnt(8)
  v_perm_b32 v80, v52, v48, s62
  v_perm_b32 v81, v60, v56, s62
  v_perm_b32 v82, v68, v64, s62
  v_perm_b32 v83, v76, v72, s62
  v_perm_b32 v84, v52, v48, s63
  v_perm_b32 v85, v60, v56, s63
  v_perm_b32 v86, v68, v64, s63
  v_perm_b32 v87, v76, v72, s63
  v_perm_b32 v88, v53, v49, s62
  v_perm_b32 v89, v61, v57, s62
  v_perm_b32 v90, v69, v65, s62
  v_perm_b32 v91, v77, v73, s62
  v_perm_b32 v92, v53, v49, s63
  v_perm_b32 v93, v61, v57, s63
  v_perm_b32 v94, v69, v65, s63
  v_perm_b32 v95, v77, v73, s63
  v_perm_b32 v96, v54, v50, s62
  v_perm_b32 v97, v62, v58, s62
  v_perm_b32 v98, v70, v66, s62
  v_perm_b32 v99, v78, v74, s62
  v_perm_b32 v100, v54, v50, s63
  v_perm_b32 v101, v62, v58, s63
  v_perm_b32 v102, v70, v66, s63
  v_perm_b32 v103, v78, v74, s63
  v_perm_b32 v104, v55, v51, s62
  v_perm_b32 v105, v63, v59, s62
  v_perm_b32 v106, v71, v67, s62
  v_perm_b32 v107, v79, v75, s62
  v_perm_b32 v108, v55, v51, s63
  v_perm_b32 v109, v63, v59, s63
  v_perm_b32 v110, v71, v67, s63
  v_perm_b32 v111, v79, v75, s63
  v_accvgpr_write_b32 a32, v80
  v_accvgpr_write_b32 a33, v81
  v_accvgpr_write_b32 a34, v82
  v_accvgpr_write_b32 a35, v83
  v_accvgpr_write_b32 a36, v84
  v_accvgpr_write_b32 a37, v85
  v_accvgpr_write_b32 a38, v86
  v_accvgpr_write_b32 a39, v87
  v_accvgpr_write_b32 a40, v88
  v_accvgpr_write_b32 a41, v89
  v_accvgpr_write_b32 a42, v90
  v_accvgpr_write_b32 a43, v91
  v_accvgpr_write_b32 a44, v92
  v_accvgpr_write_b32 a45, v93
  v_accvgpr_write_b32 a46, v94
  v_accvgpr_write_b32 a47, v95
  v_accvgpr_write_b32 a48, v96
  v_accvgpr_write_b32 a49, v97
  v_accvgpr_write_b32 a50, v98
  v_accvgpr_write_b32 a51, v99
  v_accvgpr_write_b32 a52, v100
  v_accvgpr_write_b32 a53, v101
  v_accvgpr_write_b32 a54, v102
  v_accvgpr_write_b32 a55, v103
  v_accvgpr_write_b32 a56, v104
  v_accvgpr_write_b32 a57, v105
  v_accvgpr_write_b32 a58, v106
  v_accvgpr_write_b32 a59, v107
  v_accvgpr_write_b32 a60, v108
  v_accvgpr_write_b32 a61, v109
  v_accvgpr_write_b32 a62, v110
  v_accvgpr_write_b32 a63, v111
  s_add_u32 s76, s40, 122880
  buffer_load_dwordx4 v[48:51], v125, s[96:99], s76 offen nt
  buffer_load_dwordx4 v[52:55], v125, s[96:99], s76 offen offset:1280 nt
  buffer_load_dwordx4 v[56:59], v125, s[96:99], s76 offen offset:2560 nt
  s_add_u32 s76, s40, 126720
  buffer_load_dwordx4 v[60:63], v125, s[96:99], s76 offen nt
  buffer_load_dwordx4 v[64:67], v125, s[96:99], s76 offen offset:1280 nt
  buffer_load_dwordx4 v[68:71], v125, s[96:99], s76 offen offset:2560 nt
  s_add_u32 s76, s40, 130560
  buffer_load_dwordx4 v[72:75], v125, s[96:99], s76 offen nt
  buffer_load_dwordx4 v[76:79], v125, s[96:99], s76 offen offset:1280 nt
  s_waitcnt vmcnt(8)
  v_perm_b32 v80, v20, v16, s62
  v_perm_b32 v81, v28, v24, s62
  v_perm_b32 v82, v36, v32, s62
  v_perm_b32 v83, v44, v40, s62
  v_perm_b32 v84, v20, v16, s63
  v_perm_b32 v85, v28, v24, s63
  v_perm_b32 v86, v36, v32, s63
  v_perm_b32 v87, v44, v40, s63
  v_perm_b32 v88, v21, v17, s62
  v_perm_b32 v89, v29, v25, s62
  v_perm_b32 v90, v37, v33, s62
  v_perm_b32 v91, v45, v41, s62
  v_perm_b32 v92, v21, v17, s63
  v_perm_b32 v93, v29, v25, s63
  v_perm_b32 v94, v37, v33, s63
  v_perm_b32 v95, v45, v41, s63
  v_perm_b32 v96, v22, v18, s62
  v_perm_b32 v97, v30, v26, s62
  v_perm_b32 v98, v38, v34, s62
  v_perm_b32 v99, v46, v42, s62
  v_perm_b32 v100, v22, v18, s63
  v_perm_b32 v101, v30, v26, s63
  v_perm_b32 v102, v38, v34, s63
  v_perm_b32 v103, v46, v42, s63
  v_perm_b32 v104, v23, v19, s62
  v_perm_b32 v105, v31, v27, s62
  v_perm_b32 v106, v39, v35, s62
  v_perm_b32 v107, v47, v43, s62
  v_perm_b32 v108, v23, v19, s63
  v_perm_b32 v109, v31, v27, s63
  v_perm_b32 v110, v39, v35, s63
  v_perm_b32 v111, v47, v43, s63
  v_accvgpr_write_b32 a64, v80
  v_accvgpr_write_b32 a65, v81
  v_accvgpr_write_b32 a66, v82
  v_accvgpr_write_b32 a67, v83
  v_accvgpr_write_b32 a68, v84
  v_accvgpr_write_b32 a69, v85
  v_accvgpr_write_b32 a70, v86
  v_accvgpr_write_b32 a71, v87
  v_accvgpr_write_b32 a72, v88
  v_accvgpr_write_b32 a73, v89
  v_accvgpr_write_b32 a74, v90
  v_accvgpr_write_b32 a75, v91
  v_accvgpr_write_b32 a76, v92
  v_accvgpr_write_b32 a77, v93
  v_accvgpr_write_b32 a78, v94
  v_accvgpr_write_b32 a79, v95
  v_accvgpr_write_b32 a80, v96
  v_accvgpr_write_b32 a81, v97
  v_accvgpr_write_b32 a82, v98
  v_accvgpr_write_b32 a83, v99
  v_accvgpr_write_b32 a84, v100
  v_accvgpr_write_b32 a85, v101
  v_accvgpr_write_b32 a86, v102
  v_accvgpr_write_b32 a87, v103
  v_accvgpr_write_b32 a88, v104
  v_accvgpr_write_b32 a89, v105
  v_accvgpr_write_b32 a90, v106
  v_accvgpr_write_b32 a91, v107
  v_accvgpr_write_b32 a92, v108
  v_accvgpr_write_b32 a93, v109
  v_accvgpr_write_b32 a94, v110
  v_accvgpr_write_b32 a95, v111
  s_add_u32 s76, s40, 163840
  buffer_load_dwordx4 v[16:19], v125, s[96:99], s76 offen nt
  buffer_load_dwordx4 v[20:23], v125, s[96:99], s76 offen offset:1280 nt
  buffer_load_dwordx4 v[24:27], v125, s[96:99], s76 offen offset:2560 nt
  s_add_u32 s76, s40, 167680
  buffer_load_dwordx4 v[28:31], v125, s[96:99], s76 offen nt
  buffer_load_dwordx4 v[32:35], v125, s[96:99], s76 offen offset:1280 nt
  buffer_load_dwordx4 v[36:39], v125, s[96:99], s76 offen offset:2560 nt
  s_add_u32 s76, s40, 171520
  buffer_load_dwordx4 v[40:43], v125, s[96:99], s76 offen nt
  buffer_load_dwordx4 v[44:47], v125, s[96:99], s76 offen offset:1280 nt
  s_waitcnt vmcnt(8)
  v_perm_b32 v80, v52, v48, s62
  v_perm_b32 v81, v60, v56, s62
  v_perm_b32 v82, v68, v64, s62
  v_perm_b32 v83, v76, v72, s62
  v_perm_b32 v84, v52, v48, s63
  v_perm_b32 v85, v60, v56, s63
  v_perm_b32 v86, v68, v64, s63
  v_perm_b32 v87, v76, v72, s63
  v_perm_b32 v88, v53, v49, s62
  v_perm_b32 v89, v61, v57, s62
  v_perm_b32 v90, v69, v65, s62
  v_perm_b32 v91, v77, v73, s62
  v_perm_b32 v92, v53, v49, s63
  v_perm_b32 v93, v61, v57, s63
  v_perm_b32 v94, v69, v65, s63
  v_perm_b32 v95, v77, v73, s63
  v_perm_b32 v96, v54, v50, s62
  v_perm_b32 v97, v62, v58, s62
  v_perm_b32 v98, v70, v66, s62
  v_perm_b32 v99, v78, v74, s62
  v_perm_b32 v100, v54, v50, s63
  v_perm_b32 v101, v62, v58, s63
  v_perm_b32 v102, v70, v66, s63
  v_perm_b32 v103, v78, v74, s63
  v_perm_b32 v104, v55, v51, s62
  v_perm_b32 v105, v63, v59, s62
  v_perm_b32 v106, v71, v67, s62
  v_perm_b32 v107, v79, v75, s62
  v_perm_b32 v108, v55, v51, s63
  v_perm_b32 v109, v63, v59, s63
  v_perm_b32 v110, v71, v67, s63
  v_perm_b32 v111, v79, v75, s63
  v_accvgpr_write_b32 a96, v80
  v_accvgpr_write_b32 a97, v81
  v_accvgpr_write_b32 a98, v82
  v_accvgpr_write_b32 a99, v83
  v_accvgpr_write_b32 a100, v84
  v_accvgpr_write_b32 a101, v85
  v_accvgpr_write_b32 a102, v86
  v_accvgpr_write_b32 a103, v87
  v_accvgpr_write_b32 a104, v88
  v_accvgpr_write_b32 a105, v89
  v_accvgpr_write_b32 a106, v90
  v_accvgpr_write_b32 a107, v91
  v_accvgpr_write_b32 a108, v92
  v_accvgpr_write_b32 a109, v93
  v_accvgpr_write_b32 a110, v94
  v_accvgpr_write_b32 a111, v95
  v_accvgpr_write_b32 a112, v96
  v_accvgpr_write_b32 a113, v97
  v_accvgpr_write_b32 a114, v98
  v_accvgpr_write_b32 a115, v99
  v_accvgpr_write_b32 a116, v100
  v_accvgpr_write_b32 a117, v101
  v_accvgpr_write_b32 a118, v102
  v_accvgpr_write_b32 a119, v103
  v_accvgpr_write_b32 a120, v104
  v_accvgpr_write_b32 a121, v105
  v_accvgpr_write_b32 a122, v106
  v_accvgpr_write_b32 a123, v107
  v_accvgpr_write_b32 a124, v108
  v_accvgpr_write_b32 a125, v109
  v_accvgpr_write_b32 a126, v110
  v_accvgpr_write_b32 a127, v111
  s_add_u32 s76, s40, 204800
  buffer_load_dwordx4 v[48:51], v125, s[96:99], s76 offen nt
  buffer_load_dwordx4 v[52:55], v125, s[96:99], s76 offen offset:1280 nt
  buffer_load_dwordx4 v[56:59], v125, s[96:99], s76 offen offset:2560 nt
  s_add_u32 s76, s40, 208640
  buffer_load_dwordx4 v[60:63], v125, s[96:99], s76 offen nt
  buffer_load_dwordx4 v[64:67], v125, s[96:99], s76 offen offset:1280 nt
  buffer_load_dwordx4 v[68:71], v125, s[96:99], s76 offen offset:2560 nt
  s_add_u32 s76, s40, 212480
  buffer_load_dwordx4 v[72:75], v125, s[96:99], s76 offen nt
  buffer_load_dwordx4 v[76:79], v125, s[96:99], s76 offen offset:1280 nt
  s_waitcnt vmcnt(8)
  v_perm_b32 v80, v20, v16, s62
  v_perm_b32 v81, v28, v24, s62
  v_perm_b32 v82, v36, v32, s62
  v_perm_b32 v83, v44, v40, s62
  v_perm_b32 v84, v20, v16, s63
  v_perm_b32 v85, v28, v24, s63
  v_perm_b32 v86, v36, v32, s63
  v_perm_b32 v87, v44, v40, s63
  v_perm_b32 v88, v21, v17, s62
  v_perm_b32 v89, v29, v25, s62
  v_perm_b32 v90, v37, v33, s62
  v_perm_b32 v91, v45, v41, s62
  v_perm_b32 v92, v21, v17, s63
  v_perm_b32 v93, v29, v25, s63
  v_perm_b32 v94, v37, v33, s63
  v_perm_b32 v95, v45, v41, s63
  v_perm_b32 v96, v22, v18, s62
  v_perm_b32 v97, v30, v26, s62
  v_perm_b32 v98, v38, v34, s62
  v_perm_b32 v99, v46, v42, s62
  v_perm_b32 v100, v22, v18, s63
  v_perm_b32 v101, v30, v26, s63
  v_perm_b32 v102, v38, v34, s63
  v_perm_b32 v103, v46, v42, s63
  v_perm_b32 v104, v23, v19, s62
  v_perm_b32 v105, v31, v27, s62
  v_perm_b32 v106, v39, v35, s62
  v_perm_b32 v107, v47, v43, s62
  v_perm_b32 v108, v23, v19, s63
  v_perm_b32 v109, v31, v27, s63
  v_perm_b32 v110, v39, v35, s63
  v_perm_b32 v111, v47, v43, s63
  v_accvgpr_write_b32 a128, v80
  v_accvgpr_write_b32 a129, v81
  v_accvgpr_write_b32 a130, v82
  v_accvgpr_write_b32 a131, v83
  v_accvgpr_write_b32 a132, v84
  v_accvgpr_write_b32 a133, v85
  v_accvgpr_write_b32 a134, v86
  v_accvgpr_write_b32 a135, v87
  v_accvgpr_write_b32 a136, v88
  v_accvgpr_write_b32 a137, v89
  v_accvgpr_write_b32 a138, v90
  v_accvgpr_write_b32 a139, v91
  v_accvgpr_write_b32 a140, v92
  v_accvgpr_write_b32 a141, v93
  v_accvgpr_write_b32 a142, v94
  v_accvgpr_write_b32 a143, v95
  v_accvgpr_write_b32 a144, v96
  v_accvgpr_write_b32 a145, v97
  v_accvgpr_write_b32 a146, v98
  v_accvgpr_write_b32 a147, v99
  v_accvgpr_write_b32 a148, v100
  v_accvgpr_write_b32 a149, v101
  v_accvgpr_write_b32 a150, v102
  v_accvgpr_write_b32 a151, v103
  v_accvgpr_write_b32 a152, v104
  v_accvgpr_write_b32 a153, v105
  v_accvgpr_write_b32 a154, v106
  v_accvgpr_write_b32 a155, v107
  v_accvgpr_write_b32 a156, v108
  v_accvgpr_write_b32 a157, v109
  v_accvgpr_write_b32 a158, v110
  v_accvgpr_write_b32 a159, v111
  s_add_u32 s76, s41, 0
  buffer_load_dwordx4 v[16:19], v125, s[96:99], s76 offen nt
  buffer_load_dwordx4 v[20:23], v125, s[96:99], s76 offen offset:1280 nt
  buffer_load_dwordx4 v[24:27], v125, s[96:99], s76 offen offset:2560 nt
  s_add_u32 s76, s41, 3840
  buffer_load_dwordx4 v[28:31], v125, s[96:99], s76 offen nt
  buffer_load_dwordx4 v[32:35], v125, s[96:99], s76 offen offset:1280 nt
  buffer_load_dwordx4 v[36:39], v125, s[96:99], s76 offen offset:2560 nt
  s_add_u32 s76, s41, 7680
  buffer_load_dwordx4 v[40:43], v125, s[96:99], s76 offen nt
  buffer_load_dwordx4 v[44:47], v125, s[96:99], s76 offen offset:1280 nt
  s_waitcnt vmcnt(8)
  v_perm_b32 v80, v52, v48, s62
  v_perm_b32 v81, v60, v56, s62
  v_perm_b32 v82, v68, v64, s62
  v_perm_b32 v83, v76, v72, s62
  v_perm_b32 v84, v52, v48, s63
  v_perm_b32 v85, v60, v56, s63
  v_perm_b32 v86, v68, v64, s63
  v_perm_b32 v87, v76, v72, s63
  v_perm_b32 v88, v53, v49, s62
  v_perm_b32 v89, v61, v57, s62
  v_perm_b32 v90, v69, v65, s62
  v_perm_b32 v91, v77, v73, s62
  v_perm_b32 v92, v53, v49, s63
  v_perm_b32 v93, v61, v57, s63
  v_perm_b32 v94, v69, v65, s63
  v_perm_b32 v95, v77, v73, s63
  v_perm_b32 v96, v54, v50, s62
  v_perm_b32 v97, v62, v58, s62
  v_perm_b32 v98, v70, v66, s62
  v_perm_b32 v99, v78, v74, s62
  v_perm_b32 v100, v54, v50, s63
  v_perm_b32 v101, v62, v58, s63
  v_perm_b32 v102, v70, v66, s63
  v_perm_b32 v103, v78, v74, s63
  v_perm_b32 v104, v55, v51, s62
  v_perm_b32 v105, v63, v59, s62
  v_perm_b32 v106, v71, v67, s62
  v_perm_b32 v107, v79, v75, s62
  v_perm_b32 v108, v55, v51, s63
  v_perm_b32 v109, v63, v59, s63
  v_perm_b32 v110, v71, v67, s63
  v_perm_b32 v111, v79, v75, s63
  v_accvgpr_write_b32 a160, v80
  v_accvgpr_write_b32 a161, v81
  v_accvgpr_write_b32 a162, v82
  v_accvgpr_write_b32 a163, v83
  v_accvgpr_write_b32 a164, v84
  v_accvgpr_write_b32 a165, v85
  v_accvgpr_write_b32 a166, v86
  v_accvgpr_write_b32 a167, v87
  v_accvgpr_write_b32 a168, v88
  v_accvgpr_write_b32 a169, v89
  v_accvgpr_write_b32 a170, v90
  v_accvgpr_write_b32 a171, v91
  v_accvgpr_write_b32 a172, v92
  v_accvgpr_write_b32 a173, v93
  v_accvgpr_write_b32 a174, v94
  v_accvgpr_write_b32 a175, v95
  v_accvgpr_write_b32 a176, v96
  v_accvgpr_write_b32 a177, v97
  v_accvgpr_write_b32 a178, v98
  v_accvgpr_write_b32 a179, v99
  v_accvgpr_write_b32 a180, v100
  v_accvgpr_write_b32 a181, v101
  v_accvgpr_write_b32 a182, v102
  v_accvgpr_write_b32 a183, v103
  v_accvgpr_write_b32 a184, v104
  v_accvgpr_write_b32 a185, v105
  v_accvgpr_write_b32 a186, v106
  v_accvgpr_write_b32 a187, v107
  v_accvgpr_write_b32 a188, v108
  v_accvgpr_write_b32 a189, v109
  v_accvgpr_write_b32 a190, v110
  v_accvgpr_write_b32 a191, v111
  s_add_u32 s76, s41, 163840
  buffer_load_dwordx4 v[48:51], v125, s[96:99], s76 offen nt
  buffer_load_dwordx4 v[52:55], v125, s[96:99], s76 offen offset:1280 nt
  buffer_load_dwordx4 v[56:59], v125, s[96:99], s76 offen offset:2560 nt
  s_add_u32 s76, s41, 167680
  buffer_load_dwordx4 v[60:63], v125, s[96:99], s76 offen nt
  buffer_load_dwordx4 v[64:67], v125, s[96:99], s76 offen offset:1280 nt
  buffer_load_dwordx4 v[68:71], v125, s[96:99], s76 offen offset:2560 nt
  s_add_u32 s76, s41, 171520
  buffer_load_dwordx4 v[72:75], v125, s[96:99], s76 offen nt
  buffer_load_dwordx4 v[76:79], v125, s[96:99], s76 offen offset:1280 nt
  s_waitcnt vmcnt(8)
  v_perm_b32 v80, v20, v16, s62
  v_perm_b32 v81, v28, v24, s62
  v_perm_b32 v82, v36, v32, s62
  v_perm_b32 v83, v44, v40, s62
  v_perm_b32 v84, v20, v16, s63
  v_perm_b32 v85, v28, v24, s63
  v_perm_b32 v86, v36, v32, s63
  v_perm_b32 v87, v44, v40, s63
  v_perm_b32 v88, v21, v17, s62
  v_perm_b32 v89, v29, v25, s62
  v_perm_b32 v90, v37, v33, s62
  v_perm_b32 v91, v45, v41, s62
  v_perm_b32 v92, v21, v17, s63
  v_perm_b32 v93, v29, v25, s63
  v_perm_b32 v94, v37, v33, s63
  v_perm_b32 v95, v45, v41, s63
  v_perm_b32 v96, v22, v18, s62
  v_perm_b32 v97, v30, v26, s62
  v_perm_b32 v98, v38, v34, s62
  v_perm_b32 v99, v46, v42, s62
  v_perm_b32 v100, v22, v18, s63
  v_perm_b32 v101, v30, v26, s63
  v_perm_b32 v102, v38, v34, s63
  v_perm_b32 v103, v46, v42, s63
  v_perm_b32 v104, v23, v19, s62
  v_perm_b32 v105, v31, v27, s62
  v_perm_b32 v106, v39, v35, s62
  v_perm_b32 v107, v47, v43, s62
  v_perm_b32 v108, v23, v19, s63
  v_perm_b32 v109, v31, v27, s63
  v_perm_b32 v110, v39, v35, s63
  v_perm_b32 v111, v47, v43, s63
  v_accvgpr_write_b32 a192, v80
  v_accvgpr_write_b32 a193, v81
  v_accvgpr_write_b32 a194, v82
  v_accvgpr_write_b32 a195, v83
  v_accvgpr_write_b32 a196, v84
  v_accvgpr_write_b32 a197, v85
  v_accvgpr_write_b32 a198, v86
  v_accvgpr_write_b32 a199, v87
  v_accvgpr_write_b32 a200, v88
  v_accvgpr_write_b32 a201, v89
  v_accvgpr_write_b32 a202, v90
  v_accvgpr_write_b32 a203, v91
  v_accvgpr_write_b32 a204, v92
  v_accvgpr_write_b32 a205, v93
  v_accvgpr_write_b32 a206, v94
  v_accvgpr_write_b32 a207, v95
  v_accvgpr_write_b32 a208, v96
  v_accvgpr_write_b32 a209, v97
  v_accvgpr_write_b32 a210, v98
  v_accvgpr_write_b32 a211, v99
  v_accvgpr_write_b32 a212, v100
  v_accvgpr_write_b32 a213, v101
  v_accvgpr_write_b32 a214, v102
  v_accvgpr_write_b32 a215, v103
  v_accvgpr_write_b32 a216, v104
  v_accvgpr_write_b32 a217, v105
  v_accvgpr_write_b32 a218, v106
  v_accvgpr_write_b32 a219, v107
  v_accvgpr_write_b32 a220, v108
  v_accvgpr_write_b32 a221, v109
  v_accvgpr_write_b32 a222, v110
  v_accvgpr_write_b32 a223, v111
  s_add_u32 s76, s42, 0
  s_mov_b64 exec, s[88:89]
  buffer_load_dwordx4 v[16:19], v126, s[80:83], s76 offen nt
  s_mov_b64 exec, s[90:91]
  buffer_load_dwordx4 v[16:19], v126, s[84:87], s76 offen nt
  s_add_u32 s76, s42, 3072
  s_mov_b64 exec, s[88:89]
  buffer_load_dwordx4 v[20:23], v126, s[80:83], s76 offen nt
  s_mov_b64 exec, s[90:91]
  buffer_load_dwordx4 v[20:23], v126, s[84:87], s76 offen nt
  s_add_u32 s76, s42, 6144
  s_mov_b64 exec, s[88:89]
  buffer_load_dwordx4 v[24:27], v126, s[80:83], s76 offen nt
  s_mov_b64 exec, s[90:91]
  buffer_load_dwordx4 v[24:27], v126, s[84:87], s76 offen nt
  s_add_u32 s76, s42, 9216
  s_mov_b64 exec, s[88:89]
  buffer_load_dwordx4 v[28:31], v126, s[80:83], s76 offen nt
  s_mov_b64 exec, s[90:91]
  buffer_load_dwordx4 v[28:31], v126, s[84:87], s76 offen nt
  s_add_u32 s76, s42, 12288
  s_mov_b64 exec, s[88:89]
  buffer_load_dwordx4 v[32:35], v126, s[80:83], s76 offen nt
  s_mov_b64 exec, s[90:91]
  buffer_load_dwordx4 v[32:35], v126, s[84:87], s76 offen nt
  s_add_u32 s76, s42, 15360
  s_mov_b64 exec, s[88:89]
  buffer_load_dwordx4 v[36:39], v126, s[80:83], s76 offen nt
  s_mov_b64 exec, s[90:91]
  buffer_load_dwordx4 v[36:39], v126, s[84:87], s76 offen nt
  s_add_u32 s76, s42, 18432
  s_mov_b64 exec, s[88:89]
  buffer_load_dwordx4 v[40:43], v126, s[80:83], s76 offen nt
  s_mov_b64 exec, s[90:91]
  buffer_load_dwordx4 v[40:43], v126, s[84:87], s76 offen nt
  s_add_u32 s76, s42, 21504
  s_mov_b64 exec, s[88:89]
  buffer_load_dwordx4 v[44:47], v126, s[80:83], s76 offen nt
  s_mov_b64 exec, s[90:91]
  buffer_load_dwordx4 v[44:47], v126, s[84:87], s76 offen nt
  s_mov_b64 exec, -1
  s_waitcnt vmcnt(16)
  v_perm_b32 v80, v52, v48, s62
  v_perm_b32 v81, v60, v56, s62
  v_perm_b32 v82, v68, v64, s62
  v_perm_b32 v83, v76, v72, s62
  v_perm_b32 v84, v52, v48, s63
  v_perm_b32 v85, v60, v56, s63
  v_perm_b32 v86, v68, v64, s63
  v_perm_b32 v87, v76, v72, s63
  v_perm_b32 v88, v53, v49, s62
  v_perm_b32 v89, v61, v57, s62
  v_perm_b32 v90, v69, v65, s62
  v_perm_b32 v91, v77, v73, s62
  v_perm_b32 v92, v53, v49, s63
  v_perm_b32 v93, v61, v57, s63
  v_perm_b32 v94, v69, v65, s63
  v_perm_b32 v95, v77, v73, s63
  v_perm_b32 v96, v54, v50, s62
  v_perm_b32 v97, v62, v58, s62
  v_perm_b32 v98, v70, v66, s62
  v_perm_b32 v99, v78, v74, s62
  v_perm_b32 v100, v54, v50, s63
  v_perm_b32 v101, v62, v58, s63
  v_perm_b32 v102, v70, v66, s63
  v_perm_b32 v103, v78, v74, s63
  v_perm_b32 v104, v55, v51, s62
  v_perm_b32 v105, v63, v59, s62
  v_perm_b32 v106, v71, v67, s62
  v_perm_b32 v107, v79, v75, s62
  v_perm_b32 v108, v55, v51, s63
  v_perm_b32 v109, v63, v59, s63
  v_perm_b32 v110, v71, v67, s63
  v_perm_b32 v111, v79, v75, s63
  v_accvgpr_write_b32 a224, v80
  v_accvgpr_write_b32 a225, v81
  v_accvgpr_write_b32 a226, v82
  v_accvgpr_write_b32 a227, v83
  v_accvgpr_write_b32 a228, v84
  v_accvgpr_write_b32 a229, v85
  v_accvgpr_write_b32 a230, v86
  v_accvgpr_write_b32 a231, v87
  v_accvgpr_write_b32 a232, v88
  v_accvgpr_write_b32 a233, v89
  v_accvgpr_write_b32 a234, v90
  v_accvgpr_write_b32 a235, v91
  v_accvgpr_write_b32 a236, v92
  v_accvgpr_write_b32 a237, v93
  v_accvgpr_write_b32 a238, v94
  v_accvgpr_write_b32 a239, v95
  v_accvgpr_write_b32 a240, v96
  v_accvgpr_write_b32 a241, v97
  v_accvgpr_write_b32 a242, v98
  v_accvgpr_write_b32 a243, v99
  v_accvgpr_write_b32 a244, v100
  v_accvgpr_write_b32 a245, v101
  v_accvgpr_write_b32 a246, v102
  v_accvgpr_write_b32 a247, v103
  v_accvgpr_write_b32 a248, v104
  v_accvgpr_write_b32 a249, v105
  v_accvgpr_write_b32 a250, v106
  v_accvgpr_write_b32 a251, v107
  v_accvgpr_write_b32 a252, v108
  v_accvgpr_write_b32 a253, v109
  v_accvgpr_write_b32 a254, v110
  v_accvgpr_write_b32 a255, v111
  s_add_u32 s76, s42, 98304
  s_mov_b64 exec, s[88:89]
  buffer_load_dwordx4 v[48:51], v126, s[80:83], s76 offen nt
  s_mov_b64 exec, s[90:91]
  buffer_load_dwordx4 v[48:51], v126, s[84:87], s76 offen nt
  s_add_u32 s76, s42, 101376
  s_mov_b64 exec, s[88:89]
  buffer_load_dwordx4 v[52:55], v126, s[80:83], s76 offen nt
  s_mov_b64 exec, s[90:91]
  buffer_load_dwordx4 v[52:55], v126, s[84:87], s76 offen nt
  s_add_u32 s76, s42, 104448
  s_mov_b64 exec, s[88:89]
  buffer_load_dwordx4 v[56:59], v126, s[80:83], s76 offen nt
  s_mov_b64 exec, s[90:91]
  buffer_load_dwordx4 v[56:59], v126, s[84:87], s76 offen nt
  s_add_u32 s76, s42, 107520
  s_mov_b64 exec, s[88:89]
  buffer_load_dwordx4 v[60:63], v126, s[80:83], s76 offen nt
  s_mov_b64 exec, s[90:91]
  buffer_load_dwordx4 v[60:63], v126, s[84:87], s76 offen nt
  s_add_u32 s76, s42, 110592
  s_mov_b64 exec, s[88:89]
  buffer_load_dwordx4 v[64:67], v126, s[80:83], s76 offen nt
  s_mov_b64 exec, s[90:91]
  buffer_load_dwordx4 v[64:67], v126, s[84:87], s76 offen nt
  s_add_u32 s76, s42, 113664
  s_mov_b64 exec, s[88:89]
  buffer_load_dwordx4 v[68:71], v126, s[80:83], s76 offen nt
  s_mov_b64 exec, s[90:91]
  buffer_load_dwordx4 v[68:71], v126, s[84:87], s76 offen nt
  s_add_u32 s76, s42, 116736
  s_mov_b64 exec, s[88:89]
  buffer_load_dwordx4 v[72:75], v126, s[80:83], s76 offen nt
  s_mov_b64 exec, s[90:91]
  buffer_load_dwordx4 v[72:75], v126, s[84:87], s76 offen nt
  s_add_u32 s76, s42, 119808
  s_mov_b64 exec, s[88:89]
  buffer_load_dwordx4 v[76:79], v126, s[80:83], s76 offen nt
  s_mov_b64 exec, s[90:91]
  buffer_load_dwordx4 v[76:79], v126, s[84:87], s76 offen nt
  s_mov_b64 exec, -1
  s_waitcnt vmcnt(16)
  v_perm_b32 v128, v20, v16, s62
  v_perm_b32 v129, v28, v24, s62
  v_perm_b32 v130, v36, v32, s62
  v_perm_b32 v131, v44, v40, s62
  v_perm_b32 v132, v20, v16, s63
  v_perm_b32 v133, v28, v24, s63
  v_perm_b32 v134, v36, v32, s63
  v_perm_b32 v135, v44, v40, s63
  v_perm_b32 v136, v21, v17, s62
  v_perm_b32 v137, v29, v25, s62
  v_perm_b32 v138, v37, v33, s62
  v_perm_b32 v139, v45, v41, s62
  v_perm_b32 v140, v21, v17, s63
  v_perm_b32 v141, v29, v25, s63
  v_perm_b32 v142, v37, v33, s63
  v_perm_b32 v143, v45, v41, s63
  v_perm_b32 v144, v22, v18, s62
  v_perm_b32 v145, v30, v26, s62
  v_perm_b32 v146, v38, v34, s62
  v_perm_b32 v147, v46, v42, s62
  v_perm_b32 v148, v22, v18, s63
  v_perm_b32 v149, v30, v26, s63
  v_perm_b32 v150, v38, v34, s63
  v_perm_b32 v151, v46, v42, s63
  v_perm_b32 v152, v23, v19, s62
  v_perm_b32 v153, v31, v27, s62
  v_perm_b32 v154, v39, v35, s62
  v_perm_b32 v155, v47, v43, s62
  v_perm_b32 v156, v23, v19, s63
  v_perm_b32 v157, v31, v27, s63
  v_perm_b32 v158, v39, v35, s63
  v_perm_b32 v159, v47, v43, s63
  s_add_u32 s76, s42, 196608
  s_mov_b64 exec, s[88:89]
  buffer_load_dwordx4 v[16:19], v126, s[80:83], s76 offen nt
  s_mov_b64 exec, s[90:91]
  buffer_load_dwordx4 v[16:19], v126, s[84:87], s76 offen nt
  s_add_u32 s76, s42, 199680
  s_mov_b64 exec, s[88:89]
  buffer_load_dwordx4 v[20:23], v126, s[80:83], s76 offen nt
  s_mov_b64 exec, s[90:91]
  buffer_load_dwordx4 v[20:23], v126, s[84:87], s76 offen nt
  s_add_u32 s76, s42, 202752
  s_mov_b64 exec, s[88:89]
  buffer_load_dwordx4 v[24:27], v126, s[80:83], s76 offen nt
  s_mov_b64 exec, s[90:91]
  buffer_load_dwordx4 v[24:27], v126, s[84:87], s76 offen nt
  s_add_u32 s76, s42, 205824
  s_mov_b64 exec, s[88:89]
  buffer_load_dwordx4 v[28:31], v126, s[80:83], s76 offen nt
  s_mov_b64 exec, s[90:91]
  buffer_load_dwordx4 v[28:31], v126, s[84:87], s76 offen nt
  s_add_u32 s76, s42, 208896
  s_mov_b64 exec, s[88:89]
  buffer_load_dwordx4 v[32:35], v126, s[80:83], s76 offen nt
  s_mov_b64 exec, s[90:91]
  buffer_load_dwordx4 v[32:35], v126, s[84:87], s76 offen nt
  s_add_u32 s76, s42, 211968
  s_mov_b64 exec, s[88:89]
  buffer_load_dwordx4 v[36:39], v126, s[80:83], s76 offen nt
  s_mov_b64 exec, s[90:91]
  buffer_load_dwordx4 v[36:39], v126, s[84:87], s76 offen nt
  s_add_u32 s76, s42, 215040
  s_mov_b64 exec, s[88:89]
  buffer_load_dwordx4 v[40:43], v126, s[80:83], s76 offen nt
  s_mov_b64 exec, s[90:91]
  buffer_load_dwordx4 v[40:43], v126, s[84:87], s76 offen nt
  s_add_u32 s76, s42, 218112
  s_mov_b64 exec, s[88:89]
  buffer_load_dwordx4 v[44:47], v126, s[80:83], s76 offen nt
  s_mov_b64 exec, s[90:91]
  buffer_load_dwordx4 v[44:47], v126, s[84:87], s76 offen nt
  s_mov_b64 exec, -1
  s_waitcnt vmcnt(16)
  v_perm_b32 v160, v52, v48, s62
  v_perm_b32 v161, v60, v56, s62
  v_perm_b32 v162, v68, v64, s62
  v_perm_b32 v163, v76, v72, s62
  v_perm_b32 v164, v52, v48, s63
  v_perm_b32 v165, v60, v56, s63
  v_perm_b32 v166, v68, v64, s63
  v_perm_b32 v167, v76, v72, s63
  v_perm_b32 v168, v53, v49, s62
  v_perm_b32 v169, v61, v57, s62
  v_perm_b32 v170, v69, v65, s62
  v_perm_b32 v171, v77, v73, s62
  v_perm_b32 v172, v53, v49, s63
  v_perm_b32 v173, v61, v57, s63
  v_perm_b32 v174, v69, v65, s63
  v_perm_b32 v175, v77, v73, s63
  v_perm_b32 v176, v54, v50, s62
  v_perm_b32 v177, v62, v58, s62
  v_perm_b32 v178, v70, v66, s62
  v_perm_b32 v179, v78, v74, s62
  v_perm_b32 v180, v54, v50, s63
  v_perm_b32 v181, v62, v58, s63
  v_perm_b32 v182, v70, v66, s63
  v_perm_b32 v183, v78, v74, s63
  v_perm_b32 v184, v55, v51, s62
  v_perm_b32 v185, v63, v59, s62
  v_perm_b32 v186, v71, v67, s62
  v_perm_b32 v187, v79, v75, s62
  v_perm_b32 v188, v55, v51, s63
  v_perm_b32 v189, v63, v59, s63
  v_perm_b32 v190, v71, v67, s63
  v_perm_b32 v191, v79, v75, s63
  s_add_u32 s76, s42, 294912
  s_mov_b64 exec, s[88:89]
  buffer_load_dwordx4 v[48:51], v126, s[80:83], s76 offen nt
  s_mov_b64 exec, s[90:91]
  buffer_load_dwordx4 v[48:51], v126, s[84:87], s76 offen nt
  s_add_u32 s76, s42, 297984
  s_mov_b64 exec, s[88:89]
  buffer_load_dwordx4 v[52:55], v126, s[80:83], s76 offen nt
  s_mov_b64 exec, s[90:91]
  buffer_load_dwordx4 v[52:55], v126, s[84:87], s76 offen nt
  s_add_u32 s76, s42, 301056
  s_mov_b64 exec, s[88:89]
  buffer_load_dwordx4 v[56:59], v126, s[80:83], s76 offen nt
  s_mov_b64 exec, s[90:91]
  buffer_load_dwordx4 v[56:59], v126, s[84:87], s76 offen nt
  s_add_u32 s76, s42, 304128
  s_mov_b64 exec, s[88:89]
  buffer_load_dwordx4 v[60:63], v126, s[80:83], s76 offen nt
  s_mov_b64 exec, s[90:91]
  buffer_load_dwordx4 v[60:63], v126, s[84:87], s76 offen nt
  s_add_u32 s76, s42, 307200
  s_mov_b64 exec, s[88:89]
  buffer_load_dwordx4 v[64:67], v126, s[80:83], s76 offen nt
  s_mov_b64 exec, s[90:91]
  buffer_load_dwordx4 v[64:67], v126, s[84:87], s76 offen nt
  s_add_u32 s76, s42, 310272
  s_mov_b64 exec, s[88:89]
  buffer_load_dwordx4 v[68:71], v126, s[80:83], s76 offen nt
  s_mov_b64 exec, s[90:91]
  buffer_load_dwordx4 v[68:71], v126, s[84:87], s76 offen nt
  s_add_u32 s76, s42, 313344
  s_mov_b64 exec, s[88:89]
  buffer_load_dwordx4 v[72:75], v126, s[80:83], s76 offen nt
  s_mov_b64 exec, s[90:91]
  buffer_load_dwordx4 v[72:75], v126, s[84:87], s76 offen nt
  s_add_u32 s76, s42, 316416
  s_mov_b64 exec, s[88:89]
  buffer_load_dwordx4 v[76:79], v126, s[80:83], s76 offen nt
  s_mov_b64 exec, s[90:91]
  buffer_load_dwordx4 v[76:79], v126, s[84:87], s76 offen nt
  s_mov_b64 exec, -1
  s_waitcnt vmcnt(16)
  v_perm_b32 v192, v20, v16, s62
  v_perm_b32 v193, v28, v24, s62
  v_perm_b32 v194, v36, v32, s62
  v_perm_b32 v195, v44, v40, s62
  v_perm_b32 v196, v20, v16, s63
  v_perm_b32 v197, v28, v24, s63
  v_perm_b32 v198, v36, v32, s63
  v_perm_b32 v199, v44, v40, s63
  v_perm_b32 v200, v21, v17, s62
  v_perm_b32 v201, v29, v25, s62
  v_perm_b32 v202, v37, v33, s62
  v_perm_b32 v203, v45, v41, s62
  v_perm_b32 v204, v21, v17, s63
  v_perm_b32 v205, v29, v25, s63
  v_perm_b32 v206, v37, v33, s63
  v_perm_b32 v207, v45, v41, s63
  v_perm_b32 v208, v22, v18, s62
  v_perm_b32 v209, v30, v26, s62
  v_perm_b32 v210, v38, v34, s62
  v_perm_b32 v211, v46, v42, s62
  v_perm_b32 v212, v22, v18, s63
  v_perm_b32 v213, v30, v26, s63
  v_perm_b32 v214, v38, v34, s63
  v_perm_b32 v215, v46, v42, s63
  v_perm_b32 v216, v23, v19, s62
  v_perm_b32 v217, v31, v27, s62
  v_perm_b32 v218, v39, v35, s62
  v_perm_b32 v219, v47, v43, s62
  v_perm_b32 v220, v23, v19, s63
  v_perm_b32 v221, v31, v27, s63
  v_perm_b32 v222, v39, v35, s63
  v_perm_b32 v223, v47, v43, s63
  s_add_u32 s76, s42, 393216
  s_mov_b64 exec, s[88:89]
  buffer_load_dwordx4 v[16:19], v126, s[80:83], s76 offen nt
  s_mov_b64 exec, s[90:91]
  buffer_load_dwordx4 v[16:19], v126, s[84:87], s76 offen nt
  s_add_u32 s76, s42, 396288
  s_mov_b64 exec, s[88:89]
  buffer_load_dwordx4 v[20:23], v126, s[80:83], s76 offen nt
  s_mov_b64 exec, s[90:91]
  buffer_load_dwordx4 v[20:23], v126, s[84:87], s76 offen nt
  s_add_u32 s76, s42, 399360
  s_mov_b64 exec, s[88:89]
  buffer_load_dwordx4 v[24:27], v126, s[80:83], s76 offen nt
  s_mov_b64 exec, s[90:91]
  buffer_load_dwordx4 v[24:27], v126, s[84:87], s76 offen nt
  s_add_u32 s76, s42, 402432
  s_mov_b64 exec, s[88:89]
  buffer_load_dwordx4 v[28:31], v126, s[80:83], s76 offen nt
  s_mov_b64 exec, s[90:91]
  buffer_load_dwordx4 v[28:31], v126, s[84:87], s76 offen nt
  s_add_u32 s76, s42, 405504
  s_mov_b64 exec, s[88:89]
  buffer_load_dwordx4 v[32:35], v126, s[80:83], s76 offen nt
  s_mov_b64 exec, s[90:91]
  buffer_load_dwordx4 v[32:35], v126, s[84:87], s76 offen nt
  s_add_u32 s76, s42, 408576
  s_mov_b64 exec, s[88:89]
  buffer_load_dwordx4 v[36:39], v126, s[80:83], s76 offen nt
  s_mov_b64 exec, s[90:91]
  buffer_load_dwordx4 v[36:39], v126, s[84:87], s76 offen nt
  s_add_u32 s76, s42, 411648
  s_mov_b64 exec, s[88:89]
  buffer_load_dwordx4 v[40:43], v126, s[80:83], s76 offen nt
  s_mov_b64 exec, s[90:91]
  buffer_load_dwordx4 v[40:43], v126, s[84:87], s76 offen nt
  s_add_u32 s76, s42, 414720
  s_mov_b64 exec, s[88:89]
  buffer_load_dwordx4 v[44:47], v126, s[80:83], s76 offen nt
  s_mov_b64 exec, s[90:91]
  buffer_load_dwordx4 v[44:47], v126, s[84:87], s76 offen nt
  s_mov_b64 exec, -1
  s_waitcnt vmcnt(16)
  v_perm_b32 v224, v52, v48, s62
  v_perm_b32 v225, v60, v56, s62
  v_perm_b32 v226, v68, v64, s62
  v_perm_b32 v227, v76, v72, s62
  v_perm_b32 v228, v52, v48, s63
  v_perm_b32 v229, v60, v56, s63
  v_perm_b32 v230, v68, v64, s63
  v_perm_b32 v231, v76, v72, s63
  v_perm_b32 v232, v53, v49, s62
  v_perm_b32 v233, v61, v57, s62
  v_perm_b32 v234, v69, v65, s62
  v_perm_b32 v235, v77, v73, s62
  v_perm_b32 v236, v53, v49, s63
  v_perm_b32 v237, v61, v57, s63
  v_perm_b32 v238, v69, v65, s63
  v_perm_b32 v239, v77, v73, s63
  v_perm_b32 v240, v54, v50, s62
  v_perm_b32 v241, v62, v58, s62
  v_perm_b32 v242, v70, v66, s62
  v_perm_b32 v243, v78, v74, s62
  v_perm_b32 v244, v54, v50, s63
  v_perm_b32 v245, v62, v58, s63
  v_perm_b32 v246, v70, v66, s63
  v_perm_b32 v247, v78, v74, s63
  v_perm_b32 v248, v55, v51, s62
  v_perm_b32 v249, v63, v59, s62
  v_perm_b32 v250, v71, v67, s62
  v_perm_b32 v251, v79, v75, s62
  v_perm_b32 v252, v55, v51, s63
  v_perm_b32 v253, v63, v59, s63
  v_perm_b32 v254, v71, v67, s63
  v_perm_b32 v255, v79, v75, s63
  s_add_u32 s76, s40, 0
  buffer_load_dwordx4 v[48:51], v125, s[92:95], s76 offen nt
  buffer_load_dwordx4 v[52:55], v125, s[92:95], s76 offen offset:1280 nt
  buffer_load_dwordx4 v[56:59], v125, s[92:95], s76 offen offset:2560 nt
  s_add_u32 s76, s40, 3840
  buffer_load_dwordx4 v[60:63], v125, s[92:95], s76 offen nt
  buffer_load_dwordx4 v[64:67], v125, s[92:95], s76 offen offset:1280 nt
  buffer_load_dwordx4 v[68:71], v125, s[92:95], s76 offen offset:2560 nt
  s_add_u32 s76, s40, 7680
  buffer_load_dwordx4 v[72:75], v125, s[92:95], s76 offen nt
  buffer_load_dwordx4 v[76:79], v125, s[92:95], s76 offen offset:1280 nt
  s_waitcnt vmcnt(8)
  v_perm_b32 v80, v20, v16, s62
  v_perm_b32 v81, v28, v24, s62
  v_perm_b32 v82, v36, v32, s62
  v_perm_b32 v83, v44, v40, s62
  v_perm_b32 v84, v20, v16, s63
  v_perm_b32 v85, v28, v24, s63
  v_perm_b32 v86, v36, v32, s63
  v_perm_b32 v87, v44, v40, s63
  v_perm_b32 v88, v21, v17, s62
  v_perm_b32 v89, v29, v25, s62
  v_perm_b32 v90, v37, v33, s62
  v_perm_b32 v91, v45, v41, s62
  v_perm_b32 v92, v21, v17, s63
  v_perm_b32 v93, v29, v25, s63
  v_perm_b32 v94, v37, v33, s63
  v_perm_b32 v95, v45, v41, s63
  v_perm_b32 v96, v22, v18, s62
  v_perm_b32 v97, v30, v26, s62
  v_perm_b32 v98, v38, v34, s62
  v_perm_b32 v99, v46, v42, s62
  v_perm_b32 v100, v22, v18, s63
  v_perm_b32 v101, v30, v26, s63
  v_perm_b32 v102, v38, v34, s63
  v_perm_b32 v103, v46, v42, s63
  v_perm_b32 v104, v23, v19, s62
  v_perm_b32 v105, v31, v27, s62
  v_perm_b32 v106, v39, v35, s62
  v_perm_b32 v107, v47, v43, s62
  v_perm_b32 v108, v23, v19, s63
  v_perm_b32 v109, v31, v27, s63
  v_perm_b32 v110, v39, v35, s63
  v_perm_b32 v111, v47, v43, s63
  ds_write_b128 v14, v[80:83] offset:0
  ds_write_b128 v14, v[84:87] offset:1024
  ds_write_b128 v14, v[88:91] offset:2048
  ds_write_b128 v14, v[92:95] offset:3072
  ds_write_b128 v14, v[96:99] offset:4096
  ds_write_b128 v14, v[100:103] offset:5120
  ds_write_b128 v14, v[104:107] offset:6144
  ds_write_b128 v14, v[108:111] offset:7168
  s_waitcnt lgkmcnt(0)
  s_add_u32 s76, s40, 40960
  buffer_load_dwordx4 v[16:19], v125, s[92:95], s76 offen nt
  buffer_load_dwordx4 v[20:23], v125, s[92:95], s76 offen offset:1280 nt
  buffer_load_dwordx4 v[24:27], v125, s[92:95], s76 offen offset:2560 nt
  s_add_u32 s76, s40, 44800
  buffer_load_dwordx4 v[28:31], v125, s[92:95], s76 offen nt
  buffer_load_dwordx4 v[32:35], v125, s[92:95], s76 offen offset:1280 nt
  buffer_load_dwordx4 v[36:39], v125, s[92:95], s76 offen offset:2560 nt
  s_add_u32 s76, s40, 48640
  buffer_load_dwordx4 v[40:43], v125, s[92:95], s76 offen nt
  buffer_load_dwordx4 v[44:47], v125, s[92:95], s76 offen offset:1280 nt
  s_waitcnt vmcnt(8)
  v_perm_b32 v80, v52, v48, s62
  v_perm_b32 v81, v60, v56, s62
  v_perm_b32 v82, v68, v64, s62
  v_perm_b32 v83, v76, v72, s62
  v_perm_b32 v84, v52, v48, s63
  v_perm_b32 v85, v60, v56, s63
  v_perm_b32 v86, v68, v64, s63
  v_perm_b32 v87, v76, v72, s63
  v_perm_b32 v88, v53, v49, s62
  v_perm_b32 v89, v61, v57, s62
  v_perm_b32 v90, v69, v65, s62
  v_perm_b32 v91, v77, v73, s62
  v_perm_b32 v92, v53, v49, s63
  v_perm_b32 v93, v61, v57, s63
  v_perm_b32 v94, v69, v65, s63
  v_perm_b32 v95, v77, v73, s63
  v_perm_b32 v96, v54, v50, s62
  v_perm_b32 v97, v62, v58, s62
  v_perm_b32 v98, v70, v66, s62
  v_perm_b32 v99, v78, v74, s62
  v_perm_b32 v100, v54, v50, s63
  v_perm_b32 v101, v62, v58, s63
  v_perm_b32 v102, v70, v66, s63
  v_perm_b32 v103, v78, v74, s63
  v_perm_b32 v104, v55, v51, s62
  v_perm_b32 v105, v63, v59, s62
  v_perm_b32 v106, v71, v67, s62
  v_perm_b32 v107, v79, v75, s62
  v_perm_b32 v108, v55, v51, s63
  v_perm_b32 v109, v63, v59, s63
  v_perm_b32 v110, v71, v67, s63
  v_perm_b32 v111, v79, v75, s63
  ds_write_b128 v14, v[80:83] offset:8192
  ds_write_b128 v14, v[84:87] offset:9216
  ds_write_b128 v14, v[88:91] offset:10240
  ds_write_b128 v14, v[92:95] offset:11264
  ds_write_b128 v14, v[96:99] offset:12288
  ds_write_b128 v14, v[100:103] offset:13312
  ds_write_b128 v14, v[104:107] offset:14336
  ds_write_b128 v14, v[108:111] offset:15360
  s_waitcnt lgkmcnt(0)
  s_add_u32 s76, s41, 0
  buffer_load_dwordx4 v[48:51], v125, s[92:95], s76 offen nt
  buffer_load_dwordx4 v[52:55], v125, s[92:95], s76 offen offset:1280 nt
  buffer_load_dwordx4 v[56:59], v125, s[92:95], s76 offen offset:2560 nt
  s_add_u32 s76, s41, 3840
  buffer_load_dwordx4 v[60:63], v125, s[92:95], s76 offen nt
  buffer_load_dwordx4 v[64:67], v125, s[92:95], s76 offen offset:1280 nt
  buffer_load_dwordx4 v[68:71], v125, s[92:95], s76 offen offset:2560 nt
  s_add_u32 s76, s41, 7680
  buffer_load_dwordx4 v[72:75], v125, s[92:95], s76 offen nt
  buffer_load_dwordx4 v[76:79], v125, s[92:95], s76 offen offset:1280 nt
  s_waitcnt vmcnt(8)
  v_perm_b32 v80, v20, v16, s62
  v_perm_b32 v81, v28, v24, s62
  v_perm_b32 v82, v36, v32, s62
  v_perm_b32 v83, v44, v40, s62
  v_perm_b32 v84, v20, v16, s63
  v_perm_b32 v85, v28, v24, s63
  v_perm_b32 v86, v36, v32, s63
  v_perm_b32 v87, v44, v40, s63
  v_perm_b32 v88, v21, v17, s62
  v_perm_b32 v89, v29, v25, s62
  v_perm_b32 v90, v37, v33, s62
  v_perm_b32 v91, v45, v41, s62
  v_perm_b32 v92, v21, v17, s63
  v_perm_b32 v93, v29, v25, s63
  v_perm_b32 v94, v37, v33, s63
  v_perm_b32 v95, v45, v41, s63
  v_perm_b32 v96, v22, v18, s62
  v_perm_b32 v97, v30, v26, s62
  v_perm_b32 v98, v38, v34, s62
  v_perm_b32 v99, v46, v42, s62
  v_perm_b32 v100, v22, v18, s63
  v_perm_b32 v101, v30, v26, s63
  v_perm_b32 v102, v38, v34, s63
  v_perm_b32 v103, v46, v42, s63
  v_perm_b32 v104, v23, v19, s62
  v_perm_b32 v105, v31, v27, s62
  v_perm_b32 v106, v39, v35, s62
  v_perm_b32 v107, v47, v43, s62
  v_perm_b32 v108, v23, v19, s63
  v_perm_b32 v109, v31, v27, s63
  v_perm_b32 v110, v39, v35, s63
  v_perm_b32 v111, v47, v43, s63
  ds_write_b128 v14, v[80:83] offset:16384
  ds_write_b128 v14, v[84:87] offset:17408
  ds_write_b128 v14, v[88:91] offset:18432
  ds_write_b128 v14, v[92:95] offset:19456
  ds_write_b128 v14, v[96:99] offset:20480
  ds_write_b128 v14, v[100:103] offset:21504
  ds_write_b128 v14, v[104:107] offset:22528
  ds_write_b128 v14, v[108:111] offset:23552
  s_waitcnt lgkmcnt(0)
  s_waitcnt vmcnt(0)
  v_perm_b32 v80, v52, v48, s62
  v_perm_b32 v81, v60, v56, s62
  v_perm_b32 v82, v68, v64, s62
  v_perm_b32 v83, v76, v72, s62
  v_perm_b32 v84, v52, v48, s63
  v_perm_b32 v85, v60, v56, s63
  v_perm_b32 v86, v68, v64, s63
  v_perm_b32 v87, v76, v72, s63
  v_perm_b32 v88, v53, v49, s62
  v_perm_b32 v89, v61, v57, s62
  v_perm_b32 v90, v69, v65, s62
  v_perm_b32 v91, v77, v73, s62
  v_perm_b32 v92, v53, v49, s63
  v_perm_b32 v93, v61, v57, s63
  v_perm_b32 v94, v69, v65, s63
  v_perm_b32 v95, v77, v73, s63
  v_perm_b32 v96, v54, v50, s62
  v_perm_b32 v97, v62, v58, s62
  v_perm_b32 v98, v70, v66, s62
  v_perm_b32 v99, v78, v74, s62
  v_perm_b32 v100, v54, v50, s63
  v_perm_b32 v101, v62, v58, s63
  v_perm_b32 v102, v70, v66, s63
  v_perm_b32 v103, v78, v74, s63
  v_perm_b32 v104, v55, v51, s62
  v_perm_b32 v105, v63, v59, s62
  v_perm_b32 v106, v71, v67, s62
  v_perm_b32 v107, v79, v75, s62
  v_perm_b32 v108, v55, v51, s63
  v_perm_b32 v109, v63, v59, s63
  v_perm_b32 v110, v71, v67, s63
  v_perm_b32 v111, v79, v75, s63
  s_cmp_ge_u32 s3, 2
  s_cbranch_scc1 Lpb72
  ds_write_b128 v120, v[80:83] offset:0
  ds_write_b128 v120, v[84:87] offset:1024
  ds_write_b128 v120, v[88:91] offset:2048
  ds_write_b128 v120, v[92:95] offset:3072
  ds_write_b128 v120, v[96:99] offset:4096
  ds_write_b128 v120, v[100:103] offset:5120
  ds_write_b128 v120, v[104:107] offset:6144
  ds_write_b128 v120, v[108:111] offset:7168
  s_waitcnt lgkmcnt(0)
Lpb72:
  s_nop 4
  s_waitcnt lgkmcnt(0)
  s_cmp_lg_u32 s3, 0
  s_cbranch_scc1 Lw073
  s_mov_b32 s96, s8
  s_and_b32 s97, s9, 0xffff
  s_mov_b32 s98, 0x1400
  s_mov_b32 s99, 0x20000
  v_lshlrev_b32 v127, 2, v0
  s_mov_b32 s76, 0
  buffer_load_dword v16, v127, s[96:99], s76 offen offset:0
  buffer_load_dword v17, v127, s[96:99], s76 offen offset:256
  buffer_load_dword v18, v127, s[96:99], s76 offen offset:512
  buffer_load_dword v19, v127, s[96:99], s76 offen offset:768
  buffer_load_dword v20, v127, s[96:99], s76 offen offset:1024
  s_mov_b32 s76, 0x500
  buffer_load_dword v21, v127, s[96:99], s76 offen offset:0
  buffer_load_dword v22, v127, s[96:99], s76 offen offset:256
  buffer_load_dword v23, v127, s[96:99], s76 offen offset:512
  buffer_load_dword v24, v127, s[96:99], s76 offen offset:768
  buffer_load_dword v25, v127, s[96:99], s76 offen offset:1024
  s_mov_b32 s76, 0xa00
  buffer_load_dword v26, v127, s[96:99], s76 offen offset:0
  buffer_load_dword v27, v127, s[96:99], s76 offen offset:256
  buffer_load_dword v28, v127, s[96:99], s76 offen offset:512
  buffer_load_dword v29, v127, s[96:99], s76 offen offset:768
  buffer_load_dword v30, v127, s[96:99], s76 offen offset:1024
  s_mov_b32 s76, 0xf00
  buffer_load_dword v31, v127, s[96:99], s76 offen offset:0
  buffer_load_dword v32, v127, s[96:99], s76 offen offset:256
  buffer_load_dword v33, v127, s[96:99], s76 offen offset:512
  buffer_load_dword v34, v127, s[96:99], s76 offen offset:768
  buffer_load_dword v35, v127, s[96:99], s76 offen offset:1024
  s_waitcnt vmcnt(0)
  v_lshlrev_b32 v40, 16, v16
  v_and_b32 v41, 0xffff0000, v16
  ds_write_b64 v12, v[40:41] offset:25600
  v_lshlrev_b32 v42, 16, v17
  v_and_b32 v43, 0xffff0000, v17
  ds_write_b64 v12, v[42:43] offset:26112
  v_lshlrev_b32 v44, 16, v18
  v_and_b32 v45, 0xffff0000, v18
  ds_write_b64 v12, v[44:45] offset:26624
  v_lshlrev_b32 v46, 16, v19
  v_and_b32 v47, 0xffff0000, v19
  ds_write_b64 v12, v[46:47] offset:27136
  v_lshlrev_b32 v48, 16, v20
  v_and_b32 v49, 0xffff0000, v20
  ds_write_b64 v12, v[48:49] offset:27648
  v_lshlrev_b32 v50, 16, v21
  v_and_b32 v51, 0xffff0000, v21
  ds_write_b64 v12, v[50:51] offset:28160
  v_lshlrev_b32 v52, 16, v22
  v_and_b32 v53, 0xffff0000, v22
  ds_write_b64 v12, v[52:53] offset:28672
  v_lshlrev_b32 v54, 16, v23
  v_and_b32 v55, 0xffff0000, v23
  ds_write_b64 v12, v[54:55] offset:29184
  v_lshlrev_b32 v56, 16, v24
  v_and_b32 v57, 0xffff0000, v24
  ds_write_b64 v12, v[56:57] offset:29696
  v_lshlrev_b32 v58, 16, v25
  v_and_b32 v59, 0xffff0000, v25
  ds_write_b64 v12, v[58:59] offset:30208
  v_lshlrev_b32 v60, 16, v26
  v_and_b32 v61, 0xffff0000, v26
  ds_write_b64 v12, v[60:61] offset:30720
  v_lshlrev_b32 v62, 16, v27
  v_and_b32 v63, 0xffff0000, v27
  ds_write_b64 v12, v[62:63] offset:31232
  v_lshlrev_b32 v64, 16, v28
  v_and_b32 v65, 0xffff0000, v28
  ds_write_b64 v12, v[64:65] offset:31744
  v_lshlrev_b32 v66, 16, v29
  v_and_b32 v67, 0xffff0000, v29
  ds_write_b64 v12, v[66:67] offset:32256
  v_lshlrev_b32 v68, 16, v30
  v_and_b32 v69, 0xffff0000, v30
  ds_write_b64 v12, v[68:69] offset:32768
  v_lshlrev_b32 v70, 16, v31
  v_and_b32 v71, 0xffff0000, v31
  ds_write_b64 v12, v[70:71] offset:33280
  s_waitcnt lgkmcnt(8)
  v_lshlrev_b32 v72, 16, v32
  v_and_b32 v73, 0xffff0000, v32
  ds_write_b64 v12, v[72:73] offset:33792
  v_lshlrev_b32 v74, 16, v33
  v_and_b32 v75, 0xffff0000, v33
  ds_write_b64 v12, v[74:75] offset:34304
  v_lshlrev_b32 v76, 16, v34
  v_and_b32 v77, 0xffff0000, v34
  ds_write_b64 v12, v[76:77] offset:34816
  v_lshlrev_b32 v78, 16, v35
  v_and_b32 v79, 0xffff0000, v35
  ds_write_b64 v12, v[78:79] offset:35328
  s_waitcnt lgkmcnt(0)
Lw073:
  s_nop 4
  s_lshl_b32 s4, s3, 9
  v_lshlrev_b32 v115, 5, v3
  v_add_u32 v115, s4, v115
  v_add_u32 v116, 5120, v115
  s_mul_i32 s4, s3, 384
  v_lshlrev_b32 v11, 5, v3
  v_add_u32 v11, s4, v11
  v_add_u32 v11, 5120, v11
  s_waitcnt lgkmcnt(0)
  s_barrier
  v_lshlrev_b32 v117, 2, v0
  v_add_u32 v117, s3, v117
  v_min_u32 v117, 25, v117
  v_mul_u32_u24 v117, 784, v117
  v_add_u32 v117, 772, v117
  s_mul_i32 s71, s2, 20384
  s_mul_i32 s72, s3, 784
  s_add_u32 s72, s72, s71
  s_mul_i32 s4, s3, 784
  s_add_u32 s4, s4, 5120
  v_add_u32 v118, s4, v13
  v_add_u32 v117, s71, v117
  s_mov_b32 s75, 0x61a80
  v_min_u32 v126, 23, v0
  v_lshlrev_b32 v126, 2, v126
  v_add_u32 v126, 128, v126
  global_load_dword v127, v126, s[28:29]
  s_waitcnt vmcnt(0)
  v_cmp_ne_u32 vcc, 0x10001, v127
  s_cbranch_vccz Lad75
Lar74:
  global_load_dword v127, v126, s[28:29] sc1
  s_waitcnt vmcnt(0)
  v_cmp_ne_u32 vcc, 0x10001, v127
  s_cbranch_vccz Lad75
  s_sleep 8
  s_sub_u32 s75, s75, 1
  s_cmp_lg_u32 s75, 0
  s_cbranch_scc1 Lar74
Lad75:
  s_nop 4
  s_mov_b32 s56, 0x14020400
  s_mov_b32 s57, 0xa4e31804
  s_mov_b32 s58, 0xb948340b
  s_mov_b32 s59, 0x44103c0c
  s_mov_b32 s78, 0
L_aloop:
  s_nop 4
  s_lshl_b32 s4, s78, 2
  s_lshr_b32 s79, 0x76532410, s4
  s_and_b32 s79, s79, 15
  s_mul_i32 s81, s79, 163840
  s_add_u32 s81, s81, 0xb33000
  s_add_u32 s82, s81, 81920
  s_and_b32 s83, s79, 3
  s_mul_i32 s84, s83, 1280
  s_mul_i32 s4, s83, 2560
  v_add_u32 v121, s4, v12
  s_lshr_b32 s85, s79, 2
  s_add_u32 s4, s4, 100352
  v_add_u32 v124, s4, v12
  s_lshl_b32 s88, s78, 6
  s_and_b32 s4, s78, 3
  s_lshl_b32 s4, s4, 4
  s_cmp_lt_u32 s78, 4
  s_cselect_b64 s[60:61], s[56:57], s[58:59]
  s_lshr_b64 s[60:61], s[60:61], s4
  s_bfe_u32 s4, s60, 0x50000
  s_mul_i32 s43, s4, 652288
  s_bfe_u32 s4, s60, 0x50005
  s_mul_i32 s44, s4, 652288
  s_bfe_u32 s4, s60, 0x5000a
  s_mul_i32 s45, s4, 652288
  s_bfe_u32 s89, s60, 0x1000f
  s_mov_b32 s75, 0x61a80
  s_mov_b32 exec_lo, 0x7f
  s_mov_b32 exec_hi, 0
Lpi76:
  buffer_load_dword v127, v117, s[64:67], s45 offen sc1
  s_waitcnt vmcnt(0)
  v_cmp_ne_u32 vcc, -1, v127
  s_cbranch_vccnz Lpd77
  s_sleep 3
  s_sub_u32 s75, s75, 1
  s_cmp_lg_u32 s75, 0
  s_cbranch_scc1 Lpi76
Lpd77:
  s_mov_b64 exec, -1
  v_mov_b32 v40, 0xf149f2ca
  v_mov_b32 v41, 0
  v_mov_b32 v42, 0
  v_mov_b32 v43, 0
  v_mov_b32 v44, 0xf149f2ca
  v_mov_b32 v45, 0
  v_mov_b32 v46, 0
  v_mov_b32 v47, 0
  v_mov_b32 v48, 0xf149f2ca
  v_mov_b32 v49, 0
  v_mov_b32 v50, 0
  v_mov_b32 v51, 0
  v_mov_b32 v52, 0xf149f2ca
  v_mov_b32 v53, 0
  v_mov_b32 v54, 0
  v_mov_b32 v55, 0
  v_mov_b32 v56, 0xf149f2ca
  v_mov_b32 v57, 0
  v_mov_b32 v58, 0
  v_mov_b32 v59, 0
  v_mov_b32 v60, 0xf149f2ca
  v_mov_b32 v61, 0
  v_mov_b32 v62, 0
  v_mov_b32 v63, 0
  v_mov_b32 v64, 0xf149f2ca
  v_mov_b32 v65, 0
  v_mov_b32 v66, 0
  v_mov_b32 v67, 0
  v_mov_b32 v68, 0xf149f2ca
  v_mov_b32 v69, 0
  v_mov_b32 v70, 0
  v_mov_b32 v71, 0
  v_mov_b32 v96, 0xf149f2ca
  v_mov_b32 v97, 0
  v_mov_b32 v98, 0
  v_mov_b32 v99, 0
  s_mov_b32 exec_lo, -1
  s_mov_b32 exec_hi, 0x1ffff
  s_cmp_ge_u32 s3, 2
  s_mov_b32 s91, 0x1fffff
  s_cselect_b32 s91, 0xfdfbf, s91
  s_cmp_eq_u32 s89, 0
  s_cselect_b32 s4, 0x3f80, 0
  s_andn2_b32 s91, s91, s4
  s_mov_b32 s75, 0x61a80
Lgs78:
  s_bitcmp1_b32 s91, 0
  s_cbranch_scc0 Lgk80
  s_add_u32 s76, s72, s43
  s_add_u32 s76, s76, 0
  buffer_load_dwordx4 v[16:19], v13, s[64:67], s76 offen sc1
Lgk80:
  s_bitcmp1_b32 s91, 1
  s_cbranch_scc0 Lgk81
  s_add_u32 s76, s72, s43
  s_add_u32 s76, s76, 3136
  buffer_load_dwordx4 v[20:23], v13, s[64:67], s76 offen sc1
Lgk81:
  s_bitcmp1_b32 s91, 2
  s_cbranch_scc0 Lgk82
  s_add_u32 s76, s72, s43
  s_add_u32 s76, s76, 6272
  buffer_load_dwordx4 v[24:27], v13, s[64:67], s76 offen sc1
Lgk82:
  s_bitcmp1_b32 s91, 3
  s_cbranch_scc0 Lgk83
  s_add_u32 s76, s72, s43
  s_add_u32 s76, s76, 9408
  buffer_load_dwordx4 v[28:31], v13, s[64:67], s76 offen sc1
Lgk83:
  s_bitcmp1_b32 s91, 4
  s_cbranch_scc0 Lgk84
  s_add_u32 s76, s72, s43
  s_add_u32 s76, s76, 12544
  buffer_load_dwordx4 v[32:35], v13, s[64:67], s76 offen sc1
Lgk84:
  s_bitcmp1_b32 s91, 5
  s_cbranch_scc0 Lgk85
  s_add_u32 s76, s72, s43
  s_add_u32 s76, s76, 15680
  buffer_load_dwordx4 v[36:39], v13, s[64:67], s76 offen sc1
Lgk85:
  s_bitcmp1_b32 s91, 6
  s_cbranch_scc0 Lgk86
  s_add_u32 s76, s72, s43
  s_add_u32 s76, s76, 18816
  buffer_load_dwordx4 v[40:43], v13, s[64:67], s76 offen sc1
Lgk86:
  s_bitcmp1_b32 s91, 7
  s_cbranch_scc0 Lgk87
  s_add_u32 s76, s72, s44
  s_add_u32 s76, s76, 0
  buffer_load_dwordx4 v[44:47], v13, s[64:67], s76 offen sc1
Lgk87:
  s_bitcmp1_b32 s91, 8
  s_cbranch_scc0 Lgk88
  s_add_u32 s76, s72, s44
  s_add_u32 s76, s76, 3136
  buffer_load_dwordx4 v[48:51], v13, s[64:67], s76 offen sc1
Lgk88:
  s_bitcmp1_b32 s91, 9
  s_cbranch_scc0 Lgk89
  s_add_u32 s76, s72, s44
  s_add_u32 s76, s76, 6272
  buffer_load_dwordx4 v[52:55], v13, s[64:67], s76 offen sc1
Lgk89:
  s_bitcmp1_b32 s91, 10
  s_cbranch_scc0 Lgk90
  s_add_u32 s76, s72, s44
  s_add_u32 s76, s76, 9408
  buffer_load_dwordx4 v[56:59], v13, s[64:67], s76 offen sc1
Lgk90:
  s_bitcmp1_b32 s91, 11
  s_cbranch_scc0 Lgk91
  s_add_u32 s76, s72, s44
  s_add_u32 s76, s76, 12544
  buffer_load_dwordx4 v[60:63], v13, s[64:67], s76 offen sc1
Lgk91:
  s_bitcmp1_b32 s91, 12
  s_cbranch_scc0 Lgk92
  s_add_u32 s76, s72, s44
  s_add_u32 s76, s76, 15680
  buffer_load_dwordx4 v[64:67], v13, s[64:67], s76 offen sc1
Lgk92:
  s_bitcmp1_b32 s91, 13
  s_cbranch_scc0 Lgk93
  s_add_u32 s76, s72, s44
  s_add_u32 s76, s76, 18816
  buffer_load_dwordx4 v[68:71], v13, s[64:67], s76 offen sc1
Lgk93:
  s_bitcmp1_b32 s91, 14
  s_cbranch_scc0 Lgk94
  s_add_u32 s76, s72, s45
  s_add_u32 s76, s76, 0
  buffer_load_dwordx4 v[72:75], v13, s[64:67], s76 offen sc1
Lgk94:
  s_bitcmp1_b32 s91, 15
  s_cbranch_scc0 Lgk95
  s_add_u32 s76, s72, s45
  s_add_u32 s76, s76, 3136
  buffer_load_dwordx4 v[76:79], v13, s[64:67], s76 offen sc1
Lgk95:
  s_bitcmp1_b32 s91, 16
  s_cbranch_scc0 Lgk96
  s_add_u32 s76, s72, s45
  s_add_u32 s76, s76, 6272
  buffer_load_dwordx4 v[80:83], v13, s[64:67], s76 offen sc1
Lgk96:
  s_bitcmp1_b32 s91, 17
  s_cbranch_scc0 Lgk97
  s_add_u32 s76, s72, s45
  s_add_u32 s76, s76, 9408
  buffer_load_dwordx4 v[84:87], v13, s[64:67], s76 offen sc1
Lgk97:
  s_bitcmp1_b32 s91, 18
  s_cbranch_scc0 Lgk98
  s_add_u32 s76, s72, s45
  s_add_u32 s76, s76, 12544
  buffer_load_dwordx4 v[88:91], v13, s[64:67], s76 offen sc1
Lgk98:
  s_bitcmp1_b32 s91, 19
  s_cbranch_scc0 Lgk99
  s_add_u32 s76, s72, s45
  s_add_u32 s76, s76, 15680
  buffer_load_dwordx4 v[92:95], v13, s[64:67], s76 offen sc1
Lgk99:
  s_bitcmp1_b32 s91, 20
  s_cbranch_scc0 Lgk100
  s_add_u32 s76, s72, s45
  s_add_u32 s76, s76, 18816
  buffer_load_dwordx4 v[96:99], v13, s[64:67], s76 offen sc1
Lgk100:
  s_waitcnt vmcnt(0)
  s_bitcmp1_b32 s91, 0
  s_cbranch_scc0 Lgc101
  v_max3_u32 v127, v16, v17, v18
  v_max_u32 v127, v127, v19
  v_cmp_eq_u32 vcc, -1, v127
  s_cbranch_vccnz Lgc101
  s_bitset0_b32 s91, 0
Lgc101:
  s_bitcmp1_b32 s91, 1
  s_cbranch_scc0 Lgc102
  v_max3_u32 v127, v20, v21, v22
  v_max_u32 v127, v127, v23
  v_cmp_eq_u32 vcc, -1, v127
  s_cbranch_vccnz Lgc102
  s_bitset0_b32 s91, 1
Lgc102:
  s_bitcmp1_b32 s91, 2
  s_cbranch_scc0 Lgc103
  v_max3_u32 v127, v24, v25, v26
  v_max_u32 v127, v127, v27
  v_cmp_eq_u32 vcc, -1, v127
  s_cbranch_vccnz Lgc103
  s_bitset0_b32 s91, 2
Lgc103:
  s_bitcmp1_b32 s91, 3
  s_cbranch_scc0 Lgc104
  v_max3_u32 v127, v28, v29, v30
  v_max_u32 v127, v127, v31
  v_cmp_eq_u32 vcc, -1, v127
  s_cbranch_vccnz Lgc104
  s_bitset0_b32 s91, 3
Lgc104:
  s_bitcmp1_b32 s91, 4
  s_cbranch_scc0 Lgc105
  v_max3_u32 v127, v32, v33, v34
  v_max_u32 v127, v127, v35
  v_cmp_eq_u32 vcc, -1, v127
  s_cbranch_vccnz Lgc105
  s_bitset0_b32 s91, 4
Lgc105:
  s_bitcmp1_b32 s91, 5
  s_cbranch_scc0 Lgc106
  v_max3_u32 v127, v36, v37, v38
  v_max_u32 v127, v127, v39
  v_cmp_eq_u32 vcc, -1, v127
  s_cbranch_vccnz Lgc106
  s_bitset0_b32 s91, 5
Lgc106:
  s_bitcmp1_b32 s91, 6
  s_cbranch_scc0 Lgc107
  v_max3_u32 v127, v40, v41, v42
  v_max_u32 v127, v127, v43
  v_cmp_eq_u32 vcc, -1, v127
  s_cbranch_vccnz Lgc107
  s_bitset0_b32 s91, 6
Lgc107:
  s_bitcmp1_b32 s91, 7
  s_cbranch_scc0 Lgc108
  v_max3_u32 v127, v44, v45, v46
  v_max_u32 v127, v127, v47
  v_cmp_eq_u32 vcc, -1, v127
  s_cbranch_vccnz Lgc108
  s_bitset0_b32 s91, 7
Lgc108:
  s_bitcmp1_b32 s91, 8
  s_cbranch_scc0 Lgc109
  v_max3_u32 v127, v48, v49, v50
  v_max_u32 v127, v127, v51
  v_cmp_eq_u32 vcc, -1, v127
  s_cbranch_vccnz Lgc109
  s_bitset0_b32 s91, 8
Lgc109:
  s_bitcmp1_b32 s91, 9
  s_cbranch_scc0 Lgc110
  v_max3_u32 v127, v52, v53, v54
  v_max_u32 v127, v127, v55
  v_cmp_eq_u32 vcc, -1, v127
  s_cbranch_vccnz Lgc110
  s_bitset0_b32 s91, 9
Lgc110:
  s_bitcmp1_b32 s91, 10
  s_cbranch_scc0 Lgc111
  v_max3_u32 v127, v56, v57, v58
  v_max_u32 v127, v127, v59
  v_cmp_eq_u32 vcc, -1, v127
  s_cbranch_vccnz Lgc111
  s_bitset0_b32 s91, 10
Lgc111:
  s_bitcmp1_b32 s91, 11
  s_cbranch_scc0 Lgc112
  v_max3_u32 v127, v60, v61, v62
  v_max_u32 v127, v127, v63
  v_cmp_eq_u32 vcc, -1, v127
  s_cbranch_vccnz Lgc112
  s_bitset0_b32 s91, 11
Lgc112:
  s_bitcmp1_b32 s91, 12
  s_cbranch_scc0 Lgc113
  v_max3_u32 v127, v64, v65, v66
  v_max_u32 v127, v127, v67
  v_cmp_eq_u32 vcc, -1, v127
  s_cbranch_vccnz Lgc113
  s_bitset0_b32 s91, 12
Lgc113:
  s_bitcmp1_b32 s91, 13
  s_cbranch_scc0 Lgc114
  v_max3_u32 v127, v68, v69, v70
  v_max_u32 v127, v127, v71
  v_cmp_eq_u32 vcc, -1, v127
  s_cbranch_vccnz Lgc114
  s_bitset0_b32 s91, 13
Lgc114:
  s_bitcmp1_b32 s91, 14
  s_cbranch_scc0 Lgc115
  v_max3_u32 v127, v72, v73, v74
  v_max_u32 v127, v127, v75
  v_cmp_eq_u32 vcc, -1, v127
  s_cbranch_vccnz Lgc115
  s_bitset0_b32 s91, 14
Lgc115:
  s_bitcmp1_b32 s91, 15
  s_cbranch_scc0 Lgc116
  v_max3_u32 v127, v76, v77, v78
  v_max_u32 v127, v127, v79
  v_cmp_eq_u32 vcc, -1, v127
  s_cbranch_vccnz Lgc116
  s_bitset0_b32 s91, 15
Lgc116:
  s_bitcmp1_b32 s91, 16
  s_cbranch_scc0 Lgc117
  v_max3_u32 v127, v80, v81, v82
  v_max_u32 v127, v127, v83
  v_cmp_eq_u32 vcc, -1, v127
  s_cbranch_vccnz Lgc117
  s_bitset0_b32 s91, 16
Lgc117:
  s_bitcmp1_b32 s91, 17
  s_cbranch_scc0 Lgc118
  v_max3_u32 v127, v84, v85, v86
  v_max_u32 v127, v127, v87
  v_cmp_eq_u32 vcc, -1, v127
  s_cbranch_vccnz Lgc118
  s_bitset0_b32 s91, 17
Lgc118:
  s_bitcmp1_b32 s91, 18
  s_cbranch_scc0 Lgc119
  v_max3_u32 v127, v88, v89, v90
  v_max_u32 v127, v127, v91
  v_cmp_eq_u32 vcc, -1, v127
  s_cbranch_vccnz Lgc119
  s_bitset0_b32 s91, 18
Lgc119:
  s_bitcmp1_b32 s91, 19
  s_cbranch_scc0 Lgc120
  v_max3_u32 v127, v92, v93, v94
  v_max_u32 v127, v127, v95
  v_cmp_eq_u32 vcc, -1, v127
  s_cbranch_vccnz Lgc120
  s_bitset0_b32 s91, 19
Lgc120:
  s_bitcmp1_b32 s91, 20
  s_cbranch_scc0 Lgc121
  v_max3_u32 v127, v96, v97, v98
  v_max_u32 v127, v127, v99
  v_cmp_eq_u32 vcc, -1, v127
  s_cbranch_vccnz Lgc121
  s_bitset0_b32 s91, 20
Lgc121:
  s_cmp_eq_u32 s91, 0
  s_cbranch_scc1 Lgsd79
  s_sub_u32 s75, s75, 1
  s_cmp_lg_u32 s75, 0
  s_cbranch_scc1 Lgs78
Lgsd79:
  s_nop 4
  s_mov_b64 exec, -1
  v_readlane_b32 s40, v16, 48
  v_readlane_b32 s41, v20, 48
  s_nop 0
  v_mov_b32 v100, s40
  v_readlane_b32 s40, v24, 48
  v_max_f32 v100, s41, v100
  v_readlane_b32 s41, v28, 48
  v_max_f32 v100, s40, v100
  v_readlane_b32 s40, v32, 48
  v_max_f32 v100, s41, v100
  v_readlane_b32 s41, v36, 48
  v_max_f32 v100, s40, v100
  v_readlane_b32 s40, v40, 48
  v_max_f32 v100, s41, v100
  v_readlane_b32 s41, v44, 48
  v_max_f32 v100, s40, v100
  v_readlane_b32 s40, v48, 48
  v_max_f32 v100, s41, v100
  v_readlane_b32 s41, v52, 48
  v_max_f32 v100, s40, v100
  v_readlane_b32 s40, v56, 48
  v_max_f32 v100, s41, v100
  v_readlane_b32 s41, v60, 48
  v_max_f32 v100, s40, v100
  v_readlane_b32 s40, v64, 48
  v_max_f32 v100, s41, v100
  v_readlane_b32 s41, v68, 48
  v_max_f32 v100, s40, v100
  v_readlane_b32 s40, v72, 48
  v_max_f32 v100, s41, v100
  v_readlane_b32 s41, v76, 48
  v_max_f32 v100, s40, v100
  v_readlane_b32 s40, v80, 48
  v_max_f32 v100, s41, v100
  v_readlane_b32 s41, v84, 48
  v_max_f32 v100, s40, v100
  v_readlane_b32 s40, v88, 48
  v_max_f32 v100, s41, v100
  v_readlane_b32 s41, v92, 48
  v_max_f32 v100, s40, v100
  v_readlane_b32 s40, v96, 48
  v_max_f32 v100, s41, v100
  s_nop 0
  v_max_f32 v100, s40, v100
  v_mov_b32 v101, 0
  v_mov_b32 v104, 0
  v_mov_b32 v105, 0
  v_mov_b32 v106, 0
  v_mov_b32 v107, 0
  v_readlane_b32 s40, v16, 48
  v_readlane_b32 s41, v17, 48
  v_readlane_b32 s42, v20, 48
  v_readlane_b32 s43, v21, 48
  v_sub_f32 v102, s40, v100
  v_exp_f32 v102, v102
  s_nop 0
  v_fma_f32 v101, v102, s41, v101
  v_fma_f32 v104, v102, v16, v104
  v_fma_f32 v105, v102, v17, v105
  v_fma_f32 v106, v102, v18, v106
  v_fma_f32 v107, v102, v19, v107
  v_readlane_b32 s40, v24, 48
  v_readlane_b32 s41, v25, 48
  v_sub_f32 v103, s42, v100
  v_exp_f32 v103, v103
  s_nop 0
  v_fma_f32 v101, v103, s43, v101
  v_fma_f32 v104, v103, v20, v104
  v_fma_f32 v105, v103, v21, v105
  v_fma_f32 v106, v103, v22, v106
  v_fma_f32 v107, v103, v23, v107
  v_readlane_b32 s42, v28, 48
  v_readlane_b32 s43, v29, 48
  v_sub_f32 v102, s40, v100
  v_exp_f32 v102, v102
  s_nop 0
  v_fma_f32 v101, v102, s41, v101
  v_fma_f32 v104, v102, v24, v104
  v_fma_f32 v105, v102, v25, v105
  v_fma_f32 v106, v102, v26, v106
  v_fma_f32 v107, v102, v27, v107
  v_readlane_b32 s40, v32, 48
  v_readlane_b32 s41, v33, 48
  v_sub_f32 v103, s42, v100
  v_exp_f32 v103, v103
  s_nop 0
  v_fma_f32 v101, v103, s43, v101
  v_fma_f32 v104, v103, v28, v104
  v_fma_f32 v105, v103, v29, v105
  v_fma_f32 v106, v103, v30, v106
  v_fma_f32 v107, v103, v31, v107
  v_readlane_b32 s42, v36, 48
  v_readlane_b32 s43, v37, 48
  v_sub_f32 v102, s40, v100
  v_exp_f32 v102, v102
  s_nop 0
  v_fma_f32 v101, v102, s41, v101
  v_fma_f32 v104, v102, v32, v104
  v_fma_f32 v105, v102, v33, v105
  v_fma_f32 v106, v102, v34, v106
  v_fma_f32 v107, v102, v35, v107
  v_readlane_b32 s40, v40, 48
  v_readlane_b32 s41, v41, 48
  v_sub_f32 v103, s42, v100
  v_exp_f32 v103, v103
  s_nop 0
  v_fma_f32 v101, v103, s43, v101
  v_fma_f32 v104, v103, v36, v104
  v_fma_f32 v105, v103, v37, v105
  v_fma_f32 v106, v103, v38, v106
  v_fma_f32 v107, v103, v39, v107
  v_readlane_b32 s42, v44, 48
  v_readlane_b32 s43, v45, 48
  v_sub_f32 v102, s40, v100
  v_exp_f32 v102, v102
  s_nop 0
  v_fma_f32 v101, v102, s41, v101
  v_fma_f32 v104, v102, v40, v104
  v_fma_f32 v105, v102, v41, v105
  v_fma_f32 v106, v102, v42, v106
  v_fma_f32 v107, v102, v43, v107
  v_readlane_b32 s40, v48, 48
  v_readlane_b32 s41, v49, 48
  v_sub_f32 v103, s42, v100
  v_exp_f32 v103, v103
  s_nop 0
  v_fma_f32 v101, v103, s43, v101
  v_fma_f32 v104, v103, v44, v104
  v_fma_f32 v105, v103, v45, v105
  v_fma_f32 v106, v103, v46, v106
  v_fma_f32 v107, v103, v47, v107
  v_readlane_b32 s42, v52, 48
  v_readlane_b32 s43, v53, 48
  v_sub_f32 v102, s40, v100
  v_exp_f32 v102, v102
  s_nop 0
  v_fma_f32 v101, v102, s41, v101
  v_fma_f32 v104, v102, v48, v104
  v_fma_f32 v105, v102, v49, v105
  v_fma_f32 v106, v102, v50, v106
  v_fma_f32 v107, v102, v51, v107
  v_readlane_b32 s40, v56, 48
  v_readlane_b32 s41, v57, 48
  v_sub_f32 v103, s42, v100
  v_exp_f32 v103, v103
  s_nop 0
  v_fma_f32 v101, v103, s43, v101
  v_fma_f32 v104, v103, v52, v104
  v_fma_f32 v105, v103, v53, v105
  v_fma_f32 v106, v103, v54, v106
  v_fma_f32 v107, v103, v55, v107
  v_readlane_b32 s42, v60, 48
  v_readlane_b32 s43, v61, 48
  v_sub_f32 v102, s40, v100
  v_exp_f32 v102, v102
  s_nop 0
  v_fma_f32 v101, v102, s41, v101
  v_fma_f32 v104, v102, v56, v104
  v_fma_f32 v105, v102, v57, v105
  v_fma_f32 v106, v102, v58, v106
  v_fma_f32 v107, v102, v59, v107
  v_readlane_b32 s40, v64, 48
  v_readlane_b32 s41, v65, 48
  v_sub_f32 v103, s42, v100
  v_exp_f32 v103, v103
  s_nop 0
  v_fma_f32 v101, v103, s43, v101
  v_fma_f32 v104, v103, v60, v104
  v_fma_f32 v105, v103, v61, v105
  v_fma_f32 v106, v103, v62, v106
  v_fma_f32 v107, v103, v63, v107
  v_readlane_b32 s42, v68, 48
  v_readlane_b32 s43, v69, 48
  v_sub_f32 v102, s40, v100
  v_exp_f32 v102, v102
  s_nop 0
  v_fma_f32 v101, v102, s41, v101
  v_fma_f32 v104, v102, v64, v104
  v_fma_f32 v105, v102, v65, v105
  v_fma_f32 v106, v102, v66, v106
  v_fma_f32 v107, v102, v67, v107
  v_readlane_b32 s40, v72, 48
  v_readlane_b32 s41, v73, 48
  v_sub_f32 v103, s42, v100
  v_exp_f32 v103, v103
  s_nop 0
  v_fma_f32 v101, v103, s43, v101
  v_fma_f32 v104, v103, v68, v104
  v_fma_f32 v105, v103, v69, v105
  v_fma_f32 v106, v103, v70, v106
  v_fma_f32 v107, v103, v71, v107
  v_readlane_b32 s42, v76, 48
  v_readlane_b32 s43, v77, 48
  v_sub_f32 v102, s40, v100
  v_exp_f32 v102, v102
  s_nop 0
  v_fma_f32 v101, v102, s41, v101
  v_fma_f32 v104, v102, v72, v104
  v_fma_f32 v105, v102, v73, v105
  v_fma_f32 v106, v102, v74, v106
  v_fma_f32 v107, v102, v75, v107
  v_readlane_b32 s40, v80, 48
  v_readlane_b32 s41, v81, 48
  v_sub_f32 v103, s42, v100
  v_exp_f32 v103, v103
  s_nop 0
  v_fma_f32 v101, v103, s43, v101
  v_fma_f32 v104, v103, v76, v104
  v_fma_f32 v105, v103, v77, v105
  v_fma_f32 v106, v103, v78, v106
  v_fma_f32 v107, v103, v79, v107
  v_readlane_b32 s42, v84, 48
  v_readlane_b32 s43, v85, 48
  v_sub_f32 v102, s40, v100
  v_exp_f32 v102, v102
  s_nop 0
  v_fma_f32 v101, v102, s41, v101
  v_fma_f32 v104, v102, v80, v104
  v_fma_f32 v105, v102, v81, v105
  v_fma_f32 v106, v102, v82, v106
  v_fma_f32 v107, v102, v83, v107
  v_readlane_b32 s40, v88, 48
  v_readlane_b32 s41, v89, 48
  v_sub_f32 v103, s42, v100
  v_exp_f32 v103, v103
  s_nop 0
  v_fma_f32 v101, v103, s43, v101
  v_fma_f32 v104, v103, v84, v104
  v_fma_f32 v105, v103, v85, v105
  v_fma_f32 v106, v103, v86, v106
  v_fma_f32 v107, v103, v87, v107
  v_readlane_b32 s42, v92, 48
  v_readlane_b32 s43, v93, 48
  v_sub_f32 v102, s40, v100
  v_exp_f32 v102, v102
  s_nop 0
  v_fma_f32 v101, v102, s41, v101
  v_fma_f32 v104, v102, v88, v104
  v_fma_f32 v105, v102, v89, v105
  v_fma_f32 v106, v102, v90, v106
  v_fma_f32 v107, v102, v91, v107
  v_readlane_b32 s40, v96, 48
  v_readlane_b32 s41, v97, 48
  v_sub_f32 v103, s42, v100
  v_exp_f32 v103, v103
  s_nop 0
  v_fma_f32 v101, v103, s43, v101
  v_fma_f32 v104, v103, v92, v104
  v_fma_f32 v105, v103, v93, v105
  v_fma_f32 v106, v103, v94, v106
  v_fma_f32 v107, v103, v95, v107
  v_sub_f32 v102, s40, v100
  v_exp_f32 v102, v102
  s_nop 0
  v_fma_f32 v101, v102, s41, v101
  v_fma_f32 v104, v102, v96, v104
  v_fma_f32 v105, v102, v97, v105
  v_fma_f32 v106, v102, v98, v106
  v_fma_f32 v107, v102, v99, v107
  s_mov_b32 exec_lo, 0
  s_mov_b32 exec_hi, 0x10000
  v_mov_b32 v104, v100
  v_mov_b32 v105, v101
  s_mov_b64 exec, -1
  v_mov_b32 v52, v104
  v_mov_b32 v53, v105
  v_mov_b32 v54, v106
  v_mov_b32 v55, v107
  s_mov_b32 exec_lo, -1
  s_mov_b32 exec_hi, 0x1ffff
  ds_write_b128 v118, v[52:55]
  s_mov_b64 exec, -1
  s_waitcnt lgkmcnt(0)
  s_barrier
  s_cmp_lg_u32 s3, 0
  s_cbranch_scc1 Lw0122
  ds_read_b128 v[16:19], v13 offset:5120
  ds_read_b128 v[20:23], v13 offset:5904
  ds_read_b128 v[24:27], v13 offset:6688
  ds_read_b128 v[28:31], v13 offset:7472
  s_waitcnt lgkmcnt(0)
  v_readlane_b32 s40, v16, 48
  v_readlane_b32 s48, v17, 48
  v_readlane_b32 s41, v20, 48
  v_readlane_b32 s49, v21, 48
  v_readlane_b32 s42, v24, 48
  v_readlane_b32 s50, v25, 48
  v_readlane_b32 s43, v28, 48
  v_readlane_b32 s51, v29, 48
  v_mov_b32 v48, s40
  v_max_f32 v48, s41, v48
  v_max_f32 v48, s42, v48
  v_max_f32 v48, s43, v48
  v_sub_f32 v100, s40, v48
  v_sub_f32 v101, s41, v48
  v_sub_f32 v102, s42, v48
  v_sub_f32 v103, s43, v48
  v_exp_f32 v100, v100
  v_exp_f32 v101, v101
  v_exp_f32 v102, v102
  v_exp_f32 v103, v103
  v_mul_f32 v49, s48, v100
  v_fma_f32 v49, v101, s49, v49
  v_fma_f32 v49, v102, s50, v49
  v_fma_f32 v49, v103, s51, v49
  v_mul_f32 v52, v100, v16
  v_mul_f32 v53, v100, v17
  v_mul_f32 v54, v100, v18
  v_mul_f32 v55, v100, v19
  v_fma_f32 v52, v101, v20, v52
  v_fma_f32 v53, v101, v21, v53
  v_fma_f32 v54, v101, v22, v54
  v_fma_f32 v55, v101, v23, v55
  v_fma_f32 v52, v102, v24, v52
  v_fma_f32 v53, v102, v25, v53
  v_fma_f32 v54, v102, v26, v54
  v_fma_f32 v55, v102, v27, v55
  v_fma_f32 v52, v103, v28, v52
  v_fma_f32 v53, v103, v29, v53
  v_fma_f32 v54, v103, v30, v54
  v_fma_f32 v55, v103, v31, v55
  v_rcp_f32 v50, v49
  s_nop 0
  v_mul_f32 v52, v52, v50
  v_mul_f32 v53, v53, v50
  v_mul_f32 v54, v54, v50
  v_mul_f32 v55, v55, v50
  v_cvt_pk_bf16_f32 v56, v52, v53
  v_cvt_pk_bf16_f32 v57, v54, v55
  s_mov_b32 exec_lo, 0
  s_mov_b32 exec_hi, 0xffff0000
  v_mov_b32 v56, 0
  v_mov_b32 v57, 0
  s_mov_b64 exec, -1
  ds_write_b64 v12, v[56:57] offset:0
  s_waitcnt lgkmcnt(0)
Lw0122:
  s_nop 4
  s_waitcnt lgkmcnt(0)
  s_barrier
  ds_read_b128 v[80:83], v112 offset:0
  ds_read_b128 v[84:87], v112 offset:64
  ds_read_b128 v[88:91], v112 offset:128
  ds_read_b128 v[92:95], v112 offset:192
  ds_read_b128 v[96:99], v112 offset:256
  ds_read_b128 v[100:103], v112 offset:320
  ds_read_b128 v[104:107], v113 offset:0
  ds_read_b128 v[108:111], v113 offset:256
  s_waitcnt lgkmcnt(0)
  v_mfma_f32_16x16x32_bf16 v[48:51], v[104:107], a[192:195], 0
  v_mfma_f32_16x16x32_bf16 v[52:55], v[104:107], a[196:199], 0
  v_mfma_f32_16x16x32_bf16 v[56:59], v[104:107], a[200:203], 0
  v_mfma_f32_16x16x32_bf16 v[60:63], v[104:107], a[204:207], 0
  v_mfma_f32_16x16x32_bf16 v[64:67], v[104:107], a[208:211], 0
  v_mfma_f32_16x16x32_bf16 v[68:71], v[104:107], a[212:215], 0
  v_mfma_f32_16x16x32_bf16 v[72:75], v[104:107], a[216:219], 0
  v_mfma_f32_16x16x32_bf16 v[76:79], v[104:107], a[220:223], 0
  v_mfma_f32_16x16x32_bf16 v[48:51], v[108:111], a[224:227], v[48:51]
  v_mfma_f32_16x16x32_bf16 v[52:55], v[108:111], a[228:231], v[52:55]
  v_mfma_f32_16x16x32_bf16 v[56:59], v[108:111], a[232:235], v[56:59]
  v_mfma_f32_16x16x32_bf16 v[60:63], v[108:111], a[236:239], v[60:63]
  v_mfma_f32_16x16x32_bf16 v[64:67], v[108:111], a[240:243], v[64:67]
  v_mfma_f32_16x16x32_bf16 v[68:71], v[108:111], a[244:247], v[68:71]
  v_mfma_f32_16x16x32_bf16 v[72:75], v[108:111], a[248:251], v[72:75]
  v_mfma_f32_16x16x32_bf16 v[76:79], v[108:111], a[252:255], v[76:79]
  v_mfma_f32_16x16x32_bf16 v[16:19], v[80:83], a[0:3], 0
  v_mfma_f32_16x16x32_bf16 v[20:23], v[80:83], a[4:7], 0
  v_mfma_f32_16x16x32_bf16 v[24:27], v[80:83], a[8:11], 0
  v_mfma_f32_16x16x32_bf16 v[28:31], v[80:83], a[12:15], 0
  v_mfma_f32_16x16x32_bf16 v[32:35], v[80:83], a[16:19], 0
  v_mfma_f32_16x16x32_bf16 v[36:39], v[80:83], a[20:23], 0
  v_mfma_f32_16x16x32_bf16 v[40:43], v[80:83], a[24:27], 0
  v_mfma_f32_16x16x32_bf16 v[44:47], v[80:83], a[28:31], 0
  v_mfma_f32_16x16x32_bf16 v[16:19], v[84:87], a[32:35], v[16:19]
  v_mfma_f32_16x16x32_bf16 v[20:23], v[84:87], a[36:39], v[20:23]
  v_mfma_f32_16x16x32_bf16 v[24:27], v[84:87], a[40:43], v[24:27]
  v_mfma_f32_16x16x32_bf16 v[28:31], v[84:87], a[44:47], v[28:31]
  v_mfma_f32_16x16x32_bf16 v[32:35], v[84:87], a[48:51], v[32:35]
  v_mfma_f32_16x16x32_bf16 v[36:39], v[84:87], a[52:55], v[36:39]
  v_mfma_f32_16x16x32_bf16 v[40:43], v[84:87], a[56:59], v[40:43]
  v_mfma_f32_16x16x32_bf16 v[44:47], v[84:87], a[60:63], v[44:47]
  v_mfma_f32_16x16x32_bf16 v[16:19], v[88:91], a[64:67], v[16:19]
  v_mfma_f32_16x16x32_bf16 v[20:23], v[88:91], a[68:71], v[20:23]
  v_mfma_f32_16x16x32_bf16 v[24:27], v[88:91], a[72:75], v[24:27]
  v_mfma_f32_16x16x32_bf16 v[28:31], v[88:91], a[76:79], v[28:31]
  v_mfma_f32_16x16x32_bf16 v[32:35], v[88:91], a[80:83], v[32:35]
  v_mfma_f32_16x16x32_bf16 v[36:39], v[88:91], a[84:87], v[36:39]
  v_mfma_f32_16x16x32_bf16 v[40:43], v[88:91], a[88:91], v[40:43]
  v_mfma_f32_16x16x32_bf16 v[44:47], v[88:91], a[92:95], v[44:47]
  v_mfma_f32_16x16x32_bf16 v[16:19], v[92:95], a[96:99], v[16:19]
  v_mfma_f32_16x16x32_bf16 v[20:23], v[92:95], a[100:103], v[20:23]
  v_mfma_f32_16x16x32_bf16 v[24:27], v[92:95], a[104:107], v[24:27]
  v_mfma_f32_16x16x32_bf16 v[28:31], v[92:95], a[108:111], v[28:31]
  v_mfma_f32_16x16x32_bf16 v[32:35], v[92:95], a[112:115], v[32:35]
  v_mfma_f32_16x16x32_bf16 v[36:39], v[92:95], a[116:119], v[36:39]
  v_mfma_f32_16x16x32_bf16 v[40:43], v[92:95], a[120:123], v[40:43]
  v_mfma_f32_16x16x32_bf16 v[44:47], v[92:95], a[124:127], v[44:47]
  v_mfma_f32_16x16x32_bf16 v[16:19], v[96:99], a[128:131], v[16:19]
  v_mfma_f32_16x16x32_bf16 v[20:23], v[96:99], a[132:135], v[20:23]
  v_mfma_f32_16x16x32_bf16 v[24:27], v[96:99], a[136:139], v[24:27]
  v_mfma_f32_16x16x32_bf16 v[28:31], v[96:99], a[140:143], v[28:31]
  v_mfma_f32_16x16x32_bf16 v[32:35], v[96:99], a[144:147], v[32:35]
  v_mfma_f32_16x16x32_bf16 v[36:39], v[96:99], a[148:151], v[36:39]
  v_mfma_f32_16x16x32_bf16 v[40:43], v[96:99], a[152:155], v[40:43]
  v_mfma_f32_16x16x32_bf16 v[44:47], v[96:99], a[156:159], v[44:47]
  v_mfma_f32_16x16x32_bf16 v[16:19], v[100:103], a[160:163], v[16:19]
  v_mfma_f32_16x16x32_bf16 v[20:23], v[100:103], a[164:167], v[20:23]
  v_mfma_f32_16x16x32_bf16 v[24:27], v[100:103], a[168:171], v[24:27]
  v_mfma_f32_16x16x32_bf16 v[28:31], v[100:103], a[172:175], v[28:31]
  v_mfma_f32_16x16x32_bf16 v[32:35], v[100:103], a[176:179], v[32:35]
  v_mfma_f32_16x16x32_bf16 v[36:39], v[100:103], a[180:183], v[36:39]
  v_mfma_f32_16x16x32_bf16 v[40:43], v[100:103], a[184:187], v[40:43]
  v_mfma_f32_16x16x32_bf16 v[44:47], v[100:103], a[188:191], v[44:47]
  v_mov_b32 v100, v48
  v_mov_b32 v101, v52
  v_mov_b32 v102, v56
  v_mov_b32 v103, v60
  v_mov_b32 v104, v64
  v_mov_b32 v105, v68
  v_mov_b32 v106, v72
  v_mov_b32 v107, v76
  v_mov_b32 v92, v16
  v_mov_b32 v93, v20
  v_mov_b32 v94, v24
  v_mov_b32 v95, v28
  v_mov_b32 v96, v32
  v_mov_b32 v97, v36
  v_mov_b32 v98, v40
  v_mov_b32 v99, v44
  s_add_u32 s76, s70, s81
  s_mov_b32 exec_lo, 0xffff
  s_mov_b32 exec_hi, 0
  buffer_store_dwordx4 v[92:95], v115, s[64:67], s76 offen sc1
  buffer_store_dwordx4 v[96:99], v115, s[64:67], s76 offen offset:16 sc1
  s_mov_b64 exec, -1
  s_mov_b32 exec_lo, 0xffff
  s_mov_b32 exec_hi, 0
  ds_write_b128 v116, v[100:103]
  ds_write_b128 v116, v[104:107] offset:16
  s_mov_b64 exec, -1
  s_waitcnt lgkmcnt(0)
  s_barrier
  s_cmp_lg_u32 s3, 0
  s_cbranch_scc1 Lw0123
  ds_read_b128 v[16:19], v13 offset:5120
  ds_read_b128 v[20:23], v13 offset:5632
  ds_read_b128 v[24:27], v13 offset:6144
  ds_read_b128 v[28:31], v13 offset:6656
  s_waitcnt lgkmcnt(0)
  v_add_f32 v16, v16, v20
  v_add_f32 v17, v17, v21
  v_add_f32 v18, v18, v22
  v_add_f32 v19, v19, v23
  v_add_f32 v16, v16, v24
  v_add_f32 v17, v17, v25
  v_add_f32 v18, v18, v26
  v_add_f32 v19, v19, v27
  v_add_f32 v16, v16, v28
  v_add_f32 v17, v17, v29
  v_add_f32 v18, v18, v30
  v_add_f32 v19, v19, v31
  s_add_u32 s76, s70, s81
  s_mov_b32 exec_lo, 0xffffffff
  s_mov_b32 exec_hi, 0
  buffer_store_dwordx4 v[16:19], v13, s[64:67], s76 offen offset:2048 sc1
  s_mov_b64 exec, -1
  s_waitcnt lgkmcnt(0)
Lw0123:
  s_nop 4
  s_cmp_eq_u32 s85, 0
  s_cbranch_scc1 Ldf124
  s_cmp_lg_u32 s3, 0
  s_cbranch_scc1 Lw0125
  s_mul_i32 s90, s83, 2560
  s_add_u32 s90, s90, 0xc8b000
  s_mov_b32 s75, 0x61a80
Lx2126:
  buffer_load_dwordx2 v[16:17], v12, s[64:67], s90 offen offset:0 sc1
  buffer_load_dwordx2 v[18:19], v12, s[64:67], s90 offen offset:512 sc1
  buffer_load_dwordx2 v[20:21], v12, s[64:67], s90 offen offset:1024 sc1
  buffer_load_dwordx2 v[22:23], v12, s[64:67], s90 offen offset:1536 sc1
  buffer_load_dwordx2 v[24:25], v12, s[64:67], s90 offen offset:2048 sc1
  s_waitcnt vmcnt(0)
  v_max3_u32 v127, v16, v17, v18
  v_max3_u32 v127, v127, v19, v20
  v_max3_u32 v127, v127, v21, v22
  v_max3_u32 v127, v127, v23, v24
  v_max3_u32 v127, v127, v25, v25
  v_cmp_eq_u32 vcc, -1, v127
  s_cbranch_vccz Lx2d127
  s_sleep 2
  s_sub_u32 s75, s75, 1
  s_cmp_lg_u32 s75, 0
  s_cbranch_scc1 Lx2126
Lx2d127:
  ds_write_b64 v121, v[16:17] offset:25600
  ds_write_b64 v121, v[18:19] offset:26112
  ds_write_b64 v121, v[20:21] offset:26624
  ds_write_b64 v121, v[22:23] offset:27136
  ds_write_b64 v121, v[24:25] offset:27648
  s_waitcnt lgkmcnt(0)
Lw0125:
  s_nop 4
Ldf124:
  s_nop 4
  s_mov_b32 s75, 0x61a80
  s_mov_b32 exec_lo, 0xff
  s_mov_b32 exec_hi, 0
Lpi129:
  buffer_load_dword v127, v8, s[64:67], s81 offen sc1
  s_waitcnt vmcnt(0)
  v_cmp_ne_u32 vcc, -1, v127
  s_cbranch_vccnz Lpd130
  s_sleep 3
  s_sub_u32 s75, s75, 1
  s_cmp_lg_u32 s75, 0
  s_cbranch_scc1 Lpi129
Lpd130:
  s_mov_b64 exec, -1
Lnoind128:
  s_mov_b32 s91, 0xfffff
  s_mov_b32 s75, 0x61a80
Lgs131:
  s_bitcmp1_b32 s91, 0
  s_cbranch_scc0 Lgk133
  s_add_u32 s76, s81, 0
  buffer_load_dwordx4 v[16:19], v9, s[64:67], s76 offen sc1
Lgk133:
  s_bitcmp1_b32 s91, 1
  s_cbranch_scc0 Lgk134
  s_add_u32 s76, s81, 0
  buffer_load_dwordx4 v[20:23], v9, s[64:67], s76 offen offset:1024 sc1
Lgk134:
  s_bitcmp1_b32 s91, 2
  s_cbranch_scc0 Lgk135
  s_add_u32 s76, s81, 0
  buffer_load_dwordx4 v[24:27], v9, s[64:67], s76 offen offset:2048 sc1
Lgk135:
  s_bitcmp1_b32 s91, 3
  s_cbranch_scc0 Lgk136
  s_add_u32 s76, s81, 0
  buffer_load_dwordx4 v[28:31], v9, s[64:67], s76 offen offset:3072 sc1
Lgk136:
  s_bitcmp1_b32 s91, 4
  s_cbranch_scc0 Lgk137
  s_add_u32 s76, s81, 4096
  buffer_load_dwordx4 v[32:35], v9, s[64:67], s76 offen sc1
Lgk137:
  s_bitcmp1_b32 s91, 5
  s_cbranch_scc0 Lgk138
  s_add_u32 s76, s81, 4096
  buffer_load_dwordx4 v[36:39], v9, s[64:67], s76 offen offset:1024 sc1
Lgk138:
  s_bitcmp1_b32 s91, 6
  s_cbranch_scc0 Lgk139
  s_add_u32 s76, s81, 4096
  buffer_load_dwordx4 v[40:43], v9, s[64:67], s76 offen offset:2048 sc1
Lgk139:
  s_bitcmp1_b32 s91, 7
  s_cbranch_scc0 Lgk140
  s_add_u32 s76, s81, 4096
  buffer_load_dwordx4 v[44:47], v9, s[64:67], s76 offen offset:3072 sc1
Lgk140:
  s_bitcmp1_b32 s91, 8
  s_cbranch_scc0 Lgk141
  s_add_u32 s76, s81, 8192
  buffer_load_dwordx4 v[48:51], v9, s[64:67], s76 offen sc1
Lgk141:
  s_bitcmp1_b32 s91, 9
  s_cbranch_scc0 Lgk142
  s_add_u32 s76, s81, 8192
  buffer_load_dwordx4 v[52:55], v9, s[64:67], s76 offen offset:1024 sc1
Lgk142:
  s_bitcmp1_b32 s91, 10
  s_cbranch_scc0 Lgk143
  s_add_u32 s76, s81, 8192
  buffer_load_dwordx4 v[56:59], v9, s[64:67], s76 offen offset:2048 sc1
Lgk143:
  s_bitcmp1_b32 s91, 11
  s_cbranch_scc0 Lgk144
  s_add_u32 s76, s81, 8192
  buffer_load_dwordx4 v[60:63], v9, s[64:67], s76 offen offset:3072 sc1
Lgk144:
  s_bitcmp1_b32 s91, 12
  s_cbranch_scc0 Lgk145
  s_add_u32 s76, s81, 12288
  buffer_load_dwordx4 v[64:67], v9, s[64:67], s76 offen sc1
Lgk145:
  s_bitcmp1_b32 s91, 13
  s_cbranch_scc0 Lgk146
  s_add_u32 s76, s81, 12288
  buffer_load_dwordx4 v[68:71], v9, s[64:67], s76 offen offset:1024 sc1
Lgk146:
  s_bitcmp1_b32 s91, 14
  s_cbranch_scc0 Lgk147
  s_add_u32 s76, s81, 12288
  buffer_load_dwordx4 v[72:75], v9, s[64:67], s76 offen offset:2048 sc1
Lgk147:
  s_bitcmp1_b32 s91, 15
  s_cbranch_scc0 Lgk148
  s_add_u32 s76, s81, 12288
  buffer_load_dwordx4 v[76:79], v9, s[64:67], s76 offen offset:3072 sc1
Lgk148:
  s_bitcmp1_b32 s91, 16
  s_cbranch_scc0 Lgk149
  s_add_u32 s76, s81, 16384
  buffer_load_dwordx4 v[80:83], v9, s[64:67], s76 offen sc1
Lgk149:
  s_bitcmp1_b32 s91, 17
  s_cbranch_scc0 Lgk150
  s_add_u32 s76, s81, 16384
  buffer_load_dwordx4 v[84:87], v9, s[64:67], s76 offen offset:1024 sc1
Lgk150:
  s_bitcmp1_b32 s91, 18
  s_cbranch_scc0 Lgk151
  s_add_u32 s76, s81, 16384
  buffer_load_dwordx4 v[88:91], v9, s[64:67], s76 offen offset:2048 sc1
Lgk151:
  s_bitcmp1_b32 s91, 19
  s_cbranch_scc0 Lgk152
  s_add_u32 s76, s81, 16384
  buffer_load_dwordx4 v[92:95], v9, s[64:67], s76 offen offset:3072 sc1
Lgk152:
  s_waitcnt vmcnt(0)
  s_bitcmp1_b32 s91, 0
  s_cbranch_scc0 Lgc153
  v_max3_u32 v127, v16, v17, v18
  v_max_u32 v127, v127, v19
  v_cmp_eq_u32 vcc, -1, v127
  s_cbranch_vccnz Lgc153
  s_bitset0_b32 s91, 0
Lgc153:
  s_bitcmp1_b32 s91, 1
  s_cbranch_scc0 Lgc154
  v_max3_u32 v127, v20, v21, v22
  v_max_u32 v127, v127, v23
  v_cmp_eq_u32 vcc, -1, v127
  s_cbranch_vccnz Lgc154
  s_bitset0_b32 s91, 1
Lgc154:
  s_bitcmp1_b32 s91, 2
  s_cbranch_scc0 Lgc155
  v_max3_u32 v127, v24, v25, v26
  v_max_u32 v127, v127, v27
  v_cmp_eq_u32 vcc, -1, v127
  s_cbranch_vccnz Lgc155
  s_bitset0_b32 s91, 2
Lgc155:
  s_bitcmp1_b32 s91, 3
  s_cbranch_scc0 Lgc156
  v_max3_u32 v127, v28, v29, v30
  v_max_u32 v127, v127, v31
  v_cmp_eq_u32 vcc, -1, v127
  s_cbranch_vccnz Lgc156
  s_bitset0_b32 s91, 3
Lgc156:
  s_bitcmp1_b32 s91, 4
  s_cbranch_scc0 Lgc157
  v_max3_u32 v127, v32, v33, v34
  v_max_u32 v127, v127, v35
  v_cmp_eq_u32 vcc, -1, v127
  s_cbranch_vccnz Lgc157
  s_bitset0_b32 s91, 4
Lgc157:
  s_bitcmp1_b32 s91, 5
  s_cbranch_scc0 Lgc158
  v_max3_u32 v127, v36, v37, v38
  v_max_u32 v127, v127, v39
  v_cmp_eq_u32 vcc, -1, v127
  s_cbranch_vccnz Lgc158
  s_bitset0_b32 s91, 5
Lgc158:
  s_bitcmp1_b32 s91, 6
  s_cbranch_scc0 Lgc159
  v_max3_u32 v127, v40, v41, v42
  v_max_u32 v127, v127, v43
  v_cmp_eq_u32 vcc, -1, v127
  s_cbranch_vccnz Lgc159
  s_bitset0_b32 s91, 6
Lgc159:
  s_bitcmp1_b32 s91, 7
  s_cbranch_scc0 Lgc160
  v_max3_u32 v127, v44, v45, v46
  v_max_u32 v127, v127, v47
  v_cmp_eq_u32 vcc, -1, v127
  s_cbranch_vccnz Lgc160
  s_bitset0_b32 s91, 7
Lgc160:
  s_bitcmp1_b32 s91, 8
  s_cbranch_scc0 Lgc161
  v_max3_u32 v127, v48, v49, v50
  v_max_u32 v127, v127, v51
  v_cmp_eq_u32 vcc, -1, v127
  s_cbranch_vccnz Lgc161
  s_bitset0_b32 s91, 8
Lgc161:
  s_bitcmp1_b32 s91, 9
  s_cbranch_scc0 Lgc162
  v_max3_u32 v127, v52, v53, v54
  v_max_u32 v127, v127, v55
  v_cmp_eq_u32 vcc, -1, v127
  s_cbranch_vccnz Lgc162
  s_bitset0_b32 s91, 9
Lgc162:
  s_bitcmp1_b32 s91, 10
  s_cbranch_scc0 Lgc163
  v_max3_u32 v127, v56, v57, v58
  v_max_u32 v127, v127, v59
  v_cmp_eq_u32 vcc, -1, v127
  s_cbranch_vccnz Lgc163
  s_bitset0_b32 s91, 10
Lgc163:
  s_bitcmp1_b32 s91, 11
  s_cbranch_scc0 Lgc164
  v_max3_u32 v127, v60, v61, v62
  v_max_u32 v127, v127, v63
  v_cmp_eq_u32 vcc, -1, v127
  s_cbranch_vccnz Lgc164
  s_bitset0_b32 s91, 11
Lgc164:
  s_bitcmp1_b32 s91, 12
  s_cbranch_scc0 Lgc165
  v_max3_u32 v127, v64, v65, v66
  v_max_u32 v127, v127, v67
  v_cmp_eq_u32 vcc, -1, v127
  s_cbranch_vccnz Lgc165
  s_bitset0_b32 s91, 12
Lgc165:
  s_bitcmp1_b32 s91, 13
  s_cbranch_scc0 Lgc166
  v_max3_u32 v127, v68, v69, v70
  v_max_u32 v127, v127, v71
  v_cmp_eq_u32 vcc, -1, v127
  s_cbranch_vccnz Lgc166
  s_bitset0_b32 s91, 13
Lgc166:
  s_bitcmp1_b32 s91, 14
  s_cbranch_scc0 Lgc167
  v_max3_u32 v127, v72, v73, v74
  v_max_u32 v127, v127, v75
  v_cmp_eq_u32 vcc, -1, v127
  s_cbranch_vccnz Lgc167
  s_bitset0_b32 s91, 14
Lgc167:
  s_bitcmp1_b32 s91, 15
  s_cbranch_scc0 Lgc168
  v_max3_u32 v127, v76, v77, v78
  v_max_u32 v127, v127, v79
  v_cmp_eq_u32 vcc, -1, v127
  s_cbranch_vccnz Lgc168
  s_bitset0_b32 s91, 15
Lgc168:
  s_bitcmp1_b32 s91, 16
  s_cbranch_scc0 Lgc169
  v_max3_u32 v127, v80, v81, v82
  v_max_u32 v127, v127, v83
  v_cmp_eq_u32 vcc, -1, v127
  s_cbranch_vccnz Lgc169
  s_bitset0_b32 s91, 16
Lgc169:
  s_bitcmp1_b32 s91, 17
  s_cbranch_scc0 Lgc170
  v_max3_u32 v127, v84, v85, v86
  v_max_u32 v127, v127, v87
  v_cmp_eq_u32 vcc, -1, v127
  s_cbranch_vccnz Lgc170
  s_bitset0_b32 s91, 17
Lgc170:
  s_bitcmp1_b32 s91, 18
  s_cbranch_scc0 Lgc171
  v_max3_u32 v127, v88, v89, v90
  v_max_u32 v127, v127, v91
  v_cmp_eq_u32 vcc, -1, v127
  s_cbranch_vccnz Lgc171
  s_bitset0_b32 s91, 18
Lgc171:
  s_bitcmp1_b32 s91, 19
  s_cbranch_scc0 Lgc172
  v_max3_u32 v127, v92, v93, v94
  v_max_u32 v127, v127, v95
  v_cmp_eq_u32 vcc, -1, v127
  s_cbranch_vccnz Lgc172
  s_bitset0_b32 s91, 19
Lgc172:
  s_cmp_eq_u32 s91, 0
  s_cbranch_scc1 Lgsd132
  s_sub_u32 s75, s75, 1
  s_cmp_lg_u32 s75, 0
  s_cbranch_scc1 Lgs131
Lgsd132:
  s_nop 4
  v_add_f32 v16, v16, v36
  v_add_f32 v17, v17, v37
  v_add_f32 v18, v18, v38
  v_add_f32 v19, v19, v39
  v_add_f32 v16, v16, v56
  v_add_f32 v17, v17, v57
  v_add_f32 v18, v18, v58
  v_add_f32 v19, v19, v59
  v_add_f32 v16, v16, v76
  v_add_f32 v17, v17, v77
  v_add_f32 v18, v18, v78
  v_add_f32 v19, v19, v79
  v_add_f32 v20, v20, v40
  v_add_f32 v21, v21, v41
  v_add_f32 v22, v22, v42
  v_add_f32 v23, v23, v43
  v_add_f32 v20, v20, v60
  v_add_f32 v21, v21, v61
  v_add_f32 v22, v22, v62
  v_add_f32 v23, v23, v63
  v_add_f32 v20, v20, v80
  v_add_f32 v21, v21, v81
  v_add_f32 v22, v22, v82
  v_add_f32 v23, v23, v83
  v_add_f32 v24, v24, v44
  v_add_f32 v25, v25, v45
  v_add_f32 v26, v26, v46
  v_add_f32 v27, v27, v47
  v_add_f32 v24, v24, v64
  v_add_f32 v25, v25, v65
  v_add_f32 v26, v26, v66
  v_add_f32 v27, v27, v67
  v_add_f32 v24, v24, v84
  v_add_f32 v25, v25, v85
  v_add_f32 v26, v26, v86
  v_add_f32 v27, v27, v87
  v_add_f32 v28, v28, v48
  v_add_f32 v29, v29, v49
  v_add_f32 v30, v30, v50
  v_add_f32 v31, v31, v51
  v_add_f32 v28, v28, v68
  v_add_f32 v29, v29, v69
  v_add_f32 v30, v30, v70
  v_add_f32 v31, v31, v71
  v_add_f32 v28, v28, v88
  v_add_f32 v29, v29, v89
  v_add_f32 v30, v30, v90
  v_add_f32 v31, v31, v91
  v_add_f32 v32, v32, v52
  v_add_f32 v33, v33, v53
  v_add_f32 v34, v34, v54
  v_add_f32 v35, v35, v55
  v_add_f32 v32, v32, v72
  v_add_f32 v33, v33, v73
  v_add_f32 v34, v34, v74
  v_add_f32 v35, v35, v75
  v_add_f32 v32, v32, v92
  v_add_f32 v33, v33, v93
  v_add_f32 v34, v34, v94
  v_add_f32 v35, v35, v95
  ds_write_b128 v10, v[16:19] offset:0
  ds_write_b128 v10, v[20:23] offset:1024
  ds_write_b128 v10, v[24:27] offset:2048
  ds_write_b128 v10, v[28:31] offset:3072
  ds_write_b128 v10, v[32:35] offset:4096
  s_waitcnt lgkmcnt(0)
  s_barrier
  s_cmp_lg_u32 s3, 0
  s_cbranch_scc1 Lw0173
  ds_read_b64 v[32:33], v12 offset:5120
  ds_read_b64 v[34:35], v12 offset:5632
  ds_read_b64 v[36:37], v12 offset:6144
  ds_read_b64 v[38:39], v12 offset:6656
  ds_read_b64 v[40:41], v12 offset:7168
  ds_read_b64 v[42:43], v12 offset:7680
  ds_read_b64 v[44:45], v12 offset:8192
  ds_read_b64 v[46:47], v12 offset:8704
  ds_read_b64 v[48:49], v12 offset:9216
  ds_read_b64 v[50:51], v12 offset:9728
  ds_read_b64 v[52:53], v12 offset:10240
  ds_read_b64 v[54:55], v12 offset:10752
  ds_read_b64 v[56:57], v12 offset:11264
  ds_read_b64 v[58:59], v12 offset:11776
  ds_read_b64 v[60:61], v12 offset:12288
  ds_read_b64 v[62:63], v12 offset:12800
  s_waitcnt lgkmcnt(8)
  ds_read_b64 v[64:65], v12 offset:13312
  ds_read_b64 v[66:67], v12 offset:13824
  ds_read_b64 v[68:69], v12 offset:14336
  ds_read_b64 v[70:71], v12 offset:14848
  ds_read_b64 v[72:73], v12 offset:15360
  ds_read_b64 v[74:75], v12 offset:15872
  ds_read_b64 v[76:77], v12 offset:16384
  ds_read_b64 v[78:79], v12 offset:16896
  s_waitcnt lgkmcnt(8)
  ds_read_b64 v[80:81], v12 offset:17408
  ds_read_b64 v[82:83], v12 offset:17920
  ds_read_b64 v[84:85], v12 offset:18432
  ds_read_b64 v[86:87], v12 offset:18944
  ds_read_b64 v[88:89], v12 offset:19456
  ds_read_b64 v[90:91], v12 offset:19968
  ds_read_b64 v[92:93], v12 offset:20480
  ds_read_b64 v[94:95], v12 offset:20992
  s_waitcnt lgkmcnt(8)
  ds_read_b64 v[96:97], v12 offset:21504
  ds_read_b64 v[98:99], v12 offset:22016
  ds_read_b64 v[100:101], v12 offset:22528
  ds_read_b64 v[102:103], v12 offset:23040
  ds_read_b64 v[104:105], v12 offset:23552
  ds_read_b64 v[106:107], v12 offset:24064
  ds_read_b64 v[108:109], v12 offset:24576
  ds_read_b64 v[110:111], v12 offset:25088
  s_waitcnt lgkmcnt(8)
  s_waitcnt lgkmcnt(0)
  v_add_f32 v16, v32, v42
  v_add_f32 v17, v33, v43
  v_add_f32 v18, v34, v44
  v_add_f32 v19, v35, v45
  v_add_f32 v20, v36, v46
  v_add_f32 v21, v37, v47
  v_add_f32 v22, v38, v48
  v_add_f32 v23, v39, v49
  v_add_f32 v24, v40, v50
  v_add_f32 v25, v41, v51
  v_add_f32 v16, v16, v52
  v_add_f32 v17, v17, v53
  v_add_f32 v18, v18, v54
  v_add_f32 v19, v19, v55
  v_add_f32 v20, v20, v56
  v_add_f32 v21, v21, v57
  v_add_f32 v22, v22, v58
  v_add_f32 v23, v23, v59
  v_add_f32 v24, v24, v60
  v_add_f32 v25, v25, v61
  v_add_f32 v16, v16, v62
  v_add_f32 v17, v17, v63
  v_add_f32 v18, v18, v64
  v_add_f32 v19, v19, v65
  v_add_f32 v20, v20, v66
  v_add_f32 v21, v21, v67
  v_add_f32 v22, v22, v68
  v_add_f32 v23, v23, v69
  v_add_f32 v24, v24, v70
  v_add_f32 v25, v25, v71
  v_add_f32 v16, v16, v72
  v_add_f32 v17, v17, v73
  v_add_f32 v18, v18, v74
  v_add_f32 v19, v19, v75
  v_add_f32 v20, v20, v76
  v_add_f32 v21, v21, v77
  v_add_f32 v22, v22, v78
  v_add_f32 v23, v23, v79
  v_add_f32 v24, v24, v80
  v_add_f32 v25, v25, v81
  v_add_f32 v16, v16, v82
  v_add_f32 v17, v17, v83
  v_add_f32 v18, v18, v84
  v_add_f32 v19, v19, v85
  v_add_f32 v20, v20, v86
  v_add_f32 v21, v21, v87
  v_add_f32 v22, v22, v88
  v_add_f32 v23, v23, v89
  v_add_f32 v24, v24, v90
  v_add_f32 v25, v25, v91
  v_add_f32 v16, v16, v92
  v_add_f32 v17, v17, v93
  v_add_f32 v18, v18, v94
  v_add_f32 v19, v19, v95
  v_add_f32 v20, v20, v96
  v_add_f32 v21, v21, v97
  v_add_f32 v22, v22, v98
  v_add_f32 v23, v23, v99
  v_add_f32 v24, v24, v100
  v_add_f32 v25, v25, v101
  v_add_f32 v16, v16, v102
  v_add_f32 v17, v17, v103
  v_add_f32 v18, v18, v104
  v_add_f32 v19, v19, v105
  v_add_f32 v20, v20, v106
  v_add_f32 v21, v21, v107
  v_add_f32 v22, v22, v108
  v_add_f32 v23, v23, v109
  v_add_f32 v24, v24, v110
  v_add_f32 v25, v25, v111
  ds_read_b64 v[32:33], v121 offset:25600
  ds_read_b64 v[34:35], v121 offset:26112
  ds_read_b64 v[36:37], v121 offset:26624
  ds_read_b64 v[38:39], v121 offset:27136
  ds_read_b64 v[40:41], v121 offset:27648
  v_cvt_pk_bf16_f32 v16, 0, v16
  v_cvt_pk_bf16_f32 v17, 0, v17
  v_cvt_pk_bf16_f32 v18, 0, v18
  v_cvt_pk_bf16_f32 v19, 0, v19
  v_cvt_pk_bf16_f32 v20, 0, v20
  v_cvt_pk_bf16_f32 v21, 0, v21
  v_cvt_pk_bf16_f32 v22, 0, v22
  v_cvt_pk_bf16_f32 v23, 0, v23
  v_cvt_pk_bf16_f32 v24, 0, v24
  v_cvt_pk_bf16_f32 v25, 0, v25
  s_waitcnt lgkmcnt(0)
  v_add_f32 v16, v16, v32
  v_add_f32 v17, v17, v33
  v_add_f32 v18, v18, v34
  v_add_f32 v19, v19, v35
  v_add_f32 v20, v20, v36
  v_add_f32 v21, v21, v37
  v_add_f32 v22, v22, v38
  v_add_f32 v23, v23, v39
  v_add_f32 v24, v24, v40
  v_add_f32 v25, v25, v41
  v_cvt_pk_bf16_f32 v16, 0, v16
  v_cvt_pk_bf16_f32 v17, 0, v17
  v_cvt_pk_bf16_f32 v18, 0, v18
  v_cvt_pk_bf16_f32 v19, 0, v19
  v_cvt_pk_bf16_f32 v20, 0, v20
  v_cvt_pk_bf16_f32 v21, 0, v21
  v_cvt_pk_bf16_f32 v22, 0, v22
  v_cvt_pk_bf16_f32 v23, 0, v23
  v_cvt_pk_bf16_f32 v24, 0, v24
  v_cvt_pk_bf16_f32 v25, 0, v25
  v_add_f32 v32, v16, v17
  v_add_f32 v32, v32, v18
  v_add_f32 v32, v32, v19
  v_add_f32 v32, v32, v20
  v_add_f32 v32, v32, v21
  v_add_f32 v32, v32, v22
  v_add_f32 v32, v32, v23
  v_add_f32 v32, v32, v24
  v_add_f32 v32, v32, v25
  s_nop 1
  v_add_f32_dpp v32, v32, v32 quad_perm:[1,0,3,2] row_mask:0xf bank_mask:0xf
  s_nop 1
  v_add_f32_dpp v32, v32, v32 quad_perm:[2,3,0,1] row_mask:0xf bank_mask:0xf
  s_nop 1
  v_add_f32_dpp v32, v32, v32 row_half_mirror row_mask:0xf bank_mask:0xf
  s_nop 1
  v_add_f32_dpp v32, v32, v32 row_mirror row_mask:0xf bank_mask:0xf
  v_mov_b32 v33, v32
  s_nop 1
  v_permlane16_swap_b32 v32, v33
  v_add_f32 v32, v32, v33
  v_mov_b32 v33, v32
  s_nop 1
  v_permlane32_swap_b32 v32, v33
  v_add_f32 v32, v32, v33
  v_mul_f32 v34, 0x3acccccd, v32
  v_sub_f32 v40, v16, v34
  v_sub_f32 v41, v17, v34
  v_sub_f32 v42, v18, v34
  v_sub_f32 v43, v19, v34
  v_sub_f32 v44, v20, v34
  v_sub_f32 v45, v21, v34
  v_sub_f32 v46, v22, v34
  v_sub_f32 v47, v23, v34
  v_sub_f32 v48, v24, v34
  v_sub_f32 v49, v25, v34
  v_mul_f32 v32, v40, v40
  v_fmac_f32 v32, v41, v41
  v_fmac_f32 v32, v42, v42
  v_fmac_f32 v32, v43, v43
  v_fmac_f32 v32, v44, v44
  v_fmac_f32 v32, v45, v45
  v_fmac_f32 v32, v46, v46
  v_fmac_f32 v32, v47, v47
  v_fmac_f32 v32, v48, v48
  v_fmac_f32 v32, v49, v49
  s_nop 1
  v_add_f32_dpp v32, v32, v32 quad_perm:[1,0,3,2] row_mask:0xf bank_mask:0xf
  s_nop 1
  v_add_f32_dpp v32, v32, v32 quad_perm:[2,3,0,1] row_mask:0xf bank_mask:0xf
  s_nop 1
  v_add_f32_dpp v32, v32, v32 row_half_mirror row_mask:0xf bank_mask:0xf
  s_nop 1
  v_add_f32_dpp v32, v32, v32 row_mirror row_mask:0xf bank_mask:0xf
  v_mov_b32 v33, v32
  s_nop 1
  v_permlane16_swap_b32 v32, v33
  v_add_f32 v32, v32, v33
  v_mov_b32 v33, v32
  s_nop 1
  v_permlane32_swap_b32 v32, v33
  v_add_f32 v32, v32, v33
  v_mul_f32 v35, 0x3acccccd, v32
  v_cvt_pk_bf16_f32 v34, 0, v34
  v_cvt_pk_bf16_f32 v35, 0, v35
  v_add_f32 v35, 0x3727c5ac, v35
  v_cvt_pk_bf16_f32 v35, 0, v35
  v_sqrt_f32 v35, v35
  s_nop 0
  v_cvt_pk_bf16_f32 v35, 0, v35
  v_rcp_f32 v33, v35
  v_sub_f32 v40, v16, v34
  v_sub_f32 v41, v17, v34
  v_sub_f32 v42, v18, v34
  v_sub_f32 v43, v19, v34
  v_sub_f32 v44, v20, v34
  v_sub_f32 v45, v21, v34
  v_sub_f32 v46, v22, v34
  v_sub_f32 v47, v23, v34
  v_sub_f32 v48, v24, v34
  v_sub_f32 v49, v25, v34
  v_cvt_pk_bf16_f32 v40, 0, v40
  v_cvt_pk_bf16_f32 v41, 0, v41
  v_cvt_pk_bf16_f32 v42, 0, v42
  v_cvt_pk_bf16_f32 v43, 0, v43
  v_cvt_pk_bf16_f32 v44, 0, v44
  v_cvt_pk_bf16_f32 v45, 0, v45
  v_cvt_pk_bf16_f32 v46, 0, v46
  v_cvt_pk_bf16_f32 v47, 0, v47
  v_cvt_pk_bf16_f32 v48, 0, v48
  v_cvt_pk_bf16_f32 v49, 0, v49
  v_mul_f32 v50, v40, v33
  v_mul_f32 v51, v41, v33
  v_mul_f32 v52, v42, v33
  v_mul_f32 v53, v43, v33
  v_mul_f32 v54, v44, v33
  v_mul_f32 v55, v45, v33
  v_mul_f32 v56, v46, v33
  v_mul_f32 v57, v47, v33
  v_mul_f32 v58, v48, v33
  v_mul_f32 v59, v49, v33
  v_fma_f32 v60, -v50, v35, v40
  v_fma_f32 v61, -v51, v35, v41
  v_fma_f32 v62, -v52, v35, v42
  v_fma_f32 v63, -v53, v35, v43
  v_fma_f32 v64, -v54, v35, v44
  v_fma_f32 v65, -v55, v35, v45
  v_fma_f32 v66, -v56, v35, v46
  v_fma_f32 v67, -v57, v35, v47
  v_fma_f32 v68, -v58, v35, v48
  v_fma_f32 v69, -v59, v35, v49
  v_fma_f32 v50, v60, v33, v50
  v_fma_f32 v51, v61, v33, v51
  v_fma_f32 v52, v62, v33, v52
  v_fma_f32 v53, v63, v33, v53
  v_fma_f32 v54, v64, v33, v54
  v_fma_f32 v55, v65, v33, v55
  v_fma_f32 v56, v66, v33, v56
  v_fma_f32 v57, v67, v33, v57
  v_fma_f32 v58, v68, v33, v58
  v_fma_f32 v59, v69, v33, v59
  v_cvt_pk_bf16_f32 v72, v50, v51
  ds_write_b32 v119, v72 offset:0
  v_cvt_pk_bf16_f32 v73, v52, v53
  ds_write_b32 v119, v73 offset:256
  v_cvt_pk_bf16_f32 v74, v54, v55
  ds_write_b32 v119, v74 offset:512
  v_cvt_pk_bf16_f32 v75, v56, v57
  ds_write_b32 v119, v75 offset:768
  v_cvt_pk_bf16_f32 v76, v58, v59
  ds_write_b32 v119, v76 offset:1024
  s_waitcnt lgkmcnt(0)
Lw0173:
  s_nop 4
  s_waitcnt lgkmcnt(0)
  s_barrier
  ds_read_b128 v[48:51], v14 offset:0
  ds_read_b128 v[52:55], v14 offset:1024
  ds_read_b128 v[56:59], v14 offset:2048
  ds_read_b128 v[60:63], v14 offset:3072
  ds_read_b128 v[64:67], v14 offset:4096
  ds_read_b128 v[68:71], v14 offset:5120
  ds_read_b128 v[72:75], v14 offset:6144
  ds_read_b128 v[76:79], v14 offset:7168
  ds_read_b128 v[80:83], v114 offset:0
  ds_read_b128 v[84:87], v114 offset:64
  ds_read_b128 v[88:91], v114 offset:128
  ds_read_b128 v[92:95], v114 offset:192
  ds_read_b128 v[96:99], v114 offset:256
  s_waitcnt lgkmcnt(0)
  v_mfma_f32_16x16x32_bf16 v[16:19], v[80:83], v[128:131], 0
  v_mfma_f32_16x16x32_bf16 v[20:23], v[80:83], v[132:135], 0
  v_mfma_f32_16x16x32_bf16 v[24:27], v[80:83], v[136:139], 0
  v_mfma_f32_16x16x32_bf16 v[28:31], v[80:83], v[140:143], 0
  v_mfma_f32_16x16x32_bf16 v[32:35], v[80:83], v[144:147], 0
  v_mfma_f32_16x16x32_bf16 v[36:39], v[80:83], v[148:151], 0
  v_mfma_f32_16x16x32_bf16 v[40:43], v[80:83], v[152:155], 0
  v_mfma_f32_16x16x32_bf16 v[44:47], v[80:83], v[156:159], 0
  v_mfma_f32_16x16x32_bf16 v[16:19], v[84:87], v[160:163], v[16:19]
  v_mfma_f32_16x16x32_bf16 v[20:23], v[84:87], v[164:167], v[20:23]
  v_mfma_f32_16x16x32_bf16 v[24:27], v[84:87], v[168:171], v[24:27]
  v_mfma_f32_16x16x32_bf16 v[28:31], v[84:87], v[172:175], v[28:31]
  v_mfma_f32_16x16x32_bf16 v[32:35], v[84:87], v[176:179], v[32:35]
  v_mfma_f32_16x16x32_bf16 v[36:39], v[84:87], v[180:183], v[36:39]
  v_mfma_f32_16x16x32_bf16 v[40:43], v[84:87], v[184:187], v[40:43]
  v_mfma_f32_16x16x32_bf16 v[44:47], v[84:87], v[188:191], v[44:47]
  v_mfma_f32_16x16x32_bf16 v[16:19], v[88:91], v[192:195], v[16:19]
  v_mfma_f32_16x16x32_bf16 v[20:23], v[88:91], v[196:199], v[20:23]
  v_mfma_f32_16x16x32_bf16 v[24:27], v[88:91], v[200:203], v[24:27]
  v_mfma_f32_16x16x32_bf16 v[28:31], v[88:91], v[204:207], v[28:31]
  v_mfma_f32_16x16x32_bf16 v[32:35], v[88:91], v[208:211], v[32:35]
  v_mfma_f32_16x16x32_bf16 v[36:39], v[88:91], v[212:215], v[36:39]
  v_mfma_f32_16x16x32_bf16 v[40:43], v[88:91], v[216:219], v[40:43]
  v_mfma_f32_16x16x32_bf16 v[44:47], v[88:91], v[220:223], v[44:47]
  v_mfma_f32_16x16x32_bf16 v[16:19], v[92:95], v[224:227], v[16:19]
  v_mfma_f32_16x16x32_bf16 v[20:23], v[92:95], v[228:231], v[20:23]
  v_mfma_f32_16x16x32_bf16 v[24:27], v[92:95], v[232:235], v[24:27]
  v_mfma_f32_16x16x32_bf16 v[28:31], v[92:95], v[236:239], v[28:31]
  v_mfma_f32_16x16x32_bf16 v[32:35], v[92:95], v[240:243], v[32:35]
  v_mfma_f32_16x16x32_bf16 v[36:39], v[92:95], v[244:247], v[36:39]
  v_mfma_f32_16x16x32_bf16 v[40:43], v[92:95], v[248:251], v[40:43]
  v_mfma_f32_16x16x32_bf16 v[44:47], v[92:95], v[252:255], v[44:47]
  v_mfma_f32_16x16x32_bf16 v[16:19], v[96:99], v[48:51], v[16:19]
  v_mfma_f32_16x16x32_bf16 v[20:23], v[96:99], v[52:55], v[20:23]
  v_mfma_f32_16x16x32_bf16 v[24:27], v[96:99], v[56:59], v[24:27]
  v_mfma_f32_16x16x32_bf16 v[28:31], v[96:99], v[60:63], v[28:31]
  v_mfma_f32_16x16x32_bf16 v[32:35], v[96:99], v[64:67], v[32:35]
  v_mfma_f32_16x16x32_bf16 v[36:39], v[96:99], v[68:71], v[36:39]
  v_mfma_f32_16x16x32_bf16 v[40:43], v[96:99], v[72:75], v[40:43]
  v_mfma_f32_16x16x32_bf16 v[44:47], v[96:99], v[76:79], v[44:47]
  ds_read_b128 v[48:51], v14 offset:8192
  ds_read_b128 v[52:55], v14 offset:9216
  ds_read_b128 v[56:59], v14 offset:10240
  ds_read_b128 v[60:63], v14 offset:11264
  ds_read_b128 v[64:67], v14 offset:12288
  ds_read_b128 v[68:71], v14 offset:13312
  ds_read_b128 v[72:75], v14 offset:14336
  ds_read_b128 v[76:79], v14 offset:15360
  v_mov_b32 v100, v16
  v_mov_b32 v101, v20
  v_mov_b32 v102, v24
  v_mov_b32 v103, v28
  v_mov_b32 v104, v32
  v_mov_b32 v105, v36
  v_mov_b32 v106, v40
  v_mov_b32 v107, v44
  s_mov_b32 exec_lo, 0xfff
  s_mov_b32 exec_hi, 0
  ds_write_b128 v11, v[100:103]
  ds_write_b128 v11, v[104:107] offset:16
  s_mov_b64 exec, -1
  s_waitcnt lgkmcnt(0)
  s_barrier
  s_cmp_lg_u32 s3, 0
  s_cbranch_scc1 Lw0174
  ds_read_b32 v16, v119 offset:5120
  ds_read_b32 v36, v119 offset:5312
  ds_read_b32 v17, v119 offset:5504
  ds_read_b32 v37, v119 offset:5696
  ds_read_b32 v18, v119 offset:5888
  ds_read_b32 v38, v119 offset:6080
  ds_read_b32 v19, v119 offset:6272
  ds_read_b32 v39, v119 offset:6464
  s_waitcnt lgkmcnt(0)
  v_add_f32 v16, v16, v17
  v_add_f32 v36, v36, v37
  v_add_f32 v16, v16, v18
  v_add_f32 v36, v36, v38
  v_add_f32 v16, v16, v19
  v_add_f32 v36, v36, v39
  v_cvt_pk_bf16_f32 v16, 0, v16
  v_cvt_pk_bf16_f32 v36, 0, v36
  v_mul_f32 v17, v16, v16
  v_mul_f32 v17, v17, v16
  v_mov_b32 v18, 0x3d372713
  v_fma_f32 v17, v17, v18, v16
  v_mul_f32 v17, 0x40135761, v17
  v_exp_f32 v17, v17
  s_nop 0
  v_add_f32 v17, 1.0, v17
  v_rcp_f32 v17, v17
  s_nop 0
  v_fma_f32 v17, v17, -2.0, 1.0
  v_add_f32 v17, 1.0, v17
  v_mul_f32 v17, v17, v16
  v_mul_f32 v17, 0.5, v17
  v_cvt_pk_bf16_f32 v17, 0, v17
  v_mul_f32 v17, v17, v36
  v_cvt_pk_bf16_f32 v18, v17, 0
  v_mov_b32 v19, 0
  s_mov_b32 exec_lo, 0
  s_mov_b32 exec_hi, 0xffff0000
  v_mov_b32 v18, 0
  s_mov_b64 exec, -1
  v_lshlrev_b32 v20, 1, v0
  ds_write_b16 v20, v18 offset:0
  ds_write_b16 v20, v19 offset:128
  s_waitcnt lgkmcnt(0)
Lw0174:
  s_nop 4
  s_waitcnt lgkmcnt(0)
  s_barrier
  ds_read_b128 v[80:83], v112 offset:0
  ds_read_b128 v[84:87], v112 offset:64
  ds_read_b128 v[88:91], v113 offset:0
  s_waitcnt lgkmcnt(0)
  v_mfma_f32_16x16x32_bf16 v[16:19], v[80:83], v[48:51], 0
  v_mfma_f32_16x16x32_bf16 v[20:23], v[80:83], v[52:55], 0
  v_mfma_f32_16x16x32_bf16 v[24:27], v[80:83], v[56:59], 0
  v_mfma_f32_16x16x32_bf16 v[28:31], v[80:83], v[60:63], 0
  v_mfma_f32_16x16x32_bf16 v[32:35], v[80:83], v[64:67], 0
  v_mfma_f32_16x16x32_bf16 v[36:39], v[80:83], v[68:71], 0
  v_mfma_f32_16x16x32_bf16 v[40:43], v[80:83], v[72:75], 0
  v_mfma_f32_16x16x32_bf16 v[44:47], v[80:83], v[76:79], 0
  ds_read_b128 v[48:51], v14 offset:16384
  ds_read_b128 v[52:55], v14 offset:17408
  ds_read_b128 v[56:59], v14 offset:18432
  ds_read_b128 v[60:63], v14 offset:19456
  ds_read_b128 v[64:67], v14 offset:20480
  ds_read_b128 v[68:71], v14 offset:21504
  ds_read_b128 v[72:75], v14 offset:22528
  ds_read_b128 v[76:79], v14 offset:23552
  s_waitcnt lgkmcnt(0)
  v_mfma_f32_16x16x32_bf16 v[16:19], v[84:87], v[48:51], v[16:19]
  v_mfma_f32_16x16x32_bf16 v[20:23], v[84:87], v[52:55], v[20:23]
  v_mfma_f32_16x16x32_bf16 v[24:27], v[84:87], v[56:59], v[24:27]
  v_mfma_f32_16x16x32_bf16 v[28:31], v[84:87], v[60:63], v[28:31]
  v_mfma_f32_16x16x32_bf16 v[32:35], v[84:87], v[64:67], v[32:35]
  v_mfma_f32_16x16x32_bf16 v[36:39], v[84:87], v[68:71], v[36:39]
  v_mfma_f32_16x16x32_bf16 v[40:43], v[84:87], v[72:75], v[40:43]
  v_mfma_f32_16x16x32_bf16 v[44:47], v[84:87], v[76:79], v[44:47]
  ds_read_b128 v[48:51], v120 offset:0
  ds_read_b128 v[52:55], v120 offset:1024
  ds_read_b128 v[56:59], v120 offset:2048
  ds_read_b128 v[60:63], v120 offset:3072
  ds_read_b128 v[64:67], v120 offset:4096
  ds_read_b128 v[68:71], v120 offset:5120
  ds_read_b128 v[72:75], v120 offset:6144
  ds_read_b128 v[76:79], v120 offset:7168
  v_mov_b32 v92, v16
  v_mov_b32 v93, v20
  v_mov_b32 v94, v24
  v_mov_b32 v95, v28
  v_mov_b32 v96, v32
  v_mov_b32 v97, v36
  v_mov_b32 v98, v40
  v_mov_b32 v99, v44
  s_add_u32 s76, s70, s82
  s_mov_b32 exec_lo, 0xffff
  s_mov_b32 exec_hi, 0
  buffer_store_dwordx4 v[92:95], v115, s[64:67], s76 offen sc1
  buffer_store_dwordx4 v[96:99], v115, s[64:67], s76 offen offset:16 sc1
  s_mov_b64 exec, -1
  s_waitcnt lgkmcnt(0)
  v_mfma_f32_16x16x32_bf16 v[16:19], v[88:91], v[48:51], 0
  v_mfma_f32_16x16x32_bf16 v[20:23], v[88:91], v[52:55], 0
  v_mfma_f32_16x16x32_bf16 v[24:27], v[88:91], v[56:59], 0
  v_mfma_f32_16x16x32_bf16 v[28:31], v[88:91], v[60:63], 0
  v_mfma_f32_16x16x32_bf16 v[32:35], v[88:91], v[64:67], 0
  v_mfma_f32_16x16x32_bf16 v[36:39], v[88:91], v[68:71], 0
  v_mfma_f32_16x16x32_bf16 v[40:43], v[88:91], v[72:75], 0
  v_mfma_f32_16x16x32_bf16 v[44:47], v[88:91], v[76:79], 0
  s_nop 0
  v_mov_b32 v100, v16
  v_mov_b32 v101, v20
  v_mov_b32 v102, v24
  v_mov_b32 v103, v28
  v_mov_b32 v104, v32
  v_mov_b32 v105, v36
  v_mov_b32 v106, v40
  v_mov_b32 v107, v44
  s_mov_b32 exec_lo, 0xffff
  s_mov_b32 exec_hi, 0
  ds_write_b128 v116, v[100:103]
  ds_write_b128 v116, v[104:107] offset:16
  s_mov_b64 exec, -1
  s_waitcnt lgkmcnt(0)
  s_barrier
  s_cmp_lg_u32 s3, 0
  s_cbranch_scc1 Lw0175
  ds_read_b128 v[16:19], v13 offset:5120
  ds_read_b128 v[20:23], v13 offset:5632
  ds_read_b128 v[24:27], v13 offset:6144
  ds_read_b128 v[28:31], v13 offset:6656
  s_waitcnt lgkmcnt(0)
  v_add_f32 v16, v16, v20
  v_add_f32 v17, v17, v21
  v_add_f32 v18, v18, v22
  v_add_f32 v19, v19, v23
  v_add_f32 v16, v16, v24
  v_add_f32 v17, v17, v25
  v_add_f32 v18, v18, v26
  v_add_f32 v19, v19, v27
  v_add_f32 v16, v16, v28
  v_add_f32 v17, v17, v29
  v_add_f32 v18, v18, v30
  v_add_f32 v19, v19, v31
  s_add_u32 s76, s70, s82
  s_mov_b32 exec_lo, 0xffffffff
  s_mov_b32 exec_hi, 0
  buffer_store_dwordx4 v[16:19], v13, s[64:67], s76 offen offset:2048 sc1
  s_mov_b64 exec, -1
  s_waitcnt lgkmcnt(0)
Lw0175:
  s_nop 4
  s_waitcnt lgkmcnt(0)
  s_barrier
  s_add_u32 s78, s78, 1
  s_cmp_lt_u32 s78, 8
  s_cbranch_scc1 L_aloop
  s_waitcnt vmcnt(0)
  s_endpgm
  s_nop 4
L_qcu:
  s_lshl_b32 s4, s3, 6
  v_add_u32 v15, s4, v0
  v_lshlrev_b32 v15, 4, v15
  v_mov_b32 v16, -1
  v_mov_b32 v17, -1
  v_mov_b32 v18, -1
  v_mov_b32 v19, -1
  s_mov_b32 s96, s8
  s_and_b32 s97, s9, 0xffff
  s_mov_b32 s98, 0x1400
  s_mov_b32 s99, 0x20000
  v_lshlrev_b32 v254, 2, v0
  s_mul_i32 s76, s3, 1280
  buffer_load_dword v226, v254, s[96:99], s76 offen offset:0
  buffer_load_dword v227, v254, s[96:99], s76 offen offset:256
  buffer_load_dword v228, v254, s[96:99], s76 offen offset:512
  buffer_load_dword v229, v254, s[96:99], s76 offen offset:768
  buffer_load_dword v230, v254, s[96:99], s76 offen offset:1024
  s_mul_i32 s4, s2, 48
  s_sub_u32 s5, 7864320, s4
  s_add_u32 s92, s14, s4
  s_addc_u32 s93, s15, 0
  s_and_b32 s93, s93, 0xffff
  s_mov_b32 s94, s5
  s_mov_b32 s95, 0x20000
  v_and_b32 v255, 15, v0
  v_mul_u32_u24 v255, 122880, v255
  v_lshrrev_b32 v128, 4, v0
  v_min_u32 v128, 2, v128
  v_lshl_add_u32 v255, v128, 4, v255
  s_mul_i32 s4, s3, 1966080
  s_add_u32 s76, s4, 0
  buffer_load_dwordx4 v[56:59], v255, s[92:95], s76 offen
  s_add_u32 s76, s4, 12288
  buffer_load_dwordx4 v[60:63], v255, s[92:95], s76 offen
  s_add_u32 s76, s4, 24576
  buffer_load_dwordx4 v[64:67], v255, s[92:95], s76 offen
  s_add_u32 s76, s4, 36864
  buffer_load_dwordx4 v[68:71], v255, s[92:95], s76 offen
  s_add_u32 s76, s4, 49152
  buffer_load_dwordx4 v[72:75], v255, s[92:95], s76 offen
  s_add_u32 s76, s4, 61440
  buffer_load_dwordx4 v[76:79], v255, s[92:95], s76 offen
  s_add_u32 s76, s4, 73728
  buffer_load_dwordx4 v[80:83], v255, s[92:95], s76 offen
  s_add_u32 s76, s4, 86016
  buffer_load_dwordx4 v[84:87], v255, s[92:95], s76 offen
  s_add_u32 s76, s4, 98304
  buffer_load_dwordx4 v[88:91], v255, s[92:95], s76 offen
  s_add_u32 s76, s4, 110592
  buffer_load_dwordx4 v[92:95], v255, s[92:95], s76 offen
  s_waitcnt vmcnt(10)
  v_lshlrev_b32 v231, 16, v226
  v_and_b32 v232, 0xffff0000, v226
  v_lshlrev_b32 v233, 16, v227
  v_and_b32 v234, 0xffff0000, v227
  v_lshlrev_b32 v235, 16, v228
  v_and_b32 v236, 0xffff0000, v228
  v_lshlrev_b32 v237, 16, v229
  v_and_b32 v238, 0xffff0000, v229
  v_lshlrev_b32 v239, 16, v230
  v_and_b32 v240, 0xffff0000, v230
  v_add_f32 v96, v231, v232
  v_add_f32 v96, v96, v233
  v_add_f32 v96, v96, v234
  v_add_f32 v96, v96, v235
  v_add_f32 v96, v96, v236
  v_add_f32 v96, v96, v237
  v_add_f32 v96, v96, v238
  v_add_f32 v96, v96, v239
  v_add_f32 v96, v96, v240
  s_nop 1
  v_add_f32_dpp v96, v96, v96 quad_perm:[1,0,3,2] row_mask:0xf bank_mask:0xf
  s_nop 1
  v_add_f32_dpp v96, v96, v96 quad_perm:[2,3,0,1] row_mask:0xf bank_mask:0xf
  s_nop 1
  v_add_f32_dpp v96, v96, v96 row_half_mirror row_mask:0xf bank_mask:0xf
  s_nop 1
  v_add_f32_dpp v96, v96, v96 row_mirror row_mask:0xf bank_mask:0xf
  v_mov_b32 v97, v96
  s_nop 1
  v_permlane16_swap_b32 v96, v97
  v_add_f32 v96, v96, v97
  v_mov_b32 v97, v96
  s_nop 1
  v_permlane32_swap_b32 v96, v97
  v_add_f32 v96, v96, v97
  v_mul_f32 v98, 0x3acccccd, v96
  v_sub_f32 v100, v231, v98
  v_sub_f32 v101, v232, v98
  v_sub_f32 v102, v233, v98
  v_sub_f32 v103, v234, v98
  v_sub_f32 v104, v235, v98
  v_sub_f32 v105, v236, v98
  v_sub_f32 v106, v237, v98
  v_sub_f32 v107, v238, v98
  v_sub_f32 v108, v239, v98
  v_sub_f32 v109, v240, v98
  v_mul_f32 v96, v100, v100
  v_fmac_f32 v96, v101, v101
  v_fmac_f32 v96, v102, v102
  v_fmac_f32 v96, v103, v103
  v_fmac_f32 v96, v104, v104
  v_fmac_f32 v96, v105, v105
  v_fmac_f32 v96, v106, v106
  v_fmac_f32 v96, v107, v107
  v_fmac_f32 v96, v108, v108
  v_fmac_f32 v96, v109, v109
  s_nop 1
  v_add_f32_dpp v96, v96, v96 quad_perm:[1,0,3,2] row_mask:0xf bank_mask:0xf
  s_nop 1
  v_add_f32_dpp v96, v96, v96 quad_perm:[2,3,0,1] row_mask:0xf bank_mask:0xf
  s_nop 1
  v_add_f32_dpp v96, v96, v96 row_half_mirror row_mask:0xf bank_mask:0xf
  s_nop 1
  v_add_f32_dpp v96, v96, v96 row_mirror row_mask:0xf bank_mask:0xf
  v_mov_b32 v97, v96
  s_nop 1
  v_permlane16_swap_b32 v96, v97
  v_add_f32 v96, v96, v97
  v_mov_b32 v97, v96
  s_nop 1
  v_permlane32_swap_b32 v96, v97
  v_add_f32 v96, v96, v97
  v_mul_f32 v99, 0x3acccccd, v96
  v_cvt_pk_bf16_f32 v98, 0, v98
  v_cvt_pk_bf16_f32 v99, 0, v99
  v_add_f32 v99, 0x3727c5ac, v99
  v_cvt_pk_bf16_f32 v99, 0, v99
  v_sqrt_f32 v99, v99
  s_nop 0
  v_cvt_pk_bf16_f32 v99, 0, v99
  v_rcp_f32 v97, v99
  v_sub_f32 v100, v231, v98
  v_sub_f32 v101, v232, v98
  v_sub_f32 v102, v233, v98
  v_sub_f32 v103, v234, v98
  v_sub_f32 v104, v235, v98
  v_sub_f32 v105, v236, v98
  v_sub_f32 v106, v237, v98
  v_sub_f32 v107, v238, v98
  v_sub_f32 v108, v239, v98
  v_sub_f32 v109, v240, v98
  v_cvt_pk_bf16_f32 v100, 0, v100
  v_cvt_pk_bf16_f32 v101, 0, v101
  v_cvt_pk_bf16_f32 v102, 0, v102
  v_cvt_pk_bf16_f32 v103, 0, v103
  v_cvt_pk_bf16_f32 v104, 0, v104
  v_cvt_pk_bf16_f32 v105, 0, v105
  v_cvt_pk_bf16_f32 v106, 0, v106
  v_cvt_pk_bf16_f32 v107, 0, v107
  v_cvt_pk_bf16_f32 v108, 0, v108
  v_cvt_pk_bf16_f32 v109, 0, v109
  v_mul_f32 v110, v100, v97
  v_mul_f32 v111, v101, v97
  v_mul_f32 v112, v102, v97
  v_mul_f32 v113, v103, v97
  v_mul_f32 v114, v104, v97
  v_mul_f32 v115, v105, v97
  v_mul_f32 v116, v106, v97
  v_mul_f32 v117, v107, v97
  v_mul_f32 v118, v108, v97
  v_mul_f32 v119, v109, v97
  v_fma_f32 v241, -v110, v99, v100
  v_fma_f32 v242, -v111, v99, v101
  v_fma_f32 v243, -v112, v99, v102
  v_fma_f32 v244, -v113, v99, v103
  v_fma_f32 v245, -v114, v99, v104
  v_fma_f32 v246, -v115, v99, v105
  v_fma_f32 v247, -v116, v99, v106
  v_fma_f32 v248, -v117, v99, v107
  v_fma_f32 v249, -v118, v99, v108
  v_fma_f32 v250, -v119, v99, v109
  v_fma_f32 v110, v241, v97, v110
  v_fma_f32 v111, v242, v97, v111
  v_fma_f32 v112, v243, v97, v112
  v_fma_f32 v113, v244, v97, v113
  v_fma_f32 v114, v245, v97, v114
  v_fma_f32 v115, v246, v97, v115
  v_fma_f32 v116, v247, v97, v116
  v_fma_f32 v117, v248, v97, v117
  v_fma_f32 v118, v249, v97, v118
  v_fma_f32 v119, v250, v97, v119
  s_mul_i32 s4, s3, 5120
  v_lshlrev_b32 v254, 4, v0
  v_add_u32 v254, s4, v254
  v_cvt_pk_bf16_f32 v120, v110, 0
  v_cvt_pk_bf16_f32 v121, 0, v110
  v_cvt_pk_bf16_f32 v122, v111, 0
  v_cvt_pk_bf16_f32 v123, 0, v111
  ds_write_b128 v254, v[120:123] offset:0
  s_waitcnt lgkmcnt(0)
  v_cvt_pk_bf16_f32 v120, v112, 0
  v_cvt_pk_bf16_f32 v121, 0, v112
  v_cvt_pk_bf16_f32 v122, v113, 0
  v_cvt_pk_bf16_f32 v123, 0, v113
  ds_write_b128 v254, v[120:123] offset:1024
  s_waitcnt lgkmcnt(0)
  v_cvt_pk_bf16_f32 v120, v114, 0
  v_cvt_pk_bf16_f32 v121, 0, v114
  v_cvt_pk_bf16_f32 v122, v115, 0
  v_cvt_pk_bf16_f32 v123, 0, v115
  ds_write_b128 v254, v[120:123] offset:2048
  s_waitcnt lgkmcnt(0)
  v_cvt_pk_bf16_f32 v120, v116, 0
  v_cvt_pk_bf16_f32 v121, 0, v116
  v_cvt_pk_bf16_f32 v122, v117, 0
  v_cvt_pk_bf16_f32 v123, 0, v117
  ds_write_b128 v254, v[120:123] offset:3072
  s_waitcnt lgkmcnt(0)
  v_cvt_pk_bf16_f32 v120, v118, 0
  v_cvt_pk_bf16_f32 v121, 0, v118
  v_cvt_pk_bf16_f32 v122, v119, 0
  v_cvt_pk_bf16_f32 v123, 0, v119
  ds_write_b128 v254, v[120:123] offset:4096
  s_waitcnt lgkmcnt(0)
  s_waitcnt lgkmcnt(0)
  s_barrier
  v_and_b32 v254, 15, v0
  v_mul_u32_u24 v254, 80, v254
  s_mul_i32 s4, s3, 1280
  v_add_u32 v254, s4, v254
  v_mov_b32 v96, 0
  v_mov_b32 v97, 0
  v_mov_b32 v98, 0
  v_mov_b32 v99, 0
  v_mov_b32 v100, 0
  v_mov_b32 v101, 0
  v_mov_b32 v102, 0
  v_mov_b32 v103, 0
  v_mov_b32 v104, 0
  v_mov_b32 v105, 0
  v_mov_b32 v106, 0
  v_mov_b32 v107, 0
  v_mov_b32 v108, 0
  v_mov_b32 v109, 0
  v_mov_b32 v110, 0
  v_mov_b32 v111, 0
  v_mov_b32 v112, 0
  v_mov_b32 v113, 0
  v_mov_b32 v114, 0
  v_mov_b32 v115, 0
  v_mov_b32 v116, 0
  v_mov_b32 v117, 0
  v_mov_b32 v118, 0
  v_mov_b32 v119, 0
  v_mov_b32 v120, 0
  v_mov_b32 v121, 0
  v_mov_b32 v122, 0
  v_mov_b32 v123, 0
  v_mov_b32 v124, 0
  v_mov_b32 v125, 0
  v_mov_b32 v126, 0
  v_mov_b32 v127, 0
  s_waitcnt vmcnt(0)
  ds_read_b128 v[226:229], v254 offset:0
  ds_read_b128 v[230:233], v254 offset:16
  ds_read_b128 v[234:237], v254 offset:32
  ds_read_b128 v[238:241], v254 offset:48
  ds_read_b128 v[242:245], v254 offset:64
  s_waitcnt lgkmcnt(0)
  GV8 56, 226, 96
  GV8 60, 228, 96
  GV8 64, 230, 96
  GV8 68, 232, 96
  GV8 72, 234, 96
  GV8 76, 236, 96
  GV8 80, 238, 96
  GV8 84, 240, 96
  GV8 88, 242, 96
  GV8 92, 244, 96
  ds_read_b128 v[226:229], v254 offset:5120
  ds_read_b128 v[230:233], v254 offset:5136
  ds_read_b128 v[234:237], v254 offset:5152
  ds_read_b128 v[238:241], v254 offset:5168
  ds_read_b128 v[242:245], v254 offset:5184
  s_waitcnt lgkmcnt(0)
  GV8 56, 226, 104
  GV8 60, 228, 104
  GV8 64, 230, 104
  GV8 68, 232, 104
  GV8 72, 234, 104
  GV8 76, 236, 104
  GV8 80, 238, 104
  GV8 84, 240, 104
  GV8 88, 242, 104
  GV8 92, 244, 104
  ds_read_b128 v[226:229], v254 offset:10240
  ds_read_b128 v[230:233], v254 offset:10256
  ds_read_b128 v[234:237], v254 offset:10272
  ds_read_b128 v[238:241], v254 offset:10288
  ds_read_b128 v[242:245], v254 offset:10304
  s_waitcnt lgkmcnt(0)
  GV8 56, 226, 112
  GV8 60, 228, 112
  GV8 64, 230, 112
  GV8 68, 232, 112
  GV8 72, 234, 112
  GV8 76, 236, 112
  GV8 80, 238, 112
  GV8 84, 240, 112
  GV8 88, 242, 112
  GV8 92, 244, 112
  ds_read_b128 v[226:229], v254 offset:15360
  ds_read_b128 v[230:233], v254 offset:15376
  ds_read_b128 v[234:237], v254 offset:15392
  ds_read_b128 v[238:241], v254 offset:15408
  ds_read_b128 v[242:245], v254 offset:15424
  s_waitcnt lgkmcnt(0)
  GV8 56, 226, 120
  GV8 60, 228, 120
  GV8 64, 230, 120
  GV8 68, 232, 120
  GV8 72, 234, 120
  GV8 76, 236, 120
  GV8 80, 238, 120
  GV8 84, 240, 120
  GV8 88, 242, 120
  GV8 92, 244, 120
  v_add_f32_dpp v96, v96, v96 quad_perm:[1,0,3,2] row_mask:0xf bank_mask:0xf
  v_add_f32_dpp v97, v97, v97 quad_perm:[1,0,3,2] row_mask:0xf bank_mask:0xf
  v_add_f32_dpp v98, v98, v98 quad_perm:[1,0,3,2] row_mask:0xf bank_mask:0xf
  v_add_f32_dpp v99, v99, v99 quad_perm:[1,0,3,2] row_mask:0xf bank_mask:0xf
  v_add_f32_dpp v100, v100, v100 quad_perm:[1,0,3,2] row_mask:0xf bank_mask:0xf
  v_add_f32_dpp v101, v101, v101 quad_perm:[1,0,3,2] row_mask:0xf bank_mask:0xf
  v_add_f32_dpp v102, v102, v102 quad_perm:[1,0,3,2] row_mask:0xf bank_mask:0xf
  v_add_f32_dpp v103, v103, v103 quad_perm:[1,0,3,2] row_mask:0xf bank_mask:0xf
  v_add_f32_dpp v104, v104, v104 quad_perm:[1,0,3,2] row_mask:0xf bank_mask:0xf
  v_add_f32_dpp v105, v105, v105 quad_perm:[1,0,3,2] row_mask:0xf bank_mask:0xf
  v_add_f32_dpp v106, v106, v106 quad_perm:[1,0,3,2] row_mask:0xf bank_mask:0xf
  v_add_f32_dpp v107, v107, v107 quad_perm:[1,0,3,2] row_mask:0xf bank_mask:0xf
  v_add_f32_dpp v108, v108, v108 quad_perm:[1,0,3,2] row_mask:0xf bank_mask:0xf
  v_add_f32_dpp v109, v109, v109 quad_perm:[1,0,3,2] row_mask:0xf bank_mask:0xf
  v_add_f32_dpp v110, v110, v110 quad_perm:[1,0,3,2] row_mask:0xf bank_mask:0xf
  v_add_f32_dpp v111, v111, v111 quad_perm:[1,0,3,2] row_mask:0xf bank_mask:0xf
  v_add_f32_dpp v112, v112, v112 quad_perm:[1,0,3,2] row_mask:0xf bank_mask:0xf
  v_add_f32_dpp v113, v113, v113 quad_perm:[1,0,3,2] row_mask:0xf bank_mask:0xf
  v_add_f32_dpp v114, v114, v114 quad_perm:[1,0,3,2] row_mask:0xf bank_mask:0xf
  v_add_f32_dpp v115, v115, v115 quad_perm:[1,0,3,2] row_mask:0xf bank_mask:0xf
  v_add_f32_dpp v116, v116, v116 quad_perm:[1,0,3,2] row_mask:0xf bank_mask:0xf
  v_add_f32_dpp v117, v117, v117 quad_perm:[1,0,3,2] row_mask:0xf bank_mask:0xf
  v_add_f32_dpp v118, v118, v118 quad_perm:[1,0,3,2] row_mask:0xf bank_mask:0xf
  v_add_f32_dpp v119, v119, v119 quad_perm:[1,0,3,2] row_mask:0xf bank_mask:0xf
  v_add_f32_dpp v120, v120, v120 quad_perm:[1,0,3,2] row_mask:0xf bank_mask:0xf
  v_add_f32_dpp v121, v121, v121 quad_perm:[1,0,3,2] row_mask:0xf bank_mask:0xf
  v_add_f32_dpp v122, v122, v122 quad_perm:[1,0,3,2] row_mask:0xf bank_mask:0xf
  v_add_f32_dpp v123, v123, v123 quad_perm:[1,0,3,2] row_mask:0xf bank_mask:0xf
  v_add_f32_dpp v124, v124, v124 quad_perm:[1,0,3,2] row_mask:0xf bank_mask:0xf
  v_add_f32_dpp v125, v125, v125 quad_perm:[1,0,3,2] row_mask:0xf bank_mask:0xf
  v_add_f32_dpp v126, v126, v126 quad_perm:[1,0,3,2] row_mask:0xf bank_mask:0xf
  v_add_f32_dpp v127, v127, v127 quad_perm:[1,0,3,2] row_mask:0xf bank_mask:0xf
  v_add_f32_dpp v96, v96, v96 quad_perm:[2,3,0,1] row_mask:0xf bank_mask:0xf
  v_add_f32_dpp v97, v97, v97 quad_perm:[2,3,0,1] row_mask:0xf bank_mask:0xf
  v_add_f32_dpp v98, v98, v98 quad_perm:[2,3,0,1] row_mask:0xf bank_mask:0xf
  v_add_f32_dpp v99, v99, v99 quad_perm:[2,3,0,1] row_mask:0xf bank_mask:0xf
  v_add_f32_dpp v100, v100, v100 quad_perm:[2,3,0,1] row_mask:0xf bank_mask:0xf
  v_add_f32_dpp v101, v101, v101 quad_perm:[2,3,0,1] row_mask:0xf bank_mask:0xf
  v_add_f32_dpp v102, v102, v102 quad_perm:[2,3,0,1] row_mask:0xf bank_mask:0xf
  v_add_f32_dpp v103, v103, v103 quad_perm:[2,3,0,1] row_mask:0xf bank_mask:0xf
  v_add_f32_dpp v104, v104, v104 quad_perm:[2,3,0,1] row_mask:0xf bank_mask:0xf
  v_add_f32_dpp v105, v105, v105 quad_perm:[2,3,0,1] row_mask:0xf bank_mask:0xf
  v_add_f32_dpp v106, v106, v106 quad_perm:[2,3,0,1] row_mask:0xf bank_mask:0xf
  v_add_f32_dpp v107, v107, v107 quad_perm:[2,3,0,1] row_mask:0xf bank_mask:0xf
  v_add_f32_dpp v108, v108, v108 quad_perm:[2,3,0,1] row_mask:0xf bank_mask:0xf
  v_add_f32_dpp v109, v109, v109 quad_perm:[2,3,0,1] row_mask:0xf bank_mask:0xf
  v_add_f32_dpp v110, v110, v110 quad_perm:[2,3,0,1] row_mask:0xf bank_mask:0xf
  v_add_f32_dpp v111, v111, v111 quad_perm:[2,3,0,1] row_mask:0xf bank_mask:0xf
  v_add_f32_dpp v112, v112, v112 quad_perm:[2,3,0,1] row_mask:0xf bank_mask:0xf
  v_add_f32_dpp v113, v113, v113 quad_perm:[2,3,0,1] row_mask:0xf bank_mask:0xf
  v_add_f32_dpp v114, v114, v114 quad_perm:[2,3,0,1] row_mask:0xf bank_mask:0xf
  v_add_f32_dpp v115, v115, v115 quad_perm:[2,3,0,1] row_mask:0xf bank_mask:0xf
  v_add_f32_dpp v116, v116, v116 quad_perm:[2,3,0,1] row_mask:0xf bank_mask:0xf
  v_add_f32_dpp v117, v117, v117 quad_perm:[2,3,0,1] row_mask:0xf bank_mask:0xf
  v_add_f32_dpp v118, v118, v118 quad_perm:[2,3,0,1] row_mask:0xf bank_mask:0xf
  v_add_f32_dpp v119, v119, v119 quad_perm:[2,3,0,1] row_mask:0xf bank_mask:0xf
  v_add_f32_dpp v120, v120, v120 quad_perm:[2,3,0,1] row_mask:0xf bank_mask:0xf
  v_add_f32_dpp v121, v121, v121 quad_perm:[2,3,0,1] row_mask:0xf bank_mask:0xf
  v_add_f32_dpp v122, v122, v122 quad_perm:[2,3,0,1] row_mask:0xf bank_mask:0xf
  v_add_f32_dpp v123, v123, v123 quad_perm:[2,3,0,1] row_mask:0xf bank_mask:0xf
  v_add_f32_dpp v124, v124, v124 quad_perm:[2,3,0,1] row_mask:0xf bank_mask:0xf
  v_add_f32_dpp v125, v125, v125 quad_perm:[2,3,0,1] row_mask:0xf bank_mask:0xf
  v_add_f32_dpp v126, v126, v126 quad_perm:[2,3,0,1] row_mask:0xf bank_mask:0xf
  v_add_f32_dpp v127, v127, v127 quad_perm:[2,3,0,1] row_mask:0xf bank_mask:0xf
  v_add_f32_dpp v96, v96, v96 row_half_mirror row_mask:0xf bank_mask:0xf
  v_add_f32_dpp v97, v97, v97 row_half_mirror row_mask:0xf bank_mask:0xf
  v_add_f32_dpp v98, v98, v98 row_half_mirror row_mask:0xf bank_mask:0xf
  v_add_f32_dpp v99, v99, v99 row_half_mirror row_mask:0xf bank_mask:0xf
  v_add_f32_dpp v100, v100, v100 row_half_mirror row_mask:0xf bank_mask:0xf
  v_add_f32_dpp v101, v101, v101 row_half_mirror row_mask:0xf bank_mask:0xf
  v_add_f32_dpp v102, v102, v102 row_half_mirror row_mask:0xf bank_mask:0xf
  v_add_f32_dpp v103, v103, v103 row_half_mirror row_mask:0xf bank_mask:0xf
  v_add_f32_dpp v104, v104, v104 row_half_mirror row_mask:0xf bank_mask:0xf
  v_add_f32_dpp v105, v105, v105 row_half_mirror row_mask:0xf bank_mask:0xf
  v_add_f32_dpp v106, v106, v106 row_half_mirror row_mask:0xf bank_mask:0xf
  v_add_f32_dpp v107, v107, v107 row_half_mirror row_mask:0xf bank_mask:0xf
  v_add_f32_dpp v108, v108, v108 row_half_mirror row_mask:0xf bank_mask:0xf
  v_add_f32_dpp v109, v109, v109 row_half_mirror row_mask:0xf bank_mask:0xf
  v_add_f32_dpp v110, v110, v110 row_half_mirror row_mask:0xf bank_mask:0xf
  v_add_f32_dpp v111, v111, v111 row_half_mirror row_mask:0xf bank_mask:0xf
  v_add_f32_dpp v112, v112, v112 row_half_mirror row_mask:0xf bank_mask:0xf
  v_add_f32_dpp v113, v113, v113 row_half_mirror row_mask:0xf bank_mask:0xf
  v_add_f32_dpp v114, v114, v114 row_half_mirror row_mask:0xf bank_mask:0xf
  v_add_f32_dpp v115, v115, v115 row_half_mirror row_mask:0xf bank_mask:0xf
  v_add_f32_dpp v116, v116, v116 row_half_mirror row_mask:0xf bank_mask:0xf
  v_add_f32_dpp v117, v117, v117 row_half_mirror row_mask:0xf bank_mask:0xf
  v_add_f32_dpp v118, v118, v118 row_half_mirror row_mask:0xf bank_mask:0xf
  v_add_f32_dpp v119, v119, v119 row_half_mirror row_mask:0xf bank_mask:0xf
  v_add_f32_dpp v120, v120, v120 row_half_mirror row_mask:0xf bank_mask:0xf
  v_add_f32_dpp v121, v121, v121 row_half_mirror row_mask:0xf bank_mask:0xf
  v_add_f32_dpp v122, v122, v122 row_half_mirror row_mask:0xf bank_mask:0xf
  v_add_f32_dpp v123, v123, v123 row_half_mirror row_mask:0xf bank_mask:0xf
  v_add_f32_dpp v124, v124, v124 row_half_mirror row_mask:0xf bank_mask:0xf
  v_add_f32_dpp v125, v125, v125 row_half_mirror row_mask:0xf bank_mask:0xf
  v_add_f32_dpp v126, v126, v126 row_half_mirror row_mask:0xf bank_mask:0xf
  v_add_f32_dpp v127, v127, v127 row_half_mirror row_mask:0xf bank_mask:0xf
  v_add_f32_dpp v96, v96, v96 row_mirror row_mask:0xf bank_mask:0xf
  v_add_f32_dpp v97, v97, v97 row_mirror row_mask:0xf bank_mask:0xf
  v_add_f32_dpp v98, v98, v98 row_mirror row_mask:0xf bank_mask:0xf
  v_add_f32_dpp v99, v99, v99 row_mirror row_mask:0xf bank_mask:0xf
  v_add_f32_dpp v100, v100, v100 row_mirror row_mask:0xf bank_mask:0xf
  v_add_f32_dpp v101, v101, v101 row_mirror row_mask:0xf bank_mask:0xf
  v_add_f32_dpp v102, v102, v102 row_mirror row_mask:0xf bank_mask:0xf
  v_add_f32_dpp v103, v103, v103 row_mirror row_mask:0xf bank_mask:0xf
  v_add_f32_dpp v104, v104, v104 row_mirror row_mask:0xf bank_mask:0xf
  v_add_f32_dpp v105, v105, v105 row_mirror row_mask:0xf bank_mask:0xf
  v_add_f32_dpp v106, v106, v106 row_mirror row_mask:0xf bank_mask:0xf
  v_add_f32_dpp v107, v107, v107 row_mirror row_mask:0xf bank_mask:0xf
  v_add_f32_dpp v108, v108, v108 row_mirror row_mask:0xf bank_mask:0xf
  v_add_f32_dpp v109, v109, v109 row_mirror row_mask:0xf bank_mask:0xf
  v_add_f32_dpp v110, v110, v110 row_mirror row_mask:0xf bank_mask:0xf
  v_add_f32_dpp v111, v111, v111 row_mirror row_mask:0xf bank_mask:0xf
  v_add_f32_dpp v112, v112, v112 row_mirror row_mask:0xf bank_mask:0xf
  v_add_f32_dpp v113, v113, v113 row_mirror row_mask:0xf bank_mask:0xf
  v_add_f32_dpp v114, v114, v114 row_mirror row_mask:0xf bank_mask:0xf
  v_add_f32_dpp v115, v115, v115 row_mirror row_mask:0xf bank_mask:0xf
  v_add_f32_dpp v116, v116, v116 row_mirror row_mask:0xf bank_mask:0xf
  v_add_f32_dpp v117, v117, v117 row_mirror row_mask:0xf bank_mask:0xf
  v_add_f32_dpp v118, v118, v118 row_mirror row_mask:0xf bank_mask:0xf
  v_add_f32_dpp v119, v119, v119 row_mirror row_mask:0xf bank_mask:0xf
  v_add_f32_dpp v120, v120, v120 row_mirror row_mask:0xf bank_mask:0xf
  v_add_f32_dpp v121, v121, v121 row_mirror row_mask:0xf bank_mask:0xf
  v_add_f32_dpp v122, v122, v122 row_mirror row_mask:0xf bank_mask:0xf
  v_add_f32_dpp v123, v123, v123 row_mirror row_mask:0xf bank_mask:0xf
  v_add_f32_dpp v124, v124, v124 row_mirror row_mask:0xf bank_mask:0xf
  v_add_f32_dpp v125, v125, v125 row_mirror row_mask:0xf bank_mask:0xf
  v_add_f32_dpp v126, v126, v126 row_mirror row_mask:0xf bank_mask:0xf
  v_add_f32_dpp v127, v127, v127 row_mirror row_mask:0xf bank_mask:0xf
  v_lshrrev_b32 v254, 4, v0
  v_lshlrev_b32 v254, 7, v254
  s_mul_i32 s4, s3, 384
  s_add_u32 s4, s4, 20480
  v_add_u32 v254, s4, v254
  s_mov_b32 exec_lo, 0x10001
  s_mov_b32 exec_hi, 1
  ds_write_b128 v254, v[96:99] offset:0
  ds_write_b128 v254, v[100:103] offset:16
  ds_write_b128 v254, v[104:107] offset:32
  ds_write_b128 v254, v[108:111] offset:48
  ds_write_b128 v254, v[112:115] offset:64
  ds_write_b128 v254, v[116:119] offset:80
  ds_write_b128 v254, v[120:123] offset:96
  ds_write_b128 v254, v[124:127] offset:112
  s_mov_b64 exec, -1
  s_waitcnt lgkmcnt(0)
  s_barrier
  s_cmp_lg_u32 s3, 0
  s_cbranch_scc1 Lw0176
  v_mul_u32_u24 v254, 171, v0
  v_lshrrev_b32 v254, 9, v254
  v_mul_u32_u24 v255, 3, v254
  v_sub_u32 v255, v0, v255
  v_lshlrev_b32 v128, 7, v255
  v_lshl_add_u32 v128, v254, 5, v128
  v_and_b32 v128, 0x1ff, v128
  ds_read_b128 v[56:59], v128 offset:20480
  ds_read_b128 v[60:63], v128 offset:20496
  ds_read_b128 v[64:67], v128 offset:20864
  ds_read_b128 v[68:71], v128 offset:20880
  ds_read_b128 v[72:75], v128 offset:21248
  ds_read_b128 v[76:79], v128 offset:21264
  ds_read_b128 v[80:83], v128 offset:21632
  ds_read_b128 v[84:87], v128 offset:21648
  s_waitcnt lgkmcnt(0)
  v_add_f32 v56, v56, v64
  v_add_f32 v57, v57, v65
  v_add_f32 v58, v58, v66
  v_add_f32 v59, v59, v67
  v_add_f32 v60, v60, v68
  v_add_f32 v61, v61, v69
  v_add_f32 v62, v62, v70
  v_add_f32 v63, v63, v71
  v_add_f32 v56, v56, v72
  v_add_f32 v57, v57, v73
  v_add_f32 v58, v58, v74
  v_add_f32 v59, v59, v75
  v_add_f32 v60, v60, v76
  v_add_f32 v61, v61, v77
  v_add_f32 v62, v62, v78
  v_add_f32 v63, v63, v79
  v_add_f32 v56, v56, v80
  v_add_f32 v57, v57, v81
  v_add_f32 v58, v58, v82
  v_add_f32 v59, v59, v83
  v_add_f32 v60, v60, v84
  v_add_f32 v61, v61, v85
  v_add_f32 v62, v62, v86
  v_add_f32 v63, v63, v87
  v_cvt_pk_bf16_f32 v96, v56, v57
  v_cvt_pk_bf16_f32 v97, v58, v59
  v_cvt_pk_bf16_f32 v98, v60, v61
  v_cvt_pk_bf16_f32 v99, v62, v63
  v_mul_u32_u24 v254, 12288, v254
  v_lshl_add_u32 v254, v255, 4, v254
  s_mov_b32 s75, 0x61a80
  v_min_u32 v252, 11, v0
  v_lshlrev_b32 v252, 2, v252
  global_load_dword v253, v252, s[28:29]
  s_waitcnt vmcnt(0)
  v_cmp_ne_u32 vcc, 1, v253
  s_cbranch_vccz Lad178
Lar177:
  global_load_dword v253, v252, s[28:29] sc1
  s_waitcnt vmcnt(0)
  v_cmp_ne_u32 vcc, 1, v253
  s_cbranch_vccz Lad178
  s_sleep 8
  s_sub_u32 s75, s75, 1
  s_cmp_lg_u32 s75, 0
  s_cbranch_scc1 Lar177
Lad178:
  s_nop 4
  s_mul_i32 s76, s2, 48
  s_add_u32 s76, s76, 0xc73000
  s_mov_b32 exec_lo, 0xfff
  s_mov_b32 exec_hi, 0
  buffer_store_dwordx4 v[96:99], v254, s[64:67], s76 offen sc1
  s_mov_b64 exec, -1
  s_waitcnt lgkmcnt(0)
Lw0176:
  s_nop 4
  s_waitcnt lgkmcnt(0)
  s_barrier
  s_sub_u32 s2, s2, 208
  s_mul_i32 s4, s2, 274432
  s_add_u32 s76, s4, 0
  s_sub_u32 s5, s76, 0xc73000
  s_cmp_lt_u32 s5, 49152
  s_cbranch_scc1 Lsa179
  buffer_store_dwordx4 v[16:19], v15, s[64:67], s76 offen sc1
Lsa179:
  s_add_u32 s76, s4, 4096
  s_sub_u32 s5, s76, 0xc73000
  s_cmp_lt_u32 s5, 49152
  s_cbranch_scc1 Lsa180
  buffer_store_dwordx4 v[16:19], v15, s[64:67], s76 offen sc1
Lsa180:
  s_add_u32 s76, s4, 8192
  s_sub_u32 s5, s76, 0xc73000
  s_cmp_lt_u32 s5, 49152
  s_cbranch_scc1 Lsa181
  buffer_store_dwordx4 v[16:19], v15, s[64:67], s76 offen sc1
Lsa181:
  s_add_u32 s76, s4, 12288
  s_sub_u32 s5, s76, 0xc73000
  s_cmp_lt_u32 s5, 49152
  s_cbranch_scc1 Lsa182
  buffer_store_dwordx4 v[16:19], v15, s[64:67], s76 offen sc1
Lsa182:
  s_add_u32 s76, s4, 16384
  s_sub_u32 s5, s76, 0xc73000
  s_cmp_lt_u32 s5, 49152
  s_cbranch_scc1 Lsa183
  buffer_store_dwordx4 v[16:19], v15, s[64:67], s76 offen sc1
Lsa183:
  s_add_u32 s76, s4, 20480
  s_sub_u32 s5, s76, 0xc73000
  s_cmp_lt_u32 s5, 49152
  s_cbranch_scc1 Lsa184
  buffer_store_dwordx4 v[16:19], v15, s[64:67], s76 offen sc1
Lsa184:
  s_add_u32 s76, s4, 24576
  s_sub_u32 s5, s76, 0xc73000
  s_cmp_lt_u32 s5, 49152
  s_cbranch_scc1 Lsa185
  buffer_store_dwordx4 v[16:19], v15, s[64:67], s76 offen sc1
Lsa185:
  s_add_u32 s76, s4, 28672
  s_sub_u32 s5, s76, 0xc73000
  s_cmp_lt_u32 s5, 49152
  s_cbranch_scc1 Lsa186
  buffer_store_dwordx4 v[16:19], v15, s[64:67], s76 offen sc1
Lsa186:
  s_add_u32 s76, s4, 32768
  s_sub_u32 s5, s76, 0xc73000
  s_cmp_lt_u32 s5, 49152
  s_cbranch_scc1 Lsa187
  buffer_store_dwordx4 v[16:19], v15, s[64:67], s76 offen sc1
Lsa187:
  s_add_u32 s76, s4, 36864
  s_sub_u32 s5, s76, 0xc73000
  s_cmp_lt_u32 s5, 49152
  s_cbranch_scc1 Lsa188
  buffer_store_dwordx4 v[16:19], v15, s[64:67], s76 offen sc1
Lsa188:
  s_add_u32 s76, s4, 40960
  s_sub_u32 s5, s76, 0xc73000
  s_cmp_lt_u32 s5, 49152
  s_cbranch_scc1 Lsa189
  buffer_store_dwordx4 v[16:19], v15, s[64:67], s76 offen sc1
Lsa189:
  s_add_u32 s76, s4, 45056
  s_sub_u32 s5, s76, 0xc73000
  s_cmp_lt_u32 s5, 49152
  s_cbranch_scc1 Lsa190
  buffer_store_dwordx4 v[16:19], v15, s[64:67], s76 offen sc1
Lsa190:
  s_add_u32 s76, s4, 49152
  s_sub_u32 s5, s76, 0xc73000
  s_cmp_lt_u32 s5, 49152
  s_cbranch_scc1 Lsa191
  buffer_store_dwordx4 v[16:19], v15, s[64:67], s76 offen sc1
Lsa191:
  s_add_u32 s76, s4, 53248
  s_sub_u32 s5, s76, 0xc73000
  s_cmp_lt_u32 s5, 49152
  s_cbranch_scc1 Lsa192
  buffer_store_dwordx4 v[16:19], v15, s[64:67], s76 offen sc1
Lsa192:
  s_add_u32 s76, s4, 57344
  s_sub_u32 s5, s76, 0xc73000
  s_cmp_lt_u32 s5, 49152
  s_cbranch_scc1 Lsa193
  buffer_store_dwordx4 v[16:19], v15, s[64:67], s76 offen sc1
Lsa193:
  s_add_u32 s76, s4, 61440
  s_sub_u32 s5, s76, 0xc73000
  s_cmp_lt_u32 s5, 49152
  s_cbranch_scc1 Lsa194
  buffer_store_dwordx4 v[16:19], v15, s[64:67], s76 offen sc1
Lsa194:
  s_add_u32 s76, s4, 65536
  s_sub_u32 s5, s76, 0xc73000
  s_cmp_lt_u32 s5, 49152
  s_cbranch_scc1 Lsa195
  buffer_store_dwordx4 v[16:19], v15, s[64:67], s76 offen sc1
Lsa195:
  s_add_u32 s76, s4, 69632
  s_sub_u32 s5, s76, 0xc73000
  s_cmp_lt_u32 s5, 49152
  s_cbranch_scc1 Lsa196
  buffer_store_dwordx4 v[16:19], v15, s[64:67], s76 offen sc1
Lsa196:
  s_add_u32 s76, s4, 73728
  s_sub_u32 s5, s76, 0xc73000
  s_cmp_lt_u32 s5, 49152
  s_cbranch_scc1 Lsa197
  buffer_store_dwordx4 v[16:19], v15, s[64:67], s76 offen sc1
Lsa197:
  s_add_u32 s76, s4, 77824
  s_sub_u32 s5, s76, 0xc73000
  s_cmp_lt_u32 s5, 49152
  s_cbranch_scc1 Lsa198
  buffer_store_dwordx4 v[16:19], v15, s[64:67], s76 offen sc1
Lsa198:
  s_add_u32 s76, s4, 81920
  s_sub_u32 s5, s76, 0xc73000
  s_cmp_lt_u32 s5, 49152
  s_cbranch_scc1 Lsa199
  buffer_store_dwordx4 v[16:19], v15, s[64:67], s76 offen sc1
Lsa199:
  s_add_u32 s76, s4, 86016
  s_sub_u32 s5, s76, 0xc73000
  s_cmp_lt_u32 s5, 49152
  s_cbranch_scc1 Lsa200
  buffer_store_dwordx4 v[16:19], v15, s[64:67], s76 offen sc1
Lsa200:
  s_add_u32 s76, s4, 90112
  s_sub_u32 s5, s76, 0xc73000
  s_cmp_lt_u32 s5, 49152
  s_cbranch_scc1 Lsa201
  buffer_store_dwordx4 v[16:19], v15, s[64:67], s76 offen sc1
Lsa201:
  s_add_u32 s76, s4, 94208
  s_sub_u32 s5, s76, 0xc73000
  s_cmp_lt_u32 s5, 49152
  s_cbranch_scc1 Lsa202
  buffer_store_dwordx4 v[16:19], v15, s[64:67], s76 offen sc1
Lsa202:
  s_add_u32 s76, s4, 98304
  s_sub_u32 s5, s76, 0xc73000
  s_cmp_lt_u32 s5, 49152
  s_cbranch_scc1 Lsa203
  buffer_store_dwordx4 v[16:19], v15, s[64:67], s76 offen sc1
Lsa203:
  s_add_u32 s76, s4, 102400
  s_sub_u32 s5, s76, 0xc73000
  s_cmp_lt_u32 s5, 49152
  s_cbranch_scc1 Lsa204
  buffer_store_dwordx4 v[16:19], v15, s[64:67], s76 offen sc1
Lsa204:
  s_add_u32 s76, s4, 106496
  s_sub_u32 s5, s76, 0xc73000
  s_cmp_lt_u32 s5, 49152
  s_cbranch_scc1 Lsa205
  buffer_store_dwordx4 v[16:19], v15, s[64:67], s76 offen sc1
Lsa205:
  s_add_u32 s76, s4, 110592
  s_sub_u32 s5, s76, 0xc73000
  s_cmp_lt_u32 s5, 49152
  s_cbranch_scc1 Lsa206
  buffer_store_dwordx4 v[16:19], v15, s[64:67], s76 offen sc1
Lsa206:
  s_add_u32 s76, s4, 114688
  s_sub_u32 s5, s76, 0xc73000
  s_cmp_lt_u32 s5, 49152
  s_cbranch_scc1 Lsa207
  buffer_store_dwordx4 v[16:19], v15, s[64:67], s76 offen sc1
Lsa207:
  s_add_u32 s76, s4, 118784
  s_sub_u32 s5, s76, 0xc73000
  s_cmp_lt_u32 s5, 49152
  s_cbranch_scc1 Lsa208
  buffer_store_dwordx4 v[16:19], v15, s[64:67], s76 offen sc1
Lsa208:
  s_add_u32 s76, s4, 122880
  s_sub_u32 s5, s76, 0xc73000
  s_cmp_lt_u32 s5, 49152
  s_cbranch_scc1 Lsa209
  buffer_store_dwordx4 v[16:19], v15, s[64:67], s76 offen sc1
Lsa209:
  s_add_u32 s76, s4, 126976
  s_sub_u32 s5, s76, 0xc73000
  s_cmp_lt_u32 s5, 49152
  s_cbranch_scc1 Lsa210
  buffer_store_dwordx4 v[16:19], v15, s[64:67], s76 offen sc1
Lsa210:
  s_add_u32 s76, s4, 131072
  s_sub_u32 s5, s76, 0xc73000
  s_cmp_lt_u32 s5, 49152
  s_cbranch_scc1 Lsa211
  buffer_store_dwordx4 v[16:19], v15, s[64:67], s76 offen sc1
Lsa211:
  s_add_u32 s76, s4, 135168
  s_sub_u32 s5, s76, 0xc73000
  s_cmp_lt_u32 s5, 49152
  s_cbranch_scc1 Lsa212
  buffer_store_dwordx4 v[16:19], v15, s[64:67], s76 offen sc1
Lsa212:
  s_add_u32 s76, s4, 139264
  s_sub_u32 s5, s76, 0xc73000
  s_cmp_lt_u32 s5, 49152
  s_cbranch_scc1 Lsa213
  buffer_store_dwordx4 v[16:19], v15, s[64:67], s76 offen sc1
Lsa213:
  s_add_u32 s76, s4, 143360
  s_sub_u32 s5, s76, 0xc73000
  s_cmp_lt_u32 s5, 49152
  s_cbranch_scc1 Lsa214
  buffer_store_dwordx4 v[16:19], v15, s[64:67], s76 offen sc1
Lsa214:
  s_add_u32 s76, s4, 147456
  s_sub_u32 s5, s76, 0xc73000
  s_cmp_lt_u32 s5, 49152
  s_cbranch_scc1 Lsa215
  buffer_store_dwordx4 v[16:19], v15, s[64:67], s76 offen sc1
Lsa215:
  s_add_u32 s76, s4, 151552
  s_sub_u32 s5, s76, 0xc73000
  s_cmp_lt_u32 s5, 49152
  s_cbranch_scc1 Lsa216
  buffer_store_dwordx4 v[16:19], v15, s[64:67], s76 offen sc1
Lsa216:
  s_add_u32 s76, s4, 155648
  s_sub_u32 s5, s76, 0xc73000
  s_cmp_lt_u32 s5, 49152
  s_cbranch_scc1 Lsa217
  buffer_store_dwordx4 v[16:19], v15, s[64:67], s76 offen sc1
Lsa217:
  s_add_u32 s76, s4, 159744
  s_sub_u32 s5, s76, 0xc73000
  s_cmp_lt_u32 s5, 49152
  s_cbranch_scc1 Lsa218
  buffer_store_dwordx4 v[16:19], v15, s[64:67], s76 offen sc1
Lsa218:
  s_add_u32 s76, s4, 163840
  s_sub_u32 s5, s76, 0xc73000
  s_cmp_lt_u32 s5, 49152
  s_cbranch_scc1 Lsa219
  buffer_store_dwordx4 v[16:19], v15, s[64:67], s76 offen sc1
Lsa219:
  s_add_u32 s76, s4, 167936
  s_sub_u32 s5, s76, 0xc73000
  s_cmp_lt_u32 s5, 49152
  s_cbranch_scc1 Lsa220
  buffer_store_dwordx4 v[16:19], v15, s[64:67], s76 offen sc1
Lsa220:
  s_add_u32 s76, s4, 172032
  s_sub_u32 s5, s76, 0xc73000
  s_cmp_lt_u32 s5, 49152
  s_cbranch_scc1 Lsa221
  buffer_store_dwordx4 v[16:19], v15, s[64:67], s76 offen sc1
Lsa221:
  s_add_u32 s76, s4, 176128
  s_sub_u32 s5, s76, 0xc73000
  s_cmp_lt_u32 s5, 49152
  s_cbranch_scc1 Lsa222
  buffer_store_dwordx4 v[16:19], v15, s[64:67], s76 offen sc1
Lsa222:
  s_add_u32 s76, s4, 180224
  s_sub_u32 s5, s76, 0xc73000
  s_cmp_lt_u32 s5, 49152
  s_cbranch_scc1 Lsa223
  buffer_store_dwordx4 v[16:19], v15, s[64:67], s76 offen sc1
Lsa223:
  s_add_u32 s76, s4, 184320
  s_sub_u32 s5, s76, 0xc73000
  s_cmp_lt_u32 s5, 49152
  s_cbranch_scc1 Lsa224
  buffer_store_dwordx4 v[16:19], v15, s[64:67], s76 offen sc1
Lsa224:
  s_add_u32 s76, s4, 188416
  s_sub_u32 s5, s76, 0xc73000
  s_cmp_lt_u32 s5, 49152
  s_cbranch_scc1 Lsa225
  buffer_store_dwordx4 v[16:19], v15, s[64:67], s76 offen sc1
Lsa225:
  s_add_u32 s76, s4, 192512
  s_sub_u32 s5, s76, 0xc73000
  s_cmp_lt_u32 s5, 49152
  s_cbranch_scc1 Lsa226
  buffer_store_dwordx4 v[16:19], v15, s[64:67], s76 offen sc1
Lsa226:
  s_add_u32 s76, s4, 196608
  s_sub_u32 s5, s76, 0xc73000
  s_cmp_lt_u32 s5, 49152
  s_cbranch_scc1 Lsa227
  buffer_store_dwordx4 v[16:19], v15, s[64:67], s76 offen sc1
Lsa227:
  s_add_u32 s76, s4, 200704
  s_sub_u32 s5, s76, 0xc73000
  s_cmp_lt_u32 s5, 49152
  s_cbranch_scc1 Lsa228
  buffer_store_dwordx4 v[16:19], v15, s[64:67], s76 offen sc1
Lsa228:
  s_add_u32 s76, s4, 204800
  s_sub_u32 s5, s76, 0xc73000
  s_cmp_lt_u32 s5, 49152
  s_cbranch_scc1 Lsa229
  buffer_store_dwordx4 v[16:19], v15, s[64:67], s76 offen sc1
Lsa229:
  s_add_u32 s76, s4, 208896
  s_sub_u32 s5, s76, 0xc73000
  s_cmp_lt_u32 s5, 49152
  s_cbranch_scc1 Lsa230
  buffer_store_dwordx4 v[16:19], v15, s[64:67], s76 offen sc1
Lsa230:
  s_add_u32 s76, s4, 212992
  s_sub_u32 s5, s76, 0xc73000
  s_cmp_lt_u32 s5, 49152
  s_cbranch_scc1 Lsa231
  buffer_store_dwordx4 v[16:19], v15, s[64:67], s76 offen sc1
Lsa231:
  s_add_u32 s76, s4, 217088
  s_sub_u32 s5, s76, 0xc73000
  s_cmp_lt_u32 s5, 49152
  s_cbranch_scc1 Lsa232
  buffer_store_dwordx4 v[16:19], v15, s[64:67], s76 offen sc1
Lsa232:
  s_add_u32 s76, s4, 221184
  s_sub_u32 s5, s76, 0xc73000
  s_cmp_lt_u32 s5, 49152
  s_cbranch_scc1 Lsa233
  buffer_store_dwordx4 v[16:19], v15, s[64:67], s76 offen sc1
Lsa233:
  s_add_u32 s76, s4, 225280
  s_sub_u32 s5, s76, 0xc73000
  s_cmp_lt_u32 s5, 49152
  s_cbranch_scc1 Lsa234
  buffer_store_dwordx4 v[16:19], v15, s[64:67], s76 offen sc1
Lsa234:
  s_add_u32 s76, s4, 229376
  s_sub_u32 s5, s76, 0xc73000
  s_cmp_lt_u32 s5, 49152
  s_cbranch_scc1 Lsa235
  buffer_store_dwordx4 v[16:19], v15, s[64:67], s76 offen sc1
Lsa235:
  s_add_u32 s76, s4, 233472
  s_sub_u32 s5, s76, 0xc73000
  s_cmp_lt_u32 s5, 49152
  s_cbranch_scc1 Lsa236
  buffer_store_dwordx4 v[16:19], v15, s[64:67], s76 offen sc1
Lsa236:
  s_add_u32 s76, s4, 237568
  s_sub_u32 s5, s76, 0xc73000
  s_cmp_lt_u32 s5, 49152
  s_cbranch_scc1 Lsa237
  buffer_store_dwordx4 v[16:19], v15, s[64:67], s76 offen sc1
Lsa237:
  s_add_u32 s76, s4, 241664
  s_sub_u32 s5, s76, 0xc73000
  s_cmp_lt_u32 s5, 49152
  s_cbranch_scc1 Lsa238
  buffer_store_dwordx4 v[16:19], v15, s[64:67], s76 offen sc1
Lsa238:
  s_add_u32 s76, s4, 245760
  s_sub_u32 s5, s76, 0xc73000
  s_cmp_lt_u32 s5, 49152
  s_cbranch_scc1 Lsa239
  buffer_store_dwordx4 v[16:19], v15, s[64:67], s76 offen sc1
Lsa239:
  s_add_u32 s76, s4, 249856
  s_sub_u32 s5, s76, 0xc73000
  s_cmp_lt_u32 s5, 49152
  s_cbranch_scc1 Lsa240
  buffer_store_dwordx4 v[16:19], v15, s[64:67], s76 offen sc1
Lsa240:
  s_add_u32 s76, s4, 253952
  s_sub_u32 s5, s76, 0xc73000
  s_cmp_lt_u32 s5, 49152
  s_cbranch_scc1 Lsa241
  buffer_store_dwordx4 v[16:19], v15, s[64:67], s76 offen sc1
Lsa241:
  s_add_u32 s76, s4, 258048
  s_sub_u32 s5, s76, 0xc73000
  s_cmp_lt_u32 s5, 49152
  s_cbranch_scc1 Lsa242
  buffer_store_dwordx4 v[16:19], v15, s[64:67], s76 offen sc1
Lsa242:
  s_add_u32 s76, s4, 262144
  s_sub_u32 s5, s76, 0xc73000
  s_cmp_lt_u32 s5, 49152
  s_cbranch_scc1 Lsa243
  buffer_store_dwordx4 v[16:19], v15, s[64:67], s76 offen sc1
Lsa243:
  s_add_u32 s76, s4, 266240
  s_sub_u32 s5, s76, 0xc73000
  s_cmp_lt_u32 s5, 49152
  s_cbranch_scc1 Lsa244
  buffer_store_dwordx4 v[16:19], v15, s[64:67], s76 offen sc1
Lsa244:
  s_add_u32 s76, s4, 270336
  s_sub_u32 s5, s76, 0xc73000
  s_cmp_lt_u32 s5, 49152
  s_cbranch_scc1 Lsa245
  buffer_store_dwordx4 v[16:19], v15, s[64:67], s76 offen sc1
Lsa245:
  s_waitcnt vmcnt(0)
  s_barrier
  s_cmp_lg_u32 s3, 0
  s_cbranch_scc1 Lw0246
  s_lshl_b32 s4, s2, 1
  s_add_u32 s4, s4, 128
  v_mov_b32 v150, s4
  v_mov_b32 v151, 1
  s_mov_b32 exec_lo, 0x1
  s_mov_b32 exec_hi, 0
  global_store_short v150, v151, s[28:29] sc1
  s_mov_b64 exec, -1
Lw0246:
  s_nop 4
  s_lshl_b32 s4, s3, 6
  v_add_u32 v1, s4, v0
  v_lshlrev_b32 v15, 4, v1
  v_min_u32 v2, 59, v0
  s_mul_i32 s4, s3, 60
  v_add_u32 v2, s4, v2
  v_lshlrev_b32 v14, 4, v2
  v_add_u32 v14, 38912, v14
  v_add_u32 v120, 61440, v14
  s_lshl_b32 s4, s3, 3
  v_add_u32 v8, s4, v0
  v_mul_u32_u24 v8, 2560, v8
  v_add_u32 v8, 2556, v8
  s_mul_i32 s4, s3, 20480
  v_lshlrev_b32 v13, 4, v0
  v_add_u32 v9, s4, v13
  s_mul_i32 s4, s3, 5120
  s_add_u32 s4, s4, 5120
  v_add_u32 v10, s4, v13
  v_lshlrev_b32 v12, 3, v0
  s_lshl_b32 s4, s2, 2
  s_add_u32 s4, s4, s3
  s_lshl_b32 s77, s4, 9
  s_add_u32 s77, s77, 0xcc4000
  s_sub_u32 s5, s2, 32
  s_mov_b32 s62, 0x5040100
  s_mov_b32 s63, 0x7060302
  v_and_b32 v3, 15, v0
  v_lshrrev_b32 v4, 4, v0
  v_lshlrev_b32 v112, 4, v4
  v_add_u32 v112, 0, v112
  s_lshl_b32 s4, s3, 6
  v_add_u32 v113, s4, v112
  s_mul_i32 s4, s3, 320
  v_add_u32 v114, s4, v112
  s_mul_i32 s70, s5, 768
  s_sub_u32 s6, 7864320, s70
  s_add_u32 s96, s14, s70
  s_addc_u32 s97, s15, 0
  s_and_b32 s97, s97, 0xffff
  s_mov_b32 s98, s6
  s_mov_b32 s99, 0x20000
  v_mul_u32_u24 v126, 98304, v4
  v_lshl_add_u32 v126, v3, 4, v126
  s_mul_i32 s4, s3, 24576
  s_add_u32 s4, s4, 38912
  v_add_u32 v14, s4, v13
  s_mul_i32 s42, s3, 1966080
  s_add_u32 s76, s42, 0
  buffer_load_dwordx4 v[16:19], v126, s[96:99], s76 offen nt
  s_add_u32 s76, s42, 12288
  buffer_load_dwordx4 v[20:23], v126, s[96:99], s76 offen nt
  s_add_u32 s76, s42, 24576
  buffer_load_dwordx4 v[24:27], v126, s[96:99], s76 offen nt
  s_add_u32 s76, s42, 36864
  buffer_load_dwordx4 v[28:31], v126, s[96:99], s76 offen nt
  s_add_u32 s76, s42, 49152
  buffer_load_dwordx4 v[32:35], v126, s[96:99], s76 offen nt
  s_add_u32 s76, s42, 61440
  buffer_load_dwordx4 v[36:39], v126, s[96:99], s76 offen nt
  s_add_u32 s76, s42, 73728
  buffer_load_dwordx4 v[40:43], v126, s[96:99], s76 offen nt
  s_add_u32 s76, s42, 86016
  buffer_load_dwordx4 v[44:47], v126, s[96:99], s76 offen nt
  s_add_u32 s76, s42, 393216
  buffer_load_dwordx4 v[48:51], v126, s[96:99], s76 offen nt
  s_add_u32 s76, s42, 405504
  buffer_load_dwordx4 v[52:55], v126, s[96:99], s76 offen nt
  s_add_u32 s76, s42, 417792
  buffer_load_dwordx4 v[56:59], v126, s[96:99], s76 offen nt
  s_add_u32 s76, s42, 430080
  buffer_load_dwordx4 v[60:63], v126, s[96:99], s76 offen nt
  s_add_u32 s76, s42, 442368
  buffer_load_dwordx4 v[64:67], v126, s[96:99], s76 offen nt
  s_add_u32 s76, s42, 454656
  buffer_load_dwordx4 v[68:71], v126, s[96:99], s76 offen nt
  s_add_u32 s76, s42, 466944
  buffer_load_dwordx4 v[72:75], v126, s[96:99], s76 offen nt
  s_add_u32 s76, s42, 479232
  buffer_load_dwordx4 v[76:79], v126, s[96:99], s76 offen nt
  s_waitcnt vmcnt(8)
  v_perm_b32 v80, v20, v16, s62
  v_perm_b32 v81, v28, v24, s62
  v_perm_b32 v82, v36, v32, s62
  v_perm_b32 v83, v44, v40, s62
  v_perm_b32 v84, v20, v16, s63
  v_perm_b32 v85, v28, v24, s63
  v_perm_b32 v86, v36, v32, s63
  v_perm_b32 v87, v44, v40, s63
  v_perm_b32 v88, v21, v17, s62
  v_perm_b32 v89, v29, v25, s62
  v_perm_b32 v90, v37, v33, s62
  v_perm_b32 v91, v45, v41, s62
  v_perm_b32 v92, v21, v17, s63
  v_perm_b32 v93, v29, v25, s63
  v_perm_b32 v94, v37, v33, s63
  v_perm_b32 v95, v45, v41, s63
  v_perm_b32 v96, v22, v18, s62
  v_perm_b32 v97, v30, v26, s62
  v_perm_b32 v98, v38, v34, s62
  v_perm_b32 v99, v46, v42, s62
  v_perm_b32 v100, v22, v18, s63
  v_perm_b32 v101, v30, v26, s63
  v_perm_b32 v102, v38, v34, s63
  v_perm_b32 v103, v46, v42, s63
  v_perm_b32 v104, v23, v19, s62
  v_perm_b32 v105, v31, v27, s62
  v_perm_b32 v106, v39, v35, s62
  v_perm_b32 v107, v47, v43, s62
  v_perm_b32 v108, v23, v19, s63
  v_perm_b32 v109, v31, v27, s63
  v_perm_b32 v110, v39, v35, s63
  v_perm_b32 v111, v47, v43, s63
  v_accvgpr_write_b32 a0, v80
  v_accvgpr_write_b32 a1, v81
  v_accvgpr_write_b32 a2, v82
  v_accvgpr_write_b32 a3, v83
  v_accvgpr_write_b32 a4, v84
  v_accvgpr_write_b32 a5, v85
  v_accvgpr_write_b32 a6, v86
  v_accvgpr_write_b32 a7, v87
  v_accvgpr_write_b32 a8, v88
  v_accvgpr_write_b32 a9, v89
  v_accvgpr_write_b32 a10, v90
  v_accvgpr_write_b32 a11, v91
  v_accvgpr_write_b32 a12, v92
  v_accvgpr_write_b32 a13, v93
  v_accvgpr_write_b32 a14, v94
  v_accvgpr_write_b32 a15, v95
  v_accvgpr_write_b32 a16, v96
  v_accvgpr_write_b32 a17, v97
  v_accvgpr_write_b32 a18, v98
  v_accvgpr_write_b32 a19, v99
  v_accvgpr_write_b32 a20, v100
  v_accvgpr_write_b32 a21, v101
  v_accvgpr_write_b32 a22, v102
  v_accvgpr_write_b32 a23, v103
  v_accvgpr_write_b32 a24, v104
  v_accvgpr_write_b32 a25, v105
  v_accvgpr_write_b32 a26, v106
  v_accvgpr_write_b32 a27, v107
  v_accvgpr_write_b32 a28, v108
  v_accvgpr_write_b32 a29, v109
  v_accvgpr_write_b32 a30, v110
  v_accvgpr_write_b32 a31, v111
  s_add_u32 s76, s42, 786432
  buffer_load_dwordx4 v[16:19], v126, s[96:99], s76 offen nt
  s_add_u32 s76, s42, 798720
  buffer_load_dwordx4 v[20:23], v126, s[96:99], s76 offen nt
  s_add_u32 s76, s42, 811008
  buffer_load_dwordx4 v[24:27], v126, s[96:99], s76 offen nt
  s_add_u32 s76, s42, 823296
  buffer_load_dwordx4 v[28:31], v126, s[96:99], s76 offen nt
  s_add_u32 s76, s42, 835584
  buffer_load_dwordx4 v[32:35], v126, s[96:99], s76 offen nt
  s_add_u32 s76, s42, 847872
  buffer_load_dwordx4 v[36:39], v126, s[96:99], s76 offen nt
  s_add_u32 s76, s42, 860160
  buffer_load_dwordx4 v[40:43], v126, s[96:99], s76 offen nt
  s_add_u32 s76, s42, 872448
  buffer_load_dwordx4 v[44:47], v126, s[96:99], s76 offen nt
  s_waitcnt vmcnt(8)
  v_perm_b32 v80, v52, v48, s62
  v_perm_b32 v81, v60, v56, s62
  v_perm_b32 v82, v68, v64, s62
  v_perm_b32 v83, v76, v72, s62
  v_perm_b32 v84, v52, v48, s63
  v_perm_b32 v85, v60, v56, s63
  v_perm_b32 v86, v68, v64, s63
  v_perm_b32 v87, v76, v72, s63
  v_perm_b32 v88, v53, v49, s62
  v_perm_b32 v89, v61, v57, s62
  v_perm_b32 v90, v69, v65, s62
  v_perm_b32 v91, v77, v73, s62
  v_perm_b32 v92, v53, v49, s63
  v_perm_b32 v93, v61, v57, s63
  v_perm_b32 v94, v69, v65, s63
  v_perm_b32 v95, v77, v73, s63
  v_perm_b32 v96, v54, v50, s62
  v_perm_b32 v97, v62, v58, s62
  v_perm_b32 v98, v70, v66, s62
  v_perm_b32 v99, v78, v74, s62
  v_perm_b32 v100, v54, v50, s63
  v_perm_b32 v101, v62, v58, s63
  v_perm_b32 v102, v70, v66, s63
  v_perm_b32 v103, v78, v74, s63
  v_perm_b32 v104, v55, v51, s62
  v_perm_b32 v105, v63, v59, s62
  v_perm_b32 v106, v71, v67, s62
  v_perm_b32 v107, v79, v75, s62
  v_perm_b32 v108, v55, v51, s63
  v_perm_b32 v109, v63, v59, s63
  v_perm_b32 v110, v71, v67, s63
  v_perm_b32 v111, v79, v75, s63
  v_accvgpr_write_b32 a32, v80
  v_accvgpr_write_b32 a33, v81
  v_accvgpr_write_b32 a34, v82
  v_accvgpr_write_b32 a35, v83
  v_accvgpr_write_b32 a36, v84
  v_accvgpr_write_b32 a37, v85
  v_accvgpr_write_b32 a38, v86
  v_accvgpr_write_b32 a39, v87
  v_accvgpr_write_b32 a40, v88
  v_accvgpr_write_b32 a41, v89
  v_accvgpr_write_b32 a42, v90
  v_accvgpr_write_b32 a43, v91
  v_accvgpr_write_b32 a44, v92
  v_accvgpr_write_b32 a45, v93
  v_accvgpr_write_b32 a46, v94
  v_accvgpr_write_b32 a47, v95
  v_accvgpr_write_b32 a48, v96
  v_accvgpr_write_b32 a49, v97
  v_accvgpr_write_b32 a50, v98
  v_accvgpr_write_b32 a51, v99
  v_accvgpr_write_b32 a52, v100
  v_accvgpr_write_b32 a53, v101
  v_accvgpr_write_b32 a54, v102
  v_accvgpr_write_b32 a55, v103
  v_accvgpr_write_b32 a56, v104
  v_accvgpr_write_b32 a57, v105
  v_accvgpr_write_b32 a58, v106
  v_accvgpr_write_b32 a59, v107
  v_accvgpr_write_b32 a60, v108
  v_accvgpr_write_b32 a61, v109
  v_accvgpr_write_b32 a62, v110
  v_accvgpr_write_b32 a63, v111
  s_add_u32 s76, s42, 1179648
  buffer_load_dwordx4 v[48:51], v126, s[96:99], s76 offen nt
  s_add_u32 s76, s42, 1191936
  buffer_load_dwordx4 v[52:55], v126, s[96:99], s76 offen nt
  s_add_u32 s76, s42, 1204224
  buffer_load_dwordx4 v[56:59], v126, s[96:99], s76 offen nt
  s_add_u32 s76, s42, 1216512
  buffer_load_dwordx4 v[60:63], v126, s[96:99], s76 offen nt
  s_add_u32 s76, s42, 1228800
  buffer_load_dwordx4 v[64:67], v126, s[96:99], s76 offen nt
  s_add_u32 s76, s42, 1241088
  buffer_load_dwordx4 v[68:71], v126, s[96:99], s76 offen nt
  s_add_u32 s76, s42, 1253376
  buffer_load_dwordx4 v[72:75], v126, s[96:99], s76 offen nt
  s_add_u32 s76, s42, 1265664
  buffer_load_dwordx4 v[76:79], v126, s[96:99], s76 offen nt
  s_waitcnt vmcnt(8)
  v_perm_b32 v80, v20, v16, s62
  v_perm_b32 v81, v28, v24, s62
  v_perm_b32 v82, v36, v32, s62
  v_perm_b32 v83, v44, v40, s62
  v_perm_b32 v84, v20, v16, s63
  v_perm_b32 v85, v28, v24, s63
  v_perm_b32 v86, v36, v32, s63
  v_perm_b32 v87, v44, v40, s63
  v_perm_b32 v88, v21, v17, s62
  v_perm_b32 v89, v29, v25, s62
  v_perm_b32 v90, v37, v33, s62
  v_perm_b32 v91, v45, v41, s62
  v_perm_b32 v92, v21, v17, s63
  v_perm_b32 v93, v29, v25, s63
  v_perm_b32 v94, v37, v33, s63
  v_perm_b32 v95, v45, v41, s63
  v_perm_b32 v96, v22, v18, s62
  v_perm_b32 v97, v30, v26, s62
  v_perm_b32 v98, v38, v34, s62
  v_perm_b32 v99, v46, v42, s62
  v_perm_b32 v100, v22, v18, s63
  v_perm_b32 v101, v30, v26, s63
  v_perm_b32 v102, v38, v34, s63
  v_perm_b32 v103, v46, v42, s63
  v_perm_b32 v104, v23, v19, s62
  v_perm_b32 v105, v31, v27, s62
  v_perm_b32 v106, v39, v35, s62
  v_perm_b32 v107, v47, v43, s62
  v_perm_b32 v108, v23, v19, s63
  v_perm_b32 v109, v31, v27, s63
  v_perm_b32 v110, v39, v35, s63
  v_perm_b32 v111, v47, v43, s63
  v_accvgpr_write_b32 a64, v80
  v_accvgpr_write_b32 a65, v81
  v_accvgpr_write_b32 a66, v82
  v_accvgpr_write_b32 a67, v83
  v_accvgpr_write_b32 a68, v84
  v_accvgpr_write_b32 a69, v85
  v_accvgpr_write_b32 a70, v86
  v_accvgpr_write_b32 a71, v87
  v_accvgpr_write_b32 a72, v88
  v_accvgpr_write_b32 a73, v89
  v_accvgpr_write_b32 a74, v90
  v_accvgpr_write_b32 a75, v91
  v_accvgpr_write_b32 a76, v92
  v_accvgpr_write_b32 a77, v93
  v_accvgpr_write_b32 a78, v94
  v_accvgpr_write_b32 a79, v95
  v_accvgpr_write_b32 a80, v96
  v_accvgpr_write_b32 a81, v97
  v_accvgpr_write_b32 a82, v98
  v_accvgpr_write_b32 a83, v99
  v_accvgpr_write_b32 a84, v100
  v_accvgpr_write_b32 a85, v101
  v_accvgpr_write_b32 a86, v102
  v_accvgpr_write_b32 a87, v103
  v_accvgpr_write_b32 a88, v104
  v_accvgpr_write_b32 a89, v105
  v_accvgpr_write_b32 a90, v106
  v_accvgpr_write_b32 a91, v107
  v_accvgpr_write_b32 a92, v108
  v_accvgpr_write_b32 a93, v109
  v_accvgpr_write_b32 a94, v110
  v_accvgpr_write_b32 a95, v111
  s_add_u32 s76, s42, 1572864
  buffer_load_dwordx4 v[16:19], v126, s[96:99], s76 offen nt
  s_add_u32 s76, s42, 1585152
  buffer_load_dwordx4 v[20:23], v126, s[96:99], s76 offen nt
  s_add_u32 s76, s42, 1597440
  buffer_load_dwordx4 v[24:27], v126, s[96:99], s76 offen nt
  s_add_u32 s76, s42, 1609728
  buffer_load_dwordx4 v[28:31], v126, s[96:99], s76 offen nt
  s_add_u32 s76, s42, 1622016
  buffer_load_dwordx4 v[32:35], v126, s[96:99], s76 offen nt
  s_add_u32 s76, s42, 1634304
  buffer_load_dwordx4 v[36:39], v126, s[96:99], s76 offen nt
  s_add_u32 s76, s42, 1646592
  buffer_load_dwordx4 v[40:43], v126, s[96:99], s76 offen nt
  s_add_u32 s76, s42, 1658880
  buffer_load_dwordx4 v[44:47], v126, s[96:99], s76 offen nt
  s_waitcnt vmcnt(8)
  v_perm_b32 v80, v52, v48, s62
  v_perm_b32 v81, v60, v56, s62
  v_perm_b32 v82, v68, v64, s62
  v_perm_b32 v83, v76, v72, s62
  v_perm_b32 v84, v52, v48, s63
  v_perm_b32 v85, v60, v56, s63
  v_perm_b32 v86, v68, v64, s63
  v_perm_b32 v87, v76, v72, s63
  v_perm_b32 v88, v53, v49, s62
  v_perm_b32 v89, v61, v57, s62
  v_perm_b32 v90, v69, v65, s62
  v_perm_b32 v91, v77, v73, s62
  v_perm_b32 v92, v53, v49, s63
  v_perm_b32 v93, v61, v57, s63
  v_perm_b32 v94, v69, v65, s63
  v_perm_b32 v95, v77, v73, s63
  v_perm_b32 v96, v54, v50, s62
  v_perm_b32 v97, v62, v58, s62
  v_perm_b32 v98, v70, v66, s62
  v_perm_b32 v99, v78, v74, s62
  v_perm_b32 v100, v54, v50, s63
  v_perm_b32 v101, v62, v58, s63
  v_perm_b32 v102, v70, v66, s63
  v_perm_b32 v103, v78, v74, s63
  v_perm_b32 v104, v55, v51, s62
  v_perm_b32 v105, v63, v59, s62
  v_perm_b32 v106, v71, v67, s62
  v_perm_b32 v107, v79, v75, s62
  v_perm_b32 v108, v55, v51, s63
  v_perm_b32 v109, v63, v59, s63
  v_perm_b32 v110, v71, v67, s63
  v_perm_b32 v111, v79, v75, s63
  v_accvgpr_write_b32 a96, v80
  v_accvgpr_write_b32 a97, v81
  v_accvgpr_write_b32 a98, v82
  v_accvgpr_write_b32 a99, v83
  v_accvgpr_write_b32 a100, v84
  v_accvgpr_write_b32 a101, v85
  v_accvgpr_write_b32 a102, v86
  v_accvgpr_write_b32 a103, v87
  v_accvgpr_write_b32 a104, v88
  v_accvgpr_write_b32 a105, v89
  v_accvgpr_write_b32 a106, v90
  v_accvgpr_write_b32 a107, v91
  v_accvgpr_write_b32 a108, v92
  v_accvgpr_write_b32 a109, v93
  v_accvgpr_write_b32 a110, v94
  v_accvgpr_write_b32 a111, v95
  v_accvgpr_write_b32 a112, v96
  v_accvgpr_write_b32 a113, v97
  v_accvgpr_write_b32 a114, v98
  v_accvgpr_write_b32 a115, v99
  v_accvgpr_write_b32 a116, v100
  v_accvgpr_write_b32 a117, v101
  v_accvgpr_write_b32 a118, v102
  v_accvgpr_write_b32 a119, v103
  v_accvgpr_write_b32 a120, v104
  v_accvgpr_write_b32 a121, v105
  v_accvgpr_write_b32 a122, v106
  v_accvgpr_write_b32 a123, v107
  v_accvgpr_write_b32 a124, v108
  v_accvgpr_write_b32 a125, v109
  v_accvgpr_write_b32 a126, v110
  v_accvgpr_write_b32 a127, v111
  s_add_u32 s76, s42, 256
  buffer_load_dwordx4 v[48:51], v126, s[96:99], s76 offen nt
  s_add_u32 s76, s42, 12544
  buffer_load_dwordx4 v[52:55], v126, s[96:99], s76 offen nt
  s_add_u32 s76, s42, 24832
  buffer_load_dwordx4 v[56:59], v126, s[96:99], s76 offen nt
  s_add_u32 s76, s42, 37120
  buffer_load_dwordx4 v[60:63], v126, s[96:99], s76 offen nt
  s_add_u32 s76, s42, 49408
  buffer_load_dwordx4 v[64:67], v126, s[96:99], s76 offen nt
  s_add_u32 s76, s42, 61696
  buffer_load_dwordx4 v[68:71], v126, s[96:99], s76 offen nt
  s_add_u32 s76, s42, 73984
  buffer_load_dwordx4 v[72:75], v126, s[96:99], s76 offen nt
  s_add_u32 s76, s42, 86272
  buffer_load_dwordx4 v[76:79], v126, s[96:99], s76 offen nt
  s_waitcnt vmcnt(8)
  v_perm_b32 v80, v20, v16, s62
  v_perm_b32 v81, v28, v24, s62
  v_perm_b32 v82, v36, v32, s62
  v_perm_b32 v83, v44, v40, s62
  v_perm_b32 v84, v20, v16, s63
  v_perm_b32 v85, v28, v24, s63
  v_perm_b32 v86, v36, v32, s63
  v_perm_b32 v87, v44, v40, s63
  v_perm_b32 v88, v21, v17, s62
  v_perm_b32 v89, v29, v25, s62
  v_perm_b32 v90, v37, v33, s62
  v_perm_b32 v91, v45, v41, s62
  v_perm_b32 v92, v21, v17, s63
  v_perm_b32 v93, v29, v25, s63
  v_perm_b32 v94, v37, v33, s63
  v_perm_b32 v95, v45, v41, s63
  v_perm_b32 v96, v22, v18, s62
  v_perm_b32 v97, v30, v26, s62
  v_perm_b32 v98, v38, v34, s62
  v_perm_b32 v99, v46, v42, s62
  v_perm_b32 v100, v22, v18, s63
  v_perm_b32 v101, v30, v26, s63
  v_perm_b32 v102, v38, v34, s63
  v_perm_b32 v103, v46, v42, s63
  v_perm_b32 v104, v23, v19, s62
  v_perm_b32 v105, v31, v27, s62
  v_perm_b32 v106, v39, v35, s62
  v_perm_b32 v107, v47, v43, s62
  v_perm_b32 v108, v23, v19, s63
  v_perm_b32 v109, v31, v27, s63
  v_perm_b32 v110, v39, v35, s63
  v_perm_b32 v111, v47, v43, s63
  ds_write_b128 v14, v[80:83] offset:0
  ds_write_b128 v14, v[84:87] offset:1024
  ds_write_b128 v14, v[88:91] offset:2048
  ds_write_b128 v14, v[92:95] offset:3072
  ds_write_b128 v14, v[96:99] offset:4096
  ds_write_b128 v14, v[100:103] offset:5120
  ds_write_b128 v14, v[104:107] offset:6144
  ds_write_b128 v14, v[108:111] offset:7168
  s_waitcnt lgkmcnt(0)
  s_add_u32 s76, s42, 393472
  buffer_load_dwordx4 v[16:19], v126, s[96:99], s76 offen nt
  s_add_u32 s76, s42, 405760
  buffer_load_dwordx4 v[20:23], v126, s[96:99], s76 offen nt
  s_add_u32 s76, s42, 418048
  buffer_load_dwordx4 v[24:27], v126, s[96:99], s76 offen nt
  s_add_u32 s76, s42, 430336
  buffer_load_dwordx4 v[28:31], v126, s[96:99], s76 offen nt
  s_add_u32 s76, s42, 442624
  buffer_load_dwordx4 v[32:35], v126, s[96:99], s76 offen nt
  s_add_u32 s76, s42, 454912
  buffer_load_dwordx4 v[36:39], v126, s[96:99], s76 offen nt
  s_add_u32 s76, s42, 467200
  buffer_load_dwordx4 v[40:43], v126, s[96:99], s76 offen nt
  s_add_u32 s76, s42, 479488
  buffer_load_dwordx4 v[44:47], v126, s[96:99], s76 offen nt
  s_waitcnt vmcnt(8)
  v_perm_b32 v80, v52, v48, s62
  v_perm_b32 v81, v60, v56, s62
  v_perm_b32 v82, v68, v64, s62
  v_perm_b32 v83, v76, v72, s62
  v_perm_b32 v84, v52, v48, s63
  v_perm_b32 v85, v60, v56, s63
  v_perm_b32 v86, v68, v64, s63
  v_perm_b32 v87, v76, v72, s63
  v_perm_b32 v88, v53, v49, s62
  v_perm_b32 v89, v61, v57, s62
  v_perm_b32 v90, v69, v65, s62
  v_perm_b32 v91, v77, v73, s62
  v_perm_b32 v92, v53, v49, s63
  v_perm_b32 v93, v61, v57, s63
  v_perm_b32 v94, v69, v65, s63
  v_perm_b32 v95, v77, v73, s63
  v_perm_b32 v96, v54, v50, s62
  v_perm_b32 v97, v62, v58, s62
  v_perm_b32 v98, v70, v66, s62
  v_perm_b32 v99, v78, v74, s62
  v_perm_b32 v100, v54, v50, s63
  v_perm_b32 v101, v62, v58, s63
  v_perm_b32 v102, v70, v66, s63
  v_perm_b32 v103, v78, v74, s63
  v_perm_b32 v104, v55, v51, s62
  v_perm_b32 v105, v63, v59, s62
  v_perm_b32 v106, v71, v67, s62
  v_perm_b32 v107, v79, v75, s62
  v_perm_b32 v108, v55, v51, s63
  v_perm_b32 v109, v63, v59, s63
  v_perm_b32 v110, v71, v67, s63
  v_perm_b32 v111, v79, v75, s63
  v_accvgpr_write_b32 a128, v80
  v_accvgpr_write_b32 a129, v81
  v_accvgpr_write_b32 a130, v82
  v_accvgpr_write_b32 a131, v83
  v_accvgpr_write_b32 a132, v84
  v_accvgpr_write_b32 a133, v85
  v_accvgpr_write_b32 a134, v86
  v_accvgpr_write_b32 a135, v87
  v_accvgpr_write_b32 a136, v88
  v_accvgpr_write_b32 a137, v89
  v_accvgpr_write_b32 a138, v90
  v_accvgpr_write_b32 a139, v91
  v_accvgpr_write_b32 a140, v92
  v_accvgpr_write_b32 a141, v93
  v_accvgpr_write_b32 a142, v94
  v_accvgpr_write_b32 a143, v95
  v_accvgpr_write_b32 a144, v96
  v_accvgpr_write_b32 a145, v97
  v_accvgpr_write_b32 a146, v98
  v_accvgpr_write_b32 a147, v99
  v_accvgpr_write_b32 a148, v100
  v_accvgpr_write_b32 a149, v101
  v_accvgpr_write_b32 a150, v102
  v_accvgpr_write_b32 a151, v103
  v_accvgpr_write_b32 a152, v104
  v_accvgpr_write_b32 a153, v105
  v_accvgpr_write_b32 a154, v106
  v_accvgpr_write_b32 a155, v107
  v_accvgpr_write_b32 a156, v108
  v_accvgpr_write_b32 a157, v109
  v_accvgpr_write_b32 a158, v110
  v_accvgpr_write_b32 a159, v111
  s_add_u32 s76, s42, 786688
  buffer_load_dwordx4 v[48:51], v126, s[96:99], s76 offen nt
  s_add_u32 s76, s42, 798976
  buffer_load_dwordx4 v[52:55], v126, s[96:99], s76 offen nt
  s_add_u32 s76, s42, 811264
  buffer_load_dwordx4 v[56:59], v126, s[96:99], s76 offen nt
  s_add_u32 s76, s42, 823552
  buffer_load_dwordx4 v[60:63], v126, s[96:99], s76 offen nt
  s_add_u32 s76, s42, 835840
  buffer_load_dwordx4 v[64:67], v126, s[96:99], s76 offen nt
  s_add_u32 s76, s42, 848128
  buffer_load_dwordx4 v[68:71], v126, s[96:99], s76 offen nt
  s_add_u32 s76, s42, 860416
  buffer_load_dwordx4 v[72:75], v126, s[96:99], s76 offen nt
  s_add_u32 s76, s42, 872704
  buffer_load_dwordx4 v[76:79], v126, s[96:99], s76 offen nt
  s_waitcnt vmcnt(8)
  v_perm_b32 v80, v20, v16, s62
  v_perm_b32 v81, v28, v24, s62
  v_perm_b32 v82, v36, v32, s62
  v_perm_b32 v83, v44, v40, s62
  v_perm_b32 v84, v20, v16, s63
  v_perm_b32 v85, v28, v24, s63
  v_perm_b32 v86, v36, v32, s63
  v_perm_b32 v87, v44, v40, s63
  v_perm_b32 v88, v21, v17, s62
  v_perm_b32 v89, v29, v25, s62
  v_perm_b32 v90, v37, v33, s62
  v_perm_b32 v91, v45, v41, s62
  v_perm_b32 v92, v21, v17, s63
  v_perm_b32 v93, v29, v25, s63
  v_perm_b32 v94, v37, v33, s63
  v_perm_b32 v95, v45, v41, s63
  v_perm_b32 v96, v22, v18, s62
  v_perm_b32 v97, v30, v26, s62
  v_perm_b32 v98, v38, v34, s62
  v_perm_b32 v99, v46, v42, s62
  v_perm_b32 v100, v22, v18, s63
  v_perm_b32 v101, v30, v26, s63
  v_perm_b32 v102, v38, v34, s63
  v_perm_b32 v103, v46, v42, s63
  v_perm_b32 v104, v23, v19, s62
  v_perm_b32 v105, v31, v27, s62
  v_perm_b32 v106, v39, v35, s62
  v_perm_b32 v107, v47, v43, s62
  v_perm_b32 v108, v23, v19, s63
  v_perm_b32 v109, v31, v27, s63
  v_perm_b32 v110, v39, v35, s63
  v_perm_b32 v111, v47, v43, s63
  v_accvgpr_write_b32 a160, v80
  v_accvgpr_write_b32 a161, v81
  v_accvgpr_write_b32 a162, v82
  v_accvgpr_write_b32 a163, v83
  v_accvgpr_write_b32 a164, v84
  v_accvgpr_write_b32 a165, v85
  v_accvgpr_write_b32 a166, v86
  v_accvgpr_write_b32 a167, v87
  v_accvgpr_write_b32 a168, v88
  v_accvgpr_write_b32 a169, v89
  v_accvgpr_write_b32 a170, v90
  v_accvgpr_write_b32 a171, v91
  v_accvgpr_write_b32 a172, v92
  v_accvgpr_write_b32 a173, v93
  v_accvgpr_write_b32 a174, v94
  v_accvgpr_write_b32 a175, v95
  v_accvgpr_write_b32 a176, v96
  v_accvgpr_write_b32 a177, v97
  v_accvgpr_write_b32 a178, v98
  v_accvgpr_write_b32 a179, v99
  v_accvgpr_write_b32 a180, v100
  v_accvgpr_write_b32 a181, v101
  v_accvgpr_write_b32 a182, v102
  v_accvgpr_write_b32 a183, v103
  v_accvgpr_write_b32 a184, v104
  v_accvgpr_write_b32 a185, v105
  v_accvgpr_write_b32 a186, v106
  v_accvgpr_write_b32 a187, v107
  v_accvgpr_write_b32 a188, v108
  v_accvgpr_write_b32 a189, v109
  v_accvgpr_write_b32 a190, v110
  v_accvgpr_write_b32 a191, v111
  s_add_u32 s76, s42, 1179904
  buffer_load_dwordx4 v[16:19], v126, s[96:99], s76 offen nt
  s_add_u32 s76, s42, 1192192
  buffer_load_dwordx4 v[20:23], v126, s[96:99], s76 offen nt
  s_add_u32 s76, s42, 1204480
  buffer_load_dwordx4 v[24:27], v126, s[96:99], s76 offen nt
  s_add_u32 s76, s42, 1216768
  buffer_load_dwordx4 v[28:31], v126, s[96:99], s76 offen nt
  s_add_u32 s76, s42, 1229056
  buffer_load_dwordx4 v[32:35], v126, s[96:99], s76 offen nt
  s_add_u32 s76, s42, 1241344
  buffer_load_dwordx4 v[36:39], v126, s[96:99], s76 offen nt
  s_add_u32 s76, s42, 1253632
  buffer_load_dwordx4 v[40:43], v126, s[96:99], s76 offen nt
  s_add_u32 s76, s42, 1265920
  buffer_load_dwordx4 v[44:47], v126, s[96:99], s76 offen nt
  s_waitcnt vmcnt(8)
  v_perm_b32 v80, v52, v48, s62
  v_perm_b32 v81, v60, v56, s62
  v_perm_b32 v82, v68, v64, s62
  v_perm_b32 v83, v76, v72, s62
  v_perm_b32 v84, v52, v48, s63
  v_perm_b32 v85, v60, v56, s63
  v_perm_b32 v86, v68, v64, s63
  v_perm_b32 v87, v76, v72, s63
  v_perm_b32 v88, v53, v49, s62
  v_perm_b32 v89, v61, v57, s62
  v_perm_b32 v90, v69, v65, s62
  v_perm_b32 v91, v77, v73, s62
  v_perm_b32 v92, v53, v49, s63
  v_perm_b32 v93, v61, v57, s63
  v_perm_b32 v94, v69, v65, s63
  v_perm_b32 v95, v77, v73, s63
  v_perm_b32 v96, v54, v50, s62
  v_perm_b32 v97, v62, v58, s62
  v_perm_b32 v98, v70, v66, s62
  v_perm_b32 v99, v78, v74, s62
  v_perm_b32 v100, v54, v50, s63
  v_perm_b32 v101, v62, v58, s63
  v_perm_b32 v102, v70, v66, s63
  v_perm_b32 v103, v78, v74, s63
  v_perm_b32 v104, v55, v51, s62
  v_perm_b32 v105, v63, v59, s62
  v_perm_b32 v106, v71, v67, s62
  v_perm_b32 v107, v79, v75, s62
  v_perm_b32 v108, v55, v51, s63
  v_perm_b32 v109, v63, v59, s63
  v_perm_b32 v110, v71, v67, s63
  v_perm_b32 v111, v79, v75, s63
  v_accvgpr_write_b32 a192, v80
  v_accvgpr_write_b32 a193, v81
  v_accvgpr_write_b32 a194, v82
  v_accvgpr_write_b32 a195, v83
  v_accvgpr_write_b32 a196, v84
  v_accvgpr_write_b32 a197, v85
  v_accvgpr_write_b32 a198, v86
  v_accvgpr_write_b32 a199, v87
  v_accvgpr_write_b32 a200, v88
  v_accvgpr_write_b32 a201, v89
  v_accvgpr_write_b32 a202, v90
  v_accvgpr_write_b32 a203, v91
  v_accvgpr_write_b32 a204, v92
  v_accvgpr_write_b32 a205, v93
  v_accvgpr_write_b32 a206, v94
  v_accvgpr_write_b32 a207, v95
  v_accvgpr_write_b32 a208, v96
  v_accvgpr_write_b32 a209, v97
  v_accvgpr_write_b32 a210, v98
  v_accvgpr_write_b32 a211, v99
  v_accvgpr_write_b32 a212, v100
  v_accvgpr_write_b32 a213, v101
  v_accvgpr_write_b32 a214, v102
  v_accvgpr_write_b32 a215, v103
  v_accvgpr_write_b32 a216, v104
  v_accvgpr_write_b32 a217, v105
  v_accvgpr_write_b32 a218, v106
  v_accvgpr_write_b32 a219, v107
  v_accvgpr_write_b32 a220, v108
  v_accvgpr_write_b32 a221, v109
  v_accvgpr_write_b32 a222, v110
  v_accvgpr_write_b32 a223, v111
  s_add_u32 s76, s42, 1573120
  buffer_load_dwordx4 v[48:51], v126, s[96:99], s76 offen nt
  s_add_u32 s76, s42, 1585408
  buffer_load_dwordx4 v[52:55], v126, s[96:99], s76 offen nt
  s_add_u32 s76, s42, 1597696
  buffer_load_dwordx4 v[56:59], v126, s[96:99], s76 offen nt
  s_add_u32 s76, s42, 1609984
  buffer_load_dwordx4 v[60:63], v126, s[96:99], s76 offen nt
  s_add_u32 s76, s42, 1622272
  buffer_load_dwordx4 v[64:67], v126, s[96:99], s76 offen nt
  s_add_u32 s76, s42, 1634560
  buffer_load_dwordx4 v[68:71], v126, s[96:99], s76 offen nt
  s_add_u32 s76, s42, 1646848
  buffer_load_dwordx4 v[72:75], v126, s[96:99], s76 offen nt
  s_add_u32 s76, s42, 1659136
  buffer_load_dwordx4 v[76:79], v126, s[96:99], s76 offen nt
  s_waitcnt vmcnt(8)
  v_perm_b32 v80, v20, v16, s62
  v_perm_b32 v81, v28, v24, s62
  v_perm_b32 v82, v36, v32, s62
  v_perm_b32 v83, v44, v40, s62
  v_perm_b32 v84, v20, v16, s63
  v_perm_b32 v85, v28, v24, s63
  v_perm_b32 v86, v36, v32, s63
  v_perm_b32 v87, v44, v40, s63
  v_perm_b32 v88, v21, v17, s62
  v_perm_b32 v89, v29, v25, s62
  v_perm_b32 v90, v37, v33, s62
  v_perm_b32 v91, v45, v41, s62
  v_perm_b32 v92, v21, v17, s63
  v_perm_b32 v93, v29, v25, s63
  v_perm_b32 v94, v37, v33, s63
  v_perm_b32 v95, v45, v41, s63
  v_perm_b32 v96, v22, v18, s62
  v_perm_b32 v97, v30, v26, s62
  v_perm_b32 v98, v38, v34, s62
  v_perm_b32 v99, v46, v42, s62
  v_perm_b32 v100, v22, v18, s63
  v_perm_b32 v101, v30, v26, s63
  v_perm_b32 v102, v38, v34, s63
  v_perm_b32 v103, v46, v42, s63
  v_perm_b32 v104, v23, v19, s62
  v_perm_b32 v105, v31, v27, s62
  v_perm_b32 v106, v39, v35, s62
  v_perm_b32 v107, v47, v43, s62
  v_perm_b32 v108, v23, v19, s63
  v_perm_b32 v109, v31, v27, s63
  v_perm_b32 v110, v39, v35, s63
  v_perm_b32 v111, v47, v43, s63
  v_accvgpr_write_b32 a224, v80
  v_accvgpr_write_b32 a225, v81
  v_accvgpr_write_b32 a226, v82
  v_accvgpr_write_b32 a227, v83
  v_accvgpr_write_b32 a228, v84
  v_accvgpr_write_b32 a229, v85
  v_accvgpr_write_b32 a230, v86
  v_accvgpr_write_b32 a231, v87
  v_accvgpr_write_b32 a232, v88
  v_accvgpr_write_b32 a233, v89
  v_accvgpr_write_b32 a234, v90
  v_accvgpr_write_b32 a235, v91
  v_accvgpr_write_b32 a236, v92
  v_accvgpr_write_b32 a237, v93
  v_accvgpr_write_b32 a238, v94
  v_accvgpr_write_b32 a239, v95
  v_accvgpr_write_b32 a240, v96
  v_accvgpr_write_b32 a241, v97
  v_accvgpr_write_b32 a242, v98
  v_accvgpr_write_b32 a243, v99
  v_accvgpr_write_b32 a244, v100
  v_accvgpr_write_b32 a245, v101
  v_accvgpr_write_b32 a246, v102
  v_accvgpr_write_b32 a247, v103
  v_accvgpr_write_b32 a248, v104
  v_accvgpr_write_b32 a249, v105
  v_accvgpr_write_b32 a250, v106
  v_accvgpr_write_b32 a251, v107
  v_accvgpr_write_b32 a252, v108
  v_accvgpr_write_b32 a253, v109
  v_accvgpr_write_b32 a254, v110
  v_accvgpr_write_b32 a255, v111
  s_add_u32 s76, s42, 512
  buffer_load_dwordx4 v[16:19], v126, s[96:99], s76 offen nt
  s_add_u32 s76, s42, 12800
  buffer_load_dwordx4 v[20:23], v126, s[96:99], s76 offen nt
  s_add_u32 s76, s42, 25088
  buffer_load_dwordx4 v[24:27], v126, s[96:99], s76 offen nt
  s_add_u32 s76, s42, 37376
  buffer_load_dwordx4 v[28:31], v126, s[96:99], s76 offen nt
  s_add_u32 s76, s42, 49664
  buffer_load_dwordx4 v[32:35], v126, s[96:99], s76 offen nt
  s_add_u32 s76, s42, 61952
  buffer_load_dwordx4 v[36:39], v126, s[96:99], s76 offen nt
  s_add_u32 s76, s42, 74240
  buffer_load_dwordx4 v[40:43], v126, s[96:99], s76 offen nt
  s_add_u32 s76, s42, 86528
  buffer_load_dwordx4 v[44:47], v126, s[96:99], s76 offen nt
  s_waitcnt vmcnt(8)
  v_perm_b32 v80, v52, v48, s62
  v_perm_b32 v81, v60, v56, s62
  v_perm_b32 v82, v68, v64, s62
  v_perm_b32 v83, v76, v72, s62
  v_perm_b32 v84, v52, v48, s63
  v_perm_b32 v85, v60, v56, s63
  v_perm_b32 v86, v68, v64, s63
  v_perm_b32 v87, v76, v72, s63
  v_perm_b32 v88, v53, v49, s62
  v_perm_b32 v89, v61, v57, s62
  v_perm_b32 v90, v69, v65, s62
  v_perm_b32 v91, v77, v73, s62
  v_perm_b32 v92, v53, v49, s63
  v_perm_b32 v93, v61, v57, s63
  v_perm_b32 v94, v69, v65, s63
  v_perm_b32 v95, v77, v73, s63
  v_perm_b32 v96, v54, v50, s62
  v_perm_b32 v97, v62, v58, s62
  v_perm_b32 v98, v70, v66, s62
  v_perm_b32 v99, v78, v74, s62
  v_perm_b32 v100, v54, v50, s63
  v_perm_b32 v101, v62, v58, s63
  v_perm_b32 v102, v70, v66, s63
  v_perm_b32 v103, v78, v74, s63
  v_perm_b32 v104, v55, v51, s62
  v_perm_b32 v105, v63, v59, s62
  v_perm_b32 v106, v71, v67, s62
  v_perm_b32 v107, v79, v75, s62
  v_perm_b32 v108, v55, v51, s63
  v_perm_b32 v109, v63, v59, s63
  v_perm_b32 v110, v71, v67, s63
  v_perm_b32 v111, v79, v75, s63
  ds_write_b128 v14, v[80:83] offset:8192
  ds_write_b128 v14, v[84:87] offset:9216
  ds_write_b128 v14, v[88:91] offset:10240
  ds_write_b128 v14, v[92:95] offset:11264
  ds_write_b128 v14, v[96:99] offset:12288
  ds_write_b128 v14, v[100:103] offset:13312
  ds_write_b128 v14, v[104:107] offset:14336
  ds_write_b128 v14, v[108:111] offset:15360
  s_waitcnt lgkmcnt(0)
  s_add_u32 s76, s42, 393728
  buffer_load_dwordx4 v[48:51], v126, s[96:99], s76 offen nt
  s_add_u32 s76, s42, 406016
  buffer_load_dwordx4 v[52:55], v126, s[96:99], s76 offen nt
  s_add_u32 s76, s42, 418304
  buffer_load_dwordx4 v[56:59], v126, s[96:99], s76 offen nt
  s_add_u32 s76, s42, 430592
  buffer_load_dwordx4 v[60:63], v126, s[96:99], s76 offen nt
  s_add_u32 s76, s42, 442880
  buffer_load_dwordx4 v[64:67], v126, s[96:99], s76 offen nt
  s_add_u32 s76, s42, 455168
  buffer_load_dwordx4 v[68:71], v126, s[96:99], s76 offen nt
  s_add_u32 s76, s42, 467456
  buffer_load_dwordx4 v[72:75], v126, s[96:99], s76 offen nt
  s_add_u32 s76, s42, 479744
  buffer_load_dwordx4 v[76:79], v126, s[96:99], s76 offen nt
  s_waitcnt vmcnt(8)
  v_perm_b32 v128, v20, v16, s62
  v_perm_b32 v129, v28, v24, s62
  v_perm_b32 v130, v36, v32, s62
  v_perm_b32 v131, v44, v40, s62
  v_perm_b32 v132, v20, v16, s63
  v_perm_b32 v133, v28, v24, s63
  v_perm_b32 v134, v36, v32, s63
  v_perm_b32 v135, v44, v40, s63
  v_perm_b32 v136, v21, v17, s62
  v_perm_b32 v137, v29, v25, s62
  v_perm_b32 v138, v37, v33, s62
  v_perm_b32 v139, v45, v41, s62
  v_perm_b32 v140, v21, v17, s63
  v_perm_b32 v141, v29, v25, s63
  v_perm_b32 v142, v37, v33, s63
  v_perm_b32 v143, v45, v41, s63
  v_perm_b32 v144, v22, v18, s62
  v_perm_b32 v145, v30, v26, s62
  v_perm_b32 v146, v38, v34, s62
  v_perm_b32 v147, v46, v42, s62
  v_perm_b32 v148, v22, v18, s63
  v_perm_b32 v149, v30, v26, s63
  v_perm_b32 v150, v38, v34, s63
  v_perm_b32 v151, v46, v42, s63
  v_perm_b32 v152, v23, v19, s62
  v_perm_b32 v153, v31, v27, s62
  v_perm_b32 v154, v39, v35, s62
  v_perm_b32 v155, v47, v43, s62
  v_perm_b32 v156, v23, v19, s63
  v_perm_b32 v157, v31, v27, s63
  v_perm_b32 v158, v39, v35, s63
  v_perm_b32 v159, v47, v43, s63
  s_add_u32 s76, s42, 786944
  buffer_load_dwordx4 v[16:19], v126, s[96:99], s76 offen nt
  s_add_u32 s76, s42, 799232
  buffer_load_dwordx4 v[20:23], v126, s[96:99], s76 offen nt
  s_add_u32 s76, s42, 811520
  buffer_load_dwordx4 v[24:27], v126, s[96:99], s76 offen nt
  s_add_u32 s76, s42, 823808
  buffer_load_dwordx4 v[28:31], v126, s[96:99], s76 offen nt
  s_add_u32 s76, s42, 836096
  buffer_load_dwordx4 v[32:35], v126, s[96:99], s76 offen nt
  s_add_u32 s76, s42, 848384
  buffer_load_dwordx4 v[36:39], v126, s[96:99], s76 offen nt
  s_add_u32 s76, s42, 860672
  buffer_load_dwordx4 v[40:43], v126, s[96:99], s76 offen nt
  s_add_u32 s76, s42, 872960
  buffer_load_dwordx4 v[44:47], v126, s[96:99], s76 offen nt
  s_waitcnt vmcnt(8)
  v_perm_b32 v160, v52, v48, s62
  v_perm_b32 v161, v60, v56, s62
  v_perm_b32 v162, v68, v64, s62
  v_perm_b32 v163, v76, v72, s62
  v_perm_b32 v164, v52, v48, s63
  v_perm_b32 v165, v60, v56, s63
  v_perm_b32 v166, v68, v64, s63
  v_perm_b32 v167, v76, v72, s63
  v_perm_b32 v168, v53, v49, s62
  v_perm_b32 v169, v61, v57, s62
  v_perm_b32 v170, v69, v65, s62
  v_perm_b32 v171, v77, v73, s62
  v_perm_b32 v172, v53, v49, s63
  v_perm_b32 v173, v61, v57, s63
  v_perm_b32 v174, v69, v65, s63
  v_perm_b32 v175, v77, v73, s63
  v_perm_b32 v176, v54, v50, s62
  v_perm_b32 v177, v62, v58, s62
  v_perm_b32 v178, v70, v66, s62
  v_perm_b32 v179, v78, v74, s62
  v_perm_b32 v180, v54, v50, s63
  v_perm_b32 v181, v62, v58, s63
  v_perm_b32 v182, v70, v66, s63
  v_perm_b32 v183, v78, v74, s63
  v_perm_b32 v184, v55, v51, s62
  v_perm_b32 v185, v63, v59, s62
  v_perm_b32 v186, v71, v67, s62
  v_perm_b32 v187, v79, v75, s62
  v_perm_b32 v188, v55, v51, s63
  v_perm_b32 v189, v63, v59, s63
  v_perm_b32 v190, v71, v67, s63
  v_perm_b32 v191, v79, v75, s63
  s_add_u32 s76, s42, 1180160
  buffer_load_dwordx4 v[48:51], v126, s[96:99], s76 offen nt
  s_add_u32 s76, s42, 1192448
  buffer_load_dwordx4 v[52:55], v126, s[96:99], s76 offen nt
  s_add_u32 s76, s42, 1204736
  buffer_load_dwordx4 v[56:59], v126, s[96:99], s76 offen nt
  s_add_u32 s76, s42, 1217024
  buffer_load_dwordx4 v[60:63], v126, s[96:99], s76 offen nt
  s_add_u32 s76, s42, 1229312
  buffer_load_dwordx4 v[64:67], v126, s[96:99], s76 offen nt
  s_add_u32 s76, s42, 1241600
  buffer_load_dwordx4 v[68:71], v126, s[96:99], s76 offen nt
  s_add_u32 s76, s42, 1253888
  buffer_load_dwordx4 v[72:75], v126, s[96:99], s76 offen nt
  s_add_u32 s76, s42, 1266176
  buffer_load_dwordx4 v[76:79], v126, s[96:99], s76 offen nt
  s_waitcnt vmcnt(8)
  v_perm_b32 v192, v20, v16, s62
  v_perm_b32 v193, v28, v24, s62
  v_perm_b32 v194, v36, v32, s62
  v_perm_b32 v195, v44, v40, s62
  v_perm_b32 v196, v20, v16, s63
  v_perm_b32 v197, v28, v24, s63
  v_perm_b32 v198, v36, v32, s63
  v_perm_b32 v199, v44, v40, s63
  v_perm_b32 v200, v21, v17, s62
  v_perm_b32 v201, v29, v25, s62
  v_perm_b32 v202, v37, v33, s62
  v_perm_b32 v203, v45, v41, s62
  v_perm_b32 v204, v21, v17, s63
  v_perm_b32 v205, v29, v25, s63
  v_perm_b32 v206, v37, v33, s63
  v_perm_b32 v207, v45, v41, s63
  v_perm_b32 v208, v22, v18, s62
  v_perm_b32 v209, v30, v26, s62
  v_perm_b32 v210, v38, v34, s62
  v_perm_b32 v211, v46, v42, s62
  v_perm_b32 v212, v22, v18, s63
  v_perm_b32 v213, v30, v26, s63
  v_perm_b32 v214, v38, v34, s63
  v_perm_b32 v215, v46, v42, s63
  v_perm_b32 v216, v23, v19, s62
  v_perm_b32 v217, v31, v27, s62
  v_perm_b32 v218, v39, v35, s62
  v_perm_b32 v219, v47, v43, s62
  v_perm_b32 v220, v23, v19, s63
  v_perm_b32 v221, v31, v27, s63
  v_perm_b32 v222, v39, v35, s63
  v_perm_b32 v223, v47, v43, s63
  s_add_u32 s76, s42, 1573376
  buffer_load_dwordx4 v[16:19], v126, s[96:99], s76 offen nt
  s_add_u32 s76, s42, 1585664
  buffer_load_dwordx4 v[20:23], v126, s[96:99], s76 offen nt
  s_add_u32 s76, s42, 1597952
  buffer_load_dwordx4 v[24:27], v126, s[96:99], s76 offen nt
  s_add_u32 s76, s42, 1610240
  buffer_load_dwordx4 v[28:31], v126, s[96:99], s76 offen nt
  s_add_u32 s76, s42, 1622528
  buffer_load_dwordx4 v[32:35], v126, s[96:99], s76 offen nt
  s_add_u32 s76, s42, 1634816
  buffer_load_dwordx4 v[36:39], v126, s[96:99], s76 offen nt
  s_add_u32 s76, s42, 1647104
  buffer_load_dwordx4 v[40:43], v126, s[96:99], s76 offen nt
  s_add_u32 s76, s42, 1659392
  buffer_load_dwordx4 v[44:47], v126, s[96:99], s76 offen nt
  s_waitcnt vmcnt(8)
  v_perm_b32 v224, v52, v48, s62
  v_perm_b32 v225, v60, v56, s62
  v_perm_b32 v226, v68, v64, s62
  v_perm_b32 v227, v76, v72, s62
  v_perm_b32 v228, v52, v48, s63
  v_perm_b32 v229, v60, v56, s63
  v_perm_b32 v230, v68, v64, s63
  v_perm_b32 v231, v76, v72, s63
  v_perm_b32 v232, v53, v49, s62
  v_perm_b32 v233, v61, v57, s62
  v_perm_b32 v234, v69, v65, s62
  v_perm_b32 v235, v77, v73, s62
  v_perm_b32 v236, v53, v49, s63
  v_perm_b32 v237, v61, v57, s63
  v_perm_b32 v238, v69, v65, s63
  v_perm_b32 v239, v77, v73, s63
  v_perm_b32 v240, v54, v50, s62
  v_perm_b32 v241, v62, v58, s62
  v_perm_b32 v242, v70, v66, s62
  v_perm_b32 v243, v78, v74, s62
  v_perm_b32 v244, v54, v50, s63
  v_perm_b32 v245, v62, v58, s63
  v_perm_b32 v246, v70, v66, s63
  v_perm_b32 v247, v78, v74, s63
  v_perm_b32 v248, v55, v51, s62
  v_perm_b32 v249, v63, v59, s62
  v_perm_b32 v250, v71, v67, s62
  v_perm_b32 v251, v79, v75, s62
  v_perm_b32 v252, v55, v51, s63
  v_perm_b32 v253, v63, v59, s63
  v_perm_b32 v254, v71, v67, s63
  v_perm_b32 v255, v79, v75, s63
  s_waitcnt vmcnt(0)
  v_perm_b32 v80, v20, v16, s62
  v_perm_b32 v81, v28, v24, s62
  v_perm_b32 v82, v36, v32, s62
  v_perm_b32 v83, v44, v40, s62
  v_perm_b32 v84, v20, v16, s63
  v_perm_b32 v85, v28, v24, s63
  v_perm_b32 v86, v36, v32, s63
  v_perm_b32 v87, v44, v40, s63
  v_perm_b32 v88, v21, v17, s62
  v_perm_b32 v89, v29, v25, s62
  v_perm_b32 v90, v37, v33, s62
  v_perm_b32 v91, v45, v41, s62
  v_perm_b32 v92, v21, v17, s63
  v_perm_b32 v93, v29, v25, s63
  v_perm_b32 v94, v37, v33, s63
  v_perm_b32 v95, v45, v41, s63
  v_perm_b32 v96, v22, v18, s62
  v_perm_b32 v97, v30, v26, s62
  v_perm_b32 v98, v38, v34, s62
  v_perm_b32 v99, v46, v42, s62
  v_perm_b32 v100, v22, v18, s63
  v_perm_b32 v101, v30, v26, s63
  v_perm_b32 v102, v38, v34, s63
  v_perm_b32 v103, v46, v42, s63
  v_perm_b32 v104, v23, v19, s62
  v_perm_b32 v105, v31, v27, s62
  v_perm_b32 v106, v39, v35, s62
  v_perm_b32 v107, v47, v43, s62
  v_perm_b32 v108, v23, v19, s63
  v_perm_b32 v109, v31, v27, s63
  v_perm_b32 v110, v39, v35, s63
  v_perm_b32 v111, v47, v43, s63
  ds_write_b128 v14, v[80:83] offset:16384
  ds_write_b128 v14, v[84:87] offset:17408
  ds_write_b128 v14, v[88:91] offset:18432
  ds_write_b128 v14, v[92:95] offset:19456
  ds_write_b128 v14, v[96:99] offset:20480
  ds_write_b128 v14, v[100:103] offset:21504
  ds_write_b128 v14, v[104:107] offset:22528
  ds_write_b128 v14, v[108:111] offset:23552
  s_waitcnt lgkmcnt(0)
  s_waitcnt lgkmcnt(0)
  s_cmp_lg_u32 s3, 0
  s_cbranch_scc1 Lw0247
  s_mov_b32 s96, s8
  s_and_b32 s97, s9, 0xffff
  s_mov_b32 s98, 0x1400
  s_mov_b32 s99, 0x20000
  v_lshlrev_b32 v127, 2, v0
  s_mov_b32 s76, 0
  buffer_load_dword v16, v127, s[96:99], s76 offen offset:0
  buffer_load_dword v17, v127, s[96:99], s76 offen offset:256
  buffer_load_dword v18, v127, s[96:99], s76 offen offset:512
  buffer_load_dword v19, v127, s[96:99], s76 offen offset:768
  buffer_load_dword v20, v127, s[96:99], s76 offen offset:1024
  s_mov_b32 s76, 0x500
  buffer_load_dword v21, v127, s[96:99], s76 offen offset:0
  buffer_load_dword v22, v127, s[96:99], s76 offen offset:256
  buffer_load_dword v23, v127, s[96:99], s76 offen offset:512
  buffer_load_dword v24, v127, s[96:99], s76 offen offset:768
  buffer_load_dword v25, v127, s[96:99], s76 offen offset:1024
  s_mov_b32 s76, 0xa00
  buffer_load_dword v26, v127, s[96:99], s76 offen offset:0
  buffer_load_dword v27, v127, s[96:99], s76 offen offset:256
  buffer_load_dword v28, v127, s[96:99], s76 offen offset:512
  buffer_load_dword v29, v127, s[96:99], s76 offen offset:768
  buffer_load_dword v30, v127, s[96:99], s76 offen offset:1024
  s_mov_b32 s76, 0xf00
  buffer_load_dword v31, v127, s[96:99], s76 offen offset:0
  buffer_load_dword v32, v127, s[96:99], s76 offen offset:256
  buffer_load_dword v33, v127, s[96:99], s76 offen offset:512
  buffer_load_dword v34, v127, s[96:99], s76 offen offset:768
  buffer_load_dword v35, v127, s[96:99], s76 offen offset:1024
  s_waitcnt vmcnt(0)
  v_lshlrev_b32 v40, 16, v16
  v_and_b32 v41, 0xffff0000, v16
  ds_write_b64 v12, v[40:41] offset:25600
  v_lshlrev_b32 v42, 16, v17
  v_and_b32 v43, 0xffff0000, v17
  ds_write_b64 v12, v[42:43] offset:26112
  v_lshlrev_b32 v44, 16, v18
  v_and_b32 v45, 0xffff0000, v18
  ds_write_b64 v12, v[44:45] offset:26624
  v_lshlrev_b32 v46, 16, v19
  v_and_b32 v47, 0xffff0000, v19
  ds_write_b64 v12, v[46:47] offset:27136
  v_lshlrev_b32 v48, 16, v20
  v_and_b32 v49, 0xffff0000, v20
  ds_write_b64 v12, v[48:49] offset:27648
  v_lshlrev_b32 v50, 16, v21
  v_and_b32 v51, 0xffff0000, v21
  ds_write_b64 v12, v[50:51] offset:28160
  v_lshlrev_b32 v52, 16, v22
  v_and_b32 v53, 0xffff0000, v22
  ds_write_b64 v12, v[52:53] offset:28672
  v_lshlrev_b32 v54, 16, v23
  v_and_b32 v55, 0xffff0000, v23
  ds_write_b64 v12, v[54:55] offset:29184
  v_lshlrev_b32 v56, 16, v24
  v_and_b32 v57, 0xffff0000, v24
  ds_write_b64 v12, v[56:57] offset:29696
  v_lshlrev_b32 v58, 16, v25
  v_and_b32 v59, 0xffff0000, v25
  ds_write_b64 v12, v[58:59] offset:30208
  v_lshlrev_b32 v60, 16, v26
  v_and_b32 v61, 0xffff0000, v26
  ds_write_b64 v12, v[60:61] offset:30720
  v_lshlrev_b32 v62, 16, v27
  v_and_b32 v63, 0xffff0000, v27
  ds_write_b64 v12, v[62:63] offset:31232
  v_lshlrev_b32 v64, 16, v28
  v_and_b32 v65, 0xffff0000, v28
  ds_write_b64 v12, v[64:65] offset:31744
  v_lshlrev_b32 v66, 16, v29
  v_and_b32 v67, 0xffff0000, v29
  ds_write_b64 v12, v[66:67] offset:32256
  v_lshlrev_b32 v68, 16, v30
  v_and_b32 v69, 0xffff0000, v30
  ds_write_b64 v12, v[68:69] offset:32768
  v_lshlrev_b32 v70, 16, v31
  v_and_b32 v71, 0xffff0000, v31
  ds_write_b64 v12, v[70:71] offset:33280
  s_waitcnt lgkmcnt(8)
  v_lshlrev_b32 v72, 16, v32
  v_and_b32 v73, 0xffff0000, v32
  ds_write_b64 v12, v[72:73] offset:33792
  v_lshlrev_b32 v74, 16, v33
  v_and_b32 v75, 0xffff0000, v33
  ds_write_b64 v12, v[74:75] offset:34304
  v_lshlrev_b32 v76, 16, v34
  v_and_b32 v77, 0xffff0000, v34
  ds_write_b64 v12, v[76:77] offset:34816
  v_lshlrev_b32 v78, 16, v35
  v_and_b32 v79, 0xffff0000, v35
  ds_write_b64 v12, v[78:79] offset:35328
  s_waitcnt lgkmcnt(0)
Lw0247:
  s_nop 4
  s_mul_i32 s4, s3, 1536
  v_lshlrev_b32 v115, 5, v3
  v_add_u32 v115, s4, v115
  v_add_u32 v115, 5120, v115
  s_waitcnt lgkmcnt(0)
  s_barrier
  s_mov_b32 s75, 0x61a80
  v_min_u32 v126, 23, v0
  v_lshlrev_b32 v126, 2, v126
  v_add_u32 v126, 128, v126
  global_load_dword v127, v126, s[28:29]
  s_waitcnt vmcnt(0)
  v_cmp_ne_u32 vcc, 0x10001, v127
  s_cbranch_vccz Lad249
Lar248:
  global_load_dword v127, v126, s[28:29] sc1
  s_waitcnt vmcnt(0)
  v_cmp_ne_u32 vcc, 0x10001, v127
  s_cbranch_vccz Lad249
  s_sleep 8
  s_sub_u32 s75, s75, 1
  s_cmp_lg_u32 s75, 0
  s_cbranch_scc1 Lar248
Lad249:
  s_nop 4
  s_mov_b32 s92, s26
  s_and_b32 s93, s27, 0xffff
  s_mov_b32 s94, 0x1400
  s_mov_b32 s95, 0x20000
  v_lshlrev_b32 v119, 2, v0
  s_mov_b32 s78, 0
L_qloop:
  s_nop 4
  s_lshl_b32 s4, s78, 2
  s_lshr_b32 s79, 0x76532410, s4
  s_and_b32 s79, s79, 15
  s_and_b32 s83, s79, 3
  s_lshr_b32 s85, s79, 2
  s_mul_i32 s84, s83, 1280
  s_mul_i32 s4, s83, 2560
  v_add_u32 v121, s4, v12
  s_mul_i32 s86, s83, 12288
  s_add_u32 s86, s86, 0xc7f000
  s_mul_i32 s81, s79, 163840
  s_add_u32 s81, s81, 0xb33000
  s_add_u32 s82, s81, 81920
  s_lshl_b32 s88, s78, 6
  s_cmp_eq_u32 s85, 0
  s_cbranch_scc1 L_qgo
  s_cmp_lg_u32 s2, 32
  s_cbranch_scc1 L_qnext
L_qgo:
  s_nop 4
  s_mov_b32 s75, 0x61a80
  s_mov_b32 exec_lo, 0xff
  s_mov_b32 exec_hi, 0
Lpi251:
  buffer_load_dword v127, v8, s[64:67], s81 offen sc1
  s_waitcnt vmcnt(0)
  v_cmp_ne_u32 vcc, -1, v127
  s_cbranch_vccnz Lpd252
  s_sleep 3
  s_sub_u32 s75, s75, 1
  s_cmp_lg_u32 s75, 0
  s_cbranch_scc1 Lpi251
Lpd252:
  s_mov_b64 exec, -1
Lnoind250:
  s_mov_b32 s91, 0xfffff
  s_mov_b32 s75, 0x61a80
Lgs253:
  s_bitcmp1_b32 s91, 0
  s_cbranch_scc0 Lgk255
  s_add_u32 s76, s81, 0
  buffer_load_dwordx4 v[16:19], v9, s[64:67], s76 offen sc1
Lgk255:
  s_bitcmp1_b32 s91, 1
  s_cbranch_scc0 Lgk256
  s_add_u32 s76, s81, 0
  buffer_load_dwordx4 v[20:23], v9, s[64:67], s76 offen offset:1024 sc1
Lgk256:
  s_bitcmp1_b32 s91, 2
  s_cbranch_scc0 Lgk257
  s_add_u32 s76, s81, 0
  buffer_load_dwordx4 v[24:27], v9, s[64:67], s76 offen offset:2048 sc1
Lgk257:
  s_bitcmp1_b32 s91, 3
  s_cbranch_scc0 Lgk258
  s_add_u32 s76, s81, 0
  buffer_load_dwordx4 v[28:31], v9, s[64:67], s76 offen offset:3072 sc1
Lgk258:
  s_bitcmp1_b32 s91, 4
  s_cbranch_scc0 Lgk259
  s_add_u32 s76, s81, 4096
  buffer_load_dwordx4 v[32:35], v9, s[64:67], s76 offen sc1
Lgk259:
  s_bitcmp1_b32 s91, 5
  s_cbranch_scc0 Lgk260
  s_add_u32 s76, s81, 4096
  buffer_load_dwordx4 v[36:39], v9, s[64:67], s76 offen offset:1024 sc1
Lgk260:
  s_bitcmp1_b32 s91, 6
  s_cbranch_scc0 Lgk261
  s_add_u32 s76, s81, 4096
  buffer_load_dwordx4 v[40:43], v9, s[64:67], s76 offen offset:2048 sc1
Lgk261:
  s_bitcmp1_b32 s91, 7
  s_cbranch_scc0 Lgk262
  s_add_u32 s76, s81, 4096
  buffer_load_dwordx4 v[44:47], v9, s[64:67], s76 offen offset:3072 sc1
Lgk262:
  s_bitcmp1_b32 s91, 8
  s_cbranch_scc0 Lgk263
  s_add_u32 s76, s81, 8192
  buffer_load_dwordx4 v[48:51], v9, s[64:67], s76 offen sc1
Lgk263:
  s_bitcmp1_b32 s91, 9
  s_cbranch_scc0 Lgk264
  s_add_u32 s76, s81, 8192
  buffer_load_dwordx4 v[52:55], v9, s[64:67], s76 offen offset:1024 sc1
Lgk264:
  s_bitcmp1_b32 s91, 10
  s_cbranch_scc0 Lgk265
  s_add_u32 s76, s81, 8192
  buffer_load_dwordx4 v[56:59], v9, s[64:67], s76 offen offset:2048 sc1
Lgk265:
  s_bitcmp1_b32 s91, 11
  s_cbranch_scc0 Lgk266
  s_add_u32 s76, s81, 8192
  buffer_load_dwordx4 v[60:63], v9, s[64:67], s76 offen offset:3072 sc1
Lgk266:
  s_bitcmp1_b32 s91, 12
  s_cbranch_scc0 Lgk267
  s_add_u32 s76, s81, 12288
  buffer_load_dwordx4 v[64:67], v9, s[64:67], s76 offen sc1
Lgk267:
  s_bitcmp1_b32 s91, 13
  s_cbranch_scc0 Lgk268
  s_add_u32 s76, s81, 12288
  buffer_load_dwordx4 v[68:71], v9, s[64:67], s76 offen offset:1024 sc1
Lgk268:
  s_bitcmp1_b32 s91, 14
  s_cbranch_scc0 Lgk269
  s_add_u32 s76, s81, 12288
  buffer_load_dwordx4 v[72:75], v9, s[64:67], s76 offen offset:2048 sc1
Lgk269:
  s_bitcmp1_b32 s91, 15
  s_cbranch_scc0 Lgk270
  s_add_u32 s76, s81, 12288
  buffer_load_dwordx4 v[76:79], v9, s[64:67], s76 offen offset:3072 sc1
Lgk270:
  s_bitcmp1_b32 s91, 16
  s_cbranch_scc0 Lgk271
  s_add_u32 s76, s81, 16384
  buffer_load_dwordx4 v[80:83], v9, s[64:67], s76 offen sc1
Lgk271:
  s_bitcmp1_b32 s91, 17
  s_cbranch_scc0 Lgk272
  s_add_u32 s76, s81, 16384
  buffer_load_dwordx4 v[84:87], v9, s[64:67], s76 offen offset:1024 sc1
Lgk272:
  s_bitcmp1_b32 s91, 18
  s_cbranch_scc0 Lgk273
  s_add_u32 s76, s81, 16384
  buffer_load_dwordx4 v[88:91], v9, s[64:67], s76 offen offset:2048 sc1
Lgk273:
  s_bitcmp1_b32 s91, 19
  s_cbranch_scc0 Lgk274
  s_add_u32 s76, s81, 16384
  buffer_load_dwordx4 v[92:95], v9, s[64:67], s76 offen offset:3072 sc1
Lgk274:
  s_waitcnt vmcnt(0)
  s_bitcmp1_b32 s91, 0
  s_cbranch_scc0 Lgc275
  v_max3_u32 v127, v16, v17, v18
  v_max_u32 v127, v127, v19
  v_cmp_eq_u32 vcc, -1, v127
  s_cbranch_vccnz Lgc275
  s_bitset0_b32 s91, 0
Lgc275:
  s_bitcmp1_b32 s91, 1
  s_cbranch_scc0 Lgc276
  v_max3_u32 v127, v20, v21, v22
  v_max_u32 v127, v127, v23
  v_cmp_eq_u32 vcc, -1, v127
  s_cbranch_vccnz Lgc276
  s_bitset0_b32 s91, 1
Lgc276:
  s_bitcmp1_b32 s91, 2
  s_cbranch_scc0 Lgc277
  v_max3_u32 v127, v24, v25, v26
  v_max_u32 v127, v127, v27
  v_cmp_eq_u32 vcc, -1, v127
  s_cbranch_vccnz Lgc277
  s_bitset0_b32 s91, 2
Lgc277:
  s_bitcmp1_b32 s91, 3
  s_cbranch_scc0 Lgc278
  v_max3_u32 v127, v28, v29, v30
  v_max_u32 v127, v127, v31
  v_cmp_eq_u32 vcc, -1, v127
  s_cbranch_vccnz Lgc278
  s_bitset0_b32 s91, 3
Lgc278:
  s_bitcmp1_b32 s91, 4
  s_cbranch_scc0 Lgc279
  v_max3_u32 v127, v32, v33, v34
  v_max_u32 v127, v127, v35
  v_cmp_eq_u32 vcc, -1, v127
  s_cbranch_vccnz Lgc279
  s_bitset0_b32 s91, 4
Lgc279:
  s_bitcmp1_b32 s91, 5
  s_cbranch_scc0 Lgc280
  v_max3_u32 v127, v36, v37, v38
  v_max_u32 v127, v127, v39
  v_cmp_eq_u32 vcc, -1, v127
  s_cbranch_vccnz Lgc280
  s_bitset0_b32 s91, 5
Lgc280:
  s_bitcmp1_b32 s91, 6
  s_cbranch_scc0 Lgc281
  v_max3_u32 v127, v40, v41, v42
  v_max_u32 v127, v127, v43
  v_cmp_eq_u32 vcc, -1, v127
  s_cbranch_vccnz Lgc281
  s_bitset0_b32 s91, 6
Lgc281:
  s_bitcmp1_b32 s91, 7
  s_cbranch_scc0 Lgc282
  v_max3_u32 v127, v44, v45, v46
  v_max_u32 v127, v127, v47
  v_cmp_eq_u32 vcc, -1, v127
  s_cbranch_vccnz Lgc282
  s_bitset0_b32 s91, 7
Lgc282:
  s_bitcmp1_b32 s91, 8
  s_cbranch_scc0 Lgc283
  v_max3_u32 v127, v48, v49, v50
  v_max_u32 v127, v127, v51
  v_cmp_eq_u32 vcc, -1, v127
  s_cbranch_vccnz Lgc283
  s_bitset0_b32 s91, 8
Lgc283:
  s_bitcmp1_b32 s91, 9
  s_cbranch_scc0 Lgc284
  v_max3_u32 v127, v52, v53, v54
  v_max_u32 v127, v127, v55
  v_cmp_eq_u32 vcc, -1, v127
  s_cbranch_vccnz Lgc284
  s_bitset0_b32 s91, 9
Lgc284:
  s_bitcmp1_b32 s91, 10
  s_cbranch_scc0 Lgc285
  v_max3_u32 v127, v56, v57, v58
  v_max_u32 v127, v127, v59
  v_cmp_eq_u32 vcc, -1, v127
  s_cbranch_vccnz Lgc285
  s_bitset0_b32 s91, 10
Lgc285:
  s_bitcmp1_b32 s91, 11
  s_cbranch_scc0 Lgc286
  v_max3_u32 v127, v60, v61, v62
  v_max_u32 v127, v127, v63
  v_cmp_eq_u32 vcc, -1, v127
  s_cbranch_vccnz Lgc286
  s_bitset0_b32 s91, 11
Lgc286:
  s_bitcmp1_b32 s91, 12
  s_cbranch_scc0 Lgc287
  v_max3_u32 v127, v64, v65, v66
  v_max_u32 v127, v127, v67
  v_cmp_eq_u32 vcc, -1, v127
  s_cbranch_vccnz Lgc287
  s_bitset0_b32 s91, 12
Lgc287:
  s_bitcmp1_b32 s91, 13
  s_cbranch_scc0 Lgc288
  v_max3_u32 v127, v68, v69, v70
  v_max_u32 v127, v127, v71
  v_cmp_eq_u32 vcc, -1, v127
  s_cbranch_vccnz Lgc288
  s_bitset0_b32 s91, 13
Lgc288:
  s_bitcmp1_b32 s91, 14
  s_cbranch_scc0 Lgc289
  v_max3_u32 v127, v72, v73, v74
  v_max_u32 v127, v127, v75
  v_cmp_eq_u32 vcc, -1, v127
  s_cbranch_vccnz Lgc289
  s_bitset0_b32 s91, 14
Lgc289:
  s_bitcmp1_b32 s91, 15
  s_cbranch_scc0 Lgc290
  v_max3_u32 v127, v76, v77, v78
  v_max_u32 v127, v127, v79
  v_cmp_eq_u32 vcc, -1, v127
  s_cbranch_vccnz Lgc290
  s_bitset0_b32 s91, 15
Lgc290:
  s_bitcmp1_b32 s91, 16
  s_cbranch_scc0 Lgc291
  v_max3_u32 v127, v80, v81, v82
  v_max_u32 v127, v127, v83
  v_cmp_eq_u32 vcc, -1, v127
  s_cbranch_vccnz Lgc291
  s_bitset0_b32 s91, 16
Lgc291:
  s_bitcmp1_b32 s91, 17
  s_cbranch_scc0 Lgc292
  v_max3_u32 v127, v84, v85, v86
  v_max_u32 v127, v127, v87
  v_cmp_eq_u32 vcc, -1, v127
  s_cbranch_vccnz Lgc292
  s_bitset0_b32 s91, 17
Lgc292:
  s_bitcmp1_b32 s91, 18
  s_cbranch_scc0 Lgc293
  v_max3_u32 v127, v88, v89, v90
  v_max_u32 v127, v127, v91
  v_cmp_eq_u32 vcc, -1, v127
  s_cbranch_vccnz Lgc293
  s_bitset0_b32 s91, 18
Lgc293:
  s_bitcmp1_b32 s91, 19
  s_cbranch_scc0 Lgc294
  v_max3_u32 v127, v92, v93, v94
  v_max_u32 v127, v127, v95
  v_cmp_eq_u32 vcc, -1, v127
  s_cbranch_vccnz Lgc294
  s_bitset0_b32 s91, 19
Lgc294:
  s_cmp_eq_u32 s91, 0
  s_cbranch_scc1 Lgsd254
  s_sub_u32 s75, s75, 1
  s_cmp_lg_u32 s75, 0
  s_cbranch_scc1 Lgs253
Lgsd254:
  s_nop 4
  v_add_f32 v16, v16, v36
  v_add_f32 v17, v17, v37
  v_add_f32 v18, v18, v38
  v_add_f32 v19, v19, v39
  v_add_f32 v16, v16, v56
  v_add_f32 v17, v17, v57
  v_add_f32 v18, v18, v58
  v_add_f32 v19, v19, v59
  v_add_f32 v16, v16, v76
  v_add_f32 v17, v17, v77
  v_add_f32 v18, v18, v78
  v_add_f32 v19, v19, v79
  v_add_f32 v20, v20, v40
  v_add_f32 v21, v21, v41
  v_add_f32 v22, v22, v42
  v_add_f32 v23, v23, v43
  v_add_f32 v20, v20, v60
  v_add_f32 v21, v21, v61
  v_add_f32 v22, v22, v62
  v_add_f32 v23, v23, v63
  v_add_f32 v20, v20, v80
  v_add_f32 v21, v21, v81
  v_add_f32 v22, v22, v82
  v_add_f32 v23, v23, v83
  v_add_f32 v24, v24, v44
  v_add_f32 v25, v25, v45
  v_add_f32 v26, v26, v46
  v_add_f32 v27, v27, v47
  v_add_f32 v24, v24, v64
  v_add_f32 v25, v25, v65
  v_add_f32 v26, v26, v66
  v_add_f32 v27, v27, v67
  v_add_f32 v24, v24, v84
  v_add_f32 v25, v25, v85
  v_add_f32 v26, v26, v86
  v_add_f32 v27, v27, v87
  v_add_f32 v28, v28, v48
  v_add_f32 v29, v29, v49
  v_add_f32 v30, v30, v50
  v_add_f32 v31, v31, v51
  v_add_f32 v28, v28, v68
  v_add_f32 v29, v29, v69
  v_add_f32 v30, v30, v70
  v_add_f32 v31, v31, v71
  v_add_f32 v28, v28, v88
  v_add_f32 v29, v29, v89
  v_add_f32 v30, v30, v90
  v_add_f32 v31, v31, v91
  v_add_f32 v32, v32, v52
  v_add_f32 v33, v33, v53
  v_add_f32 v34, v34, v54
  v_add_f32 v35, v35, v55
  v_add_f32 v32, v32, v72
  v_add_f32 v33, v33, v73
  v_add_f32 v34, v34, v74
  v_add_f32 v35, v35, v75
  v_add_f32 v32, v32, v92
  v_add_f32 v33, v33, v93
  v_add_f32 v34, v34, v94
  v_add_f32 v35, v35, v95
  ds_write_b128 v10, v[16:19] offset:0
  ds_write_b128 v10, v[20:23] offset:1024
  ds_write_b128 v10, v[24:27] offset:2048
  ds_write_b128 v10, v[28:31] offset:3072
  ds_write_b128 v10, v[32:35] offset:4096
  s_waitcnt lgkmcnt(0)
  s_barrier
  s_cmp_lg_u32 s3, 0
  s_cbranch_scc1 Lw0295
  ds_read_b64 v[32:33], v12 offset:5120
  ds_read_b64 v[34:35], v12 offset:5632
  ds_read_b64 v[36:37], v12 offset:6144
  ds_read_b64 v[38:39], v12 offset:6656
  ds_read_b64 v[40:41], v12 offset:7168
  ds_read_b64 v[42:43], v12 offset:7680
  ds_read_b64 v[44:45], v12 offset:8192
  ds_read_b64 v[46:47], v12 offset:8704
  ds_read_b64 v[48:49], v12 offset:9216
  ds_read_b64 v[50:51], v12 offset:9728
  ds_read_b64 v[52:53], v12 offset:10240
  ds_read_b64 v[54:55], v12 offset:10752
  ds_read_b64 v[56:57], v12 offset:11264
  ds_read_b64 v[58:59], v12 offset:11776
  ds_read_b64 v[60:61], v12 offset:12288
  ds_read_b64 v[62:63], v12 offset:12800
  s_waitcnt lgkmcnt(8)
  ds_read_b64 v[64:65], v12 offset:13312
  ds_read_b64 v[66:67], v12 offset:13824
  ds_read_b64 v[68:69], v12 offset:14336
  ds_read_b64 v[70:71], v12 offset:14848
  ds_read_b64 v[72:73], v12 offset:15360
  ds_read_b64 v[74:75], v12 offset:15872
  ds_read_b64 v[76:77], v12 offset:16384
  ds_read_b64 v[78:79], v12 offset:16896
  s_waitcnt lgkmcnt(8)
  ds_read_b64 v[80:81], v12 offset:17408
  ds_read_b64 v[82:83], v12 offset:17920
  ds_read_b64 v[84:85], v12 offset:18432
  ds_read_b64 v[86:87], v12 offset:18944
  ds_read_b64 v[88:89], v12 offset:19456
  ds_read_b64 v[90:91], v12 offset:19968
  ds_read_b64 v[92:93], v12 offset:20480
  ds_read_b64 v[94:95], v12 offset:20992
  s_waitcnt lgkmcnt(8)
  ds_read_b64 v[96:97], v12 offset:21504
  ds_read_b64 v[98:99], v12 offset:22016
  ds_read_b64 v[100:101], v12 offset:22528
  ds_read_b64 v[102:103], v12 offset:23040
  ds_read_b64 v[104:105], v12 offset:23552
  ds_read_b64 v[106:107], v12 offset:24064
  ds_read_b64 v[108:109], v12 offset:24576
  ds_read_b64 v[110:111], v12 offset:25088
  s_waitcnt lgkmcnt(8)
  s_waitcnt lgkmcnt(0)
  v_add_f32 v16, v32, v42
  v_add_f32 v17, v33, v43
  v_add_f32 v18, v34, v44
  v_add_f32 v19, v35, v45
  v_add_f32 v20, v36, v46
  v_add_f32 v21, v37, v47
  v_add_f32 v22, v38, v48
  v_add_f32 v23, v39, v49
  v_add_f32 v24, v40, v50
  v_add_f32 v25, v41, v51
  v_add_f32 v16, v16, v52
  v_add_f32 v17, v17, v53
  v_add_f32 v18, v18, v54
  v_add_f32 v19, v19, v55
  v_add_f32 v20, v20, v56
  v_add_f32 v21, v21, v57
  v_add_f32 v22, v22, v58
  v_add_f32 v23, v23, v59
  v_add_f32 v24, v24, v60
  v_add_f32 v25, v25, v61
  v_add_f32 v16, v16, v62
  v_add_f32 v17, v17, v63
  v_add_f32 v18, v18, v64
  v_add_f32 v19, v19, v65
  v_add_f32 v20, v20, v66
  v_add_f32 v21, v21, v67
  v_add_f32 v22, v22, v68
  v_add_f32 v23, v23, v69
  v_add_f32 v24, v24, v70
  v_add_f32 v25, v25, v71
  v_add_f32 v16, v16, v72
  v_add_f32 v17, v17, v73
  v_add_f32 v18, v18, v74
  v_add_f32 v19, v19, v75
  v_add_f32 v20, v20, v76
  v_add_f32 v21, v21, v77
  v_add_f32 v22, v22, v78
  v_add_f32 v23, v23, v79
  v_add_f32 v24, v24, v80
  v_add_f32 v25, v25, v81
  v_add_f32 v16, v16, v82
  v_add_f32 v17, v17, v83
  v_add_f32 v18, v18, v84
  v_add_f32 v19, v19, v85
  v_add_f32 v20, v20, v86
  v_add_f32 v21, v21, v87
  v_add_f32 v22, v22, v88
  v_add_f32 v23, v23, v89
  v_add_f32 v24, v24, v90
  v_add_f32 v25, v25, v91
  v_add_f32 v16, v16, v92
  v_add_f32 v17, v17, v93
  v_add_f32 v18, v18, v94
  v_add_f32 v19, v19, v95
  v_add_f32 v20, v20, v96
  v_add_f32 v21, v21, v97
  v_add_f32 v22, v22, v98
  v_add_f32 v23, v23, v99
  v_add_f32 v24, v24, v100
  v_add_f32 v25, v25, v101
  v_add_f32 v16, v16, v102
  v_add_f32 v17, v17, v103
  v_add_f32 v18, v18, v104
  v_add_f32 v19, v19, v105
  v_add_f32 v20, v20, v106
  v_add_f32 v21, v21, v107
  v_add_f32 v22, v22, v108
  v_add_f32 v23, v23, v109
  v_add_f32 v24, v24, v110
  v_add_f32 v25, v25, v111
  ds_read_b64 v[32:33], v121 offset:25600
  ds_read_b64 v[34:35], v121 offset:26112
  ds_read_b64 v[36:37], v121 offset:26624
  ds_read_b64 v[38:39], v121 offset:27136
  ds_read_b64 v[40:41], v121 offset:27648
  v_cvt_pk_bf16_f32 v16, 0, v16
  v_cvt_pk_bf16_f32 v17, 0, v17
  v_cvt_pk_bf16_f32 v18, 0, v18
  v_cvt_pk_bf16_f32 v19, 0, v19
  v_cvt_pk_bf16_f32 v20, 0, v20
  v_cvt_pk_bf16_f32 v21, 0, v21
  v_cvt_pk_bf16_f32 v22, 0, v22
  v_cvt_pk_bf16_f32 v23, 0, v23
  v_cvt_pk_bf16_f32 v24, 0, v24
  v_cvt_pk_bf16_f32 v25, 0, v25
  s_waitcnt lgkmcnt(0)
  v_add_f32 v16, v16, v32
  v_add_f32 v17, v17, v33
  v_add_f32 v18, v18, v34
  v_add_f32 v19, v19, v35
  v_add_f32 v20, v20, v36
  v_add_f32 v21, v21, v37
  v_add_f32 v22, v22, v38
  v_add_f32 v23, v23, v39
  v_add_f32 v24, v24, v40
  v_add_f32 v25, v25, v41
  v_cvt_pk_bf16_f32 v16, 0, v16
  v_cvt_pk_bf16_f32 v17, 0, v17
  v_cvt_pk_bf16_f32 v18, 0, v18
  v_cvt_pk_bf16_f32 v19, 0, v19
  v_cvt_pk_bf16_f32 v20, 0, v20
  v_cvt_pk_bf16_f32 v21, 0, v21
  v_cvt_pk_bf16_f32 v22, 0, v22
  v_cvt_pk_bf16_f32 v23, 0, v23
  v_cvt_pk_bf16_f32 v24, 0, v24
  v_cvt_pk_bf16_f32 v25, 0, v25
  ds_write_b64 v12, v[16:17] offset:35840
  ds_write_b64 v12, v[18:19] offset:36352
  ds_write_b64 v12, v[20:21] offset:36864
  ds_write_b64 v12, v[22:23] offset:37376
  ds_write_b64 v12, v[24:25] offset:37888
  s_waitcnt lgkmcnt(0)
Lw0295:
  s_nop 4
  s_waitcnt lgkmcnt(0)
  s_barrier
  s_mov_b32 s75, 0x61a80
  s_mov_b32 exec_lo, 0xff
  s_mov_b32 exec_hi, 0
Lpi297:
  buffer_load_dword v127, v8, s[64:67], s82 offen sc1
  s_waitcnt vmcnt(0)
  v_cmp_ne_u32 vcc, -1, v127
  s_cbranch_vccnz Lpd298
  s_sleep 3
  s_sub_u32 s75, s75, 1
  s_cmp_lg_u32 s75, 0
  s_cbranch_scc1 Lpi297
Lpd298:
  s_mov_b64 exec, -1
Lnoind296:
  s_mov_b32 s91, 0xfffff
  s_mov_b32 s75, 0x61a80
Lgs299:
  s_bitcmp1_b32 s91, 0
  s_cbranch_scc0 Lgk301
  s_add_u32 s76, s82, 0
  buffer_load_dwordx4 v[16:19], v9, s[64:67], s76 offen sc1
Lgk301:
  s_bitcmp1_b32 s91, 1
  s_cbranch_scc0 Lgk302
  s_add_u32 s76, s82, 0
  buffer_load_dwordx4 v[20:23], v9, s[64:67], s76 offen offset:1024 sc1
Lgk302:
  s_bitcmp1_b32 s91, 2
  s_cbranch_scc0 Lgk303
  s_add_u32 s76, s82, 0
  buffer_load_dwordx4 v[24:27], v9, s[64:67], s76 offen offset:2048 sc1
Lgk303:
  s_bitcmp1_b32 s91, 3
  s_cbranch_scc0 Lgk304
  s_add_u32 s76, s82, 0
  buffer_load_dwordx4 v[28:31], v9, s[64:67], s76 offen offset:3072 sc1
Lgk304:
  s_bitcmp1_b32 s91, 4
  s_cbranch_scc0 Lgk305
  s_add_u32 s76, s82, 4096
  buffer_load_dwordx4 v[32:35], v9, s[64:67], s76 offen sc1
Lgk305:
  s_bitcmp1_b32 s91, 5
  s_cbranch_scc0 Lgk306
  s_add_u32 s76, s82, 4096
  buffer_load_dwordx4 v[36:39], v9, s[64:67], s76 offen offset:1024 sc1
Lgk306:
  s_bitcmp1_b32 s91, 6
  s_cbranch_scc0 Lgk307
  s_add_u32 s76, s82, 4096
  buffer_load_dwordx4 v[40:43], v9, s[64:67], s76 offen offset:2048 sc1
Lgk307:
  s_bitcmp1_b32 s91, 7
  s_cbranch_scc0 Lgk308
  s_add_u32 s76, s82, 4096
  buffer_load_dwordx4 v[44:47], v9, s[64:67], s76 offen offset:3072 sc1
Lgk308:
  s_bitcmp1_b32 s91, 8
  s_cbranch_scc0 Lgk309
  s_add_u32 s76, s82, 8192
  buffer_load_dwordx4 v[48:51], v9, s[64:67], s76 offen sc1
Lgk309:
  s_bitcmp1_b32 s91, 9
  s_cbranch_scc0 Lgk310
  s_add_u32 s76, s82, 8192
  buffer_load_dwordx4 v[52:55], v9, s[64:67], s76 offen offset:1024 sc1
Lgk310:
  s_bitcmp1_b32 s91, 10
  s_cbranch_scc0 Lgk311
  s_add_u32 s76, s82, 8192
  buffer_load_dwordx4 v[56:59], v9, s[64:67], s76 offen offset:2048 sc1
Lgk311:
  s_bitcmp1_b32 s91, 11
  s_cbranch_scc0 Lgk312
  s_add_u32 s76, s82, 8192
  buffer_load_dwordx4 v[60:63], v9, s[64:67], s76 offen offset:3072 sc1
Lgk312:
  s_bitcmp1_b32 s91, 12
  s_cbranch_scc0 Lgk313
  s_add_u32 s76, s82, 12288
  buffer_load_dwordx4 v[64:67], v9, s[64:67], s76 offen sc1
Lgk313:
  s_bitcmp1_b32 s91, 13
  s_cbranch_scc0 Lgk314
  s_add_u32 s76, s82, 12288
  buffer_load_dwordx4 v[68:71], v9, s[64:67], s76 offen offset:1024 sc1
Lgk314:
  s_bitcmp1_b32 s91, 14
  s_cbranch_scc0 Lgk315
  s_add_u32 s76, s82, 12288
  buffer_load_dwordx4 v[72:75], v9, s[64:67], s76 offen offset:2048 sc1
Lgk315:
  s_bitcmp1_b32 s91, 15
  s_cbranch_scc0 Lgk316
  s_add_u32 s76, s82, 12288
  buffer_load_dwordx4 v[76:79], v9, s[64:67], s76 offen offset:3072 sc1
Lgk316:
  s_bitcmp1_b32 s91, 16
  s_cbranch_scc0 Lgk317
  s_add_u32 s76, s82, 16384
  buffer_load_dwordx4 v[80:83], v9, s[64:67], s76 offen sc1
Lgk317:
  s_bitcmp1_b32 s91, 17
  s_cbranch_scc0 Lgk318
  s_add_u32 s76, s82, 16384
  buffer_load_dwordx4 v[84:87], v9, s[64:67], s76 offen offset:1024 sc1
Lgk318:
  s_bitcmp1_b32 s91, 18
  s_cbranch_scc0 Lgk319
  s_add_u32 s76, s82, 16384
  buffer_load_dwordx4 v[88:91], v9, s[64:67], s76 offen offset:2048 sc1
Lgk319:
  s_bitcmp1_b32 s91, 19
  s_cbranch_scc0 Lgk320
  s_add_u32 s76, s82, 16384
  buffer_load_dwordx4 v[92:95], v9, s[64:67], s76 offen offset:3072 sc1
Lgk320:
  s_waitcnt vmcnt(0)
  s_bitcmp1_b32 s91, 0
  s_cbranch_scc0 Lgc321
  v_max3_u32 v127, v16, v17, v18
  v_max_u32 v127, v127, v19
  v_cmp_eq_u32 vcc, -1, v127
  s_cbranch_vccnz Lgc321
  s_bitset0_b32 s91, 0
Lgc321:
  s_bitcmp1_b32 s91, 1
  s_cbranch_scc0 Lgc322
  v_max3_u32 v127, v20, v21, v22
  v_max_u32 v127, v127, v23
  v_cmp_eq_u32 vcc, -1, v127
  s_cbranch_vccnz Lgc322
  s_bitset0_b32 s91, 1
Lgc322:
  s_bitcmp1_b32 s91, 2
  s_cbranch_scc0 Lgc323
  v_max3_u32 v127, v24, v25, v26
  v_max_u32 v127, v127, v27
  v_cmp_eq_u32 vcc, -1, v127
  s_cbranch_vccnz Lgc323
  s_bitset0_b32 s91, 2
Lgc323:
  s_bitcmp1_b32 s91, 3
  s_cbranch_scc0 Lgc324
  v_max3_u32 v127, v28, v29, v30
  v_max_u32 v127, v127, v31
  v_cmp_eq_u32 vcc, -1, v127
  s_cbranch_vccnz Lgc324
  s_bitset0_b32 s91, 3
Lgc324:
  s_bitcmp1_b32 s91, 4
  s_cbranch_scc0 Lgc325
  v_max3_u32 v127, v32, v33, v34
  v_max_u32 v127, v127, v35
  v_cmp_eq_u32 vcc, -1, v127
  s_cbranch_vccnz Lgc325
  s_bitset0_b32 s91, 4
Lgc325:
  s_bitcmp1_b32 s91, 5
  s_cbranch_scc0 Lgc326
  v_max3_u32 v127, v36, v37, v38
  v_max_u32 v127, v127, v39
  v_cmp_eq_u32 vcc, -1, v127
  s_cbranch_vccnz Lgc326
  s_bitset0_b32 s91, 5
Lgc326:
  s_bitcmp1_b32 s91, 6
  s_cbranch_scc0 Lgc327
  v_max3_u32 v127, v40, v41, v42
  v_max_u32 v127, v127, v43
  v_cmp_eq_u32 vcc, -1, v127
  s_cbranch_vccnz Lgc327
  s_bitset0_b32 s91, 6
Lgc327:
  s_bitcmp1_b32 s91, 7
  s_cbranch_scc0 Lgc328
  v_max3_u32 v127, v44, v45, v46
  v_max_u32 v127, v127, v47
  v_cmp_eq_u32 vcc, -1, v127
  s_cbranch_vccnz Lgc328
  s_bitset0_b32 s91, 7
Lgc328:
  s_bitcmp1_b32 s91, 8
  s_cbranch_scc0 Lgc329
  v_max3_u32 v127, v48, v49, v50
  v_max_u32 v127, v127, v51
  v_cmp_eq_u32 vcc, -1, v127
  s_cbranch_vccnz Lgc329
  s_bitset0_b32 s91, 8
Lgc329:
  s_bitcmp1_b32 s91, 9
  s_cbranch_scc0 Lgc330
  v_max3_u32 v127, v52, v53, v54
  v_max_u32 v127, v127, v55
  v_cmp_eq_u32 vcc, -1, v127
  s_cbranch_vccnz Lgc330
  s_bitset0_b32 s91, 9
Lgc330:
  s_bitcmp1_b32 s91, 10
  s_cbranch_scc0 Lgc331
  v_max3_u32 v127, v56, v57, v58
  v_max_u32 v127, v127, v59
  v_cmp_eq_u32 vcc, -1, v127
  s_cbranch_vccnz Lgc331
  s_bitset0_b32 s91, 10
Lgc331:
  s_bitcmp1_b32 s91, 11
  s_cbranch_scc0 Lgc332
  v_max3_u32 v127, v60, v61, v62
  v_max_u32 v127, v127, v63
  v_cmp_eq_u32 vcc, -1, v127
  s_cbranch_vccnz Lgc332
  s_bitset0_b32 s91, 11
Lgc332:
  s_bitcmp1_b32 s91, 12
  s_cbranch_scc0 Lgc333
  v_max3_u32 v127, v64, v65, v66
  v_max_u32 v127, v127, v67
  v_cmp_eq_u32 vcc, -1, v127
  s_cbranch_vccnz Lgc333
  s_bitset0_b32 s91, 12
Lgc333:
  s_bitcmp1_b32 s91, 13
  s_cbranch_scc0 Lgc334
  v_max3_u32 v127, v68, v69, v70
  v_max_u32 v127, v127, v71
  v_cmp_eq_u32 vcc, -1, v127
  s_cbranch_vccnz Lgc334
  s_bitset0_b32 s91, 13
Lgc334:
  s_bitcmp1_b32 s91, 14
  s_cbranch_scc0 Lgc335
  v_max3_u32 v127, v72, v73, v74
  v_max_u32 v127, v127, v75
  v_cmp_eq_u32 vcc, -1, v127
  s_cbranch_vccnz Lgc335
  s_bitset0_b32 s91, 14
Lgc335:
  s_bitcmp1_b32 s91, 15
  s_cbranch_scc0 Lgc336
  v_max3_u32 v127, v76, v77, v78
  v_max_u32 v127, v127, v79
  v_cmp_eq_u32 vcc, -1, v127
  s_cbranch_vccnz Lgc336
  s_bitset0_b32 s91, 15
Lgc336:
  s_bitcmp1_b32 s91, 16
  s_cbranch_scc0 Lgc337
  v_max3_u32 v127, v80, v81, v82
  v_max_u32 v127, v127, v83
  v_cmp_eq_u32 vcc, -1, v127
  s_cbranch_vccnz Lgc337
  s_bitset0_b32 s91, 16
Lgc337:
  s_bitcmp1_b32 s91, 17
  s_cbranch_scc0 Lgc338
  v_max3_u32 v127, v84, v85, v86
  v_max_u32 v127, v127, v87
  v_cmp_eq_u32 vcc, -1, v127
  s_cbranch_vccnz Lgc338
  s_bitset0_b32 s91, 17
Lgc338:
  s_bitcmp1_b32 s91, 18
  s_cbranch_scc0 Lgc339
  v_max3_u32 v127, v88, v89, v90
  v_max_u32 v127, v127, v91
  v_cmp_eq_u32 vcc, -1, v127
  s_cbranch_vccnz Lgc339
  s_bitset0_b32 s91, 18
Lgc339:
  s_bitcmp1_b32 s91, 19
  s_cbranch_scc0 Lgc340
  v_max3_u32 v127, v92, v93, v94
  v_max_u32 v127, v127, v95
  v_cmp_eq_u32 vcc, -1, v127
  s_cbranch_vccnz Lgc340
  s_bitset0_b32 s91, 19
Lgc340:
  s_cmp_eq_u32 s91, 0
  s_cbranch_scc1 Lgsd300
  s_sub_u32 s75, s75, 1
  s_cmp_lg_u32 s75, 0
  s_cbranch_scc1 Lgs299
Lgsd300:
  s_nop 4
  v_add_f32 v16, v16, v36
  v_add_f32 v17, v17, v37
  v_add_f32 v18, v18, v38
  v_add_f32 v19, v19, v39
  v_add_f32 v16, v16, v56
  v_add_f32 v17, v17, v57
  v_add_f32 v18, v18, v58
  v_add_f32 v19, v19, v59
  v_add_f32 v16, v16, v76
  v_add_f32 v17, v17, v77
  v_add_f32 v18, v18, v78
  v_add_f32 v19, v19, v79
  v_add_f32 v20, v20, v40
  v_add_f32 v21, v21, v41
  v_add_f32 v22, v22, v42
  v_add_f32 v23, v23, v43
  v_add_f32 v20, v20, v60
  v_add_f32 v21, v21, v61
  v_add_f32 v22, v22, v62
  v_add_f32 v23, v23, v63
  v_add_f32 v20, v20, v80
  v_add_f32 v21, v21, v81
  v_add_f32 v22, v22, v82
  v_add_f32 v23, v23, v83
  v_add_f32 v24, v24, v44
  v_add_f32 v25, v25, v45
  v_add_f32 v26, v26, v46
  v_add_f32 v27, v27, v47
  v_add_f32 v24, v24, v64
  v_add_f32 v25, v25, v65
  v_add_f32 v26, v26, v66
  v_add_f32 v27, v27, v67
  v_add_f32 v24, v24, v84
  v_add_f32 v25, v25, v85
  v_add_f32 v26, v26, v86
  v_add_f32 v27, v27, v87
  v_add_f32 v28, v28, v48
  v_add_f32 v29, v29, v49
  v_add_f32 v30, v30, v50
  v_add_f32 v31, v31, v51
  v_add_f32 v28, v28, v68
  v_add_f32 v29, v29, v69
  v_add_f32 v30, v30, v70
  v_add_f32 v31, v31, v71
  v_add_f32 v28, v28, v88
  v_add_f32 v29, v29, v89
  v_add_f32 v30, v30, v90
  v_add_f32 v31, v31, v91
  v_add_f32 v32, v32, v52
  v_add_f32 v33, v33, v53
  v_add_f32 v34, v34, v54
  v_add_f32 v35, v35, v55
  v_add_f32 v32, v32, v72
  v_add_f32 v33, v33, v73
  v_add_f32 v34, v34, v74
  v_add_f32 v35, v35, v75
  v_add_f32 v32, v32, v92
  v_add_f32 v33, v33, v93
  v_add_f32 v34, v34, v94
  v_add_f32 v35, v35, v95
  ds_write_b128 v10, v[16:19] offset:0
  ds_write_b128 v10, v[20:23] offset:1024
  ds_write_b128 v10, v[24:27] offset:2048
  ds_write_b128 v10, v[28:31] offset:3072
  ds_write_b128 v10, v[32:35] offset:4096
  s_waitcnt lgkmcnt(0)
  s_barrier
  s_cmp_lg_u32 s3, 0
  s_cbranch_scc1 Lw0341
  ds_read_b64 v[32:33], v12 offset:5120
  ds_read_b64 v[34:35], v12 offset:5632
  ds_read_b64 v[36:37], v12 offset:6144
  ds_read_b64 v[38:39], v12 offset:6656
  ds_read_b64 v[40:41], v12 offset:7168
  ds_read_b64 v[42:43], v12 offset:7680
  ds_read_b64 v[44:45], v12 offset:8192
  ds_read_b64 v[46:47], v12 offset:8704
  ds_read_b64 v[48:49], v12 offset:9216
  ds_read_b64 v[50:51], v12 offset:9728
  ds_read_b64 v[52:53], v12 offset:10240
  ds_read_b64 v[54:55], v12 offset:10752
  ds_read_b64 v[56:57], v12 offset:11264
  ds_read_b64 v[58:59], v12 offset:11776
  ds_read_b64 v[60:61], v12 offset:12288
  ds_read_b64 v[62:63], v12 offset:12800
  s_waitcnt lgkmcnt(8)
  ds_read_b64 v[64:65], v12 offset:13312
  ds_read_b64 v[66:67], v12 offset:13824
  ds_read_b64 v[68:69], v12 offset:14336
  ds_read_b64 v[70:71], v12 offset:14848
  ds_read_b64 v[72:73], v12 offset:15360
  ds_read_b64 v[74:75], v12 offset:15872
  ds_read_b64 v[76:77], v12 offset:16384
  ds_read_b64 v[78:79], v12 offset:16896
  s_waitcnt lgkmcnt(8)
  ds_read_b64 v[80:81], v12 offset:17408
  ds_read_b64 v[82:83], v12 offset:17920
  ds_read_b64 v[84:85], v12 offset:18432
  ds_read_b64 v[86:87], v12 offset:18944
  ds_read_b64 v[88:89], v12 offset:19456
  ds_read_b64 v[90:91], v12 offset:19968
  ds_read_b64 v[92:93], v12 offset:20480
  ds_read_b64 v[94:95], v12 offset:20992
  s_waitcnt lgkmcnt(8)
  ds_read_b64 v[96:97], v12 offset:21504
  ds_read_b64 v[98:99], v12 offset:22016
  ds_read_b64 v[100:101], v12 offset:22528
  ds_read_b64 v[102:103], v12 offset:23040
  ds_read_b64 v[104:105], v12 offset:23552
  ds_read_b64 v[106:107], v12 offset:24064
  ds_read_b64 v[108:109], v12 offset:24576
  ds_read_b64 v[110:111], v12 offset:25088
  s_waitcnt lgkmcnt(8)
  s_waitcnt lgkmcnt(0)
  v_add_f32 v16, v32, v42
  v_add_f32 v17, v33, v43
  v_add_f32 v18, v34, v44
  v_add_f32 v19, v35, v45
  v_add_f32 v20, v36, v46
  v_add_f32 v21, v37, v47
  v_add_f32 v22, v38, v48
  v_add_f32 v23, v39, v49
  v_add_f32 v24, v40, v50
  v_add_f32 v25, v41, v51
  v_add_f32 v16, v16, v52
  v_add_f32 v17, v17, v53
  v_add_f32 v18, v18, v54
  v_add_f32 v19, v19, v55
  v_add_f32 v20, v20, v56
  v_add_f32 v21, v21, v57
  v_add_f32 v22, v22, v58
  v_add_f32 v23, v23, v59
  v_add_f32 v24, v24, v60
  v_add_f32 v25, v25, v61
  v_add_f32 v16, v16, v62
  v_add_f32 v17, v17, v63
  v_add_f32 v18, v18, v64
  v_add_f32 v19, v19, v65
  v_add_f32 v20, v20, v66
  v_add_f32 v21, v21, v67
  v_add_f32 v22, v22, v68
  v_add_f32 v23, v23, v69
  v_add_f32 v24, v24, v70
  v_add_f32 v25, v25, v71
  v_add_f32 v16, v16, v72
  v_add_f32 v17, v17, v73
  v_add_f32 v18, v18, v74
  v_add_f32 v19, v19, v75
  v_add_f32 v20, v20, v76
  v_add_f32 v21, v21, v77
  v_add_f32 v22, v22, v78
  v_add_f32 v23, v23, v79
  v_add_f32 v24, v24, v80
  v_add_f32 v25, v25, v81
  v_add_f32 v16, v16, v82
  v_add_f32 v17, v17, v83
  v_add_f32 v18, v18, v84
  v_add_f32 v19, v19, v85
  v_add_f32 v20, v20, v86
  v_add_f32 v21, v21, v87
  v_add_f32 v22, v22, v88
  v_add_f32 v23, v23, v89
  v_add_f32 v24, v24, v90
  v_add_f32 v25, v25, v91
  v_add_f32 v16, v16, v92
  v_add_f32 v17, v17, v93
  v_add_f32 v18, v18, v94
  v_add_f32 v19, v19, v95
  v_add_f32 v20, v20, v96
  v_add_f32 v21, v21, v97
  v_add_f32 v22, v22, v98
  v_add_f32 v23, v23, v99
  v_add_f32 v24, v24, v100
  v_add_f32 v25, v25, v101
  v_add_f32 v16, v16, v102
  v_add_f32 v17, v17, v103
  v_add_f32 v18, v18, v104
  v_add_f32 v19, v19, v105
  v_add_f32 v20, v20, v106
  v_add_f32 v21, v21, v107
  v_add_f32 v22, v22, v108
  v_add_f32 v23, v23, v109
  v_add_f32 v24, v24, v110
  v_add_f32 v25, v25, v111
  ds_read_b64 v[32:33], v12 offset:35840
  ds_read_b64 v[34:35], v12 offset:36352
  ds_read_b64 v[36:37], v12 offset:36864
  ds_read_b64 v[38:39], v12 offset:37376
  ds_read_b64 v[40:41], v12 offset:37888
  v_cvt_pk_bf16_f32 v16, 0, v16
  v_cvt_pk_bf16_f32 v17, 0, v17
  v_cvt_pk_bf16_f32 v18, 0, v18
  v_cvt_pk_bf16_f32 v19, 0, v19
  v_cvt_pk_bf16_f32 v20, 0, v20
  v_cvt_pk_bf16_f32 v21, 0, v21
  v_cvt_pk_bf16_f32 v22, 0, v22
  v_cvt_pk_bf16_f32 v23, 0, v23
  v_cvt_pk_bf16_f32 v24, 0, v24
  v_cvt_pk_bf16_f32 v25, 0, v25
  s_waitcnt lgkmcnt(0)
  v_add_f32 v16, v16, v32
  v_add_f32 v17, v17, v33
  v_add_f32 v18, v18, v34
  v_add_f32 v19, v19, v35
  v_add_f32 v20, v20, v36
  v_add_f32 v21, v21, v37
  v_add_f32 v22, v22, v38
  v_add_f32 v23, v23, v39
  v_add_f32 v24, v24, v40
  v_add_f32 v25, v25, v41
  v_cvt_pk_bf16_f32 v16, 0, v16
  v_cvt_pk_bf16_f32 v17, 0, v17
  v_cvt_pk_bf16_f32 v18, 0, v18
  v_cvt_pk_bf16_f32 v19, 0, v19
  v_cvt_pk_bf16_f32 v20, 0, v20
  v_cvt_pk_bf16_f32 v21, 0, v21
  v_cvt_pk_bf16_f32 v22, 0, v22
  v_cvt_pk_bf16_f32 v23, 0, v23
  v_cvt_pk_bf16_f32 v24, 0, v24
  v_cvt_pk_bf16_f32 v25, 0, v25
  ds_write_b64 v121, v[16:17] offset:25600
  ds_write_b64 v121, v[18:19] offset:26112
  ds_write_b64 v121, v[20:21] offset:26624
  ds_write_b64 v121, v[22:23] offset:27136
  ds_write_b64 v121, v[24:25] offset:27648
  s_cmp_eq_u32 s85, 0
  s_cbranch_scc1 Lx2p343
  v_cvt_pk_bf16_f32 v32, v16, v17
  buffer_store_dword v32, v119, s[92:95], s84 offen offset:0
  v_cvt_pk_bf16_f32 v33, v18, v19
  buffer_store_dword v33, v119, s[92:95], s84 offen offset:256
  v_cvt_pk_bf16_f32 v34, v20, v21
  buffer_store_dword v34, v119, s[92:95], s84 offen offset:512
  v_cvt_pk_bf16_f32 v35, v22, v23
  buffer_store_dword v35, v119, s[92:95], s84 offen offset:768
  v_cvt_pk_bf16_f32 v36, v24, v25
  buffer_store_dword v36, v119, s[92:95], s84 offen offset:1024
  s_branch Lw0341
Lx2p343:
  s_cmp_lg_u32 s2, 32
  s_cbranch_scc1 Lout342
  s_mul_i32 s90, s83, 2560
  s_add_u32 s90, s90, 0xc8b000
  buffer_store_dwordx2 v[16:17], v12, s[64:67], s90 offen offset:0 sc1
  buffer_store_dwordx2 v[18:19], v12, s[64:67], s90 offen offset:512 sc1
  buffer_store_dwordx2 v[20:21], v12, s[64:67], s90 offen offset:1024 sc1
  buffer_store_dwordx2 v[22:23], v12, s[64:67], s90 offen offset:1536 sc1
  buffer_store_dwordx2 v[24:25], v12, s[64:67], s90 offen offset:2048 sc1
Lout342:
  s_nop 4
  v_add_f32 v32, v16, v17
  v_add_f32 v32, v32, v18
  v_add_f32 v32, v32, v19
  v_add_f32 v32, v32, v20
  v_add_f32 v32, v32, v21
  v_add_f32 v32, v32, v22
  v_add_f32 v32, v32, v23
  v_add_f32 v32, v32, v24
  v_add_f32 v32, v32, v25
  s_nop 1
  v_add_f32_dpp v32, v32, v32 quad_perm:[1,0,3,2] row_mask:0xf bank_mask:0xf
  s_nop 1
  v_add_f32_dpp v32, v32, v32 quad_perm:[2,3,0,1] row_mask:0xf bank_mask:0xf
  s_nop 1
  v_add_f32_dpp v32, v32, v32 row_half_mirror row_mask:0xf bank_mask:0xf
  s_nop 1
  v_add_f32_dpp v32, v32, v32 row_mirror row_mask:0xf bank_mask:0xf
  v_mov_b32 v33, v32
  s_nop 1
  v_permlane16_swap_b32 v32, v33
  v_add_f32 v32, v32, v33
  v_mov_b32 v33, v32
  s_nop 1
  v_permlane32_swap_b32 v32, v33
  v_add_f32 v32, v32, v33
  v_mul_f32 v34, 0x3acccccd, v32
  v_sub_f32 v40, v16, v34
  v_sub_f32 v41, v17, v34
  v_sub_f32 v42, v18, v34
  v_sub_f32 v43, v19, v34
  v_sub_f32 v44, v20, v34
  v_sub_f32 v45, v21, v34
  v_sub_f32 v46, v22, v34
  v_sub_f32 v47, v23, v34
  v_sub_f32 v48, v24, v34
  v_sub_f32 v49, v25, v34
  v_mul_f32 v32, v40, v40
  v_fmac_f32 v32, v41, v41
  v_fmac_f32 v32, v42, v42
  v_fmac_f32 v32, v43, v43
  v_fmac_f32 v32, v44, v44
  v_fmac_f32 v32, v45, v45
  v_fmac_f32 v32, v46, v46
  v_fmac_f32 v32, v47, v47
  v_fmac_f32 v32, v48, v48
  v_fmac_f32 v32, v49, v49
  s_nop 1
  v_add_f32_dpp v32, v32, v32 quad_perm:[1,0,3,2] row_mask:0xf bank_mask:0xf
  s_nop 1
  v_add_f32_dpp v32, v32, v32 quad_perm:[2,3,0,1] row_mask:0xf bank_mask:0xf
  s_nop 1
  v_add_f32_dpp v32, v32, v32 row_half_mirror row_mask:0xf bank_mask:0xf
  s_nop 1
  v_add_f32_dpp v32, v32, v32 row_mirror row_mask:0xf bank_mask:0xf
  v_mov_b32 v33, v32
  s_nop 1
  v_permlane16_swap_b32 v32, v33
  v_add_f32 v32, v32, v33
  v_mov_b32 v33, v32
  s_nop 1
  v_permlane32_swap_b32 v32, v33
  v_add_f32 v32, v32, v33
  v_mul_f32 v35, 0x3acccccd, v32
  v_cvt_pk_bf16_f32 v34, 0, v34
  v_cvt_pk_bf16_f32 v35, 0, v35
  v_add_f32 v35, 0x3727c5ac, v35
  v_cvt_pk_bf16_f32 v35, 0, v35
  v_sqrt_f32 v35, v35
  s_nop 0
  v_cvt_pk_bf16_f32 v35, 0, v35
  v_rcp_f32 v33, v35
  v_sub_f32 v40, v16, v34
  v_sub_f32 v41, v17, v34
  v_sub_f32 v42, v18, v34
  v_sub_f32 v43, v19, v34
  v_sub_f32 v44, v20, v34
  v_sub_f32 v45, v21, v34
  v_sub_f32 v46, v22, v34
  v_sub_f32 v47, v23, v34
  v_sub_f32 v48, v24, v34
  v_sub_f32 v49, v25, v34
  v_cvt_pk_bf16_f32 v40, 0, v40
  v_cvt_pk_bf16_f32 v41, 0, v41
  v_cvt_pk_bf16_f32 v42, 0, v42
  v_cvt_pk_bf16_f32 v43, 0, v43
  v_cvt_pk_bf16_f32 v44, 0, v44
  v_cvt_pk_bf16_f32 v45, 0, v45
  v_cvt_pk_bf16_f32 v46, 0, v46
  v_cvt_pk_bf16_f32 v47, 0, v47
  v_cvt_pk_bf16_f32 v48, 0, v48
  v_cvt_pk_bf16_f32 v49, 0, v49
  v_mul_f32 v50, v40, v33
  v_mul_f32 v51, v41, v33
  v_mul_f32 v52, v42, v33
  v_mul_f32 v53, v43, v33
  v_mul_f32 v54, v44, v33
  v_mul_f32 v55, v45, v33
  v_mul_f32 v56, v46, v33
  v_mul_f32 v57, v47, v33
  v_mul_f32 v58, v48, v33
  v_mul_f32 v59, v49, v33
  v_fma_f32 v60, -v50, v35, v40
  v_fma_f32 v61, -v51, v35, v41
  v_fma_f32 v62, -v52, v35, v42
  v_fma_f32 v63, -v53, v35, v43
  v_fma_f32 v64, -v54, v35, v44
  v_fma_f32 v65, -v55, v35, v45
  v_fma_f32 v66, -v56, v35, v46
  v_fma_f32 v67, -v57, v35, v47
  v_fma_f32 v68, -v58, v35, v48
  v_fma_f32 v69, -v59, v35, v49
  v_fma_f32 v50, v60, v33, v50
  v_fma_f32 v51, v61, v33, v51
  v_fma_f32 v52, v62, v33, v52
  v_fma_f32 v53, v63, v33, v53
  v_fma_f32 v54, v64, v33, v54
  v_fma_f32 v55, v65, v33, v55
  v_fma_f32 v56, v66, v33, v56
  v_fma_f32 v57, v67, v33, v57
  v_fma_f32 v58, v68, v33, v58
  v_fma_f32 v59, v69, v33, v59
  v_cvt_pk_bf16_f32 v72, v50, v51
  ds_write_b32 v119, v72 offset:0
  v_cvt_pk_bf16_f32 v73, v52, v53
  ds_write_b32 v119, v73 offset:256
  v_cvt_pk_bf16_f32 v74, v54, v55
  ds_write_b32 v119, v74 offset:512
  v_cvt_pk_bf16_f32 v75, v56, v57
  ds_write_b32 v119, v75 offset:768
  v_cvt_pk_bf16_f32 v76, v58, v59
  ds_write_b32 v119, v76 offset:1024
  s_waitcnt lgkmcnt(0)
Lw0341:
  s_nop 4
  s_waitcnt lgkmcnt(0)
  s_barrier
  s_cmp_lg_u32 s85, 0
  s_cbranch_scc1 L_qnext
  ds_read_b128 v[48:51], v14 offset:0
  ds_read_b128 v[52:55], v14 offset:1024
  ds_read_b128 v[56:59], v14 offset:2048
  ds_read_b128 v[60:63], v14 offset:3072
  ds_read_b128 v[64:67], v14 offset:4096
  ds_read_b128 v[68:71], v14 offset:5120
  ds_read_b128 v[72:75], v14 offset:6144
  ds_read_b128 v[76:79], v14 offset:7168
  ds_read_b128 v[80:83], v114 offset:0
  ds_read_b128 v[84:87], v114 offset:64
  ds_read_b128 v[88:91], v114 offset:128
  ds_read_b128 v[92:95], v114 offset:192
  ds_read_b128 v[96:99], v114 offset:256
  s_waitcnt lgkmcnt(0)
  v_mfma_f32_16x16x32_bf16 v[16:19], v[80:83], a[0:3], 0
  v_mfma_f32_16x16x32_bf16 v[20:23], v[80:83], a[4:7], 0
  v_mfma_f32_16x16x32_bf16 v[24:27], v[80:83], a[8:11], 0
  v_mfma_f32_16x16x32_bf16 v[28:31], v[80:83], a[12:15], 0
  v_mfma_f32_16x16x32_bf16 v[32:35], v[80:83], a[16:19], 0
  v_mfma_f32_16x16x32_bf16 v[36:39], v[80:83], a[20:23], 0
  v_mfma_f32_16x16x32_bf16 v[40:43], v[80:83], a[24:27], 0
  v_mfma_f32_16x16x32_bf16 v[44:47], v[80:83], a[28:31], 0
  v_mfma_f32_16x16x32_bf16 v[16:19], v[84:87], a[32:35], v[16:19]
  v_mfma_f32_16x16x32_bf16 v[20:23], v[84:87], a[36:39], v[20:23]
  v_mfma_f32_16x16x32_bf16 v[24:27], v[84:87], a[40:43], v[24:27]
  v_mfma_f32_16x16x32_bf16 v[28:31], v[84:87], a[44:47], v[28:31]
  v_mfma_f32_16x16x32_bf16 v[32:35], v[84:87], a[48:51], v[32:35]
  v_mfma_f32_16x16x32_bf16 v[36:39], v[84:87], a[52:55], v[36:39]
  v_mfma_f32_16x16x32_bf16 v[40:43], v[84:87], a[56:59], v[40:43]
  v_mfma_f32_16x16x32_bf16 v[44:47], v[84:87], a[60:63], v[44:47]
  v_mfma_f32_16x16x32_bf16 v[16:19], v[88:91], a[64:67], v[16:19]
  v_mfma_f32_16x16x32_bf16 v[20:23], v[88:91], a[68:71], v[20:23]
  v_mfma_f32_16x16x32_bf16 v[24:27], v[88:91], a[72:75], v[24:27]
  v_mfma_f32_16x16x32_bf16 v[28:31], v[88:91], a[76:79], v[28:31]
  v_mfma_f32_16x16x32_bf16 v[32:35], v[88:91], a[80:83], v[32:35]
  v_mfma_f32_16x16x32_bf16 v[36:39], v[88:91], a[84:87], v[36:39]
  v_mfma_f32_16x16x32_bf16 v[40:43], v[88:91], a[88:91], v[40:43]
  v_mfma_f32_16x16x32_bf16 v[44:47], v[88:91], a[92:95], v[44:47]
  v_mfma_f32_16x16x32_bf16 v[16:19], v[92:95], a[96:99], v[16:19]
  v_mfma_f32_16x16x32_bf16 v[20:23], v[92:95], a[100:103], v[20:23]
  v_mfma_f32_16x16x32_bf16 v[24:27], v[92:95], a[104:107], v[24:27]
  v_mfma_f32_16x16x32_bf16 v[28:31], v[92:95], a[108:111], v[28:31]
  v_mfma_f32_16x16x32_bf16 v[32:35], v[92:95], a[112:115], v[32:35]
  v_mfma_f32_16x16x32_bf16 v[36:39], v[92:95], a[116:119], v[36:39]
  v_mfma_f32_16x16x32_bf16 v[40:43], v[92:95], a[120:123], v[40:43]
  v_mfma_f32_16x16x32_bf16 v[44:47], v[92:95], a[124:127], v[44:47]
  s_waitcnt lgkmcnt(0)
  v_mfma_f32_16x16x32_bf16 v[16:19], v[96:99], v[48:51], v[16:19]
  v_mfma_f32_16x16x32_bf16 v[20:23], v[96:99], v[52:55], v[20:23]
  v_mfma_f32_16x16x32_bf16 v[24:27], v[96:99], v[56:59], v[24:27]
  v_mfma_f32_16x16x32_bf16 v[28:31], v[96:99], v[60:63], v[28:31]
  v_mfma_f32_16x16x32_bf16 v[32:35], v[96:99], v[64:67], v[32:35]
  v_mfma_f32_16x16x32_bf16 v[36:39], v[96:99], v[68:71], v[36:39]
  v_mfma_f32_16x16x32_bf16 v[40:43], v[96:99], v[72:75], v[40:43]
  v_mfma_f32_16x16x32_bf16 v[44:47], v[96:99], v[76:79], v[44:47]
  ds_read_b128 v[48:51], v14 offset:8192
  ds_read_b128 v[52:55], v14 offset:9216
  ds_read_b128 v[56:59], v14 offset:10240
  ds_read_b128 v[60:63], v14 offset:11264
  ds_read_b128 v[64:67], v14 offset:12288
  ds_read_b128 v[68:71], v14 offset:13312
  ds_read_b128 v[72:75], v14 offset:14336
  ds_read_b128 v[76:79], v14 offset:15360
  v_mov_b32 v100, v16
  v_mov_b32 v101, v20
  v_mov_b32 v102, v24
  v_mov_b32 v103, v28
  v_mov_b32 v104, v32
  v_mov_b32 v105, v36
  v_mov_b32 v106, v40
  v_mov_b32 v107, v44
  s_mov_b32 exec_lo, 0xffff
  s_mov_b32 exec_hi, 0
  ds_write_b128 v115, v[100:103] offset:0
  ds_write_b128 v115, v[104:107] offset:16
  s_mov_b64 exec, -1
  v_mfma_f32_16x16x32_bf16 v[16:19], v[80:83], a[128:131], 0
  v_mfma_f32_16x16x32_bf16 v[20:23], v[80:83], a[132:135], 0
  v_mfma_f32_16x16x32_bf16 v[24:27], v[80:83], a[136:139], 0
  v_mfma_f32_16x16x32_bf16 v[28:31], v[80:83], a[140:143], 0
  v_mfma_f32_16x16x32_bf16 v[32:35], v[80:83], a[144:147], 0
  v_mfma_f32_16x16x32_bf16 v[36:39], v[80:83], a[148:151], 0
  v_mfma_f32_16x16x32_bf16 v[40:43], v[80:83], a[152:155], 0
  v_mfma_f32_16x16x32_bf16 v[44:47], v[80:83], a[156:159], 0
  v_mfma_f32_16x16x32_bf16 v[16:19], v[84:87], a[160:163], v[16:19]
  v_mfma_f32_16x16x32_bf16 v[20:23], v[84:87], a[164:167], v[20:23]
  v_mfma_f32_16x16x32_bf16 v[24:27], v[84:87], a[168:171], v[24:27]
  v_mfma_f32_16x16x32_bf16 v[28:31], v[84:87], a[172:175], v[28:31]
  v_mfma_f32_16x16x32_bf16 v[32:35], v[84:87], a[176:179], v[32:35]
  v_mfma_f32_16x16x32_bf16 v[36:39], v[84:87], a[180:183], v[36:39]
  v_mfma_f32_16x16x32_bf16 v[40:43], v[84:87], a[184:187], v[40:43]
  v_mfma_f32_16x16x32_bf16 v[44:47], v[84:87], a[188:191], v[44:47]
  v_mfma_f32_16x16x32_bf16 v[16:19], v[88:91], a[192:195], v[16:19]
  v_mfma_f32_16x16x32_bf16 v[20:23], v[88:91], a[196:199], v[20:23]
  v_mfma_f32_16x16x32_bf16 v[24:27], v[88:91], a[200:203], v[24:27]
  v_mfma_f32_16x16x32_bf16 v[28:31], v[88:91], a[204:207], v[28:31]
  v_mfma_f32_16x16x32_bf16 v[32:35], v[88:91], a[208:211], v[32:35]
  v_mfma_f32_16x16x32_bf16 v[36:39], v[88:91], a[212:215], v[36:39]
  v_mfma_f32_16x16x32_bf16 v[40:43], v[88:91], a[216:219], v[40:43]
  v_mfma_f32_16x16x32_bf16 v[44:47], v[88:91], a[220:223], v[44:47]
  v_mfma_f32_16x16x32_bf16 v[16:19], v[92:95], a[224:227], v[16:19]
  v_mfma_f32_16x16x32_bf16 v[20:23], v[92:95], a[228:231], v[20:23]
  v_mfma_f32_16x16x32_bf16 v[24:27], v[92:95], a[232:235], v[24:27]
  v_mfma_f32_16x16x32_bf16 v[28:31], v[92:95], a[236:239], v[28:31]
  v_mfma_f32_16x16x32_bf16 v[32:35], v[92:95], a[240:243], v[32:35]
  v_mfma_f32_16x16x32_bf16 v[36:39], v[92:95], a[244:247], v[36:39]
  v_mfma_f32_16x16x32_bf16 v[40:43], v[92:95], a[248:251], v[40:43]
  v_mfma_f32_16x16x32_bf16 v[44:47], v[92:95], a[252:255], v[44:47]
  s_waitcnt lgkmcnt(0)
  v_mfma_f32_16x16x32_bf16 v[16:19], v[96:99], v[48:51], v[16:19]
  v_mfma_f32_16x16x32_bf16 v[20:23], v[96:99], v[52:55], v[20:23]
  v_mfma_f32_16x16x32_bf16 v[24:27], v[96:99], v[56:59], v[24:27]
  v_mfma_f32_16x16x32_bf16 v[28:31], v[96:99], v[60:63], v[28:31]
  v_mfma_f32_16x16x32_bf16 v[32:35], v[96:99], v[64:67], v[32:35]
  v_mfma_f32_16x16x32_bf16 v[36:39], v[96:99], v[68:71], v[36:39]
  v_mfma_f32_16x16x32_bf16 v[40:43], v[96:99], v[72:75], v[40:43]
  v_mfma_f32_16x16x32_bf16 v[44:47], v[96:99], v[76:79], v[44:47]
  ds_read_b128 v[48:51], v14 offset:16384
  ds_read_b128 v[52:55], v14 offset:17408
  ds_read_b128 v[56:59], v14 offset:18432
  ds_read_b128 v[60:63], v14 offset:19456
  ds_read_b128 v[64:67], v14 offset:20480
  ds_read_b128 v[68:71], v14 offset:21504
  ds_read_b128 v[72:75], v14 offset:22528
  ds_read_b128 v[76:79], v14 offset:23552
  v_mov_b32 v100, v16
  v_mov_b32 v101, v20
  v_mov_b32 v102, v24
  v_mov_b32 v103, v28
  v_mov_b32 v104, v32
  v_mov_b32 v105, v36
  v_mov_b32 v106, v40
  v_mov_b32 v107, v44
  s_mov_b32 exec_lo, 0xffff
  s_mov_b32 exec_hi, 0
  ds_write_b128 v115, v[100:103] offset:512
  ds_write_b128 v115, v[104:107] offset:528
  s_mov_b64 exec, -1
  v_mfma_f32_16x16x32_bf16 v[16:19], v[80:83], v[128:131], 0
  v_mfma_f32_16x16x32_bf16 v[20:23], v[80:83], v[132:135], 0
  v_mfma_f32_16x16x32_bf16 v[24:27], v[80:83], v[136:139], 0
  v_mfma_f32_16x16x32_bf16 v[28:31], v[80:83], v[140:143], 0
  v_mfma_f32_16x16x32_bf16 v[32:35], v[80:83], v[144:147], 0
  v_mfma_f32_16x16x32_bf16 v[36:39], v[80:83], v[148:151], 0
  v_mfma_f32_16x16x32_bf16 v[40:43], v[80:83], v[152:155], 0
  v_mfma_f32_16x16x32_bf16 v[44:47], v[80:83], v[156:159], 0
  v_mfma_f32_16x16x32_bf16 v[16:19], v[84:87], v[160:163], v[16:19]
  v_mfma_f32_16x16x32_bf16 v[20:23], v[84:87], v[164:167], v[20:23]
  v_mfma_f32_16x16x32_bf16 v[24:27], v[84:87], v[168:171], v[24:27]
  v_mfma_f32_16x16x32_bf16 v[28:31], v[84:87], v[172:175], v[28:31]
  v_mfma_f32_16x16x32_bf16 v[32:35], v[84:87], v[176:179], v[32:35]
  v_mfma_f32_16x16x32_bf16 v[36:39], v[84:87], v[180:183], v[36:39]
  v_mfma_f32_16x16x32_bf16 v[40:43], v[84:87], v[184:187], v[40:43]
  v_mfma_f32_16x16x32_bf16 v[44:47], v[84:87], v[188:191], v[44:47]
  v_mfma_f32_16x16x32_bf16 v[16:19], v[88:91], v[192:195], v[16:19]
  v_mfma_f32_16x16x32_bf16 v[20:23], v[88:91], v[196:199], v[20:23]
  v_mfma_f32_16x16x32_bf16 v[24:27], v[88:91], v[200:203], v[24:27]
  v_mfma_f32_16x16x32_bf16 v[28:31], v[88:91], v[204:207], v[28:31]
  v_mfma_f32_16x16x32_bf16 v[32:35], v[88:91], v[208:211], v[32:35]
  v_mfma_f32_16x16x32_bf16 v[36:39], v[88:91], v[212:215], v[36:39]
  v_mfma_f32_16x16x32_bf16 v[40:43], v[88:91], v[216:219], v[40:43]
  v_mfma_f32_16x16x32_bf16 v[44:47], v[88:91], v[220:223], v[44:47]
  v_mfma_f32_16x16x32_bf16 v[16:19], v[92:95], v[224:227], v[16:19]
  v_mfma_f32_16x16x32_bf16 v[20:23], v[92:95], v[228:231], v[20:23]
  v_mfma_f32_16x16x32_bf16 v[24:27], v[92:95], v[232:235], v[24:27]
  v_mfma_f32_16x16x32_bf16 v[28:31], v[92:95], v[236:239], v[28:31]
  v_mfma_f32_16x16x32_bf16 v[32:35], v[92:95], v[240:243], v[32:35]
  v_mfma_f32_16x16x32_bf16 v[36:39], v[92:95], v[244:247], v[36:39]
  v_mfma_f32_16x16x32_bf16 v[40:43], v[92:95], v[248:251], v[40:43]
  v_mfma_f32_16x16x32_bf16 v[44:47], v[92:95], v[252:255], v[44:47]
  s_waitcnt lgkmcnt(0)
  v_mfma_f32_16x16x32_bf16 v[16:19], v[96:99], v[48:51], v[16:19]
  v_mfma_f32_16x16x32_bf16 v[20:23], v[96:99], v[52:55], v[20:23]
  v_mfma_f32_16x16x32_bf16 v[24:27], v[96:99], v[56:59], v[24:27]
  v_mfma_f32_16x16x32_bf16 v[28:31], v[96:99], v[60:63], v[28:31]
  v_mfma_f32_16x16x32_bf16 v[32:35], v[96:99], v[64:67], v[32:35]
  v_mfma_f32_16x16x32_bf16 v[36:39], v[96:99], v[68:71], v[36:39]
  v_mfma_f32_16x16x32_bf16 v[40:43], v[96:99], v[72:75], v[40:43]
  v_mfma_f32_16x16x32_bf16 v[44:47], v[96:99], v[76:79], v[44:47]
  s_nop 0
  v_mov_b32 v100, v16
  v_mov_b32 v101, v20
  v_mov_b32 v102, v24
  v_mov_b32 v103, v28
  v_mov_b32 v104, v32
  v_mov_b32 v105, v36
  v_mov_b32 v106, v40
  v_mov_b32 v107, v44
  s_mov_b32 exec_lo, 0xffff
  s_mov_b32 exec_hi, 0
  ds_write_b128 v115, v[100:103] offset:1024
  ds_write_b128 v115, v[104:107] offset:1040
  s_mov_b64 exec, -1
  s_waitcnt lgkmcnt(0)
  s_barrier
  s_cmp_lg_u32 s3, 0
  s_cbranch_scc1 Lw0344
  v_lshlrev_b32 v127, 1, v13
  ds_read_b128 v[16:19], v127 offset:5120
  ds_read_b128 v[20:23], v127 offset:5136
  ds_read_b128 v[24:27], v127 offset:6656
  ds_read_b128 v[28:31], v127 offset:6672
  ds_read_b128 v[32:35], v127 offset:8192
  ds_read_b128 v[36:39], v127 offset:8208
  ds_read_b128 v[40:43], v127 offset:9728
  ds_read_b128 v[44:47], v127 offset:9744
  s_waitcnt lgkmcnt(0)
  v_add_f32 v16, v16, v24
  v_add_f32 v17, v17, v25
  v_add_f32 v18, v18, v26
  v_add_f32 v19, v19, v27
  v_add_f32 v20, v20, v28
  v_add_f32 v21, v21, v29
  v_add_f32 v22, v22, v30
  v_add_f32 v23, v23, v31
  v_add_f32 v16, v16, v32
  v_add_f32 v17, v17, v33
  v_add_f32 v18, v18, v34
  v_add_f32 v19, v19, v35
  v_add_f32 v20, v20, v36
  v_add_f32 v21, v21, v37
  v_add_f32 v22, v22, v38
  v_add_f32 v23, v23, v39
  v_add_f32 v16, v16, v40
  v_add_f32 v17, v17, v41
  v_add_f32 v18, v18, v42
  v_add_f32 v19, v19, v43
  v_add_f32 v20, v20, v44
  v_add_f32 v21, v21, v45
  v_add_f32 v22, v22, v46
  v_add_f32 v23, v23, v47
  v_cvt_pk_bf16_f32 v60, v16, v17
  v_cvt_pk_bf16_f32 v61, v18, v19
  v_cvt_pk_bf16_f32 v62, v20, v21
  v_cvt_pk_bf16_f32 v63, v22, v23
  s_add_u32 s76, s70, s86
  s_mov_b32 exec_lo, -1
  s_mov_b32 exec_hi, 0xffff
  buffer_store_dwordx4 v[60:63], v13, s[64:67], s76 offen sc1
  s_mov_b64 exec, -1
  s_waitcnt lgkmcnt(0)
Lw0344:
  s_nop 4
  s_waitcnt lgkmcnt(0)
  s_barrier
L_qnext:
  s_nop 4
  s_add_u32 s78, s78, 1
  s_cmp_lt_u32 s78, 8
  s_cbranch_scc1 L_qloop
  s_waitcnt vmcnt(0)
  s_endpgm
  s_nop 4
L_stream:
  s_lshl_b32 s4, s3, 6
  v_add_u32 v15, s4, v0
  v_lshlrev_b32 v15, 4, v15
  v_mov_b32 v16, -1
  v_mov_b32 v17, -1
  v_mov_b32 v18, -1
  v_mov_b32 v19, -1
  s_cmp_ge_u32 s2, 12
  s_cbranch_scc1 Lst1345
  s_lshl_b32 s76, s2, 12
  s_add_u32 s76, s76, 0xc73000
  buffer_store_dwordx4 v[16:19], v15, s[64:67], s76 offen sc1
  s_waitcnt vmcnt(0)
  s_barrier
  s_cmp_lg_u32 s3, 0
  s_cbranch_scc1 Lw0346
  s_lshl_b32 s4, s2, 2
  v_mov_b32 v150, s4
  v_mov_b32 v151, 1
  s_mov_b32 exec_lo, 0x1
  s_mov_b32 exec_hi, 0
  global_store_dword v150, v151, s[28:29] sc1
  s_mov_b64 exec, -1
Lw0346:
  s_nop 4
Lst1345:
  s_nop 4
  s_mov_b32 s96, s8
  s_and_b32 s97, s9, 0xffff
  s_mov_b32 s98, 0x1400
  s_mov_b32 s99, 0x20000
  v_lshlrev_b32 v254, 2, v0
  s_mul_i32 s76, s3, 1280
  buffer_load_dword v226, v254, s[96:99], s76 offen offset:0
  buffer_load_dword v227, v254, s[96:99], s76 offen offset:256
  buffer_load_dword v228, v254, s[96:99], s76 offen offset:512
  buffer_load_dword v229, v254, s[96:99], s76 offen offset:768
  buffer_load_dword v230, v254, s[96:99], s76 offen offset:1024
  s_mul_i32 s4, s2, 48
  s_sub_u32 s5, 7864320, s4
  s_add_u32 s92, s14, s4
  s_addc_u32 s93, s15, 0
  s_and_b32 s93, s93, 0xffff
  s_mov_b32 s94, s5
  s_mov_b32 s95, 0x20000
  v_and_b32 v255, 15, v0
  v_mul_u32_u24 v255, 122880, v255
  v_lshrrev_b32 v128, 4, v0
  v_min_u32 v128, 2, v128
  v_lshl_add_u32 v255, v128, 4, v255
  s_mul_i32 s4, s3, 1966080
  s_add_u32 s76, s4, 0
  buffer_load_dwordx4 v[56:59], v255, s[92:95], s76 offen
  s_add_u32 s76, s4, 12288
  buffer_load_dwordx4 v[60:63], v255, s[92:95], s76 offen
  s_add_u32 s76, s4, 24576
  buffer_load_dwordx4 v[64:67], v255, s[92:95], s76 offen
  s_add_u32 s76, s4, 36864
  buffer_load_dwordx4 v[68:71], v255, s[92:95], s76 offen
  s_add_u32 s76, s4, 49152
  buffer_load_dwordx4 v[72:75], v255, s[92:95], s76 offen
  s_add_u32 s76, s4, 61440
  buffer_load_dwordx4 v[76:79], v255, s[92:95], s76 offen
  s_add_u32 s76, s4, 73728
  buffer_load_dwordx4 v[80:83], v255, s[92:95], s76 offen
  s_add_u32 s76, s4, 86016
  buffer_load_dwordx4 v[84:87], v255, s[92:95], s76 offen
  s_add_u32 s76, s4, 98304
  buffer_load_dwordx4 v[88:91], v255, s[92:95], s76 offen
  s_add_u32 s76, s4, 110592
  buffer_load_dwordx4 v[92:95], v255, s[92:95], s76 offen
  s_sub_u32 s4, s2, 0
  s_lshl_b32 s4, s4, 2
  s_add_u32 s4, s4, s3
  s_mul_i32 s5, s4, 2521
  s_lshr_b32 s5, s5, 16
  s_mul_i32 s6, s5, 26
  s_sub_u32 s6, s4, s6
  s_mul_i32 s70, s5, 3145728
  s_sub_i32 s7, s6, 0
  s_max_i32 s7, s7, 0
  s_min_i32 s7, s7, 10
  s_sub_u32 s68, s6, 0
  s_cmp_lt_u32 s68, 10
  s_cselect_b32 s68, 40, 39
  s_cselect_b32 s80, 0, 0xff800000
  s_mul_i32 s68, s68, 3072
  s_mul_i32 s71, s6, 39
  s_add_u32 s7, s7, s71
  s_mul_i32 s71, s7, 3072
  s_add_u32 s71, s71, s70
  s_add_u32 s71, s71, 0x0
  s_add_u32 s32, s10, s71
  s_addc_u32 s33, s11, 0
  s_and_b32 s33, s33, 0xffff
  s_mov_b32 s34, s68
  s_mov_b32 s35, 0x20000
  s_add_u32 s36, s12, s71
  s_addc_u32 s37, s13, 0
  s_and_b32 s37, s37, 0xffff
  s_mov_b32 s38, s68
  s_mov_b32 s39, 0x20000
  s_min_u32 s7, s6, 3
  s_sub_i32 s68, s6, 19
  s_max_i32 s68, s68, 0
  s_add_u32 s7, s7, s68
  s_sub_u32 s68, s6, 3
  s_cmp_ge_u32 s68, 16
  s_cselect_b32 s68, 40, 39
  s_cselect_b32 s81, 0, 0xff800000
  s_mul_i32 s68, s68, 3072
  s_mul_i32 s71, s6, 39
  s_add_u32 s7, s7, s71
  s_mul_i32 s71, s7, 3072
  s_add_u32 s71, s71, s70
  s_add_u32 s71, s71, 0x6000000
  s_add_u32 s40, s10, s71
  s_addc_u32 s41, s11, 0
  s_and_b32 s41, s41, 0xffff
  s_mov_b32 s42, s68
  s_mov_b32 s43, 0x20000
  s_add_u32 s44, s12, s71
  s_addc_u32 s45, s13, 0
  s_and_b32 s45, s45, 0xffff
  s_mov_b32 s46, s68
  s_mov_b32 s47, 0x20000
  s_sub_i32 s7, s6, 12
  s_max_i32 s7, s7, 0
  s_min_i32 s7, s7, 10
  s_sub_u32 s68, s6, 12
  s_cmp_lt_u32 s68, 10
  s_cselect_b32 s68, 40, 39
  s_cselect_b32 s82, 0, 0xff800000
  s_mul_i32 s68, s68, 3072
  s_mul_i32 s71, s6, 39
  s_add_u32 s7, s7, s71
  s_mul_i32 s71, s7, 3072
  s_add_u32 s71, s71, s70
  s_add_u32 s71, s71, 0xc000000
  s_add_u32 s48, s10, s71
  s_addc_u32 s49, s11, 0
  s_and_b32 s49, s49, 0xffff
  s_mov_b32 s50, s68
  s_mov_b32 s51, 0x20000
  s_add_u32 s52, s12, s71
  s_addc_u32 s53, s13, 0
  s_and_b32 s53, s53, 0xffff
  s_mov_b32 s54, s68
  s_mov_b32 s55, 0x20000
  s_sub_i32 s7, s6, 5
  s_max_i32 s7, s7, 0
  s_min_i32 s7, s7, 10
  s_sub_u32 s68, s6, 5
  s_cmp_lt_u32 s68, 10
  s_cselect_b32 s68, 40, 39
  s_cselect_b32 s83, 0, 0xff800000
  s_mul_i32 s68, s68, 3072
  s_mul_i32 s71, s6, 39
  s_add_u32 s7, s7, s71
  s_mul_i32 s71, s7, 3072
  s_add_u32 s71, s71, s70
  s_add_u32 s71, s71, 0x12000000
  s_add_u32 s56, s10, s71
  s_addc_u32 s57, s11, 0
  s_and_b32 s57, s57, 0xffff
  s_mov_b32 s58, s68
  s_mov_b32 s59, 0x20000
  s_add_u32 s60, s12, s71
  s_addc_u32 s61, s13, 0
  s_and_b32 s61, s61, 0xffff
  s_mov_b32 s62, s68
  s_mov_b32 s63, 0x20000
  s_mul_i32 s72, s5, 384
  s_add_u32 s72, s72, 0xc73000
  s_mul_i32 s73, s4, 784
  s_mov_b32 s74, 0x3dd53b95
  s_lshl_b32 s78, s4, 8
  s_add_u32 s78, s78, 0xc90000
  v_lshrrev_b32 v1, 3, v0
  v_mul_u32_u24 v1, 384, v1
  v_and_b32 v2, 7, v0
  v_lshlrev_b32 v2, 4, v2
  v_add_u32 v1, v1, v2
  s_mul_i32 s71, s3, 40960
  v_lshlrev_b32 v6, 4, v0
  v_add_u32 v3, s71, v6
  s_add_u32 s71, s71, 39936
  v_add_u32 v5, s71, v6
  v_lshlrev_b32 v4, 1, v2
  v_add_u32 v4, s71, v4
  v_bfe_u32 v7, v0, 4, 1
  v_mul_u32_u24 v7, 6, v7
  v_bfe_u32 v254, v0, 5, 1
  v_mul_u32_u24 v254, 12, v254
  v_add_u32 v7, v7, v254
  v_mov_b32 v250, 163832
  v_mov_b32 v251, 0
  ds_write_b32 v250, v251
  s_waitcnt vmcnt(10)
  s_mov_b32 s76, 0
  LDT a, 0, 32
  s_mov_b32 s76, 0xc00
  LDT a, 12, 32
  s_mov_b32 s76, 0
  LDT v, 130, 36
  s_mov_b32 s76, 0xc00
  LDT v, 142, 36
  s_mov_b32 s76, 0x1800
  LDT a, 24, 32
  s_mov_b32 s76, 0x2400
  LDT a, 36, 32
  s_mov_b32 s76, 0x1800
  LDT v, 154, 36
  v_lshlrev_b32 v231, 16, v226
  v_and_b32 v232, 0xffff0000, v226
  v_lshlrev_b32 v233, 16, v227
  v_and_b32 v234, 0xffff0000, v227
  v_lshlrev_b32 v235, 16, v228
  v_and_b32 v236, 0xffff0000, v228
  v_lshlrev_b32 v237, 16, v229
  v_and_b32 v238, 0xffff0000, v229
  v_lshlrev_b32 v239, 16, v230
  v_and_b32 v240, 0xffff0000, v230
  v_add_f32 v96, v231, v232
  v_add_f32 v96, v96, v233
  v_add_f32 v96, v96, v234
  v_add_f32 v96, v96, v235
  v_add_f32 v96, v96, v236
  v_add_f32 v96, v96, v237
  v_add_f32 v96, v96, v238
  v_add_f32 v96, v96, v239
  v_add_f32 v96, v96, v240
  s_nop 1
  v_add_f32_dpp v96, v96, v96 quad_perm:[1,0,3,2] row_mask:0xf bank_mask:0xf
  s_nop 1
  v_add_f32_dpp v96, v96, v96 quad_perm:[2,3,0,1] row_mask:0xf bank_mask:0xf
  s_nop 1
  v_add_f32_dpp v96, v96, v96 row_half_mirror row_mask:0xf bank_mask:0xf
  s_nop 1
  v_add_f32_dpp v96, v96, v96 row_mirror row_mask:0xf bank_mask:0xf
  v_mov_b32 v97, v96
  s_nop 1
  v_permlane16_swap_b32 v96, v97
  v_add_f32 v96, v96, v97
  v_mov_b32 v97, v96
  s_nop 1
  v_permlane32_swap_b32 v96, v97
  v_add_f32 v96, v96, v97
  v_mul_f32 v98, 0x3acccccd, v96
  v_sub_f32 v100, v231, v98
  v_sub_f32 v101, v232, v98
  v_sub_f32 v102, v233, v98
  v_sub_f32 v103, v234, v98
  v_sub_f32 v104, v235, v98
  v_sub_f32 v105, v236, v98
  v_sub_f32 v106, v237, v98
  v_sub_f32 v107, v238, v98
  v_sub_f32 v108, v239, v98
  v_sub_f32 v109, v240, v98
  v_mul_f32 v96, v100, v100
  v_fmac_f32 v96, v101, v101
  v_fmac_f32 v96, v102, v102
  v_fmac_f32 v96, v103, v103
  v_fmac_f32 v96, v104, v104
  v_fmac_f32 v96, v105, v105
  v_fmac_f32 v96, v106, v106
  v_fmac_f32 v96, v107, v107
  v_fmac_f32 v96, v108, v108
  v_fmac_f32 v96, v109, v109
  s_nop 1
  v_add_f32_dpp v96, v96, v96 quad_perm:[1,0,3,2] row_mask:0xf bank_mask:0xf
  s_nop 1
  v_add_f32_dpp v96, v96, v96 quad_perm:[2,3,0,1] row_mask:0xf bank_mask:0xf
  s_nop 1
  v_add_f32_dpp v96, v96, v96 row_half_mirror row_mask:0xf bank_mask:0xf
  s_nop 1
  v_add_f32_dpp v96, v96, v96 row_mirror row_mask:0xf bank_mask:0xf
  v_mov_b32 v97, v96
  s_nop 1
  v_permlane16_swap_b32 v96, v97
  v_add_f32 v96, v96, v97
  v_mov_b32 v97, v96
  s_nop 1
  v_permlane32_swap_b32 v96, v97
  v_add_f32 v96, v96, v97
  v_mul_f32 v99, 0x3acccccd, v96
  v_cvt_pk_bf16_f32 v98, 0, v98
  v_cvt_pk_bf16_f32 v99, 0, v99
  v_add_f32 v99, 0x3727c5ac, v99
  v_cvt_pk_bf16_f32 v99, 0, v99
  v_sqrt_f32 v99, v99
  s_nop 0
  v_cvt_pk_bf16_f32 v99, 0, v99
  v_rcp_f32 v97, v99
  v_sub_f32 v100, v231, v98
  v_sub_f32 v101, v232, v98
  v_sub_f32 v102, v233, v98
  v_sub_f32 v103, v234, v98
  v_sub_f32 v104, v235, v98
  v_sub_f32 v105, v236, v98
  v_sub_f32 v106, v237, v98
  v_sub_f32 v107, v238, v98
  v_sub_f32 v108, v239, v98
  v_sub_f32 v109, v240, v98
  v_cvt_pk_bf16_f32 v100, 0, v100
  v_cvt_pk_bf16_f32 v101, 0, v101
  v_cvt_pk_bf16_f32 v102, 0, v102
  v_cvt_pk_bf16_f32 v103, 0, v103
  v_cvt_pk_bf16_f32 v104, 0, v104
  v_cvt_pk_bf16_f32 v105, 0, v105
  v_cvt_pk_bf16_f32 v106, 0, v106
  v_cvt_pk_bf16_f32 v107, 0, v107
  v_cvt_pk_bf16_f32 v108, 0, v108
  v_cvt_pk_bf16_f32 v109, 0, v109
  v_mul_f32 v110, v100, v97
  v_mul_f32 v111, v101, v97
  v_mul_f32 v112, v102, v97
  v_mul_f32 v113, v103, v97
  v_mul_f32 v114, v104, v97
  v_mul_f32 v115, v105, v97
  v_mul_f32 v116, v106, v97
  v_mul_f32 v117, v107, v97
  v_mul_f32 v118, v108, v97
  v_mul_f32 v119, v109, v97
  v_fma_f32 v241, -v110, v99, v100
  v_fma_f32 v242, -v111, v99, v101
  v_fma_f32 v243, -v112, v99, v102
  v_fma_f32 v244, -v113, v99, v103
  v_fma_f32 v245, -v114, v99, v104
  v_fma_f32 v246, -v115, v99, v105
  v_fma_f32 v247, -v116, v99, v106
  v_fma_f32 v248, -v117, v99, v107
  v_fma_f32 v249, -v118, v99, v108
  v_fma_f32 v250, -v119, v99, v109
  v_fma_f32 v110, v241, v97, v110
  v_fma_f32 v111, v242, v97, v111
  v_fma_f32 v112, v243, v97, v112
  v_fma_f32 v113, v244, v97, v113
  v_fma_f32 v114, v245, v97, v114
  v_fma_f32 v115, v246, v97, v115
  v_fma_f32 v116, v247, v97, v116
  v_fma_f32 v117, v248, v97, v117
  v_fma_f32 v118, v249, v97, v118
  v_fma_f32 v119, v250, v97, v119
  s_mul_i32 s4, s3, 5120
  v_lshlrev_b32 v254, 4, v0
  v_add_u32 v254, s4, v254
  v_cvt_pk_bf16_f32 v120, v110, 0
  v_cvt_pk_bf16_f32 v121, 0, v110
  v_cvt_pk_bf16_f32 v122, v111, 0
  v_cvt_pk_bf16_f32 v123, 0, v111
  ds_write_b128 v254, v[120:123] offset:0
  s_waitcnt lgkmcnt(0)
  v_cvt_pk_bf16_f32 v120, v112, 0
  v_cvt_pk_bf16_f32 v121, 0, v112
  v_cvt_pk_bf16_f32 v122, v113, 0
  v_cvt_pk_bf16_f32 v123, 0, v113
  ds_write_b128 v254, v[120:123] offset:1024
  s_waitcnt lgkmcnt(0)
  v_cvt_pk_bf16_f32 v120, v114, 0
  v_cvt_pk_bf16_f32 v121, 0, v114
  v_cvt_pk_bf16_f32 v122, v115, 0
  v_cvt_pk_bf16_f32 v123, 0, v115
  ds_write_b128 v254, v[120:123] offset:2048
  s_waitcnt lgkmcnt(0)
  v_cvt_pk_bf16_f32 v120, v116, 0
  v_cvt_pk_bf16_f32 v121, 0, v116
  v_cvt_pk_bf16_f32 v122, v117, 0
  v_cvt_pk_bf16_f32 v123, 0, v117
  ds_write_b128 v254, v[120:123] offset:3072
  s_waitcnt lgkmcnt(0)
  v_cvt_pk_bf16_f32 v120, v118, 0
  v_cvt_pk_bf16_f32 v121, 0, v118
  v_cvt_pk_bf16_f32 v122, v119, 0
  v_cvt_pk_bf16_f32 v123, 0, v119
  ds_write_b128 v254, v[120:123] offset:4096
  s_waitcnt lgkmcnt(0)
  s_waitcnt lgkmcnt(0)
  s_barrier
  v_and_b32 v254, 15, v0
  v_mul_u32_u24 v254, 80, v254
  s_mul_i32 s4, s3, 1280
  v_add_u32 v254, s4, v254
  v_mov_b32 v96, 0
  v_mov_b32 v97, 0
  v_mov_b32 v98, 0
  v_mov_b32 v99, 0
  v_mov_b32 v100, 0
  v_mov_b32 v101, 0
  v_mov_b32 v102, 0
  v_mov_b32 v103, 0
  v_mov_b32 v104, 0
  v_mov_b32 v105, 0
  v_mov_b32 v106, 0
  v_mov_b32 v107, 0
  v_mov_b32 v108, 0
  v_mov_b32 v109, 0
  v_mov_b32 v110, 0
  v_mov_b32 v111, 0
  v_mov_b32 v112, 0
  v_mov_b32 v113, 0
  v_mov_b32 v114, 0
  v_mov_b32 v115, 0
  v_mov_b32 v116, 0
  v_mov_b32 v117, 0
  v_mov_b32 v118, 0
  v_mov_b32 v119, 0
  v_mov_b32 v120, 0
  v_mov_b32 v121, 0
  v_mov_b32 v122, 0
  v_mov_b32 v123, 0
  v_mov_b32 v124, 0
  v_mov_b32 v125, 0
  v_mov_b32 v126, 0
  v_mov_b32 v127, 0
  s_waitcnt vmcnt(21)
  ds_read_b128 v[226:229], v254 offset:0
  ds_read_b128 v[230:233], v254 offset:16
  ds_read_b128 v[234:237], v254 offset:32
  ds_read_b128 v[238:241], v254 offset:48
  ds_read_b128 v[242:245], v254 offset:64
  s_waitcnt lgkmcnt(0)
  GV8 56, 226, 96
  GV8 60, 228, 96
  GV8 64, 230, 96
  GV8 68, 232, 96
  GV8 72, 234, 96
  GV8 76, 236, 96
  GV8 80, 238, 96
  GV8 84, 240, 96
  GV8 88, 242, 96
  GV8 92, 244, 96
  ds_read_b128 v[226:229], v254 offset:5120
  ds_read_b128 v[230:233], v254 offset:5136
  ds_read_b128 v[234:237], v254 offset:5152
  ds_read_b128 v[238:241], v254 offset:5168
  ds_read_b128 v[242:245], v254 offset:5184
  s_waitcnt lgkmcnt(0)
  GV8 56, 226, 104
  GV8 60, 228, 104
  GV8 64, 230, 104
  GV8 68, 232, 104
  GV8 72, 234, 104
  GV8 76, 236, 104
  GV8 80, 238, 104
  GV8 84, 240, 104
  GV8 88, 242, 104
  GV8 92, 244, 104
  ds_read_b128 v[226:229], v254 offset:10240
  ds_read_b128 v[230:233], v254 offset:10256
  ds_read_b128 v[234:237], v254 offset:10272
  ds_read_b128 v[238:241], v254 offset:10288
  ds_read_b128 v[242:245], v254 offset:10304
  s_waitcnt lgkmcnt(0)
  GV8 56, 226, 112
  GV8 60, 228, 112
  GV8 64, 230, 112
  GV8 68, 232, 112
  GV8 72, 234, 112
  GV8 76, 236, 112
  GV8 80, 238, 112
  GV8 84, 240, 112
  GV8 88, 242, 112
  GV8 92, 244, 112
  ds_read_b128 v[226:229], v254 offset:15360
  ds_read_b128 v[230:233], v254 offset:15376
  ds_read_b128 v[234:237], v254 offset:15392
  ds_read_b128 v[238:241], v254 offset:15408
  ds_read_b128 v[242:245], v254 offset:15424
  s_waitcnt lgkmcnt(0)
  GV8 56, 226, 120
  GV8 60, 228, 120
  GV8 64, 230, 120
  GV8 68, 232, 120
  GV8 72, 234, 120
  GV8 76, 236, 120
  GV8 80, 238, 120
  GV8 84, 240, 120
  GV8 88, 242, 120
  GV8 92, 244, 120
  v_add_f32_dpp v96, v96, v96 quad_perm:[1,0,3,2] row_mask:0xf bank_mask:0xf
  v_add_f32_dpp v97, v97, v97 quad_perm:[1,0,3,2] row_mask:0xf bank_mask:0xf
  v_add_f32_dpp v98, v98, v98 quad_perm:[1,0,3,2] row_mask:0xf bank_mask:0xf
  v_add_f32_dpp v99, v99, v99 quad_perm:[1,0,3,2] row_mask:0xf bank_mask:0xf
  v_add_f32_dpp v100, v100, v100 quad_perm:[1,0,3,2] row_mask:0xf bank_mask:0xf
  v_add_f32_dpp v101, v101, v101 quad_perm:[1,0,3,2] row_mask:0xf bank_mask:0xf
  v_add_f32_dpp v102, v102, v102 quad_perm:[1,0,3,2] row_mask:0xf bank_mask:0xf
  v_add_f32_dpp v103, v103, v103 quad_perm:[1,0,3,2] row_mask:0xf bank_mask:0xf
  v_add_f32_dpp v104, v104, v104 quad_perm:[1,0,3,2] row_mask:0xf bank_mask:0xf
  v_add_f32_dpp v105, v105, v105 quad_perm:[1,0,3,2] row_mask:0xf bank_mask:0xf
  v_add_f32_dpp v106, v106, v106 quad_perm:[1,0,3,2] row_mask:0xf bank_mask:0xf
  v_add_f32_dpp v107, v107, v107 quad_perm:[1,0,3,2] row_mask:0xf bank_mask:0xf
  v_add_f32_dpp v108, v108, v108 quad_perm:[1,0,3,2] row_mask:0xf bank_mask:0xf
  v_add_f32_dpp v109, v109, v109 quad_perm:[1,0,3,2] row_mask:0xf bank_mask:0xf
  v_add_f32_dpp v110, v110, v110 quad_perm:[1,0,3,2] row_mask:0xf bank_mask:0xf
  v_add_f32_dpp v111, v111, v111 quad_perm:[1,0,3,2] row_mask:0xf bank_mask:0xf
  v_add_f32_dpp v112, v112, v112 quad_perm:[1,0,3,2] row_mask:0xf bank_mask:0xf
  v_add_f32_dpp v113, v113, v113 quad_perm:[1,0,3,2] row_mask:0xf bank_mask:0xf
  v_add_f32_dpp v114, v114, v114 quad_perm:[1,0,3,2] row_mask:0xf bank_mask:0xf
  v_add_f32_dpp v115, v115, v115 quad_perm:[1,0,3,2] row_mask:0xf bank_mask:0xf
  v_add_f32_dpp v116, v116, v116 quad_perm:[1,0,3,2] row_mask:0xf bank_mask:0xf
  v_add_f32_dpp v117, v117, v117 quad_perm:[1,0,3,2] row_mask:0xf bank_mask:0xf
  v_add_f32_dpp v118, v118, v118 quad_perm:[1,0,3,2] row_mask:0xf bank_mask:0xf
  v_add_f32_dpp v119, v119, v119 quad_perm:[1,0,3,2] row_mask:0xf bank_mask:0xf
  v_add_f32_dpp v120, v120, v120 quad_perm:[1,0,3,2] row_mask:0xf bank_mask:0xf
  v_add_f32_dpp v121, v121, v121 quad_perm:[1,0,3,2] row_mask:0xf bank_mask:0xf
  v_add_f32_dpp v122, v122, v122 quad_perm:[1,0,3,2] row_mask:0xf bank_mask:0xf
  v_add_f32_dpp v123, v123, v123 quad_perm:[1,0,3,2] row_mask:0xf bank_mask:0xf
  v_add_f32_dpp v124, v124, v124 quad_perm:[1,0,3,2] row_mask:0xf bank_mask:0xf
  v_add_f32_dpp v125, v125, v125 quad_perm:[1,0,3,2] row_mask:0xf bank_mask:0xf
  v_add_f32_dpp v126, v126, v126 quad_perm:[1,0,3,2] row_mask:0xf bank_mask:0xf
  v_add_f32_dpp v127, v127, v127 quad_perm:[1,0,3,2] row_mask:0xf bank_mask:0xf
  v_add_f32_dpp v96, v96, v96 quad_perm:[2,3,0,1] row_mask:0xf bank_mask:0xf
  v_add_f32_dpp v97, v97, v97 quad_perm:[2,3,0,1] row_mask:0xf bank_mask:0xf
  v_add_f32_dpp v98, v98, v98 quad_perm:[2,3,0,1] row_mask:0xf bank_mask:0xf
  v_add_f32_dpp v99, v99, v99 quad_perm:[2,3,0,1] row_mask:0xf bank_mask:0xf
  v_add_f32_dpp v100, v100, v100 quad_perm:[2,3,0,1] row_mask:0xf bank_mask:0xf
  v_add_f32_dpp v101, v101, v101 quad_perm:[2,3,0,1] row_mask:0xf bank_mask:0xf
  v_add_f32_dpp v102, v102, v102 quad_perm:[2,3,0,1] row_mask:0xf bank_mask:0xf
  v_add_f32_dpp v103, v103, v103 quad_perm:[2,3,0,1] row_mask:0xf bank_mask:0xf
  v_add_f32_dpp v104, v104, v104 quad_perm:[2,3,0,1] row_mask:0xf bank_mask:0xf
  v_add_f32_dpp v105, v105, v105 quad_perm:[2,3,0,1] row_mask:0xf bank_mask:0xf
  v_add_f32_dpp v106, v106, v106 quad_perm:[2,3,0,1] row_mask:0xf bank_mask:0xf
  v_add_f32_dpp v107, v107, v107 quad_perm:[2,3,0,1] row_mask:0xf bank_mask:0xf
  v_add_f32_dpp v108, v108, v108 quad_perm:[2,3,0,1] row_mask:0xf bank_mask:0xf
  v_add_f32_dpp v109, v109, v109 quad_perm:[2,3,0,1] row_mask:0xf bank_mask:0xf
  v_add_f32_dpp v110, v110, v110 quad_perm:[2,3,0,1] row_mask:0xf bank_mask:0xf
  v_add_f32_dpp v111, v111, v111 quad_perm:[2,3,0,1] row_mask:0xf bank_mask:0xf
  v_add_f32_dpp v112, v112, v112 quad_perm:[2,3,0,1] row_mask:0xf bank_mask:0xf
  v_add_f32_dpp v113, v113, v113 quad_perm:[2,3,0,1] row_mask:0xf bank_mask:0xf
  v_add_f32_dpp v114, v114, v114 quad_perm:[2,3,0,1] row_mask:0xf bank_mask:0xf
  v_add_f32_dpp v115, v115, v115 quad_perm:[2,3,0,1] row_mask:0xf bank_mask:0xf
  v_add_f32_dpp v116, v116, v116 quad_perm:[2,3,0,1] row_mask:0xf bank_mask:0xf
  v_add_f32_dpp v117, v117, v117 quad_perm:[2,3,0,1] row_mask:0xf bank_mask:0xf
  v_add_f32_dpp v118, v118, v118 quad_perm:[2,3,0,1] row_mask:0xf bank_mask:0xf
  v_add_f32_dpp v119, v119, v119 quad_perm:[2,3,0,1] row_mask:0xf bank_mask:0xf
  v_add_f32_dpp v120, v120, v120 quad_perm:[2,3,0,1] row_mask:0xf bank_mask:0xf
  v_add_f32_dpp v121, v121, v121 quad_perm:[2,3,0,1] row_mask:0xf bank_mask:0xf
  v_add_f32_dpp v122, v122, v122 quad_perm:[2,3,0,1] row_mask:0xf bank_mask:0xf
  v_add_f32_dpp v123, v123, v123 quad_perm:[2,3,0,1] row_mask:0xf bank_mask:0xf
  v_add_f32_dpp v124, v124, v124 quad_perm:[2,3,0,1] row_mask:0xf bank_mask:0xf
  v_add_f32_dpp v125, v125, v125 quad_perm:[2,3,0,1] row_mask:0xf bank_mask:0xf
  v_add_f32_dpp v126, v126, v126 quad_perm:[2,3,0,1] row_mask:0xf bank_mask:0xf
  v_add_f32_dpp v127, v127, v127 quad_perm:[2,3,0,1] row_mask:0xf bank_mask:0xf
  v_add_f32_dpp v96, v96, v96 row_half_mirror row_mask:0xf bank_mask:0xf
  v_add_f32_dpp v97, v97, v97 row_half_mirror row_mask:0xf bank_mask:0xf
  v_add_f32_dpp v98, v98, v98 row_half_mirror row_mask:0xf bank_mask:0xf
  v_add_f32_dpp v99, v99, v99 row_half_mirror row_mask:0xf bank_mask:0xf
  v_add_f32_dpp v100, v100, v100 row_half_mirror row_mask:0xf bank_mask:0xf
  v_add_f32_dpp v101, v101, v101 row_half_mirror row_mask:0xf bank_mask:0xf
  v_add_f32_dpp v102, v102, v102 row_half_mirror row_mask:0xf bank_mask:0xf
  v_add_f32_dpp v103, v103, v103 row_half_mirror row_mask:0xf bank_mask:0xf
  v_add_f32_dpp v104, v104, v104 row_half_mirror row_mask:0xf bank_mask:0xf
  v_add_f32_dpp v105, v105, v105 row_half_mirror row_mask:0xf bank_mask:0xf
  v_add_f32_dpp v106, v106, v106 row_half_mirror row_mask:0xf bank_mask:0xf
  v_add_f32_dpp v107, v107, v107 row_half_mirror row_mask:0xf bank_mask:0xf
  v_add_f32_dpp v108, v108, v108 row_half_mirror row_mask:0xf bank_mask:0xf
  v_add_f32_dpp v109, v109, v109 row_half_mirror row_mask:0xf bank_mask:0xf
  v_add_f32_dpp v110, v110, v110 row_half_mirror row_mask:0xf bank_mask:0xf
  v_add_f32_dpp v111, v111, v111 row_half_mirror row_mask:0xf bank_mask:0xf
  v_add_f32_dpp v112, v112, v112 row_half_mirror row_mask:0xf bank_mask:0xf
  v_add_f32_dpp v113, v113, v113 row_half_mirror row_mask:0xf bank_mask:0xf
  v_add_f32_dpp v114, v114, v114 row_half_mirror row_mask:0xf bank_mask:0xf
  v_add_f32_dpp v115, v115, v115 row_half_mirror row_mask:0xf bank_mask:0xf
  v_add_f32_dpp v116, v116, v116 row_half_mirror row_mask:0xf bank_mask:0xf
  v_add_f32_dpp v117, v117, v117 row_half_mirror row_mask:0xf bank_mask:0xf
  v_add_f32_dpp v118, v118, v118 row_half_mirror row_mask:0xf bank_mask:0xf
  v_add_f32_dpp v119, v119, v119 row_half_mirror row_mask:0xf bank_mask:0xf
  v_add_f32_dpp v120, v120, v120 row_half_mirror row_mask:0xf bank_mask:0xf
  v_add_f32_dpp v121, v121, v121 row_half_mirror row_mask:0xf bank_mask:0xf
  v_add_f32_dpp v122, v122, v122 row_half_mirror row_mask:0xf bank_mask:0xf
  v_add_f32_dpp v123, v123, v123 row_half_mirror row_mask:0xf bank_mask:0xf
  v_add_f32_dpp v124, v124, v124 row_half_mirror row_mask:0xf bank_mask:0xf
  v_add_f32_dpp v125, v125, v125 row_half_mirror row_mask:0xf bank_mask:0xf
  v_add_f32_dpp v126, v126, v126 row_half_mirror row_mask:0xf bank_mask:0xf
  v_add_f32_dpp v127, v127, v127 row_half_mirror row_mask:0xf bank_mask:0xf
  v_add_f32_dpp v96, v96, v96 row_mirror row_mask:0xf bank_mask:0xf
  v_add_f32_dpp v97, v97, v97 row_mirror row_mask:0xf bank_mask:0xf
  v_add_f32_dpp v98, v98, v98 row_mirror row_mask:0xf bank_mask:0xf
  v_add_f32_dpp v99, v99, v99 row_mirror row_mask:0xf bank_mask:0xf
  v_add_f32_dpp v100, v100, v100 row_mirror row_mask:0xf bank_mask:0xf
  v_add_f32_dpp v101, v101, v101 row_mirror row_mask:0xf bank_mask:0xf
  v_add_f32_dpp v102, v102, v102 row_mirror row_mask:0xf bank_mask:0xf
  v_add_f32_dpp v103, v103, v103 row_mirror row_mask:0xf bank_mask:0xf
  v_add_f32_dpp v104, v104, v104 row_mirror row_mask:0xf bank_mask:0xf
  v_add_f32_dpp v105, v105, v105 row_mirror row_mask:0xf bank_mask:0xf
  v_add_f32_dpp v106, v106, v106 row_mirror row_mask:0xf bank_mask:0xf
  v_add_f32_dpp v107, v107, v107 row_mirror row_mask:0xf bank_mask:0xf
  v_add_f32_dpp v108, v108, v108 row_mirror row_mask:0xf bank_mask:0xf
  v_add_f32_dpp v109, v109, v109 row_mirror row_mask:0xf bank_mask:0xf
  v_add_f32_dpp v110, v110, v110 row_mirror row_mask:0xf bank_mask:0xf
  v_add_f32_dpp v111, v111, v111 row_mirror row_mask:0xf bank_mask:0xf
  v_add_f32_dpp v112, v112, v112 row_mirror row_mask:0xf bank_mask:0xf
  v_add_f32_dpp v113, v113, v113 row_mirror row_mask:0xf bank_mask:0xf
  v_add_f32_dpp v114, v114, v114 row_mirror row_mask:0xf bank_mask:0xf
  v_add_f32_dpp v115, v115, v115 row_mirror row_mask:0xf bank_mask:0xf
  v_add_f32_dpp v116, v116, v116 row_mirror row_mask:0xf bank_mask:0xf
  v_add_f32_dpp v117, v117, v117 row_mirror row_mask:0xf bank_mask:0xf
  v_add_f32_dpp v118, v118, v118 row_mirror row_mask:0xf bank_mask:0xf
  v_add_f32_dpp v119, v119, v119 row_mirror row_mask:0xf bank_mask:0xf
  v_add_f32_dpp v120, v120, v120 row_mirror row_mask:0xf bank_mask:0xf
  v_add_f32_dpp v121, v121, v121 row_mirror row_mask:0xf bank_mask:0xf
  v_add_f32_dpp v122, v122, v122 row_mirror row_mask:0xf bank_mask:0xf
  v_add_f32_dpp v123, v123, v123 row_mirror row_mask:0xf bank_mask:0xf
  v_add_f32_dpp v124, v124, v124 row_mirror row_mask:0xf bank_mask:0xf
  v_add_f32_dpp v125, v125, v125 row_mirror row_mask:0xf bank_mask:0xf
  v_add_f32_dpp v126, v126, v126 row_mirror row_mask:0xf bank_mask:0xf
  v_add_f32_dpp v127, v127, v127 row_mirror row_mask:0xf bank_mask:0xf
  v_lshrrev_b32 v254, 4, v0
  v_lshlrev_b32 v254, 7, v254
  s_mul_i32 s4, s3, 384
  s_add_u32 s4, s4, 20480
  v_add_u32 v254, s4, v254
  s_mov_b32 exec_lo, 0x10001
  s_mov_b32 exec_hi, 1
  ds_write_b128 v254, v[96:99] offset:0
  ds_write_b128 v254, v[100:103] offset:16
  ds_write_b128 v254, v[104:107] offset:32
  ds_write_b128 v254, v[108:111] offset:48
  ds_write_b128 v254, v[112:115] offset:64
  ds_write_b128 v254, v[116:119] offset:80
  ds_write_b128 v254, v[120:123] offset:96
  ds_write_b128 v254, v[124:127] offset:112
  s_mov_b64 exec, -1
  s_waitcnt lgkmcnt(0)
  s_barrier
  s_cmp_lg_u32 s3, 0
  s_cbranch_scc1 Lw0347
  v_mul_u32_u24 v254, 171, v0
  v_lshrrev_b32 v254, 9, v254
  v_mul_u32_u24 v255, 3, v254
  v_sub_u32 v255, v0, v255
  v_lshlrev_b32 v128, 7, v255
  v_lshl_add_u32 v128, v254, 5, v128
  v_and_b32 v128, 0x1ff, v128
  ds_read_b128 v[56:59], v128 offset:20480
  ds_read_b128 v[60:63], v128 offset:20496
  ds_read_b128 v[64:67], v128 offset:20864
  ds_read_b128 v[68:71], v128 offset:20880
  ds_read_b128 v[72:75], v128 offset:21248
  ds_read_b128 v[76:79], v128 offset:21264
  ds_read_b128 v[80:83], v128 offset:21632
  ds_read_b128 v[84:87], v128 offset:21648
  s_waitcnt lgkmcnt(0)
  v_add_f32 v56, v56, v64
  v_add_f32 v57, v57, v65
  v_add_f32 v58, v58, v66
  v_add_f32 v59, v59, v67
  v_add_f32 v60, v60, v68
  v_add_f32 v61, v61, v69
  v_add_f32 v62, v62, v70
  v_add_f32 v63, v63, v71
  v_add_f32 v56, v56, v72
  v_add_f32 v57, v57, v73
  v_add_f32 v58, v58, v74
  v_add_f32 v59, v59, v75
  v_add_f32 v60, v60, v76
  v_add_f32 v61, v61, v77
  v_add_f32 v62, v62, v78
  v_add_f32 v63, v63, v79
  v_add_f32 v56, v56, v80
  v_add_f32 v57, v57, v81
  v_add_f32 v58, v58, v82
  v_add_f32 v59, v59, v83
  v_add_f32 v60, v60, v84
  v_add_f32 v61, v61, v85
  v_add_f32 v62, v62, v86
  v_add_f32 v63, v63, v87
  v_cvt_pk_bf16_f32 v96, v56, v57
  v_cvt_pk_bf16_f32 v97, v58, v59
  v_cvt_pk_bf16_f32 v98, v60, v61
  v_cvt_pk_bf16_f32 v99, v62, v63
  v_mul_u32_u24 v254, 12288, v254
  v_lshl_add_u32 v254, v255, 4, v254
  s_mov_b32 s75, 0x61a80
  v_min_u32 v252, 11, v0
  v_lshlrev_b32 v252, 2, v252
  global_load_dword v253, v252, s[28:29]
  s_waitcnt vmcnt(0)
  v_cmp_ne_u32 vcc, 1, v253
  s_cbranch_vccz Lad349
Lar348:
  global_load_dword v253, v252, s[28:29] sc1
  s_waitcnt vmcnt(0)
  v_cmp_ne_u32 vcc, 1, v253
  s_cbranch_vccz Lad349
  s_sleep 8
  s_sub_u32 s75, s75, 1
  s_cmp_lg_u32 s75, 0
  s_cbranch_scc1 Lar348
Lad349:
  s_nop 4
  s_mul_i32 s76, s2, 48
  s_add_u32 s76, s76, 0xc73000
  s_mov_b32 exec_lo, 0xfff
  s_mov_b32 exec_hi, 0
  buffer_store_dwordx4 v[96:99], v254, s[64:67], s76 offen sc1
  s_mov_b64 exec, -1
  v_mov_b32 v250, 163832
  v_mov_b32 v251, 1
  ds_write_b32 v250, v251
  s_waitcnt lgkmcnt(0)
Lw0347:
  s_nop 4
  s_mov_b32 s76, 0x2400
  LDT v, 166, 36
  s_waitcnt vmcnt(21)
  s_mov_b32 s76, 0x3000
  LDT a, 48, 32
  s_waitcnt vmcnt(21)
  s_mov_b32 s76, 0x3c00
  LDT a, 60, 32
  s_waitcnt vmcnt(21)
  s_mov_b32 s76, 0x3000
  LDT v, 178, 36
  s_waitcnt vmcnt(21)
  s_mov_b32 s76, 0x3c00
  LDT v, 190, 36
  s_waitcnt vmcnt(21)
  s_mov_b32 s76, 0x4800
  LDT a, 72, 32
  s_waitcnt vmcnt(21)
  s_mov_b32 s76, 0x5400
  LDT a, 84, 32
  s_waitcnt vmcnt(21)
  s_mov_b32 s76, 0x4800
  LDT v, 202, 36
  s_waitcnt vmcnt(21)
  s_mov_b32 s76, 0x5400
  LDT v, 214, 36
  s_waitcnt vmcnt(21)
  s_mov_b32 s76, 0x6000
  LDT a, 96, 32
  s_waitcnt vmcnt(21)
  s_mov_b32 s76, 0x6c00
  LDT a, 108, 32
  s_waitcnt vmcnt(21)
  s_mov_b32 s76, 0x6000
  LDT v, 8, 36
  s_waitcnt vmcnt(21)
  s_mov_b32 s76, 0x6c00
  LDT v, 20, 36
  s_waitcnt vmcnt(21)
  s_mov_b32 s76, 0x7800
  LDT a, 120, 32
  s_waitcnt vmcnt(21)
  s_mov_b32 s76, 0x8400
  LDT a, 132, 32
  s_waitcnt vmcnt(21)
  s_mov_b32 s76, 0x7800
  LDT v, 32, 36
  s_waitcnt vmcnt(21)
  s_mov_b32 s76, 0x8400
  LDT v, 44, 36
  s_waitcnt vmcnt(21)
  s_mov_b32 s76, 0x9000
  LDT a, 144, 32
  s_waitcnt vmcnt(21)
  s_mov_b32 s76, 0x9c00
  LDT a, 156, 32
  s_waitcnt vmcnt(21)
  s_mov_b32 s76, 0xa800
  LDT a, 168, 32
  s_waitcnt vmcnt(21)
  s_mov_b32 s76, 0xb400
  LDT a, 180, 32
  s_waitcnt vmcnt(21)
  s_mov_b32 s76, 0xc000
  LDT a, 192, 32
  s_waitcnt vmcnt(21)
  s_mov_b32 s76, 0xcc00
  LDT a, 204, 32
  s_waitcnt vmcnt(21)
  s_mov_b32 s76, 0xd800
  LDT a, 216, 32
  s_waitcnt vmcnt(21)
  s_mov_b32 s76, 0xe400
  LDT a, 228, 32
  s_waitcnt vmcnt(21)
  s_mov_b32 s76, 0xf000
  LDT a, 240, 32
  s_waitcnt vmcnt(21)
  s_mov_b32 s75, 0x61a80
  v_mov_b32 v250, 163832
Llf350:
  ds_read_b32 v251, v250
  s_waitcnt lgkmcnt(0)
  v_cmp_ne_u32 vcc, 1, v251
  s_cbranch_vccz Lld351
  s_sleep 1
  s_sub_u32 s75, s75, 1
  s_cmp_lg_u32 s75, 0
  s_cbranch_scc1 Llf350
Lld351:
  s_nop 4
  v_min_u32 v248, 23, v0
  v_lshlrev_b32 v248, 7, v248
  s_add_u32 s76, s72, 0x0
  buffer_load_dwordx4 v[92:95], v2, s[64:67], s76 offen sc1
  buffer_load_dwordx4 v[96:99], v2, s[64:67], s76 offen offset:128 sc1
  buffer_load_dwordx4 v[100:103], v2, s[64:67], s76 offen offset:256 sc1
  s_waitcnt vmcnt(0)
  v_max3_u32 v226, v92, v93, v94
  v_max3_u32 v226, v226, v95, v96
  v_max3_u32 v226, v226, v97, v98
  v_max3_u32 v226, v226, v99, v100
  v_max3_u32 v226, v226, v101, v102
  v_max3_u32 v226, v226, v103, v103
  v_cmp_eq_u32 vcc, -1, v226
  s_cbranch_vccz Lqo352
  s_mov_b32 s75, 0x61a80
Lqr353:
  s_sleep 2
  s_add_u32 s77, s72, 0x0
  buffer_load_dwordx4 v[92:95], v2, s[64:67], s77 offen sc1
  buffer_load_dwordx4 v[96:99], v2, s[64:67], s77 offen offset:128 sc1
  buffer_load_dwordx4 v[100:103], v2, s[64:67], s77 offen offset:256 sc1
  s_waitcnt vmcnt(0)
  v_max3_u32 v226, v92, v93, v94
  v_max3_u32 v226, v226, v95, v96
  v_max3_u32 v226, v226, v97, v98
  v_max3_u32 v226, v226, v99, v100
  v_max3_u32 v226, v226, v101, v102
  v_max3_u32 v226, v226, v103, v103
  v_cmp_eq_u32 vcc, -1, v226
  s_cbranch_vccz Lqo352
  s_sub_u32 s75, s75, 1
  s_cmp_lg_u32 s75, 0
  s_cbranch_scc1 Lqr353
Lqo352:
  v_mov_b32 v80, v92
  v_mov_b32 v81, v93
  v_mov_b32 v82, v94
  v_mov_b32 v83, v95
  v_mov_b32 v84, v96
  v_mov_b32 v85, v97
  v_mov_b32 v86, v98
  v_mov_b32 v87, v99
  v_mov_b32 v88, v100
  v_mov_b32 v89, v101
  v_mov_b32 v90, v102
  v_mov_b32 v91, v103
  v_mov_b32 v104, 0
  v_mov_b32 v105, 0
  v_mov_b32 v106, 0
  v_mov_b32 v107, 0
  v_mov_b32 v108, 0
  v_mov_b32 v109, 0
  v_mov_b32 v110, 0
  v_mov_b32 v111, 0
  v_mov_b32 v112, 0
  v_mov_b32 v113, 0
  v_mov_b32 v114, 0
  v_mov_b32 v115, 0
  v_mov_b32 v116, 0
  v_mov_b32 v117, 0
  v_mov_b32 v118, 0
  v_mov_b32 v119, 0
  v_mov_b32 v120, 0
  v_mov_b32 v121, 0
  v_mov_b32 v122, 0
  v_mov_b32 v123, 0
  v_mov_b32 v124, 0
  v_mov_b32 v125, 0
  v_mov_b32 v126, 0
  v_mov_b32 v127, 0
  v_mov_b32 v128, 0xf149f2ca
  v_mov_b32 v129, 0
  ACR 56, 0
  ACR 68, 12
  QK2 56, 68, 80, 226
  v_add_f32 v226, v226, v227
  v_add_f32 v226, v226, v228
  v_add_f32 v229, v229, v230
  v_add_f32 v229, v229, v231
  v_add_f32_dpp v226, v226, v226 quad_perm:[1,0,3,2] row_mask:0xf bank_mask:0xf
  s_nop 0
  v_add_f32_dpp v229, v229, v229 quad_perm:[1,0,3,2] row_mask:0xf bank_mask:0xf
  v_add_f32_dpp v226, v226, v226 quad_perm:[2,3,0,1] row_mask:0xf bank_mask:0xf
  s_nop 0
  v_add_f32_dpp v229, v229, v229 quad_perm:[2,3,0,1] row_mask:0xf bank_mask:0xf
  v_add_f32_dpp v226, v226, v226 row_half_mirror row_mask:0xf bank_mask:0xf
  s_nop 0
  v_add_f32_dpp v229, v229, v229 row_half_mirror row_mask:0xf bank_mask:0xf
  v_max3_f32 v232, v128, v226, v229
  v_cmp_gt_f32 vcc, v232, v128
  s_cbranch_vccz Lsk354
  v_sub_f32 v234, v128, v232
  v_mul_f32 v234, s74, v234
  v_exp_f32 v234, v234
  v_mov_b32 v128, v232
  RESC 104, 234
  v_mul_f32 v129, v234, v129
Lsk354:
  v_mul_f32 v233, s74, v128
  v_fma_f32 v235, v226, s74, -v233
  v_fma_f32 v236, v229, s74, -v233
  v_exp_f32 v235, v235
  v_exp_f32 v236, v236
  v_cvt_pk_bf16_f32 v238, v235, 0
  v_cvt_pk_bf16_f32 v239, 0, v235
  v_cvt_pk_bf16_f32 v240, v236, 0
  v_cvt_pk_bf16_f32 v241, 0, v236
  v_add_f32 v129, v129, v239
  v_add_f32 v129, v129, v241
  PV 130, 238, 104
  PV 142, 240, 104
  ACR 56, 24
  ACR 68, 36
  QK2 56, 68, 80, 226
  v_add_f32 v226, v226, v227
  v_add_f32 v226, v226, v228
  v_add_f32 v229, v229, v230
  v_add_f32 v229, v229, v231
  v_add_f32_dpp v226, v226, v226 quad_perm:[1,0,3,2] row_mask:0xf bank_mask:0xf
  s_nop 0
  v_add_f32_dpp v229, v229, v229 quad_perm:[1,0,3,2] row_mask:0xf bank_mask:0xf
  v_add_f32_dpp v226, v226, v226 quad_perm:[2,3,0,1] row_mask:0xf bank_mask:0xf
  s_nop 0
  v_add_f32_dpp v229, v229, v229 quad_perm:[2,3,0,1] row_mask:0xf bank_mask:0xf
  v_add_f32_dpp v226, v226, v226 row_half_mirror row_mask:0xf bank_mask:0xf
  s_nop 0
  v_add_f32_dpp v229, v229, v229 row_half_mirror row_mask:0xf bank_mask:0xf
  v_max3_f32 v232, v128, v226, v229
  v_cmp_gt_f32 vcc, v232, v128
  s_cbranch_vccz Lsk355
  v_sub_f32 v234, v128, v232
  v_mul_f32 v234, s74, v234
  v_exp_f32 v234, v234
  v_mov_b32 v128, v232
  RESC 104, 234
  v_mul_f32 v129, v234, v129
Lsk355:
  v_mul_f32 v233, s74, v128
  v_fma_f32 v235, v226, s74, -v233
  v_fma_f32 v236, v229, s74, -v233
  v_exp_f32 v235, v235
  v_exp_f32 v236, v236
  v_cvt_pk_bf16_f32 v238, v235, 0
  v_cvt_pk_bf16_f32 v239, 0, v235
  v_cvt_pk_bf16_f32 v240, v236, 0
  v_cvt_pk_bf16_f32 v241, 0, v236
  v_add_f32 v129, v129, v239
  v_add_f32 v129, v129, v241
  PV 154, 238, 104
  PV 166, 240, 104
  ACR 56, 48
  ACR 68, 60
  QK2 56, 68, 80, 226
  v_add_f32 v226, v226, v227
  v_add_f32 v226, v226, v228
  v_add_f32 v229, v229, v230
  v_add_f32 v229, v229, v231
  v_add_f32_dpp v226, v226, v226 quad_perm:[1,0,3,2] row_mask:0xf bank_mask:0xf
  s_nop 0
  v_add_f32_dpp v229, v229, v229 quad_perm:[1,0,3,2] row_mask:0xf bank_mask:0xf
  v_add_f32_dpp v226, v226, v226 quad_perm:[2,3,0,1] row_mask:0xf bank_mask:0xf
  s_nop 0
  v_add_f32_dpp v229, v229, v229 quad_perm:[2,3,0,1] row_mask:0xf bank_mask:0xf
  v_add_f32_dpp v226, v226, v226 row_half_mirror row_mask:0xf bank_mask:0xf
  s_nop 0
  v_add_f32_dpp v229, v229, v229 row_half_mirror row_mask:0xf bank_mask:0xf
  v_max3_f32 v232, v128, v226, v229
  v_cmp_gt_f32 vcc, v232, v128
  s_cbranch_vccz Lsk356
  v_sub_f32 v234, v128, v232
  v_mul_f32 v234, s74, v234
  v_exp_f32 v234, v234
  v_mov_b32 v128, v232
  RESC 104, 234
  v_mul_f32 v129, v234, v129
Lsk356:
  v_mul_f32 v233, s74, v128
  v_fma_f32 v235, v226, s74, -v233
  v_fma_f32 v236, v229, s74, -v233
  v_exp_f32 v235, v235
  v_exp_f32 v236, v236
  v_cvt_pk_bf16_f32 v238, v235, 0
  v_cvt_pk_bf16_f32 v239, 0, v235
  v_cvt_pk_bf16_f32 v240, v236, 0
  v_cvt_pk_bf16_f32 v241, 0, v236
  v_add_f32 v129, v129, v239
  v_add_f32 v129, v129, v241
  PV 178, 238, 104
  PV 190, 240, 104
  ACR 56, 72
  ACR 68, 84
  QK2 56, 68, 80, 226
  v_add_f32 v226, v226, v227
  v_add_f32 v226, v226, v228
  v_add_f32 v229, v229, v230
  v_add_f32 v229, v229, v231
  v_add_f32_dpp v226, v226, v226 quad_perm:[1,0,3,2] row_mask:0xf bank_mask:0xf
  s_nop 0
  v_add_f32_dpp v229, v229, v229 quad_perm:[1,0,3,2] row_mask:0xf bank_mask:0xf
  v_add_f32_dpp v226, v226, v226 quad_perm:[2,3,0,1] row_mask:0xf bank_mask:0xf
  s_nop 0
  v_add_f32_dpp v229, v229, v229 quad_perm:[2,3,0,1] row_mask:0xf bank_mask:0xf
  v_add_f32_dpp v226, v226, v226 row_half_mirror row_mask:0xf bank_mask:0xf
  s_nop 0
  v_add_f32_dpp v229, v229, v229 row_half_mirror row_mask:0xf bank_mask:0xf
  v_max3_f32 v232, v128, v226, v229
  v_cmp_gt_f32 vcc, v232, v128
  s_cbranch_vccz Lsk357
  v_sub_f32 v234, v128, v232
  v_mul_f32 v234, s74, v234
  v_exp_f32 v234, v234
  v_mov_b32 v128, v232
  RESC 104, 234
  v_mul_f32 v129, v234, v129
Lsk357:
  v_mul_f32 v233, s74, v128
  v_fma_f32 v235, v226, s74, -v233
  v_fma_f32 v236, v229, s74, -v233
  v_exp_f32 v235, v235
  v_exp_f32 v236, v236
  v_cvt_pk_bf16_f32 v238, v235, 0
  v_cvt_pk_bf16_f32 v239, 0, v235
  v_cvt_pk_bf16_f32 v240, v236, 0
  v_cvt_pk_bf16_f32 v241, 0, v236
  v_add_f32 v129, v129, v239
  v_add_f32 v129, v129, v241
  PV 202, 238, 104
  PV 214, 240, 104
  ACR 56, 96
  ACR 68, 108
  QK2 56, 68, 80, 226
  v_add_f32 v226, v226, v227
  v_add_f32 v226, v226, v228
  v_add_f32 v229, v229, v230
  v_add_f32 v229, v229, v231
  v_add_f32_dpp v226, v226, v226 quad_perm:[1,0,3,2] row_mask:0xf bank_mask:0xf
  s_nop 0
  v_add_f32_dpp v229, v229, v229 quad_perm:[1,0,3,2] row_mask:0xf bank_mask:0xf
  v_add_f32_dpp v226, v226, v226 quad_perm:[2,3,0,1] row_mask:0xf bank_mask:0xf
  s_nop 0
  v_add_f32_dpp v229, v229, v229 quad_perm:[2,3,0,1] row_mask:0xf bank_mask:0xf
  v_add_f32_dpp v226, v226, v226 row_half_mirror row_mask:0xf bank_mask:0xf
  s_nop 0
  v_add_f32_dpp v229, v229, v229 row_half_mirror row_mask:0xf bank_mask:0xf
  v_max3_f32 v232, v128, v226, v229
  v_cmp_gt_f32 vcc, v232, v128
  s_cbranch_vccz Lsk358
  v_sub_f32 v234, v128, v232
  v_mul_f32 v234, s74, v234
  v_exp_f32 v234, v234
  v_mov_b32 v128, v232
  RESC 104, 234
  v_mul_f32 v129, v234, v129
Lsk358:
  v_mul_f32 v233, s74, v128
  v_fma_f32 v235, v226, s74, -v233
  v_fma_f32 v236, v229, s74, -v233
  v_exp_f32 v235, v235
  v_exp_f32 v236, v236
  v_cvt_pk_bf16_f32 v238, v235, 0
  v_cvt_pk_bf16_f32 v239, 0, v235
  v_cvt_pk_bf16_f32 v240, v236, 0
  v_cvt_pk_bf16_f32 v241, 0, v236
  v_add_f32 v129, v129, v239
  v_add_f32 v129, v129, v241
  PV 8, 238, 104
  ds_write_b128 v3, v[8:11] offset:0
  ds_write_b128 v3, v[12:15] offset:1024
  ds_write_b128 v3, v[16:19] offset:2048
  s_mov_b32 s76, 0x9000
  LDT v, 8, 36
  PV 20, 240, 104
  ds_write_b128 v3, v[20:23] offset:3072
  ds_write_b128 v3, v[24:27] offset:4096
  ds_write_b128 v3, v[28:31] offset:5120
  s_mov_b32 s76, 0x9c00
  LDT v, 20, 36
  ACR 56, 120
  ACR 68, 132
  QK2 56, 68, 80, 226
  v_add_f32 v226, v226, v227
  v_add_f32 v226, v226, v228
  v_add_f32 v229, v229, v230
  v_add_f32 v229, v229, v231
  v_add_f32_dpp v226, v226, v226 quad_perm:[1,0,3,2] row_mask:0xf bank_mask:0xf
  s_nop 0
  v_add_f32_dpp v229, v229, v229 quad_perm:[1,0,3,2] row_mask:0xf bank_mask:0xf
  v_add_f32_dpp v226, v226, v226 quad_perm:[2,3,0,1] row_mask:0xf bank_mask:0xf
  s_nop 0
  v_add_f32_dpp v229, v229, v229 quad_perm:[2,3,0,1] row_mask:0xf bank_mask:0xf
  v_add_f32_dpp v226, v226, v226 row_half_mirror row_mask:0xf bank_mask:0xf
  s_nop 0
  v_add_f32_dpp v229, v229, v229 row_half_mirror row_mask:0xf bank_mask:0xf
  v_max3_f32 v232, v128, v226, v229
  v_cmp_gt_f32 vcc, v232, v128
  s_cbranch_vccz Lsk359
  v_sub_f32 v234, v128, v232
  v_mul_f32 v234, s74, v234
  v_exp_f32 v234, v234
  v_mov_b32 v128, v232
  RESC 104, 234
  v_mul_f32 v129, v234, v129
Lsk359:
  v_mul_f32 v233, s74, v128
  v_fma_f32 v235, v226, s74, -v233
  v_fma_f32 v236, v229, s74, -v233
  v_exp_f32 v235, v235
  v_exp_f32 v236, v236
  v_cvt_pk_bf16_f32 v238, v235, 0
  v_cvt_pk_bf16_f32 v239, 0, v235
  v_cvt_pk_bf16_f32 v240, v236, 0
  v_cvt_pk_bf16_f32 v241, 0, v236
  v_add_f32 v129, v129, v239
  v_add_f32 v129, v129, v241
  PV 32, 238, 104
  ds_write_b128 v3, v[32:35] offset:6144
  ds_write_b128 v3, v[36:39] offset:7168
  ds_write_b128 v3, v[40:43] offset:8192
  s_mov_b32 s76, 0xa800
  LDT v, 32, 36
  PV 44, 240, 104
  ds_write_b128 v3, v[44:47] offset:9216
  ds_write_b128 v3, v[48:51] offset:10240
  ds_write_b128 v3, v[52:55] offset:11264
  s_mov_b32 s76, 0xb400
  LDT v, 44, 36
  ACR 56, 144
  ACR 68, 156
  QK2 56, 68, 80, 226
  v_add_f32 v226, v226, v227
  v_add_f32 v226, v226, v228
  v_add_f32 v229, v229, v230
  v_add_f32 v229, v229, v231
  v_add_f32_dpp v226, v226, v226 quad_perm:[1,0,3,2] row_mask:0xf bank_mask:0xf
  s_nop 0
  v_add_f32_dpp v229, v229, v229 quad_perm:[1,0,3,2] row_mask:0xf bank_mask:0xf
  v_add_f32_dpp v226, v226, v226 quad_perm:[2,3,0,1] row_mask:0xf bank_mask:0xf
  s_nop 0
  v_add_f32_dpp v229, v229, v229 quad_perm:[2,3,0,1] row_mask:0xf bank_mask:0xf
  v_add_f32_dpp v226, v226, v226 row_half_mirror row_mask:0xf bank_mask:0xf
  s_nop 0
  v_add_f32_dpp v229, v229, v229 row_half_mirror row_mask:0xf bank_mask:0xf
  v_max3_f32 v232, v128, v226, v229
  v_cmp_gt_f32 vcc, v232, v128
  s_cbranch_vccz Lsk360
  v_sub_f32 v234, v128, v232
  v_mul_f32 v234, s74, v234
  v_exp_f32 v234, v234
  v_mov_b32 v128, v232
  RESC 104, 234
  v_mul_f32 v129, v234, v129
Lsk360:
  v_mul_f32 v233, s74, v128
  v_fma_f32 v235, v226, s74, -v233
  v_fma_f32 v236, v229, s74, -v233
  v_exp_f32 v235, v235
  v_exp_f32 v236, v236
  v_cvt_pk_bf16_f32 v238, v235, 0
  v_cvt_pk_bf16_f32 v239, 0, v235
  v_cvt_pk_bf16_f32 v240, v236, 0
  v_cvt_pk_bf16_f32 v241, 0, v236
  v_add_f32 v129, v129, v239
  v_add_f32 v129, v129, v241
  s_waitcnt vmcnt(9)
  PV 8, 238, 104
  ds_write_b128 v3, v[8:11] offset:12288
  ds_write_b128 v3, v[12:15] offset:13312
  ds_write_b128 v3, v[16:19] offset:14336
  s_mov_b32 s76, 0xc000
  LDT v, 8, 36
  s_waitcnt vmcnt(9)
  PV 20, 240, 104
  ds_write_b128 v3, v[20:23] offset:15360
  s_waitcnt lgkmcnt(8)
  ds_write_b128 v3, v[24:27] offset:16384
  ds_write_b128 v3, v[28:31] offset:17408
  s_mov_b32 s76, 0xcc00
  LDT v, 20, 36
  ACR 56, 168
  ACR 68, 180
  QK2 56, 68, 80, 226
  v_add_f32 v226, v226, v227
  v_add_f32 v226, v226, v228
  v_add_f32 v229, v229, v230
  v_add_f32 v229, v229, v231
  v_add_f32_dpp v226, v226, v226 quad_perm:[1,0,3,2] row_mask:0xf bank_mask:0xf
  s_nop 0
  v_add_f32_dpp v229, v229, v229 quad_perm:[1,0,3,2] row_mask:0xf bank_mask:0xf
  v_add_f32_dpp v226, v226, v226 quad_perm:[2,3,0,1] row_mask:0xf bank_mask:0xf
  s_nop 0
  v_add_f32_dpp v229, v229, v229 quad_perm:[2,3,0,1] row_mask:0xf bank_mask:0xf
  v_add_f32_dpp v226, v226, v226 row_half_mirror row_mask:0xf bank_mask:0xf
  s_nop 0
  v_add_f32_dpp v229, v229, v229 row_half_mirror row_mask:0xf bank_mask:0xf
  v_max3_f32 v232, v128, v226, v229
  v_cmp_gt_f32 vcc, v232, v128
  s_cbranch_vccz Lsk361
  v_sub_f32 v234, v128, v232
  v_mul_f32 v234, s74, v234
  v_exp_f32 v234, v234
  v_mov_b32 v128, v232
  RESC 104, 234
  v_mul_f32 v129, v234, v129
Lsk361:
  v_mul_f32 v233, s74, v128
  v_fma_f32 v235, v226, s74, -v233
  v_fma_f32 v236, v229, s74, -v233
  v_exp_f32 v235, v235
  v_exp_f32 v236, v236
  v_cvt_pk_bf16_f32 v238, v235, 0
  v_cvt_pk_bf16_f32 v239, 0, v235
  v_cvt_pk_bf16_f32 v240, v236, 0
  v_cvt_pk_bf16_f32 v241, 0, v236
  v_add_f32 v129, v129, v239
  v_add_f32 v129, v129, v241
  s_waitcnt vmcnt(9)
  PV 32, 238, 104
  ds_write_b128 v3, v[32:35] offset:18432
  ds_write_b128 v3, v[36:39] offset:19456
  ds_write_b128 v3, v[40:43] offset:20480
  s_mov_b32 s76, 0xd800
  LDT v, 32, 36
  s_waitcnt vmcnt(9)
  PV 44, 240, 104
  ds_write_b128 v3, v[44:47] offset:21504
  ds_write_b128 v3, v[48:51] offset:22528
  ds_write_b128 v3, v[52:55] offset:23552
  s_waitcnt lgkmcnt(8)
  s_mov_b32 s76, 0xe400
  LDT v, 44, 36
  ACR 56, 192
  ACR 68, 204
  QK2 56, 68, 80, 226
  v_add_f32 v226, v226, v227
  v_add_f32 v226, v226, v228
  v_add_f32 v229, v229, v230
  v_add_f32 v229, v229, v231
  v_add_f32_dpp v226, v226, v226 quad_perm:[1,0,3,2] row_mask:0xf bank_mask:0xf
  s_nop 0
  v_add_f32_dpp v229, v229, v229 quad_perm:[1,0,3,2] row_mask:0xf bank_mask:0xf
  v_add_f32_dpp v226, v226, v226 quad_perm:[2,3,0,1] row_mask:0xf bank_mask:0xf
  s_nop 0
  v_add_f32_dpp v229, v229, v229 quad_perm:[2,3,0,1] row_mask:0xf bank_mask:0xf
  v_add_f32_dpp v226, v226, v226 row_half_mirror row_mask:0xf bank_mask:0xf
  s_nop 0
  v_add_f32_dpp v229, v229, v229 row_half_mirror row_mask:0xf bank_mask:0xf
  v_max3_f32 v232, v128, v226, v229
  v_cmp_gt_f32 vcc, v232, v128
  s_cbranch_vccz Lsk362
  v_sub_f32 v234, v128, v232
  v_mul_f32 v234, s74, v234
  v_exp_f32 v234, v234
  v_mov_b32 v128, v232
  RESC 104, 234
  v_mul_f32 v129, v234, v129
Lsk362:
  v_mul_f32 v233, s74, v128
  v_fma_f32 v235, v226, s74, -v233
  v_fma_f32 v236, v229, s74, -v233
  v_exp_f32 v235, v235
  v_exp_f32 v236, v236
  v_cvt_pk_bf16_f32 v238, v235, 0
  v_cvt_pk_bf16_f32 v239, 0, v235
  v_cvt_pk_bf16_f32 v240, v236, 0
  v_cvt_pk_bf16_f32 v241, 0, v236
  v_add_f32 v129, v129, v239
  v_add_f32 v129, v129, v241
  s_waitcnt vmcnt(9)
  PV 8, 238, 104
  ds_write_b128 v3, v[8:11] offset:24576
  ds_write_b128 v3, v[12:15] offset:25600
  ds_write_b128 v3, v[16:19] offset:26624
  s_mov_b32 s76, 0xfc00
  LDC v, 8, 32
  s_waitcnt vmcnt(9)
  PV 20, 240, 104
  ds_write_b128 v3, v[20:23] offset:27648
  ds_write_b128 v3, v[24:27] offset:28672
  ds_write_b128 v3, v[28:31] offset:29696
  s_mov_b32 s76, 0xf000
  LDT v, 20, 36
  v_min_u32 v250, 23, v0
  v_lshlrev_b32 v250, 2, v250
  v_add_u32 v250, 128, v250
  global_load_dword v251, v250, s[28:29]
  ACR 56, 216
  ACR 68, 228
  QK2 56, 68, 80, 226
  v_add_f32 v226, v226, v227
  v_add_f32 v226, v226, v228
  v_add_f32 v229, v229, v230
  v_add_f32 v229, v229, v231
  v_add_f32_dpp v226, v226, v226 quad_perm:[1,0,3,2] row_mask:0xf bank_mask:0xf
  s_nop 0
  v_add_f32_dpp v229, v229, v229 quad_perm:[1,0,3,2] row_mask:0xf bank_mask:0xf
  v_add_f32_dpp v226, v226, v226 quad_perm:[2,3,0,1] row_mask:0xf bank_mask:0xf
  s_nop 0
  v_add_f32_dpp v229, v229, v229 quad_perm:[2,3,0,1] row_mask:0xf bank_mask:0xf
  v_add_f32_dpp v226, v226, v226 row_half_mirror row_mask:0xf bank_mask:0xf
  s_nop 0
  v_add_f32_dpp v229, v229, v229 row_half_mirror row_mask:0xf bank_mask:0xf
  v_max3_f32 v232, v128, v226, v229
  v_cmp_gt_f32 vcc, v232, v128
  s_cbranch_vccz Lsk363
  v_sub_f32 v234, v128, v232
  v_mul_f32 v234, s74, v234
  v_exp_f32 v234, v234
  v_mov_b32 v128, v232
  RESC 104, 234
  v_mul_f32 v129, v234, v129
Lsk363:
  v_mul_f32 v233, s74, v128
  v_fma_f32 v235, v226, s74, -v233
  v_fma_f32 v236, v229, s74, -v233
  v_exp_f32 v235, v235
  v_exp_f32 v236, v236
  v_cvt_pk_bf16_f32 v238, v235, 0
  v_cvt_pk_bf16_f32 v239, 0, v235
  v_cvt_pk_bf16_f32 v240, v236, 0
  v_cvt_pk_bf16_f32 v241, 0, v236
  v_add_f32 v129, v129, v239
  v_add_f32 v129, v129, v241
  s_waitcnt vmcnt(10)
  PV 32, 238, 104
  ds_write_b128 v3, v[32:35] offset:30720
  ds_write_b128 v3, v[36:39] offset:31744
  s_waitcnt lgkmcnt(8)
  ds_write_b128 v3, v[40:43] offset:32768
  s_mov_b32 s76, 0xfc00
  LDC v, 32, 36
  s_waitcnt vmcnt(10)
  PV 44, 240, 104
  ds_write_b128 v3, v[44:47] offset:33792
  ds_write_b128 v3, v[48:51] offset:34816
  ds_write_b128 v3, v[52:55] offset:35840
  s_mov_b32 s76, 0x10800
  LDC v, 44, 32
  s_add_u32 s76, s72, 0x0
  buffer_load_dwordx4 v[92:95], v2, s[64:67], s76 offen sc1
  buffer_load_dwordx4 v[96:99], v2, s[64:67], s76 offen offset:128 sc1
  buffer_load_dwordx4 v[100:103], v2, s[64:67], s76 offen offset:256 sc1
  ACR 56, 240
  s_waitcnt vmcnt(13)
  QK2 56, 8, 80, 226
  s_mov_b32 s76, 0x11400
  LDC v, 8, 32
  v_add_f32 v226, v226, v227
  v_add_f32 v226, v226, v228
  v_add_f32 v229, v229, v230
  v_add_f32 v229, v229, v231
  v_add_f32_dpp v226, v226, v226 quad_perm:[1,0,3,2] row_mask:0xf bank_mask:0xf
  s_nop 0
  v_add_f32_dpp v229, v229, v229 quad_perm:[1,0,3,2] row_mask:0xf bank_mask:0xf
  v_add_f32_dpp v226, v226, v226 quad_perm:[2,3,0,1] row_mask:0xf bank_mask:0xf
  s_nop 0
  v_add_f32_dpp v229, v229, v229 quad_perm:[2,3,0,1] row_mask:0xf bank_mask:0xf
  v_add_f32_dpp v226, v226, v226 row_half_mirror row_mask:0xf bank_mask:0xf
  s_nop 0
  v_add_f32_dpp v229, v229, v229 row_half_mirror row_mask:0xf bank_mask:0xf
  v_max3_f32 v232, v128, v226, v229
  v_cmp_gt_f32 vcc, v232, v128
  s_cbranch_vccz Lsk364
  v_sub_f32 v234, v128, v232
  v_mul_f32 v234, s74, v234
  v_exp_f32 v234, v234
  v_mov_b32 v128, v232
  RESC 104, 234
  v_mul_f32 v129, v234, v129
Lsk364:
  v_mul_f32 v233, s74, v128
  v_fma_f32 v235, v226, s74, -v233
  v_fma_f32 v236, v229, s74, -v233
  v_exp_f32 v235, v235
  v_exp_f32 v236, v236
  v_cvt_pk_bf16_f32 v238, v235, 0
  v_cvt_pk_bf16_f32 v239, 0, v235
  v_cvt_pk_bf16_f32 v240, v236, 0
  v_cvt_pk_bf16_f32 v241, 0, v236
  v_add_f32 v129, v129, v239
  v_add_f32 v129, v129, v241
  s_waitcnt vmcnt(13)
  PV 20, 238, 104
  ds_write_b128 v3, v[20:23] offset:36864
  ds_write_b128 v3, v[24:27] offset:37888
  ds_write_b128 v3, v[28:31] offset:38912
  s_mov_b32 s76, 0x10800
  LDC v, 20, 36
  s_waitcnt vmcnt(12)
  PV 32, 240, 104
  s_mov_b32 s76, 0x11400
  LDC v, 32, 36
  s_waitcnt vmcnt(12)
  s_waitcnt vmcnt(6)
  QK2 44, 8, 80, 226
  s_mov_b32 s76, 0x12000
  LDC v, 8, 32
  s_mov_b32 s76, 0x12000
  LDC v, 44, 36
  v_add_f32 v226, v226, v227
  v_add_f32 v226, v226, v228
  v_add_f32 v229, v229, v230
  v_add_f32 v229, v229, v231
  v_add_f32_dpp v226, v226, v226 quad_perm:[1,0,3,2] row_mask:0xf bank_mask:0xf
  s_nop 0
  v_add_f32_dpp v229, v229, v229 quad_perm:[1,0,3,2] row_mask:0xf bank_mask:0xf
  v_add_f32_dpp v226, v226, v226 quad_perm:[2,3,0,1] row_mask:0xf bank_mask:0xf
  s_nop 0
  v_add_f32_dpp v229, v229, v229 quad_perm:[2,3,0,1] row_mask:0xf bank_mask:0xf
  v_add_f32_dpp v226, v226, v226 row_half_mirror row_mask:0xf bank_mask:0xf
  s_nop 0
  v_add_f32_dpp v229, v229, v229 row_half_mirror row_mask:0xf bank_mask:0xf
  v_max3_f32 v232, v128, v226, v229
  v_cmp_gt_f32 vcc, v232, v128
  s_cbranch_vccz Lsk365
  v_sub_f32 v234, v128, v232
  v_mul_f32 v234, s74, v234
  v_exp_f32 v234, v234
  v_mov_b32 v128, v232
  RESC 104, 234
  v_mul_f32 v129, v234, v129
Lsk365:
  v_mul_f32 v233, s74, v128
  v_fma_f32 v235, v226, s74, -v233
  v_fma_f32 v236, v229, s74, -v233
  v_exp_f32 v235, v235
  v_exp_f32 v236, v236
  v_cvt_pk_bf16_f32 v238, v235, 0
  v_cvt_pk_bf16_f32 v239, 0, v235
  v_cvt_pk_bf16_f32 v240, v236, 0
  v_cvt_pk_bf16_f32 v241, 0, v236
  v_add_f32 v129, v129, v239
  v_add_f32 v129, v129, v241
  s_waitcnt vmcnt(9)
  PV 20, 238, 104
  s_mov_b32 s76, 0x12c00
  LDT v, 20, 32
  s_waitcnt vmcnt(9)
  PV 32, 240, 104
  s_mov_b32 s76, 0x13800
  LDT v, 32, 32
  s_waitcnt vmcnt(9)
  v_dot2_f32_bf16 v226, v8, v80, 0
  v_dot2_f32_bf16 v227, v12, v84, 0
  v_dot2_f32_bf16 v228, v16, v88, 0
  s_nop 0
  v_dot2c_f32_bf16 v226, v9, v81
  v_dot2c_f32_bf16 v227, v13, v85
  v_dot2c_f32_bf16 v228, v17, v89
  v_dot2c_f32_bf16 v226, v10, v82
  v_dot2c_f32_bf16 v227, v14, v86
  v_dot2c_f32_bf16 v228, v18, v90
  v_dot2c_f32_bf16 v226, v11, v83
  v_dot2c_f32_bf16 v227, v15, v87
  v_dot2c_f32_bf16 v228, v19, v91
  s_mov_b32 s76, 0x12c00
  LDT v, 8, 36
  v_add_f32 v226, v226, v227
  v_add_f32 v226, v226, v228
  s_nop 1
  v_add_f32_dpp v226, v226, v226 quad_perm:[1,0,3,2] row_mask:0xf bank_mask:0xf
  s_nop 1
  v_add_f32_dpp v226, v226, v226 quad_perm:[2,3,0,1] row_mask:0xf bank_mask:0xf
  s_nop 1
  v_add_f32_dpp v226, v226, v226 row_half_mirror row_mask:0xf bank_mask:0xf
  v_max_f32 v232, v128, v226
  v_cmp_gt_f32 vcc, v232, v128
  s_cbranch_vccz Lsk366
  v_sub_f32 v234, v128, v232
  v_mul_f32 v234, s74, v234
  v_exp_f32 v234, v234
  v_mov_b32 v128, v232
  RESC 104, 234
  v_mul_f32 v129, v234, v129
Lsk366:
  v_mul_f32 v233, s74, v128
  v_fma_f32 v235, v226, s74, -v233
  v_exp_f32 v235, v235
  s_nop 0
  v_cvt_pk_bf16_f32 v238, v235, 0
  v_cvt_pk_bf16_f32 v239, 0, v235
  v_add_f32 v129, v129, v239
  s_waitcnt vmcnt(9)
  PV 44, 238, 104
  s_mov_b32 s76, 0x13800
  LDT v, 44, 36
  v_cmp_ne_u32 vcc, 0x10001, v251
  s_cbranch_vccz Lfo367
  s_mov_b32 s75, 0x61a80
  v_min_u32 v250, 23, v0
  v_lshlrev_b32 v250, 2, v250
  v_add_u32 v250, 128, v250
Lar368:
  global_load_dword v251, v250, s[28:29] sc1
  s_waitcnt vmcnt(0)
  v_cmp_ne_u32 vcc, 0x10001, v251
  s_cbranch_vccz Lad369
  s_sleep 8
  s_sub_u32 s75, s75, 1
  s_cmp_lg_u32 s75, 0
  s_cbranch_scc1 Lar368
Lad369:
  s_nop 4
Lfo367:
  s_nop 4
  v_max_f32_dpp v226, v128, v128 row_ror:8 row_mask:0xf bank_mask:0xf
  v_mov_b32 v227, v226
  s_nop 1
  v_permlane16_swap_b32 v226, v227
  v_max_f32 v226, v226, v227
  v_mov_b32 v227, v226
  s_nop 1
  v_permlane32_swap_b32 v226, v227
  v_max_f32 v226, v226, v227
  v_sub_f32 v228, v128, v226
  v_mul_f32 v228, s74, v228
  v_exp_f32 v228, v228
  v_mul_f32 v226, s74, v226
  RESC 104, 228
  v_mul_f32 v129, v228, v129
  s_nop 1
  v_add_f32_dpp v129, v129, v129 row_ror:8 row_mask:0xf bank_mask:0xf
  v_mov_b32 v227, v129
  s_nop 1
  v_permlane16_swap_b32 v129, v227
  v_add_f32 v129, v129, v227
  v_mov_b32 v227, v129
  s_nop 1
  v_permlane32_swap_b32 v129, v227
  v_add_f32 v129, v129, v227
  v_permlane32_swap_b32 v104, v116
  v_permlane32_swap_b32 v105, v117
  v_permlane32_swap_b32 v106, v118
  v_permlane32_swap_b32 v107, v119
  v_permlane32_swap_b32 v108, v120
  v_permlane32_swap_b32 v109, v121
  v_permlane32_swap_b32 v110, v122
  v_permlane32_swap_b32 v111, v123
  v_permlane32_swap_b32 v112, v124
  v_permlane32_swap_b32 v113, v125
  v_permlane32_swap_b32 v114, v126
  v_permlane32_swap_b32 v115, v127
  v_add_f32 v104, v104, v116
  v_add_f32 v105, v105, v117
  v_add_f32 v106, v106, v118
  v_add_f32 v107, v107, v119
  v_add_f32 v108, v108, v120
  v_add_f32 v109, v109, v121
  v_add_f32 v110, v110, v122
  v_add_f32 v111, v111, v123
  v_add_f32 v112, v112, v124
  v_add_f32 v113, v113, v125
  v_add_f32 v114, v114, v126
  v_add_f32 v115, v115, v127
  v_permlane16_swap_b32 v104, v110
  v_permlane16_swap_b32 v105, v111
  v_permlane16_swap_b32 v106, v112
  v_permlane16_swap_b32 v107, v113
  v_permlane16_swap_b32 v108, v114
  v_permlane16_swap_b32 v109, v115
  v_add_f32 v104, v104, v110
  v_add_f32 v105, v105, v111
  v_add_f32 v106, v106, v112
  v_add_f32 v107, v107, v113
  v_add_f32 v108, v108, v114
  v_add_f32 v109, v109, v115
  v_add_f32_dpp v104, v104, v104 row_ror:8 row_mask:0xf bank_mask:0xf
  v_add_f32_dpp v105, v105, v105 row_ror:8 row_mask:0xf bank_mask:0xf
  v_add_f32_dpp v106, v106, v106 row_ror:8 row_mask:0xf bank_mask:0xf
  v_add_f32_dpp v107, v107, v107 row_ror:8 row_mask:0xf bank_mask:0xf
  v_add_f32_dpp v108, v108, v108 row_ror:8 row_mask:0xf bank_mask:0xf
  v_add_f32_dpp v109, v109, v109 row_ror:8 row_mask:0xf bank_mask:0xf
  v_add_u32 v229, 0, v7
  v_lshrrev_b32 v230, 3, v229
  v_and_b32 v229, 7, v229
  v_lshlrev_b32 v230, 6, v230
  v_add_u32 v229, v229, v230
  v_lshl_add_u32 v229, v229, 2, v4
  ds_write_b32 v229, v104
  s_waitcnt lgkmcnt(8)
  v_add_u32 v229, 1, v7
  v_lshrrev_b32 v230, 3, v229
  v_and_b32 v229, 7, v229
  v_lshlrev_b32 v230, 6, v230
  v_add_u32 v229, v229, v230
  v_lshl_add_u32 v229, v229, 2, v4
  ds_write_b32 v229, v105
  v_add_u32 v229, 2, v7
  v_lshrrev_b32 v230, 3, v229
  v_and_b32 v229, 7, v229
  v_lshlrev_b32 v230, 6, v230
  v_add_u32 v229, v229, v230
  v_lshl_add_u32 v229, v229, 2, v4
  ds_write_b32 v229, v106
  v_add_u32 v229, 3, v7
  v_lshrrev_b32 v230, 3, v229
  v_and_b32 v229, 7, v229
  v_lshlrev_b32 v230, 6, v230
  v_add_u32 v229, v229, v230
  v_lshl_add_u32 v229, v229, 2, v4
  ds_write_b32 v229, v107
  v_add_u32 v229, 4, v7
  v_lshrrev_b32 v230, 3, v229
  v_and_b32 v229, 7, v229
  v_lshlrev_b32 v230, 6, v230
  v_add_u32 v229, v229, v230
  v_lshl_add_u32 v229, v229, 2, v4
  ds_write_b32 v229, v108
  v_add_u32 v229, 5, v7
  v_lshrrev_b32 v230, 3, v229
  v_and_b32 v229, 7, v229
  v_lshlrev_b32 v230, 6, v230
  v_add_u32 v229, v229, v230
  v_lshl_add_u32 v229, v229, 2, v4
  ds_write_b32 v229, v109
  v_mov_b32 v234, v226
  v_mov_b32 v235, v129
  v_mov_b32 v236, 0
  v_mov_b32 v237, 0
  v_and_b32 v229, 0xffffff1f, v4
  ds_write_b128 v229, v[234:237] offset:768
  s_waitcnt lgkmcnt(0)
  ds_read_b128 v[234:237], v5
  s_waitcnt lgkmcnt(0)
  s_add_u32 s76, s73, 0x0
  s_mov_b32 exec_lo, -1
  s_mov_b32 exec_hi, 0x1ffff
  buffer_store_dwordx4 v[234:237], v6, s[64:67], s76 offen sc1
  s_mov_b64 exec, -1
  v_max3_u32 v226, v92, v93, v94
  v_max3_u32 v226, v226, v95, v96
  v_max3_u32 v226, v226, v97, v98
  v_max3_u32 v226, v226, v99, v100
  v_max3_u32 v226, v226, v101, v102
  v_max3_u32 v226, v226, v103, v103
  v_cmp_eq_u32 vcc, -1, v226
  s_cbranch_vccz Lqo370
  s_mov_b32 s75, 0x61a80
Lqr371:
  s_sleep 2
  s_add_u32 s77, s72, 0x0
  buffer_load_dwordx4 v[92:95], v2, s[64:67], s77 offen sc1
  buffer_load_dwordx4 v[96:99], v2, s[64:67], s77 offen offset:128 sc1
  buffer_load_dwordx4 v[100:103], v2, s[64:67], s77 offen offset:256 sc1
  s_waitcnt vmcnt(0)
  v_max3_u32 v226, v92, v93, v94
  v_max3_u32 v226, v226, v95, v96
  v_max3_u32 v226, v226, v97, v98
  v_max3_u32 v226, v226, v99, v100
  v_max3_u32 v226, v226, v101, v102
  v_max3_u32 v226, v226, v103, v103
  v_cmp_eq_u32 vcc, -1, v226
  s_cbranch_vccz Lqo370
  s_sub_u32 s75, s75, 1
  s_cmp_lg_u32 s75, 0
  s_cbranch_scc1 Lqr371
Lqo370:
  v_mov_b32 v80, v92
  v_mov_b32 v81, v93
  v_mov_b32 v82, v94
  v_mov_b32 v83, v95
  v_mov_b32 v84, v96
  v_mov_b32 v85, v97
  v_mov_b32 v86, v98
  v_mov_b32 v87, v99
  v_mov_b32 v88, v100
  v_mov_b32 v89, v101
  v_mov_b32 v90, v102
  v_mov_b32 v91, v103
  v_mov_b32 v104, 0
  v_mov_b32 v105, 0
  v_mov_b32 v106, 0
  v_mov_b32 v107, 0
  v_mov_b32 v108, 0
  v_mov_b32 v109, 0
  v_mov_b32 v110, 0
  v_mov_b32 v111, 0
  v_mov_b32 v112, 0
  v_mov_b32 v113, 0
  v_mov_b32 v114, 0
  v_mov_b32 v115, 0
  v_mov_b32 v116, 0
  v_mov_b32 v117, 0
  v_mov_b32 v118, 0
  v_mov_b32 v119, 0
  v_mov_b32 v120, 0
  v_mov_b32 v121, 0
  v_mov_b32 v122, 0
  v_mov_b32 v123, 0
  v_mov_b32 v124, 0
  v_mov_b32 v125, 0
  v_mov_b32 v126, 0
  v_mov_b32 v127, 0
  v_mov_b32 v128, 0xf149f2ca
  v_mov_b32 v129, 0
  s_waitcnt vmcnt(10)
  s_waitcnt vmcnt(7)
  QK2 20, 32, 80, 226
  s_mov_b32 s76, 0x14400
  LDT v, 20, 32
  s_mov_b32 s76, 0x15000
  LDT v, 32, 32
  v_add_f32 v226, v226, v227
  v_add_f32 v226, v226, v228
  v_add_f32 v229, v229, v230
  v_add_f32 v229, v229, v231
  v_add_f32_dpp v226, v226, v226 quad_perm:[1,0,3,2] row_mask:0xf bank_mask:0xf
  s_nop 0
  v_add_f32_dpp v229, v229, v229 quad_perm:[1,0,3,2] row_mask:0xf bank_mask:0xf
  v_add_f32_dpp v226, v226, v226 quad_perm:[2,3,0,1] row_mask:0xf bank_mask:0xf
  s_nop 0
  v_add_f32_dpp v229, v229, v229 quad_perm:[2,3,0,1] row_mask:0xf bank_mask:0xf
  v_add_f32_dpp v226, v226, v226 row_half_mirror row_mask:0xf bank_mask:0xf
  s_nop 0
  v_add_f32_dpp v229, v229, v229 row_half_mirror row_mask:0xf bank_mask:0xf
  v_max3_f32 v232, v128, v226, v229
  v_cmp_gt_f32 vcc, v232, v128
  s_cbranch_vccz Lsk372
  v_sub_f32 v234, v128, v232
  v_mul_f32 v234, s74, v234
  v_exp_f32 v234, v234
  v_mov_b32 v128, v232
  RESC 104, 234
  v_mul_f32 v129, v234, v129
Lsk372:
  v_mul_f32 v233, s74, v128
  v_fma_f32 v235, v226, s74, -v233
  v_fma_f32 v236, v229, s74, -v233
  v_exp_f32 v235, v235
  v_exp_f32 v236, v236
  v_cvt_pk_bf16_f32 v238, v235, 0
  v_cvt_pk_bf16_f32 v239, 0, v235
  v_cvt_pk_bf16_f32 v240, v236, 0
  v_cvt_pk_bf16_f32 v241, 0, v236
  v_add_f32 v129, v129, v239
  v_add_f32 v129, v129, v241
  s_waitcnt vmcnt(10)
  PV 8, 238, 104
  s_mov_b32 s76, 0x14400
  LDT v, 8, 36
  s_waitcnt vmcnt(10)
  PV 44, 240, 104
  s_mov_b32 s76, 0x15000
  LDT v, 44, 36
  s_waitcnt vmcnt(9)
  s_waitcnt vmcnt(6)
  QK2 20, 32, 80, 226
  s_mov_b32 s76, 0x15c00
  LDT v, 20, 32
  s_mov_b32 s76, 0x16800
  LDT v, 32, 32
  v_add_f32 v226, v226, v227
  v_add_f32 v226, v226, v228
  v_add_f32 v229, v229, v230
  v_add_f32 v229, v229, v231
  v_add_f32_dpp v226, v226, v226 quad_perm:[1,0,3,2] row_mask:0xf bank_mask:0xf
  s_nop 0
  v_add_f32_dpp v229, v229, v229 quad_perm:[1,0,3,2] row_mask:0xf bank_mask:0xf
  v_add_f32_dpp v226, v226, v226 quad_perm:[2,3,0,1] row_mask:0xf bank_mask:0xf
  s_nop 0
  v_add_f32_dpp v229, v229, v229 quad_perm:[2,3,0,1] row_mask:0xf bank_mask:0xf
  v_add_f32_dpp v226, v226, v226 row_half_mirror row_mask:0xf bank_mask:0xf
  s_nop 0
  v_add_f32_dpp v229, v229, v229 row_half_mirror row_mask:0xf bank_mask:0xf
  v_max3_f32 v232, v128, v226, v229
  v_cmp_gt_f32 vcc, v232, v128
  s_cbranch_vccz Lsk373
  v_sub_f32 v234, v128, v232
  v_mul_f32 v234, s74, v234
  v_exp_f32 v234, v234
  v_mov_b32 v128, v232
  RESC 104, 234
  v_mul_f32 v129, v234, v129
Lsk373:
  v_mul_f32 v233, s74, v128
  v_fma_f32 v235, v226, s74, -v233
  v_fma_f32 v236, v229, s74, -v233
  v_exp_f32 v235, v235
  v_exp_f32 v236, v236
  v_cvt_pk_bf16_f32 v238, v235, 0
  v_cvt_pk_bf16_f32 v239, 0, v235
  v_cvt_pk_bf16_f32 v240, v236, 0
  v_cvt_pk_bf16_f32 v241, 0, v236
  v_add_f32 v129, v129, v239
  v_add_f32 v129, v129, v241
  s_waitcnt vmcnt(9)
  PV 8, 238, 104
  s_mov_b32 s76, 0x15c00
  LDT v, 8, 36
  s_waitcnt vmcnt(9)
  PV 44, 240, 104
  s_mov_b32 s76, 0x16800
  LDT v, 44, 36
  s_waitcnt vmcnt(9)
  s_waitcnt vmcnt(6)
  QK2 20, 32, 80, 226
  s_mov_b32 s76, 0x17400
  LDT v, 20, 32
  s_mov_b32 s76, 0x18000
  LDT v, 32, 32
  v_add_f32 v226, v226, v227
  v_add_f32 v226, v226, v228
  v_add_f32 v229, v229, v230
  v_add_f32 v229, v229, v231
  v_add_f32_dpp v226, v226, v226 quad_perm:[1,0,3,2] row_mask:0xf bank_mask:0xf
  s_nop 0
  v_add_f32_dpp v229, v229, v229 quad_perm:[1,0,3,2] row_mask:0xf bank_mask:0xf
  v_add_f32_dpp v226, v226, v226 quad_perm:[2,3,0,1] row_mask:0xf bank_mask:0xf
  s_nop 0
  v_add_f32_dpp v229, v229, v229 quad_perm:[2,3,0,1] row_mask:0xf bank_mask:0xf
  v_add_f32_dpp v226, v226, v226 row_half_mirror row_mask:0xf bank_mask:0xf
  s_nop 0
  v_add_f32_dpp v229, v229, v229 row_half_mirror row_mask:0xf bank_mask:0xf
  v_max3_f32 v232, v128, v226, v229
  v_cmp_gt_f32 vcc, v232, v128
  s_cbranch_vccz Lsk374
  v_sub_f32 v234, v128, v232
  v_mul_f32 v234, s74, v234
  v_exp_f32 v234, v234
  v_mov_b32 v128, v232
  RESC 104, 234
  v_mul_f32 v129, v234, v129
Lsk374:
  v_mul_f32 v233, s74, v128
  v_fma_f32 v235, v226, s74, -v233
  v_fma_f32 v236, v229, s74, -v233
  v_exp_f32 v235, v235
  v_exp_f32 v236, v236
  v_cvt_pk_bf16_f32 v238, v235, 0
  v_cvt_pk_bf16_f32 v239, 0, v235
  v_cvt_pk_bf16_f32 v240, v236, 0
  v_cvt_pk_bf16_f32 v241, 0, v236
  v_add_f32 v129, v129, v239
  v_add_f32 v129, v129, v241
  s_waitcnt vmcnt(9)
  PV 8, 238, 104
  s_mov_b32 s76, 0x17400
  LDT v, 8, 36
  s_waitcnt vmcnt(9)
  PV 44, 240, 104
  s_mov_b32 s76, 0x18000
  LDT v, 44, 36
  s_waitcnt vmcnt(9)
  s_waitcnt vmcnt(6)
  QK2 20, 32, 80, 226
  s_mov_b32 s76, 0x18c00
  LDT v, 20, 32
  s_mov_b32 s76, 0x19800
  LDT v, 32, 32
  v_add_f32 v226, v226, v227
  v_add_f32 v226, v226, v228
  v_add_f32 v229, v229, v230
  v_add_f32 v229, v229, v231
  v_add_f32_dpp v226, v226, v226 quad_perm:[1,0,3,2] row_mask:0xf bank_mask:0xf
  s_nop 0
  v_add_f32_dpp v229, v229, v229 quad_perm:[1,0,3,2] row_mask:0xf bank_mask:0xf
  v_add_f32_dpp v226, v226, v226 quad_perm:[2,3,0,1] row_mask:0xf bank_mask:0xf
  s_nop 0
  v_add_f32_dpp v229, v229, v229 quad_perm:[2,3,0,1] row_mask:0xf bank_mask:0xf
  v_add_f32_dpp v226, v226, v226 row_half_mirror row_mask:0xf bank_mask:0xf
  s_nop 0
  v_add_f32_dpp v229, v229, v229 row_half_mirror row_mask:0xf bank_mask:0xf
  v_max3_f32 v232, v128, v226, v229
  v_cmp_gt_f32 vcc, v232, v128
  s_cbranch_vccz Lsk375
  v_sub_f32 v234, v128, v232
  v_mul_f32 v234, s74, v234
  v_exp_f32 v234, v234
  v_mov_b32 v128, v232
  RESC 104, 234
  v_mul_f32 v129, v234, v129
Lsk375:
  v_mul_f32 v233, s74, v128
  v_fma_f32 v235, v226, s74, -v233
  v_fma_f32 v236, v229, s74, -v233
  v_exp_f32 v235, v235
  v_exp_f32 v236, v236
  v_cvt_pk_bf16_f32 v238, v235, 0
  v_cvt_pk_bf16_f32 v239, 0, v235
  v_cvt_pk_bf16_f32 v240, v236, 0
  v_cvt_pk_bf16_f32 v241, 0, v236
  v_add_f32 v129, v129, v239
  v_add_f32 v129, v129, v241
  s_waitcnt vmcnt(9)
  PV 8, 238, 104
  s_mov_b32 s76, 0x18c00
  LDT v, 8, 36
  s_waitcnt vmcnt(9)
  PV 44, 240, 104
  s_mov_b32 s76, 0x19800
  LDT v, 44, 36
  s_waitcnt vmcnt(9)
  s_waitcnt vmcnt(6)
  QK2 20, 32, 80, 226
  s_mov_b32 s76, 0x1a400
  LDT v, 20, 32
  s_mov_b32 s76, 0x1b000
  LDT v, 32, 32
  v_add_f32 v226, v226, v227
  v_add_f32 v226, v226, v228
  v_add_f32 v229, v229, v230
  v_add_f32 v229, v229, v231
  v_add_f32_dpp v226, v226, v226 quad_perm:[1,0,3,2] row_mask:0xf bank_mask:0xf
  s_nop 0
  v_add_f32_dpp v229, v229, v229 quad_perm:[1,0,3,2] row_mask:0xf bank_mask:0xf
  v_add_f32_dpp v226, v226, v226 quad_perm:[2,3,0,1] row_mask:0xf bank_mask:0xf
  s_nop 0
  v_add_f32_dpp v229, v229, v229 quad_perm:[2,3,0,1] row_mask:0xf bank_mask:0xf
  v_add_f32_dpp v226, v226, v226 row_half_mirror row_mask:0xf bank_mask:0xf
  s_nop 0
  v_add_f32_dpp v229, v229, v229 row_half_mirror row_mask:0xf bank_mask:0xf
  v_max3_f32 v232, v128, v226, v229
  v_cmp_gt_f32 vcc, v232, v128
  s_cbranch_vccz Lsk376
  v_sub_f32 v234, v128, v232
  v_mul_f32 v234, s74, v234
  v_exp_f32 v234, v234
  v_mov_b32 v128, v232
  RESC 104, 234
  v_mul_f32 v129, v234, v129
Lsk376:
  v_mul_f32 v233, s74, v128
  v_fma_f32 v235, v226, s74, -v233
  v_fma_f32 v236, v229, s74, -v233
  v_exp_f32 v235, v235
  v_exp_f32 v236, v236
  v_cvt_pk_bf16_f32 v238, v235, 0
  v_cvt_pk_bf16_f32 v239, 0, v235
  v_cvt_pk_bf16_f32 v240, v236, 0
  v_cvt_pk_bf16_f32 v241, 0, v236
  v_add_f32 v129, v129, v239
  v_add_f32 v129, v129, v241
  s_waitcnt vmcnt(9)
  PV 8, 238, 104
  s_mov_b32 s76, 0x1a400
  LDT v, 8, 36
  s_waitcnt vmcnt(9)
  PV 44, 240, 104
  s_mov_b32 s76, 0x1b000
  LDT v, 44, 36
  s_add_u32 s76, s72, 0x3000
  buffer_load_dwordx4 v[92:95], v2, s[64:67], s76 offen sc1
  buffer_load_dwordx4 v[96:99], v2, s[64:67], s76 offen offset:128 sc1
  buffer_load_dwordx4 v[100:103], v2, s[64:67], s76 offen offset:256 sc1
  s_waitcnt vmcnt(12)
  s_waitcnt vmcnt(9)
  QK2 20, 32, 80, 226
  s_mov_b32 s76, 0x1bc00
  LDT v, 20, 32
  s_mov_b32 s76, 0x1c800
  LDT v, 32, 32
  v_add_f32 v226, v226, v227
  v_add_f32 v226, v226, v228
  v_add_f32 v229, v229, v230
  v_add_f32 v229, v229, v231
  v_add_f32_dpp v226, v226, v226 quad_perm:[1,0,3,2] row_mask:0xf bank_mask:0xf
  s_nop 0
  v_add_f32_dpp v229, v229, v229 quad_perm:[1,0,3,2] row_mask:0xf bank_mask:0xf
  v_add_f32_dpp v226, v226, v226 quad_perm:[2,3,0,1] row_mask:0xf bank_mask:0xf
  s_nop 0
  v_add_f32_dpp v229, v229, v229 quad_perm:[2,3,0,1] row_mask:0xf bank_mask:0xf
  v_add_f32_dpp v226, v226, v226 row_half_mirror row_mask:0xf bank_mask:0xf
  s_nop 0
  v_add_f32_dpp v229, v229, v229 row_half_mirror row_mask:0xf bank_mask:0xf
  v_max3_f32 v232, v128, v226, v229
  v_cmp_gt_f32 vcc, v232, v128
  s_cbranch_vccz Lsk377
  v_sub_f32 v234, v128, v232
  v_mul_f32 v234, s74, v234
  v_exp_f32 v234, v234
  v_mov_b32 v128, v232
  RESC 104, 234
  v_mul_f32 v129, v234, v129
Lsk377:
  v_mul_f32 v233, s74, v128
  v_fma_f32 v235, v226, s74, -v233
  v_fma_f32 v236, v229, s74, -v233
  v_exp_f32 v235, v235
  v_exp_f32 v236, v236
  v_cvt_pk_bf16_f32 v238, v235, 0
  v_cvt_pk_bf16_f32 v239, 0, v235
  v_cvt_pk_bf16_f32 v240, v236, 0
  v_cvt_pk_bf16_f32 v241, 0, v236
  v_add_f32 v129, v129, v239
  v_add_f32 v129, v129, v241
  s_waitcnt vmcnt(12)
  PV 8, 238, 104
  s_mov_b32 s76, 0x1bc00
  LDT v, 8, 36
  s_waitcnt vmcnt(12)
  PV 44, 240, 104
  s_mov_b32 s76, 0x1c800
  LDT v, 44, 36
  s_waitcnt vmcnt(9)
  s_waitcnt vmcnt(6)
  QK2 20, 32, 80, 226
  s_mov_b32 s76, 0x1d400
  LDT v, 20, 32
  s_mov_b32 s76, 0x1d400
  LDT v, 32, 36
  v_add_f32 v226, v226, v227
  v_add_f32 v226, v226, v228
  v_add_f32 v229, v229, v230
  v_add_f32 v229, v229, v231
  v_add_f32_dpp v226, v226, v226 quad_perm:[1,0,3,2] row_mask:0xf bank_mask:0xf
  s_nop 0
  v_add_f32_dpp v229, v229, v229 quad_perm:[1,0,3,2] row_mask:0xf bank_mask:0xf
  v_add_f32_dpp v226, v226, v226 quad_perm:[2,3,0,1] row_mask:0xf bank_mask:0xf
  s_nop 0
  v_add_f32_dpp v229, v229, v229 quad_perm:[2,3,0,1] row_mask:0xf bank_mask:0xf
  v_add_f32_dpp v226, v226, v226 row_half_mirror row_mask:0xf bank_mask:0xf
  s_nop 0
  v_add_f32_dpp v229, v229, v229 row_half_mirror row_mask:0xf bank_mask:0xf
  v_max3_f32 v232, v128, v226, v229
  v_cmp_gt_f32 vcc, v232, v128
  s_cbranch_vccz Lsk378
  v_sub_f32 v234, v128, v232
  v_mul_f32 v234, s74, v234
  v_exp_f32 v234, v234
  v_mov_b32 v128, v232
  RESC 104, 234
  v_mul_f32 v129, v234, v129
Lsk378:
  v_mul_f32 v233, s74, v128
  v_fma_f32 v235, v226, s74, -v233
  v_fma_f32 v236, v229, s74, -v233
  v_exp_f32 v235, v235
  v_exp_f32 v236, v236
  v_cvt_pk_bf16_f32 v238, v235, 0
  v_cvt_pk_bf16_f32 v239, 0, v235
  v_cvt_pk_bf16_f32 v240, v236, 0
  v_cvt_pk_bf16_f32 v241, 0, v236
  v_add_f32 v129, v129, v239
  v_add_f32 v129, v129, v241
  s_waitcnt vmcnt(9)
  PV 8, 238, 104
  s_mov_b32 s76, 0x12c00
  LDT v, 8, 40
  s_waitcnt vmcnt(9)
  PV 44, 240, 104
  s_mov_b32 s76, 0x13800
  LDT v, 44, 40
  s_waitcnt vmcnt(9)
  v_dot2_f32_bf16 v226, v20, v80, 0
  v_dot2_f32_bf16 v227, v24, v84, 0
  v_dot2_f32_bf16 v228, v28, v88, 0
  s_nop 0
  v_dot2c_f32_bf16 v226, v21, v81
  v_dot2c_f32_bf16 v227, v25, v85
  v_dot2c_f32_bf16 v228, v29, v89
  v_dot2c_f32_bf16 v226, v22, v82
  v_dot2c_f32_bf16 v227, v26, v86
  v_dot2c_f32_bf16 v228, v30, v90
  v_dot2c_f32_bf16 v226, v23, v83
  v_dot2c_f32_bf16 v227, v27, v87
  v_dot2c_f32_bf16 v228, v31, v91
  s_mov_b32 s76, 0x12c00
  LDT v, 20, 44
  v_add_f32 v226, v226, v227
  v_add_f32 v226, v226, v228
  s_nop 1
  v_add_f32_dpp v226, v226, v226 quad_perm:[1,0,3,2] row_mask:0xf bank_mask:0xf
  s_nop 1
  v_add_f32_dpp v226, v226, v226 quad_perm:[2,3,0,1] row_mask:0xf bank_mask:0xf
  s_nop 1
  v_add_f32_dpp v226, v226, v226 row_half_mirror row_mask:0xf bank_mask:0xf
  v_add_f32 v226, s80, v226
  v_max_f32 v232, v128, v226
  v_cmp_gt_f32 vcc, v232, v128
  s_cbranch_vccz Lsk379
  v_sub_f32 v234, v128, v232
  v_mul_f32 v234, s74, v234
  v_exp_f32 v234, v234
  v_mov_b32 v128, v232
  RESC 104, 234
  v_mul_f32 v129, v234, v129
Lsk379:
  v_mul_f32 v233, s74, v128
  v_fma_f32 v235, v226, s74, -v233
  v_exp_f32 v235, v235
  s_nop 0
  v_cvt_pk_bf16_f32 v238, v235, 0
  v_cvt_pk_bf16_f32 v239, 0, v235
  v_add_f32 v129, v129, v239
  s_waitcnt vmcnt(9)
  PV 32, 238, 104
  s_mov_b32 s76, 0x13800
  LDT v, 32, 44
  v_max_f32_dpp v226, v128, v128 row_ror:8 row_mask:0xf bank_mask:0xf
  v_mov_b32 v227, v226
  s_nop 1
  v_permlane16_swap_b32 v226, v227
  v_max_f32 v226, v226, v227
  v_mov_b32 v227, v226
  s_nop 1
  v_permlane32_swap_b32 v226, v227
  v_max_f32 v226, v226, v227
  v_sub_f32 v228, v128, v226
  v_mul_f32 v228, s74, v228
  v_exp_f32 v228, v228
  v_mul_f32 v226, s74, v226
  RESC 104, 228
  v_mul_f32 v129, v228, v129
  s_nop 1
  v_add_f32_dpp v129, v129, v129 row_ror:8 row_mask:0xf bank_mask:0xf
  v_mov_b32 v227, v129
  s_nop 1
  v_permlane16_swap_b32 v129, v227
  v_add_f32 v129, v129, v227
  v_mov_b32 v227, v129
  s_nop 1
  v_permlane32_swap_b32 v129, v227
  v_add_f32 v129, v129, v227
  v_permlane32_swap_b32 v104, v116
  v_permlane32_swap_b32 v105, v117
  v_permlane32_swap_b32 v106, v118
  v_permlane32_swap_b32 v107, v119
  v_permlane32_swap_b32 v108, v120
  v_permlane32_swap_b32 v109, v121
  v_permlane32_swap_b32 v110, v122
  v_permlane32_swap_b32 v111, v123
  v_permlane32_swap_b32 v112, v124
  v_permlane32_swap_b32 v113, v125
  v_permlane32_swap_b32 v114, v126
  v_permlane32_swap_b32 v115, v127
  v_add_f32 v104, v104, v116
  v_add_f32 v105, v105, v117
  v_add_f32 v106, v106, v118
  v_add_f32 v107, v107, v119
  v_add_f32 v108, v108, v120
  v_add_f32 v109, v109, v121
  v_add_f32 v110, v110, v122
  v_add_f32 v111, v111, v123
  v_add_f32 v112, v112, v124
  v_add_f32 v113, v113, v125
  v_add_f32 v114, v114, v126
  v_add_f32 v115, v115, v127
  v_permlane16_swap_b32 v104, v110
  v_permlane16_swap_b32 v105, v111
  v_permlane16_swap_b32 v106, v112
  v_permlane16_swap_b32 v107, v113
  v_permlane16_swap_b32 v108, v114
  v_permlane16_swap_b32 v109, v115
  v_add_f32 v104, v104, v110
  v_add_f32 v105, v105, v111
  v_add_f32 v106, v106, v112
  v_add_f32 v107, v107, v113
  v_add_f32 v108, v108, v114
  v_add_f32 v109, v109, v115
  v_add_f32_dpp v104, v104, v104 row_ror:8 row_mask:0xf bank_mask:0xf
  v_add_f32_dpp v105, v105, v105 row_ror:8 row_mask:0xf bank_mask:0xf
  v_add_f32_dpp v106, v106, v106 row_ror:8 row_mask:0xf bank_mask:0xf
  v_add_f32_dpp v107, v107, v107 row_ror:8 row_mask:0xf bank_mask:0xf
  v_add_f32_dpp v108, v108, v108 row_ror:8 row_mask:0xf bank_mask:0xf
  v_add_f32_dpp v109, v109, v109 row_ror:8 row_mask:0xf bank_mask:0xf
  v_add_u32 v229, 0, v7
  v_lshrrev_b32 v230, 3, v229
  v_and_b32 v229, 7, v229
  v_lshlrev_b32 v230, 6, v230
  v_add_u32 v229, v229, v230
  v_lshl_add_u32 v229, v229, 2, v4
  ds_write_b32 v229, v104
  v_add_u32 v229, 1, v7
  v_lshrrev_b32 v230, 3, v229
  v_and_b32 v229, 7, v229
  v_lshlrev_b32 v230, 6, v230
  v_add_u32 v229, v229, v230
  v_lshl_add_u32 v229, v229, 2, v4
  ds_write_b32 v229, v105
  v_add_u32 v229, 2, v7
  v_lshrrev_b32 v230, 3, v229
  v_and_b32 v229, 7, v229
  v_lshlrev_b32 v230, 6, v230
  v_add_u32 v229, v229, v230
  v_lshl_add_u32 v229, v229, 2, v4
  ds_write_b32 v229, v106
  v_add_u32 v229, 3, v7
  v_lshrrev_b32 v230, 3, v229
  v_and_b32 v229, 7, v229
  v_lshlrev_b32 v230, 6, v230
  v_add_u32 v229, v229, v230
  v_lshl_add_u32 v229, v229, 2, v4
  ds_write_b32 v229, v107
  v_add_u32 v229, 4, v7
  v_lshrrev_b32 v230, 3, v229
  v_and_b32 v229, 7, v229
  v_lshlrev_b32 v230, 6, v230
  v_add_u32 v229, v229, v230
  v_lshl_add_u32 v229, v229, 2, v4
  ds_write_b32 v229, v108
  v_add_u32 v229, 5, v7
  v_lshrrev_b32 v230, 3, v229
  v_and_b32 v229, 7, v229
  v_lshlrev_b32 v230, 6, v230
  v_add_u32 v229, v229, v230
  v_lshl_add_u32 v229, v229, 2, v4
  ds_write_b32 v229, v109
  v_mov_b32 v234, v226
  v_mov_b32 v235, v129
  v_mov_b32 v236, 0
  v_mov_b32 v237, 0
  v_and_b32 v229, 0xffffff1f, v4
  ds_write_b128 v229, v[234:237] offset:768
  s_waitcnt lgkmcnt(0)
  ds_read_b128 v[234:237], v5
  s_waitcnt lgkmcnt(0)
  s_add_u32 s76, s73, 0x9f400
  s_mov_b32 exec_lo, -1
  s_mov_b32 exec_hi, 0x1ffff
  buffer_store_dwordx4 v[234:237], v6, s[64:67], s76 offen sc1
  s_mov_b64 exec, -1
  v_max3_u32 v226, v92, v93, v94
  v_max3_u32 v226, v226, v95, v96
  v_max3_u32 v226, v226, v97, v98
  v_max3_u32 v226, v226, v99, v100
  v_max3_u32 v226, v226, v101, v102
  v_max3_u32 v226, v226, v103, v103
  v_cmp_eq_u32 vcc, -1, v226
  s_cbranch_vccz Lqo380
  s_mov_b32 s75, 0x61a80
Lqr381:
  s_sleep 2
  s_add_u32 s77, s72, 0x3000
  buffer_load_dwordx4 v[92:95], v2, s[64:67], s77 offen sc1
  buffer_load_dwordx4 v[96:99], v2, s[64:67], s77 offen offset:128 sc1
  buffer_load_dwordx4 v[100:103], v2, s[64:67], s77 offen offset:256 sc1
  s_waitcnt vmcnt(0)
  v_max3_u32 v226, v92, v93, v94
  v_max3_u32 v226, v226, v95, v96
  v_max3_u32 v226, v226, v97, v98
  v_max3_u32 v226, v226, v99, v100
  v_max3_u32 v226, v226, v101, v102
  v_max3_u32 v226, v226, v103, v103
  v_cmp_eq_u32 vcc, -1, v226
  s_cbranch_vccz Lqo380
  s_sub_u32 s75, s75, 1
  s_cmp_lg_u32 s75, 0
  s_cbranch_scc1 Lqr381
Lqo380:
  v_mov_b32 v80, v92
  v_mov_b32 v81, v93
  v_mov_b32 v82, v94
  v_mov_b32 v83, v95
  v_mov_b32 v84, v96
  v_mov_b32 v85, v97
  v_mov_b32 v86, v98
  v_mov_b32 v87, v99
  v_mov_b32 v88, v100
  v_mov_b32 v89, v101
  v_mov_b32 v90, v102
  v_mov_b32 v91, v103
  v_mov_b32 v104, 0
  v_mov_b32 v105, 0
  v_mov_b32 v106, 0
  v_mov_b32 v107, 0
  v_mov_b32 v108, 0
  v_mov_b32 v109, 0
  v_mov_b32 v110, 0
  v_mov_b32 v111, 0
  v_mov_b32 v112, 0
  v_mov_b32 v113, 0
  v_mov_b32 v114, 0
  v_mov_b32 v115, 0
  v_mov_b32 v116, 0
  v_mov_b32 v117, 0
  v_mov_b32 v118, 0
  v_mov_b32 v119, 0
  v_mov_b32 v120, 0
  v_mov_b32 v121, 0
  v_mov_b32 v122, 0
  v_mov_b32 v123, 0
  v_mov_b32 v124, 0
  v_mov_b32 v125, 0
  v_mov_b32 v126, 0
  v_mov_b32 v127, 0
  v_mov_b32 v128, 0xf149f2ca
  v_mov_b32 v129, 0
  s_waitcnt vmcnt(10)
  s_waitcnt vmcnt(7)
  QK2 8, 44, 80, 226
  s_mov_b32 s76, 0x14400
  LDT v, 8, 40
  s_mov_b32 s76, 0x15000
  LDT v, 44, 40
  v_add_f32 v226, v226, v227
  v_add_f32 v226, v226, v228
  v_add_f32 v229, v229, v230
  v_add_f32 v229, v229, v231
  v_add_f32_dpp v226, v226, v226 quad_perm:[1,0,3,2] row_mask:0xf bank_mask:0xf
  s_nop 0
  v_add_f32_dpp v229, v229, v229 quad_perm:[1,0,3,2] row_mask:0xf bank_mask:0xf
  v_add_f32_dpp v226, v226, v226 quad_perm:[2,3,0,1] row_mask:0xf bank_mask:0xf
  s_nop 0
  v_add_f32_dpp v229, v229, v229 quad_perm:[2,3,0,1] row_mask:0xf bank_mask:0xf
  v_add_f32_dpp v226, v226, v226 row_half_mirror row_mask:0xf bank_mask:0xf
  s_nop 0
  v_add_f32_dpp v229, v229, v229 row_half_mirror row_mask:0xf bank_mask:0xf
  v_max3_f32 v232, v128, v226, v229
  v_cmp_gt_f32 vcc, v232, v128
  s_cbranch_vccz Lsk382
  v_sub_f32 v234, v128, v232
  v_mul_f32 v234, s74, v234
  v_exp_f32 v234, v234
  v_mov_b32 v128, v232
  RESC 104, 234
  v_mul_f32 v129, v234, v129
Lsk382:
  v_mul_f32 v233, s74, v128
  v_fma_f32 v235, v226, s74, -v233
  v_fma_f32 v236, v229, s74, -v233
  v_exp_f32 v235, v235
  v_exp_f32 v236, v236
  v_cvt_pk_bf16_f32 v238, v235, 0
  v_cvt_pk_bf16_f32 v239, 0, v235
  v_cvt_pk_bf16_f32 v240, v236, 0
  v_cvt_pk_bf16_f32 v241, 0, v236
  v_add_f32 v129, v129, v239
  v_add_f32 v129, v129, v241
  s_waitcnt vmcnt(10)
  PV 20, 238, 104
  s_mov_b32 s76, 0x14400
  LDT v, 20, 44
  s_waitcnt vmcnt(10)
  PV 32, 240, 104
  s_mov_b32 s76, 0x15000
  LDT v, 32, 44
  s_waitcnt vmcnt(9)
  s_waitcnt vmcnt(6)
  QK2 8, 44, 80, 226
  s_mov_b32 s76, 0x15c00
  LDT v, 8, 40
  s_mov_b32 s76, 0x16800
  LDT v, 44, 40
  v_add_f32 v226, v226, v227
  v_add_f32 v226, v226, v228
  v_add_f32 v229, v229, v230
  v_add_f32 v229, v229, v231
  v_add_f32_dpp v226, v226, v226 quad_perm:[1,0,3,2] row_mask:0xf bank_mask:0xf
  s_nop 0
  v_add_f32_dpp v229, v229, v229 quad_perm:[1,0,3,2] row_mask:0xf bank_mask:0xf
  v_add_f32_dpp v226, v226, v226 quad_perm:[2,3,0,1] row_mask:0xf bank_mask:0xf
  s_nop 0
  v_add_f32_dpp v229, v229, v229 quad_perm:[2,3,0,1] row_mask:0xf bank_mask:0xf
  v_add_f32_dpp v226, v226, v226 row_half_mirror row_mask:0xf bank_mask:0xf
  s_nop 0
  v_add_f32_dpp v229, v229, v229 row_half_mirror row_mask:0xf bank_mask:0xf
  v_max3_f32 v232, v128, v226, v229
  v_cmp_gt_f32 vcc, v232, v128
  s_cbranch_vccz Lsk383
  v_sub_f32 v234, v128, v232
  v_mul_f32 v234, s74, v234
  v_exp_f32 v234, v234
  v_mov_b32 v128, v232
  RESC 104, 234
  v_mul_f32 v129, v234, v129
Lsk383:
  v_mul_f32 v233, s74, v128
  v_fma_f32 v235, v226, s74, -v233
  v_fma_f32 v236, v229, s74, -v233
  v_exp_f32 v235, v235
  v_exp_f32 v236, v236
  v_cvt_pk_bf16_f32 v238, v235, 0
  v_cvt_pk_bf16_f32 v239, 0, v235
  v_cvt_pk_bf16_f32 v240, v236, 0
  v_cvt_pk_bf16_f32 v241, 0, v236
  v_add_f32 v129, v129, v239
  v_add_f32 v129, v129, v241
  s_waitcnt vmcnt(9)
  PV 20, 238, 104
  s_mov_b32 s76, 0x15c00
  LDT v, 20, 44
  s_waitcnt vmcnt(9)
  PV 32, 240, 104
  s_mov_b32 s76, 0x16800
  LDT v, 32, 44
  s_waitcnt vmcnt(9)
  s_waitcnt vmcnt(6)
  QK2 8, 44, 80, 226
  s_mov_b32 s76, 0x17400
  LDT v, 8, 40
  s_mov_b32 s76, 0x18000
  LDT v, 44, 40
  v_add_f32 v226, v226, v227
  v_add_f32 v226, v226, v228
  v_add_f32 v229, v229, v230
  v_add_f32 v229, v229, v231
  v_add_f32_dpp v226, v226, v226 quad_perm:[1,0,3,2] row_mask:0xf bank_mask:0xf
  s_nop 0
  v_add_f32_dpp v229, v229, v229 quad_perm:[1,0,3,2] row_mask:0xf bank_mask:0xf
  v_add_f32_dpp v226, v226, v226 quad_perm:[2,3,0,1] row_mask:0xf bank_mask:0xf
  s_nop 0
  v_add_f32_dpp v229, v229, v229 quad_perm:[2,3,0,1] row_mask:0xf bank_mask:0xf
  v_add_f32_dpp v226, v226, v226 row_half_mirror row_mask:0xf bank_mask:0xf
  s_nop 0
  v_add_f32_dpp v229, v229, v229 row_half_mirror row_mask:0xf bank_mask:0xf
  v_max3_f32 v232, v128, v226, v229
  v_cmp_gt_f32 vcc, v232, v128
  s_cbranch_vccz Lsk384
  v_sub_f32 v234, v128, v232
  v_mul_f32 v234, s74, v234
  v_exp_f32 v234, v234
  v_mov_b32 v128, v232
  RESC 104, 234
  v_mul_f32 v129, v234, v129
Lsk384:
  v_mul_f32 v233, s74, v128
  v_fma_f32 v235, v226, s74, -v233
  v_fma_f32 v236, v229, s74, -v233
  v_exp_f32 v235, v235
  v_exp_f32 v236, v236
  v_cvt_pk_bf16_f32 v238, v235, 0
  v_cvt_pk_bf16_f32 v239, 0, v235
  v_cvt_pk_bf16_f32 v240, v236, 0
  v_cvt_pk_bf16_f32 v241, 0, v236
  v_add_f32 v129, v129, v239
  v_add_f32 v129, v129, v241
  s_waitcnt vmcnt(9)
  PV 20, 238, 104
  s_mov_b32 s76, 0x17400
  LDT v, 20, 44
  s_waitcnt vmcnt(9)
  PV 32, 240, 104
  s_mov_b32 s76, 0x18000
  LDT v, 32, 44
  s_waitcnt vmcnt(9)
  s_waitcnt vmcnt(6)
  QK2 8, 44, 80, 226
  s_mov_b32 s76, 0x18c00
  LDT v, 8, 40
  s_mov_b32 s76, 0x19800
  LDT v, 44, 40
  v_add_f32 v226, v226, v227
  v_add_f32 v226, v226, v228
  v_add_f32 v229, v229, v230
  v_add_f32 v229, v229, v231
  v_add_f32_dpp v226, v226, v226 quad_perm:[1,0,3,2] row_mask:0xf bank_mask:0xf
  s_nop 0
  v_add_f32_dpp v229, v229, v229 quad_perm:[1,0,3,2] row_mask:0xf bank_mask:0xf
  v_add_f32_dpp v226, v226, v226 quad_perm:[2,3,0,1] row_mask:0xf bank_mask:0xf
  s_nop 0
  v_add_f32_dpp v229, v229, v229 quad_perm:[2,3,0,1] row_mask:0xf bank_mask:0xf
  v_add_f32_dpp v226, v226, v226 row_half_mirror row_mask:0xf bank_mask:0xf
  s_nop 0
  v_add_f32_dpp v229, v229, v229 row_half_mirror row_mask:0xf bank_mask:0xf
  v_max3_f32 v232, v128, v226, v229
  v_cmp_gt_f32 vcc, v232, v128
  s_cbranch_vccz Lsk385
  v_sub_f32 v234, v128, v232
  v_mul_f32 v234, s74, v234
  v_exp_f32 v234, v234
  v_mov_b32 v128, v232
  RESC 104, 234
  v_mul_f32 v129, v234, v129
Lsk385:
  v_mul_f32 v233, s74, v128
  v_fma_f32 v235, v226, s74, -v233
  v_fma_f32 v236, v229, s74, -v233
  v_exp_f32 v235, v235
  v_exp_f32 v236, v236
  v_cvt_pk_bf16_f32 v238, v235, 0
  v_cvt_pk_bf16_f32 v239, 0, v235
  v_cvt_pk_bf16_f32 v240, v236, 0
  v_cvt_pk_bf16_f32 v241, 0, v236
  v_add_f32 v129, v129, v239
  v_add_f32 v129, v129, v241
  s_waitcnt vmcnt(9)
  PV 20, 238, 104
  s_mov_b32 s76, 0x18c00
  LDT v, 20, 44
  s_waitcnt vmcnt(9)
  PV 32, 240, 104
  s_mov_b32 s76, 0x19800
  LDT v, 32, 44
  s_waitcnt vmcnt(9)
  s_waitcnt vmcnt(6)
  QK2 8, 44, 80, 226
  s_mov_b32 s76, 0x1a400
  LDT v, 8, 40
  s_mov_b32 s76, 0x1b000
  LDT v, 44, 40
  v_add_f32 v226, v226, v227
  v_add_f32 v226, v226, v228
  v_add_f32 v229, v229, v230
  v_add_f32 v229, v229, v231
  v_add_f32_dpp v226, v226, v226 quad_perm:[1,0,3,2] row_mask:0xf bank_mask:0xf
  s_nop 0
  v_add_f32_dpp v229, v229, v229 quad_perm:[1,0,3,2] row_mask:0xf bank_mask:0xf
  v_add_f32_dpp v226, v226, v226 quad_perm:[2,3,0,1] row_mask:0xf bank_mask:0xf
  s_nop 0
  v_add_f32_dpp v229, v229, v229 quad_perm:[2,3,0,1] row_mask:0xf bank_mask:0xf
  v_add_f32_dpp v226, v226, v226 row_half_mirror row_mask:0xf bank_mask:0xf
  s_nop 0
  v_add_f32_dpp v229, v229, v229 row_half_mirror row_mask:0xf bank_mask:0xf
  v_max3_f32 v232, v128, v226, v229
  v_cmp_gt_f32 vcc, v232, v128
  s_cbranch_vccz Lsk386
  v_sub_f32 v234, v128, v232
  v_mul_f32 v234, s74, v234
  v_exp_f32 v234, v234
  v_mov_b32 v128, v232
  RESC 104, 234
  v_mul_f32 v129, v234, v129
Lsk386:
  v_mul_f32 v233, s74, v128
  v_fma_f32 v235, v226, s74, -v233
  v_fma_f32 v236, v229, s74, -v233
  v_exp_f32 v235, v235
  v_exp_f32 v236, v236
  v_cvt_pk_bf16_f32 v238, v235, 0
  v_cvt_pk_bf16_f32 v239, 0, v235
  v_cvt_pk_bf16_f32 v240, v236, 0
  v_cvt_pk_bf16_f32 v241, 0, v236
  v_add_f32 v129, v129, v239
  v_add_f32 v129, v129, v241
  s_waitcnt vmcnt(9)
  PV 20, 238, 104
  s_mov_b32 s76, 0x1a400
  LDT v, 20, 44
  s_waitcnt vmcnt(9)
  PV 32, 240, 104
  s_mov_b32 s76, 0x1b000
  LDT v, 32, 44
  s_add_u32 s76, s72, 0x6000
  buffer_load_dwordx4 v[92:95], v2, s[64:67], s76 offen sc1
  buffer_load_dwordx4 v[96:99], v2, s[64:67], s76 offen offset:128 sc1
  buffer_load_dwordx4 v[100:103], v2, s[64:67], s76 offen offset:256 sc1
  s_waitcnt vmcnt(12)
  s_waitcnt vmcnt(9)
  QK2 8, 44, 80, 226
  s_mov_b32 s76, 0x1bc00
  LDT v, 8, 40
  s_mov_b32 s76, 0x1c800
  LDT v, 44, 40
  v_add_f32 v226, v226, v227
  v_add_f32 v226, v226, v228
  v_add_f32 v229, v229, v230
  v_add_f32 v229, v229, v231
  v_add_f32_dpp v226, v226, v226 quad_perm:[1,0,3,2] row_mask:0xf bank_mask:0xf
  s_nop 0
  v_add_f32_dpp v229, v229, v229 quad_perm:[1,0,3,2] row_mask:0xf bank_mask:0xf
  v_add_f32_dpp v226, v226, v226 quad_perm:[2,3,0,1] row_mask:0xf bank_mask:0xf
  s_nop 0
  v_add_f32_dpp v229, v229, v229 quad_perm:[2,3,0,1] row_mask:0xf bank_mask:0xf
  v_add_f32_dpp v226, v226, v226 row_half_mirror row_mask:0xf bank_mask:0xf
  s_nop 0
  v_add_f32_dpp v229, v229, v229 row_half_mirror row_mask:0xf bank_mask:0xf
  v_max3_f32 v232, v128, v226, v229
  v_cmp_gt_f32 vcc, v232, v128
  s_cbranch_vccz Lsk387
  v_sub_f32 v234, v128, v232
  v_mul_f32 v234, s74, v234
  v_exp_f32 v234, v234
  v_mov_b32 v128, v232
  RESC 104, 234
  v_mul_f32 v129, v234, v129
Lsk387:
  v_mul_f32 v233, s74, v128
  v_fma_f32 v235, v226, s74, -v233
  v_fma_f32 v236, v229, s74, -v233
  v_exp_f32 v235, v235
  v_exp_f32 v236, v236
  v_cvt_pk_bf16_f32 v238, v235, 0
  v_cvt_pk_bf16_f32 v239, 0, v235
  v_cvt_pk_bf16_f32 v240, v236, 0
  v_cvt_pk_bf16_f32 v241, 0, v236
  v_add_f32 v129, v129, v239
  v_add_f32 v129, v129, v241
  s_waitcnt vmcnt(12)
  PV 20, 238, 104
  s_mov_b32 s76, 0x1bc00
  LDT v, 20, 44
  s_waitcnt vmcnt(12)
  PV 32, 240, 104
  s_mov_b32 s76, 0x1c800
  LDT v, 32, 44
  s_waitcnt vmcnt(9)
  s_waitcnt vmcnt(6)
  QK2 8, 44, 80, 226
  s_mov_b32 s76, 0x1d400
  LDT v, 8, 40
  s_mov_b32 s76, 0x1d400
  LDT v, 44, 44
  v_add_f32 v226, v226, v227
  v_add_f32 v226, v226, v228
  v_add_f32 v229, v229, v230
  v_add_f32 v229, v229, v231
  v_add_f32_dpp v226, v226, v226 quad_perm:[1,0,3,2] row_mask:0xf bank_mask:0xf
  s_nop 0
  v_add_f32_dpp v229, v229, v229 quad_perm:[1,0,3,2] row_mask:0xf bank_mask:0xf
  v_add_f32_dpp v226, v226, v226 quad_perm:[2,3,0,1] row_mask:0xf bank_mask:0xf
  s_nop 0
  v_add_f32_dpp v229, v229, v229 quad_perm:[2,3,0,1] row_mask:0xf bank_mask:0xf
  v_add_f32_dpp v226, v226, v226 row_half_mirror row_mask:0xf bank_mask:0xf
  s_nop 0
  v_add_f32_dpp v229, v229, v229 row_half_mirror row_mask:0xf bank_mask:0xf
  v_max3_f32 v232, v128, v226, v229
  v_cmp_gt_f32 vcc, v232, v128
  s_cbranch_vccz Lsk388
  v_sub_f32 v234, v128, v232
  v_mul_f32 v234, s74, v234
  v_exp_f32 v234, v234
  v_mov_b32 v128, v232
  RESC 104, 234
  v_mul_f32 v129, v234, v129
Lsk388:
  v_mul_f32 v233, s74, v128
  v_fma_f32 v235, v226, s74, -v233
  v_fma_f32 v236, v229, s74, -v233
  v_exp_f32 v235, v235
  v_exp_f32 v236, v236
  v_cvt_pk_bf16_f32 v238, v235, 0
  v_cvt_pk_bf16_f32 v239, 0, v235
  v_cvt_pk_bf16_f32 v240, v236, 0
  v_cvt_pk_bf16_f32 v241, 0, v236
  v_add_f32 v129, v129, v239
  v_add_f32 v129, v129, v241
  s_waitcnt vmcnt(9)
  PV 20, 238, 104
  s_mov_b32 s76, 0x12c00
  LDT v, 20, 48
  s_waitcnt vmcnt(9)
  PV 32, 240, 104
  s_mov_b32 s76, 0x13800
  LDT v, 32, 48
  s_waitcnt vmcnt(9)
  v_dot2_f32_bf16 v226, v8, v80, 0
  v_dot2_f32_bf16 v227, v12, v84, 0
  v_dot2_f32_bf16 v228, v16, v88, 0
  s_nop 0
  v_dot2c_f32_bf16 v226, v9, v81
  v_dot2c_f32_bf16 v227, v13, v85
  v_dot2c_f32_bf16 v228, v17, v89
  v_dot2c_f32_bf16 v226, v10, v82
  v_dot2c_f32_bf16 v227, v14, v86
  v_dot2c_f32_bf16 v228, v18, v90
  v_dot2c_f32_bf16 v226, v11, v83
  v_dot2c_f32_bf16 v227, v15, v87
  v_dot2c_f32_bf16 v228, v19, v91
  s_mov_b32 s76, 0x12c00
  LDT v, 8, 52
  v_add_f32 v226, v226, v227
  v_add_f32 v226, v226, v228
  s_nop 1
  v_add_f32_dpp v226, v226, v226 quad_perm:[1,0,3,2] row_mask:0xf bank_mask:0xf
  s_nop 1
  v_add_f32_dpp v226, v226, v226 quad_perm:[2,3,0,1] row_mask:0xf bank_mask:0xf
  s_nop 1
  v_add_f32_dpp v226, v226, v226 row_half_mirror row_mask:0xf bank_mask:0xf
  v_add_f32 v226, s81, v226
  v_max_f32 v232, v128, v226
  v_cmp_gt_f32 vcc, v232, v128
  s_cbranch_vccz Lsk389
  v_sub_f32 v234, v128, v232
  v_mul_f32 v234, s74, v234
  v_exp_f32 v234, v234
  v_mov_b32 v128, v232
  RESC 104, 234
  v_mul_f32 v129, v234, v129
Lsk389:
  v_mul_f32 v233, s74, v128
  v_fma_f32 v235, v226, s74, -v233
  v_exp_f32 v235, v235
  s_nop 0
  v_cvt_pk_bf16_f32 v238, v235, 0
  v_cvt_pk_bf16_f32 v239, 0, v235
  v_add_f32 v129, v129, v239
  s_waitcnt vmcnt(9)
  PV 44, 238, 104
  s_mov_b32 s76, 0x13800
  LDT v, 44, 52
  v_max_f32_dpp v226, v128, v128 row_ror:8 row_mask:0xf bank_mask:0xf
  v_mov_b32 v227, v226
  s_nop 1
  v_permlane16_swap_b32 v226, v227
  v_max_f32 v226, v226, v227
  v_mov_b32 v227, v226
  s_nop 1
  v_permlane32_swap_b32 v226, v227
  v_max_f32 v226, v226, v227
  v_sub_f32 v228, v128, v226
  v_mul_f32 v228, s74, v228
  v_exp_f32 v228, v228
  v_mul_f32 v226, s74, v226
  RESC 104, 228
  v_mul_f32 v129, v228, v129
  s_nop 1
  v_add_f32_dpp v129, v129, v129 row_ror:8 row_mask:0xf bank_mask:0xf
  v_mov_b32 v227, v129
  s_nop 1
  v_permlane16_swap_b32 v129, v227
  v_add_f32 v129, v129, v227
  v_mov_b32 v227, v129
  s_nop 1
  v_permlane32_swap_b32 v129, v227
  v_add_f32 v129, v129, v227
  v_permlane32_swap_b32 v104, v116
  v_permlane32_swap_b32 v105, v117
  v_permlane32_swap_b32 v106, v118
  v_permlane32_swap_b32 v107, v119
  v_permlane32_swap_b32 v108, v120
  v_permlane32_swap_b32 v109, v121
  v_permlane32_swap_b32 v110, v122
  v_permlane32_swap_b32 v111, v123
  v_permlane32_swap_b32 v112, v124
  v_permlane32_swap_b32 v113, v125
  v_permlane32_swap_b32 v114, v126
  v_permlane32_swap_b32 v115, v127
  v_add_f32 v104, v104, v116
  v_add_f32 v105, v105, v117
  v_add_f32 v106, v106, v118
  v_add_f32 v107, v107, v119
  v_add_f32 v108, v108, v120
  v_add_f32 v109, v109, v121
  v_add_f32 v110, v110, v122
  v_add_f32 v111, v111, v123
  v_add_f32 v112, v112, v124
  v_add_f32 v113, v113, v125
  v_add_f32 v114, v114, v126
  v_add_f32 v115, v115, v127
  v_permlane16_swap_b32 v104, v110
  v_permlane16_swap_b32 v105, v111
  v_permlane16_swap_b32 v106, v112
  v_permlane16_swap_b32 v107, v113
  v_permlane16_swap_b32 v108, v114
  v_permlane16_swap_b32 v109, v115
  v_add_f32 v104, v104, v110
  v_add_f32 v105, v105, v111
  v_add_f32 v106, v106, v112
  v_add_f32 v107, v107, v113
  v_add_f32 v108, v108, v114
  v_add_f32 v109, v109, v115
  v_add_f32_dpp v104, v104, v104 row_ror:8 row_mask:0xf bank_mask:0xf
  v_add_f32_dpp v105, v105, v105 row_ror:8 row_mask:0xf bank_mask:0xf
  v_add_f32_dpp v106, v106, v106 row_ror:8 row_mask:0xf bank_mask:0xf
  v_add_f32_dpp v107, v107, v107 row_ror:8 row_mask:0xf bank_mask:0xf
  v_add_f32_dpp v108, v108, v108 row_ror:8 row_mask:0xf bank_mask:0xf
  v_add_f32_dpp v109, v109, v109 row_ror:8 row_mask:0xf bank_mask:0xf
  v_add_u32 v229, 0, v7
  v_lshrrev_b32 v230, 3, v229
  v_and_b32 v229, 7, v229
  v_lshlrev_b32 v230, 6, v230
  v_add_u32 v229, v229, v230
  v_lshl_add_u32 v229, v229, 2, v4
  ds_write_b32 v229, v104
  v_add_u32 v229, 1, v7
  v_lshrrev_b32 v230, 3, v229
  v_and_b32 v229, 7, v229
  v_lshlrev_b32 v230, 6, v230
  v_add_u32 v229, v229, v230
  v_lshl_add_u32 v229, v229, 2, v4
  ds_write_b32 v229, v105
  v_add_u32 v229, 2, v7
  v_lshrrev_b32 v230, 3, v229
  v_and_b32 v229, 7, v229
  v_lshlrev_b32 v230, 6, v230
  v_add_u32 v229, v229, v230
  v_lshl_add_u32 v229, v229, 2, v4
  ds_write_b32 v229, v106
  v_add_u32 v229, 3, v7
  v_lshrrev_b32 v230, 3, v229
  v_and_b32 v229, 7, v229
  v_lshlrev_b32 v230, 6, v230
  v_add_u32 v229, v229, v230
  v_lshl_add_u32 v229, v229, 2, v4
  ds_write_b32 v229, v107
  v_add_u32 v229, 4, v7
  v_lshrrev_b32 v230, 3, v229
  v_and_b32 v229, 7, v229
  v_lshlrev_b32 v230, 6, v230
  v_add_u32 v229, v229, v230
  v_lshl_add_u32 v229, v229, 2, v4
  ds_write_b32 v229, v108
  v_add_u32 v229, 5, v7
  v_lshrrev_b32 v230, 3, v229
  v_and_b32 v229, 7, v229
  v_lshlrev_b32 v230, 6, v230
  v_add_u32 v229, v229, v230
  v_lshl_add_u32 v229, v229, 2, v4
  ds_write_b32 v229, v109
  v_mov_b32 v234, v226
  v_mov_b32 v235, v129
  v_mov_b32 v236, 0
  v_mov_b32 v237, 0
  v_and_b32 v229, 0xffffff1f, v4
  ds_write_b128 v229, v[234:237] offset:768
  s_waitcnt lgkmcnt(0)
  ds_read_b128 v[234:237], v5
  s_waitcnt lgkmcnt(0)
  s_add_u32 s76, s73, 0x13e800
  s_mov_b32 exec_lo, -1
  s_mov_b32 exec_hi, 0x1ffff
  buffer_store_dwordx4 v[234:237], v6, s[64:67], s76 offen sc1
  s_mov_b64 exec, -1
  v_max3_u32 v226, v92, v93, v94
  v_max3_u32 v226, v226, v95, v96
  v_max3_u32 v226, v226, v97, v98
  v_max3_u32 v226, v226, v99, v100
  v_max3_u32 v226, v226, v101, v102
  v_max3_u32 v226, v226, v103, v103
  v_cmp_eq_u32 vcc, -1, v226
  s_cbranch_vccz Lqo390
  s_mov_b32 s75, 0x61a80
Lqr391:
  s_sleep 2
  s_add_u32 s77, s72, 0x6000
  buffer_load_dwordx4 v[92:95], v2, s[64:67], s77 offen sc1
  buffer_load_dwordx4 v[96:99], v2, s[64:67], s77 offen offset:128 sc1
  buffer_load_dwordx4 v[100:103], v2, s[64:67], s77 offen offset:256 sc1
  s_waitcnt vmcnt(0)
  v_max3_u32 v226, v92, v93, v94
  v_max3_u32 v226, v226, v95, v96
  v_max3_u32 v226, v226, v97, v98
  v_max3_u32 v226, v226, v99, v100
  v_max3_u32 v226, v226, v101, v102
  v_max3_u32 v226, v226, v103, v103
  v_cmp_eq_u32 vcc, -1, v226
  s_cbranch_vccz Lqo390
  s_sub_u32 s75, s75, 1
  s_cmp_lg_u32 s75, 0
  s_cbranch_scc1 Lqr391
Lqo390:
  v_mov_b32 v80, v92
  v_mov_b32 v81, v93
  v_mov_b32 v82, v94
  v_mov_b32 v83, v95
  v_mov_b32 v84, v96
  v_mov_b32 v85, v97
  v_mov_b32 v86, v98
  v_mov_b32 v87, v99
  v_mov_b32 v88, v100
  v_mov_b32 v89, v101
  v_mov_b32 v90, v102
  v_mov_b32 v91, v103
  v_mov_b32 v104, 0
  v_mov_b32 v105, 0
  v_mov_b32 v106, 0
  v_mov_b32 v107, 0
  v_mov_b32 v108, 0
  v_mov_b32 v109, 0
  v_mov_b32 v110, 0
  v_mov_b32 v111, 0
  v_mov_b32 v112, 0
  v_mov_b32 v113, 0
  v_mov_b32 v114, 0
  v_mov_b32 v115, 0
  v_mov_b32 v116, 0
  v_mov_b32 v117, 0
  v_mov_b32 v118, 0
  v_mov_b32 v119, 0
  v_mov_b32 v120, 0
  v_mov_b32 v121, 0
  v_mov_b32 v122, 0
  v_mov_b32 v123, 0
  v_mov_b32 v124, 0
  v_mov_b32 v125, 0
  v_mov_b32 v126, 0
  v_mov_b32 v127, 0
  v_mov_b32 v128, 0xf149f2ca
  v_mov_b32 v129, 0
  s_waitcnt vmcnt(10)
  s_waitcnt vmcnt(7)
  QK2 20, 32, 80, 226
  s_mov_b32 s76, 0x14400
  LDT v, 20, 48
  s_mov_b32 s76, 0x15000
  LDT v, 32, 48
  v_add_f32 v226, v226, v227
  v_add_f32 v226, v226, v228
  v_add_f32 v229, v229, v230
  v_add_f32 v229, v229, v231
  v_add_f32_dpp v226, v226, v226 quad_perm:[1,0,3,2] row_mask:0xf bank_mask:0xf
  s_nop 0
  v_add_f32_dpp v229, v229, v229 quad_perm:[1,0,3,2] row_mask:0xf bank_mask:0xf
  v_add_f32_dpp v226, v226, v226 quad_perm:[2,3,0,1] row_mask:0xf bank_mask:0xf
  s_nop 0
  v_add_f32_dpp v229, v229, v229 quad_perm:[2,3,0,1] row_mask:0xf bank_mask:0xf
  v_add_f32_dpp v226, v226, v226 row_half_mirror row_mask:0xf bank_mask:0xf
  s_nop 0
  v_add_f32_dpp v229, v229, v229 row_half_mirror row_mask:0xf bank_mask:0xf
  v_max3_f32 v232, v128, v226, v229
  v_cmp_gt_f32 vcc, v232, v128
  s_cbranch_vccz Lsk392
  v_sub_f32 v234, v128, v232
  v_mul_f32 v234, s74, v234
  v_exp_f32 v234, v234
  v_mov_b32 v128, v232
  RESC 104, 234
  v_mul_f32 v129, v234, v129
Lsk392:
  v_mul_f32 v233, s74, v128
  v_fma_f32 v235, v226, s74, -v233
  v_fma_f32 v236, v229, s74, -v233
  v_exp_f32 v235, v235
  v_exp_f32 v236, v236
  v_cvt_pk_bf16_f32 v238, v235, 0
  v_cvt_pk_bf16_f32 v239, 0, v235
  v_cvt_pk_bf16_f32 v240, v236, 0
  v_cvt_pk_bf16_f32 v241, 0, v236
  v_add_f32 v129, v129, v239
  v_add_f32 v129, v129, v241
  s_waitcnt vmcnt(10)
  PV 8, 238, 104
  s_mov_b32 s76, 0x14400
  LDT v, 8, 52
  s_waitcnt vmcnt(10)
  PV 44, 240, 104
  s_mov_b32 s76, 0x15000
  LDT v, 44, 52
  s_add_u32 s76, s72, 0xc000
  buffer_load_dwordx4 v[92:95], v2, s[64:67], s76 offen sc1
  buffer_load_dwordx4 v[96:99], v2, s[64:67], s76 offen offset:128 sc1
  buffer_load_dwordx4 v[100:103], v2, s[64:67], s76 offen offset:256 sc1
  s_waitcnt vmcnt(12)
  s_waitcnt vmcnt(9)
  QK2 20, 32, 80, 226
  s_mov_b32 s76, 0x15c00
  LDT v, 20, 48
  s_mov_b32 s76, 0x16800
  LDT v, 32, 48
  v_add_f32 v226, v226, v227
  v_add_f32 v226, v226, v228
  v_add_f32 v229, v229, v230
  v_add_f32 v229, v229, v231
  v_add_f32_dpp v226, v226, v226 quad_perm:[1,0,3,2] row_mask:0xf bank_mask:0xf
  s_nop 0
  v_add_f32_dpp v229, v229, v229 quad_perm:[1,0,3,2] row_mask:0xf bank_mask:0xf
  v_add_f32_dpp v226, v226, v226 quad_perm:[2,3,0,1] row_mask:0xf bank_mask:0xf
  s_nop 0
  v_add_f32_dpp v229, v229, v229 quad_perm:[2,3,0,1] row_mask:0xf bank_mask:0xf
  v_add_f32_dpp v226, v226, v226 row_half_mirror row_mask:0xf bank_mask:0xf
  s_nop 0
  v_add_f32_dpp v229, v229, v229 row_half_mirror row_mask:0xf bank_mask:0xf
  v_max3_f32 v232, v128, v226, v229
  v_cmp_gt_f32 vcc, v232, v128
  s_cbranch_vccz Lsk393
  v_sub_f32 v234, v128, v232
  v_mul_f32 v234, s74, v234
  v_exp_f32 v234, v234
  v_mov_b32 v128, v232
  RESC 104, 234
  v_mul_f32 v129, v234, v129
Lsk393:
  v_mul_f32 v233, s74, v128
  v_fma_f32 v235, v226, s74, -v233
  v_fma_f32 v236, v229, s74, -v233
  v_exp_f32 v235, v235
  v_exp_f32 v236, v236
  v_cvt_pk_bf16_f32 v238, v235, 0
  v_cvt_pk_bf16_f32 v239, 0, v235
  v_cvt_pk_bf16_f32 v240, v236, 0
  v_cvt_pk_bf16_f32 v241, 0, v236
  v_add_f32 v129, v129, v239
  v_add_f32 v129, v129, v241
  s_waitcnt vmcnt(12)
  PV 8, 238, 104
  s_mov_b32 s76, 0x15c00
  LDT v, 8, 52
  s_waitcnt vmcnt(12)
  PV 44, 240, 104
  s_mov_b32 s76, 0x16800
  LDT v, 44, 52
  s_waitcnt vmcnt(9)
  s_waitcnt vmcnt(6)
  QK2 20, 32, 80, 226
  s_mov_b32 s76, 0x17400
  LDT v, 20, 48
  s_mov_b32 s76, 0x18000
  LDT v, 32, 48
  v_add_f32 v226, v226, v227
  v_add_f32 v226, v226, v228
  v_add_f32 v229, v229, v230
  v_add_f32 v229, v229, v231
  v_add_f32_dpp v226, v226, v226 quad_perm:[1,0,3,2] row_mask:0xf bank_mask:0xf
  s_nop 0
  v_add_f32_dpp v229, v229, v229 quad_perm:[1,0,3,2] row_mask:0xf bank_mask:0xf
  v_add_f32_dpp v226, v226, v226 quad_perm:[2,3,0,1] row_mask:0xf bank_mask:0xf
  s_nop 0
  v_add_f32_dpp v229, v229, v229 quad_perm:[2,3,0,1] row_mask:0xf bank_mask:0xf
  v_add_f32_dpp v226, v226, v226 row_half_mirror row_mask:0xf bank_mask:0xf
  s_nop 0
  v_add_f32_dpp v229, v229, v229 row_half_mirror row_mask:0xf bank_mask:0xf
  v_max3_f32 v232, v128, v226, v229
  v_cmp_gt_f32 vcc, v232, v128
  s_cbranch_vccz Lsk394
  v_sub_f32 v234, v128, v232
  v_mul_f32 v234, s74, v234
  v_exp_f32 v234, v234
  v_mov_b32 v128, v232
  RESC 104, 234
  v_mul_f32 v129, v234, v129
Lsk394:
  v_mul_f32 v233, s74, v128
  v_fma_f32 v235, v226, s74, -v233
  v_fma_f32 v236, v229, s74, -v233
  v_exp_f32 v235, v235
  v_exp_f32 v236, v236
  v_cvt_pk_bf16_f32 v238, v235, 0
  v_cvt_pk_bf16_f32 v239, 0, v235
  v_cvt_pk_bf16_f32 v240, v236, 0
  v_cvt_pk_bf16_f32 v241, 0, v236
  v_add_f32 v129, v129, v239
  v_add_f32 v129, v129, v241
  s_waitcnt vmcnt(9)
  PV 8, 238, 104
  s_mov_b32 s76, 0x17400
  LDT v, 8, 52
  s_waitcnt vmcnt(9)
  PV 44, 240, 104
  s_mov_b32 s76, 0x18000
  LDT v, 44, 52
  s_waitcnt vmcnt(9)
  s_waitcnt vmcnt(6)
  QK2 20, 32, 80, 226
  s_mov_b32 s76, 0xfc00
  LDT v, 20, 32
  s_mov_b32 s76, 0x10800
  LDT v, 32, 32
  v_add_f32 v226, v226, v227
  v_add_f32 v226, v226, v228
  v_add_f32 v229, v229, v230
  v_add_f32 v229, v229, v231
  v_add_f32_dpp v226, v226, v226 quad_perm:[1,0,3,2] row_mask:0xf bank_mask:0xf
  s_nop 0
  v_add_f32_dpp v229, v229, v229 quad_perm:[1,0,3,2] row_mask:0xf bank_mask:0xf
  v_add_f32_dpp v226, v226, v226 quad_perm:[2,3,0,1] row_mask:0xf bank_mask:0xf
  s_nop 0
  v_add_f32_dpp v229, v229, v229 quad_perm:[2,3,0,1] row_mask:0xf bank_mask:0xf
  v_add_f32_dpp v226, v226, v226 row_half_mirror row_mask:0xf bank_mask:0xf
  s_nop 0
  v_add_f32_dpp v229, v229, v229 row_half_mirror row_mask:0xf bank_mask:0xf
  v_max3_f32 v232, v128, v226, v229
  v_cmp_gt_f32 vcc, v232, v128
  s_cbranch_vccz Lsk395
  v_sub_f32 v234, v128, v232
  v_mul_f32 v234, s74, v234
  v_exp_f32 v234, v234
  v_mov_b32 v128, v232
  RESC 104, 234
  v_mul_f32 v129, v234, v129
Lsk395:
  v_mul_f32 v233, s74, v128
  v_fma_f32 v235, v226, s74, -v233
  v_fma_f32 v236, v229, s74, -v233
  v_exp_f32 v235, v235
  v_exp_f32 v236, v236
  v_cvt_pk_bf16_f32 v238, v235, 0
  v_cvt_pk_bf16_f32 v239, 0, v235
  v_cvt_pk_bf16_f32 v240, v236, 0
  v_cvt_pk_bf16_f32 v241, 0, v236
  v_add_f32 v129, v129, v239
  v_add_f32 v129, v129, v241
  s_waitcnt vmcnt(9)
  PV 8, 238, 104
  s_mov_b32 s76, 0xfc00
  LDT v, 8, 36
  s_waitcnt vmcnt(9)
  PV 44, 240, 104
  s_mov_b32 s76, 0x10800
  LDT v, 44, 36
  v_max_f32_dpp v226, v128, v128 row_ror:8 row_mask:0xf bank_mask:0xf
  v_mov_b32 v227, v226
  s_nop 1
  v_permlane16_swap_b32 v226, v227
  v_max_f32 v226, v226, v227
  v_mov_b32 v227, v226
  s_nop 1
  v_permlane32_swap_b32 v226, v227
  v_max_f32 v226, v226, v227
  v_sub_f32 v228, v128, v226
  v_mul_f32 v228, s74, v228
  v_exp_f32 v228, v228
  v_mul_f32 v226, s74, v226
  RESC 104, 228
  v_mul_f32 v129, v228, v129
  s_nop 1
  v_add_f32_dpp v129, v129, v129 row_ror:8 row_mask:0xf bank_mask:0xf
  v_mov_b32 v227, v129
  s_nop 1
  v_permlane16_swap_b32 v129, v227
  v_add_f32 v129, v129, v227
  v_mov_b32 v227, v129
  s_nop 1
  v_permlane32_swap_b32 v129, v227
  v_add_f32 v129, v129, v227
  v_permlane32_swap_b32 v104, v116
  v_permlane32_swap_b32 v105, v117
  v_permlane32_swap_b32 v106, v118
  v_permlane32_swap_b32 v107, v119
  v_permlane32_swap_b32 v108, v120
  v_permlane32_swap_b32 v109, v121
  v_permlane32_swap_b32 v110, v122
  v_permlane32_swap_b32 v111, v123
  v_permlane32_swap_b32 v112, v124
  v_permlane32_swap_b32 v113, v125
  v_permlane32_swap_b32 v114, v126
  v_permlane32_swap_b32 v115, v127
  v_add_f32 v104, v104, v116
  v_add_f32 v105, v105, v117
  v_add_f32 v106, v106, v118
  v_add_f32 v107, v107, v119
  v_add_f32 v108, v108, v120
  v_add_f32 v109, v109, v121
  v_add_f32 v110, v110, v122
  v_add_f32 v111, v111, v123
  v_add_f32 v112, v112, v124
  v_add_f32 v113, v113, v125
  v_add_f32 v114, v114, v126
  v_add_f32 v115, v115, v127
  v_permlane16_swap_b32 v104, v110
  v_permlane16_swap_b32 v105, v111
  v_permlane16_swap_b32 v106, v112
  v_permlane16_swap_b32 v107, v113
  v_permlane16_swap_b32 v108, v114
  v_permlane16_swap_b32 v109, v115
  v_add_f32 v104, v104, v110
  v_add_f32 v105, v105, v111
  v_add_f32 v106, v106, v112
  v_add_f32 v107, v107, v113
  v_add_f32 v108, v108, v114
  v_add_f32 v109, v109, v115
  v_add_f32_dpp v104, v104, v104 row_ror:8 row_mask:0xf bank_mask:0xf
  v_add_f32_dpp v105, v105, v105 row_ror:8 row_mask:0xf bank_mask:0xf
  v_add_f32_dpp v106, v106, v106 row_ror:8 row_mask:0xf bank_mask:0xf
  v_add_f32_dpp v107, v107, v107 row_ror:8 row_mask:0xf bank_mask:0xf
  v_add_f32_dpp v108, v108, v108 row_ror:8 row_mask:0xf bank_mask:0xf
  v_add_f32_dpp v109, v109, v109 row_ror:8 row_mask:0xf bank_mask:0xf
  v_add_u32 v229, 0, v7
  v_lshrrev_b32 v230, 3, v229
  v_and_b32 v229, 7, v229
  v_lshlrev_b32 v230, 6, v230
  v_add_u32 v229, v229, v230
  v_lshl_add_u32 v229, v229, 2, v4
  ds_write_b32 v229, v104
  v_add_u32 v229, 1, v7
  v_lshrrev_b32 v230, 3, v229
  v_and_b32 v229, 7, v229
  v_lshlrev_b32 v230, 6, v230
  v_add_u32 v229, v229, v230
  v_lshl_add_u32 v229, v229, 2, v4
  ds_write_b32 v229, v105
  v_add_u32 v229, 2, v7
  v_lshrrev_b32 v230, 3, v229
  v_and_b32 v229, 7, v229
  v_lshlrev_b32 v230, 6, v230
  v_add_u32 v229, v229, v230
  v_lshl_add_u32 v229, v229, 2, v4
  ds_write_b32 v229, v106
  v_add_u32 v229, 3, v7
  v_lshrrev_b32 v230, 3, v229
  v_and_b32 v229, 7, v229
  v_lshlrev_b32 v230, 6, v230
  v_add_u32 v229, v229, v230
  v_lshl_add_u32 v229, v229, 2, v4
  ds_write_b32 v229, v107
  v_add_u32 v229, 4, v7
  v_lshrrev_b32 v230, 3, v229
  v_and_b32 v229, 7, v229
  v_lshlrev_b32 v230, 6, v230
  v_add_u32 v229, v229, v230
  v_lshl_add_u32 v229, v229, 2, v4
  ds_write_b32 v229, v108
  v_add_u32 v229, 5, v7
  v_lshrrev_b32 v230, 3, v229
  v_and_b32 v229, 7, v229
  v_lshlrev_b32 v230, 6, v230
  v_add_u32 v229, v229, v230
  v_lshl_add_u32 v229, v229, 2, v4
  ds_write_b32 v229, v109
  v_mov_b32 v234, v226
  v_mov_b32 v235, v129
  v_mov_b32 v236, 0
  v_mov_b32 v237, 0
  v_and_b32 v229, 0xffffff1f, v4
  ds_write_b128 v229, v[234:237] offset:768
  s_waitcnt lgkmcnt(0)
  ds_read_b128 v[234:237], v5
  s_waitcnt lgkmcnt(0)
  s_add_u32 s76, s73, 0x1ddc00
  s_mov_b32 exec_lo, -1
  s_mov_b32 exec_hi, 0x1ffff
  buffer_store_dwordx4 v[234:237], v6, s[64:67], s76 offen sc1
  s_mov_b64 exec, -1
  v_max3_u32 v226, v92, v93, v94
  v_max3_u32 v226, v226, v95, v96
  v_max3_u32 v226, v226, v97, v98
  v_max3_u32 v226, v226, v99, v100
  v_max3_u32 v226, v226, v101, v102
  v_max3_u32 v226, v226, v103, v103
  v_cmp_eq_u32 vcc, -1, v226
  s_cbranch_vccz Lqo396
  s_mov_b32 s75, 0x61a80
Lqr397:
  s_sleep 2
  s_add_u32 s77, s72, 0xc000
  buffer_load_dwordx4 v[92:95], v2, s[64:67], s77 offen sc1
  buffer_load_dwordx4 v[96:99], v2, s[64:67], s77 offen offset:128 sc1
  buffer_load_dwordx4 v[100:103], v2, s[64:67], s77 offen offset:256 sc1
  s_waitcnt vmcnt(0)
  v_max3_u32 v226, v92, v93, v94
  v_max3_u32 v226, v226, v95, v96
  v_max3_u32 v226, v226, v97, v98
  v_max3_u32 v226, v226, v99, v100
  v_max3_u32 v226, v226, v101, v102
  v_max3_u32 v226, v226, v103, v103
  v_cmp_eq_u32 vcc, -1, v226
  s_cbranch_vccz Lqo396
  s_sub_u32 s75, s75, 1
  s_cmp_lg_u32 s75, 0
  s_cbranch_scc1 Lqr397
Lqo396:
  v_mov_b32 v80, v92
  v_mov_b32 v81, v93
  v_mov_b32 v82, v94
  v_mov_b32 v83, v95
  v_mov_b32 v84, v96
  v_mov_b32 v85, v97
  v_mov_b32 v86, v98
  v_mov_b32 v87, v99
  v_mov_b32 v88, v100
  v_mov_b32 v89, v101
  v_mov_b32 v90, v102
  v_mov_b32 v91, v103
  v_mov_b32 v104, 0
  v_mov_b32 v105, 0
  v_mov_b32 v106, 0
  v_mov_b32 v107, 0
  v_mov_b32 v108, 0
  v_mov_b32 v109, 0
  v_mov_b32 v110, 0
  v_mov_b32 v111, 0
  v_mov_b32 v112, 0
  v_mov_b32 v113, 0
  v_mov_b32 v114, 0
  v_mov_b32 v115, 0
  v_mov_b32 v116, 0
  v_mov_b32 v117, 0
  v_mov_b32 v118, 0
  v_mov_b32 v119, 0
  v_mov_b32 v120, 0
  v_mov_b32 v121, 0
  v_mov_b32 v122, 0
  v_mov_b32 v123, 0
  v_mov_b32 v124, 0
  v_mov_b32 v125, 0
  v_mov_b32 v126, 0
  v_mov_b32 v127, 0
  v_mov_b32 v128, 0xf149f2ca
  v_mov_b32 v129, 0
  s_waitcnt vmcnt(10)
  s_waitcnt vmcnt(7)
  QK2 20, 32, 80, 226
  s_mov_b32 s76, 0x11400
  LDT v, 20, 32
  s_mov_b32 s76, 0x12000
  LDT v, 32, 32
  v_add_f32 v226, v226, v227
  v_add_f32 v226, v226, v228
  v_add_f32 v229, v229, v230
  v_add_f32 v229, v229, v231
  v_add_f32_dpp v226, v226, v226 quad_perm:[1,0,3,2] row_mask:0xf bank_mask:0xf
  s_nop 0
  v_add_f32_dpp v229, v229, v229 quad_perm:[1,0,3,2] row_mask:0xf bank_mask:0xf
  v_add_f32_dpp v226, v226, v226 quad_perm:[2,3,0,1] row_mask:0xf bank_mask:0xf
  s_nop 0
  v_add_f32_dpp v229, v229, v229 quad_perm:[2,3,0,1] row_mask:0xf bank_mask:0xf
  v_add_f32_dpp v226, v226, v226 row_half_mirror row_mask:0xf bank_mask:0xf
  s_nop 0
  v_add_f32_dpp v229, v229, v229 row_half_mirror row_mask:0xf bank_mask:0xf
  v_max3_f32 v232, v128, v226, v229
  v_cmp_gt_f32 vcc, v232, v128
  s_cbranch_vccz Lsk398
  v_sub_f32 v234, v128, v232
  v_mul_f32 v234, s74, v234
  v_exp_f32 v234, v234
  v_mov_b32 v128, v232
  RESC 104, 234
  v_mul_f32 v129, v234, v129
Lsk398:
  v_mul_f32 v233, s74, v128
  v_fma_f32 v235, v226, s74, -v233
  v_fma_f32 v236, v229, s74, -v233
  v_exp_f32 v235, v235
  v_exp_f32 v236, v236
  v_cvt_pk_bf16_f32 v238, v235, 0
  v_cvt_pk_bf16_f32 v239, 0, v235
  v_cvt_pk_bf16_f32 v240, v236, 0
  v_cvt_pk_bf16_f32 v241, 0, v236
  v_add_f32 v129, v129, v239
  v_add_f32 v129, v129, v241
  s_waitcnt vmcnt(10)
  PV 8, 238, 104
  s_mov_b32 s76, 0x11400
  LDT v, 8, 36
  s_waitcnt vmcnt(10)
  PV 44, 240, 104
  s_mov_b32 s76, 0x12000
  LDT v, 44, 36
  s_waitcnt vmcnt(9)
  s_waitcnt vmcnt(6)
  QK2 20, 32, 80, 226
  s_mov_b32 s76, 0x6000
  LDT v, 20, 44
  s_mov_b32 s76, 0x6c00
  LDT v, 32, 44
  v_add_f32 v226, v226, v227
  v_add_f32 v226, v226, v228
  v_add_f32 v229, v229, v230
  v_add_f32 v229, v229, v231
  v_add_f32_dpp v226, v226, v226 quad_perm:[1,0,3,2] row_mask:0xf bank_mask:0xf
  s_nop 0
  v_add_f32_dpp v229, v229, v229 quad_perm:[1,0,3,2] row_mask:0xf bank_mask:0xf
  v_add_f32_dpp v226, v226, v226 quad_perm:[2,3,0,1] row_mask:0xf bank_mask:0xf
  s_nop 0
  v_add_f32_dpp v229, v229, v229 quad_perm:[2,3,0,1] row_mask:0xf bank_mask:0xf
  v_add_f32_dpp v226, v226, v226 row_half_mirror row_mask:0xf bank_mask:0xf
  s_nop 0
  v_add_f32_dpp v229, v229, v229 row_half_mirror row_mask:0xf bank_mask:0xf
  v_max3_f32 v232, v128, v226, v229
  v_cmp_gt_f32 vcc, v232, v128
  s_cbranch_vccz Lsk399
  v_sub_f32 v234, v128, v232
  v_mul_f32 v234, s74, v234
  v_exp_f32 v234, v234
  v_mov_b32 v128, v232
  RESC 104, 234
  v_mul_f32 v129, v234, v129
Lsk399:
  v_mul_f32 v233, s74, v128
  v_fma_f32 v235, v226, s74, -v233
  v_fma_f32 v236, v229, s74, -v233
  v_exp_f32 v235, v235
  v_exp_f32 v236, v236
  v_cvt_pk_bf16_f32 v238, v235, 0
  v_cvt_pk_bf16_f32 v239, 0, v235
  v_cvt_pk_bf16_f32 v240, v236, 0
  v_cvt_pk_bf16_f32 v241, 0, v236
  v_add_f32 v129, v129, v239
  v_add_f32 v129, v129, v241
  s_waitcnt vmcnt(9)
  PV 8, 238, 104
  s_mov_b32 s76, 0x7800
  LDT v, 8, 44
  s_waitcnt vmcnt(9)
  PV 44, 240, 104
  s_mov_b32 s76, 0x8400
  LDT v, 44, 44
  ACR 56, 0
  ACR 68, 12
  QK2 56, 68, 80, 226
  s_mov_b32 s76, 0
  LDT a, 0, 40
  s_mov_b32 s76, 0xc00
  LDT a, 12, 40
  v_add_f32 v226, v226, v227
  v_add_f32 v226, v226, v228
  v_add_f32 v229, v229, v230
  v_add_f32 v229, v229, v231
  v_add_f32_dpp v226, v226, v226 quad_perm:[1,0,3,2] row_mask:0xf bank_mask:0xf
  s_nop 0
  v_add_f32_dpp v229, v229, v229 quad_perm:[1,0,3,2] row_mask:0xf bank_mask:0xf
  v_add_f32_dpp v226, v226, v226 quad_perm:[2,3,0,1] row_mask:0xf bank_mask:0xf
  s_nop 0
  v_add_f32_dpp v229, v229, v229 quad_perm:[2,3,0,1] row_mask:0xf bank_mask:0xf
  v_add_f32_dpp v226, v226, v226 row_half_mirror row_mask:0xf bank_mask:0xf
  s_nop 0
  v_add_f32_dpp v229, v229, v229 row_half_mirror row_mask:0xf bank_mask:0xf
  v_max3_f32 v232, v128, v226, v229
  v_cmp_gt_f32 vcc, v232, v128
  s_cbranch_vccz Lsk400
  v_sub_f32 v234, v128, v232
  v_mul_f32 v234, s74, v234
  v_exp_f32 v234, v234
  v_mov_b32 v128, v232
  RESC 104, 234
  v_mul_f32 v129, v234, v129
Lsk400:
  v_mul_f32 v233, s74, v128
  v_fma_f32 v235, v226, s74, -v233
  v_fma_f32 v236, v229, s74, -v233
  v_exp_f32 v235, v235
  v_exp_f32 v236, v236
  v_cvt_pk_bf16_f32 v238, v235, 0
  v_cvt_pk_bf16_f32 v239, 0, v235
  v_cvt_pk_bf16_f32 v240, v236, 0
  v_cvt_pk_bf16_f32 v241, 0, v236
  v_add_f32 v129, v129, v239
  v_add_f32 v129, v129, v241
  PV 130, 238, 104
  s_mov_b32 s76, 0
  LDT v, 130, 44
  PV 142, 240, 104
  s_mov_b32 s76, 0xc00
  LDT v, 142, 44
  ACR 56, 24
  ACR 68, 36
  QK2 56, 68, 80, 226
  s_mov_b32 s76, 0x1800
  LDT a, 24, 40
  s_mov_b32 s76, 0x2400
  LDT a, 36, 40
  v_add_f32 v226, v226, v227
  v_add_f32 v226, v226, v228
  v_add_f32 v229, v229, v230
  v_add_f32 v229, v229, v231
  v_add_f32_dpp v226, v226, v226 quad_perm:[1,0,3,2] row_mask:0xf bank_mask:0xf
  s_nop 0
  v_add_f32_dpp v229, v229, v229 quad_perm:[1,0,3,2] row_mask:0xf bank_mask:0xf
  v_add_f32_dpp v226, v226, v226 quad_perm:[2,3,0,1] row_mask:0xf bank_mask:0xf
  s_nop 0
  v_add_f32_dpp v229, v229, v229 quad_perm:[2,3,0,1] row_mask:0xf bank_mask:0xf
  v_add_f32_dpp v226, v226, v226 row_half_mirror row_mask:0xf bank_mask:0xf
  s_nop 0
  v_add_f32_dpp v229, v229, v229 row_half_mirror row_mask:0xf bank_mask:0xf
  v_max3_f32 v232, v128, v226, v229
  v_cmp_gt_f32 vcc, v232, v128
  s_cbranch_vccz Lsk401
  v_sub_f32 v234, v128, v232
  v_mul_f32 v234, s74, v234
  v_exp_f32 v234, v234
  v_mov_b32 v128, v232
  RESC 104, 234
  v_mul_f32 v129, v234, v129
Lsk401:
  v_mul_f32 v233, s74, v128
  v_fma_f32 v235, v226, s74, -v233
  v_fma_f32 v236, v229, s74, -v233
  v_exp_f32 v235, v235
  v_exp_f32 v236, v236
  v_cvt_pk_bf16_f32 v238, v235, 0
  v_cvt_pk_bf16_f32 v239, 0, v235
  v_cvt_pk_bf16_f32 v240, v236, 0
  v_cvt_pk_bf16_f32 v241, 0, v236
  v_add_f32 v129, v129, v239
  v_add_f32 v129, v129, v241
  PV 154, 238, 104
  s_mov_b32 s76, 0x1800
  LDT v, 154, 44
  PV 166, 240, 104
  s_mov_b32 s76, 0x2400
  LDT v, 166, 44
  ACR 56, 48
  ACR 68, 60
  QK2 56, 68, 80, 226
  s_mov_b32 s76, 0x3000
  LDT a, 48, 40
  s_mov_b32 s76, 0x3c00
  LDT a, 60, 40
  v_add_f32 v226, v226, v227
  v_add_f32 v226, v226, v228
  v_add_f32 v229, v229, v230
  v_add_f32 v229, v229, v231
  v_add_f32_dpp v226, v226, v226 quad_perm:[1,0,3,2] row_mask:0xf bank_mask:0xf
  s_nop 0
  v_add_f32_dpp v229, v229, v229 quad_perm:[1,0,3,2] row_mask:0xf bank_mask:0xf
  v_add_f32_dpp v226, v226, v226 quad_perm:[2,3,0,1] row_mask:0xf bank_mask:0xf
  s_nop 0
  v_add_f32_dpp v229, v229, v229 quad_perm:[2,3,0,1] row_mask:0xf bank_mask:0xf
  v_add_f32_dpp v226, v226, v226 row_half_mirror row_mask:0xf bank_mask:0xf
  s_nop 0
  v_add_f32_dpp v229, v229, v229 row_half_mirror row_mask:0xf bank_mask:0xf
  v_max3_f32 v232, v128, v226, v229
  v_cmp_gt_f32 vcc, v232, v128
  s_cbranch_vccz Lsk402
  v_sub_f32 v234, v128, v232
  v_mul_f32 v234, s74, v234
  v_exp_f32 v234, v234
  v_mov_b32 v128, v232
  RESC 104, 234
  v_mul_f32 v129, v234, v129
Lsk402:
  v_mul_f32 v233, s74, v128
  v_fma_f32 v235, v226, s74, -v233
  v_fma_f32 v236, v229, s74, -v233
  v_exp_f32 v235, v235
  v_exp_f32 v236, v236
  v_cvt_pk_bf16_f32 v238, v235, 0
  v_cvt_pk_bf16_f32 v239, 0, v235
  v_cvt_pk_bf16_f32 v240, v236, 0
  v_cvt_pk_bf16_f32 v241, 0, v236
  v_add_f32 v129, v129, v239
  v_add_f32 v129, v129, v241
  PV 178, 238, 104
  s_mov_b32 s76, 0x3000
  LDT v, 178, 44
  PV 190, 240, 104
  s_mov_b32 s76, 0x3c00
  LDT v, 190, 44
  ACR 56, 72
  ACR 68, 84
  QK2 56, 68, 80, 226
  s_mov_b32 s76, 0x4800
  LDT a, 72, 40
  v_add_f32 v226, v226, v227
  v_add_f32 v226, v226, v228
  v_add_f32 v229, v229, v230
  v_add_f32 v229, v229, v231
  v_add_f32_dpp v226, v226, v226 quad_perm:[1,0,3,2] row_mask:0xf bank_mask:0xf
  s_nop 0
  v_add_f32_dpp v229, v229, v229 quad_perm:[1,0,3,2] row_mask:0xf bank_mask:0xf
  v_add_f32_dpp v226, v226, v226 quad_perm:[2,3,0,1] row_mask:0xf bank_mask:0xf
  s_nop 0
  v_add_f32_dpp v229, v229, v229 quad_perm:[2,3,0,1] row_mask:0xf bank_mask:0xf
  v_add_f32_dpp v226, v226, v226 row_half_mirror row_mask:0xf bank_mask:0xf
  s_nop 0
  v_add_f32_dpp v229, v229, v229 row_half_mirror row_mask:0xf bank_mask:0xf
  v_max3_f32 v232, v128, v226, v229
  v_cmp_gt_f32 vcc, v232, v128
  s_cbranch_vccz Lsk403
  v_sub_f32 v234, v128, v232
  v_mul_f32 v234, s74, v234
  v_exp_f32 v234, v234
  v_mov_b32 v128, v232
  RESC 104, 234
  v_mul_f32 v129, v234, v129
Lsk403:
  v_mul_f32 v233, s74, v128
  v_fma_f32 v235, v226, s74, -v233
  v_fma_f32 v236, v229, s74, -v233
  v_exp_f32 v235, v235
  v_exp_f32 v236, v236
  v_cvt_pk_bf16_f32 v238, v235, 0
  v_cvt_pk_bf16_f32 v239, 0, v235
  v_cvt_pk_bf16_f32 v240, v236, 0
  v_cvt_pk_bf16_f32 v241, 0, v236
  v_add_f32 v129, v129, v239
  v_add_f32 v129, v129, v241
  PV 202, 238, 104
  PV 214, 240, 104
  ACR 56, 96
  ACR 68, 108
  QK2 56, 68, 80, 226
  ds_read_b128 v[56:59], v3 offset:0
  ds_read_b128 v[60:63], v3 offset:1024
  ds_read_b128 v[64:67], v3 offset:2048
  ds_read_b128 v[68:71], v3 offset:3072
  ds_read_b128 v[72:75], v3 offset:4096
  ds_read_b128 v[76:79], v3 offset:5120
  v_add_f32 v226, v226, v227
  v_add_f32 v226, v226, v228
  v_add_f32 v229, v229, v230
  v_add_f32 v229, v229, v231
  v_add_f32_dpp v226, v226, v226 quad_perm:[1,0,3,2] row_mask:0xf bank_mask:0xf
  s_nop 0
  v_add_f32_dpp v229, v229, v229 quad_perm:[1,0,3,2] row_mask:0xf bank_mask:0xf
  v_add_f32_dpp v226, v226, v226 quad_perm:[2,3,0,1] row_mask:0xf bank_mask:0xf
  s_nop 0
  v_add_f32_dpp v229, v229, v229 quad_perm:[2,3,0,1] row_mask:0xf bank_mask:0xf
  v_add_f32_dpp v226, v226, v226 row_half_mirror row_mask:0xf bank_mask:0xf
  s_nop 0
  v_add_f32_dpp v229, v229, v229 row_half_mirror row_mask:0xf bank_mask:0xf
  v_max3_f32 v232, v128, v226, v229
  v_cmp_gt_f32 vcc, v232, v128
  s_cbranch_vccz Lsk404
  v_sub_f32 v234, v128, v232
  v_mul_f32 v234, s74, v234
  v_exp_f32 v234, v234
  v_mov_b32 v128, v232
  RESC 104, 234
  v_mul_f32 v129, v234, v129
Lsk404:
  v_mul_f32 v233, s74, v128
  v_fma_f32 v235, v226, s74, -v233
  v_fma_f32 v236, v229, s74, -v233
  v_exp_f32 v235, v235
  v_exp_f32 v236, v236
  v_cvt_pk_bf16_f32 v238, v235, 0
  v_cvt_pk_bf16_f32 v239, 0, v235
  v_cvt_pk_bf16_f32 v240, v236, 0
  v_cvt_pk_bf16_f32 v241, 0, v236
  v_add_f32 v129, v129, v239
  v_add_f32 v129, v129, v241
  s_waitcnt lgkmcnt(3)
  PV 56, 238, 104
  s_waitcnt lgkmcnt(0)
  PV 68, 240, 104
  ACR 56, 120
  ACR 68, 132
  QK2 56, 68, 80, 226
  ds_read_b128 v[56:59], v3 offset:6144
  ds_read_b128 v[60:63], v3 offset:7168
  ds_read_b128 v[64:67], v3 offset:8192
  ds_read_b128 v[68:71], v3 offset:9216
  ds_read_b128 v[72:75], v3 offset:10240
  ds_read_b128 v[76:79], v3 offset:11264
  v_add_f32 v226, v226, v227
  v_add_f32 v226, v226, v228
  v_add_f32 v229, v229, v230
  v_add_f32 v229, v229, v231
  v_add_f32_dpp v226, v226, v226 quad_perm:[1,0,3,2] row_mask:0xf bank_mask:0xf
  s_nop 0
  v_add_f32_dpp v229, v229, v229 quad_perm:[1,0,3,2] row_mask:0xf bank_mask:0xf
  v_add_f32_dpp v226, v226, v226 quad_perm:[2,3,0,1] row_mask:0xf bank_mask:0xf
  s_nop 0
  v_add_f32_dpp v229, v229, v229 quad_perm:[2,3,0,1] row_mask:0xf bank_mask:0xf
  v_add_f32_dpp v226, v226, v226 row_half_mirror row_mask:0xf bank_mask:0xf
  s_nop 0
  v_add_f32_dpp v229, v229, v229 row_half_mirror row_mask:0xf bank_mask:0xf
  v_max3_f32 v232, v128, v226, v229
  v_cmp_gt_f32 vcc, v232, v128
  s_cbranch_vccz Lsk405
  v_sub_f32 v234, v128, v232
  v_mul_f32 v234, s74, v234
  v_exp_f32 v234, v234
  v_mov_b32 v128, v232
  RESC 104, 234
  v_mul_f32 v129, v234, v129
Lsk405:
  v_mul_f32 v233, s74, v128
  v_fma_f32 v235, v226, s74, -v233
  v_fma_f32 v236, v229, s74, -v233
  v_exp_f32 v235, v235
  v_exp_f32 v236, v236
  v_cvt_pk_bf16_f32 v238, v235, 0
  v_cvt_pk_bf16_f32 v239, 0, v235
  v_cvt_pk_bf16_f32 v240, v236, 0
  v_cvt_pk_bf16_f32 v241, 0, v236
  v_add_f32 v129, v129, v239
  v_add_f32 v129, v129, v241
  s_waitcnt lgkmcnt(3)
  PV 56, 238, 104
  s_waitcnt lgkmcnt(0)
  PV 68, 240, 104
  s_waitcnt vmcnt(45)
  s_mov_b32 s76, 0x5400
  LDT a, 84, 40
  s_mov_b32 s76, 0x4800
  LDT v, 202, 44
  ACR 56, 144
  ACR 68, 156
  QK2 56, 68, 80, 226
  ds_read_b128 v[56:59], v3 offset:12288
  ds_read_b128 v[60:63], v3 offset:13312
  ds_read_b128 v[64:67], v3 offset:14336
  ds_read_b128 v[68:71], v3 offset:15360
  ds_read_b128 v[72:75], v3 offset:16384
  ds_read_b128 v[76:79], v3 offset:17408
  v_add_f32 v226, v226, v227
  v_add_f32 v226, v226, v228
  v_add_f32 v229, v229, v230
  v_add_f32 v229, v229, v231
  v_add_f32_dpp v226, v226, v226 quad_perm:[1,0,3,2] row_mask:0xf bank_mask:0xf
  s_nop 0
  v_add_f32_dpp v229, v229, v229 quad_perm:[1,0,3,2] row_mask:0xf bank_mask:0xf
  v_add_f32_dpp v226, v226, v226 quad_perm:[2,3,0,1] row_mask:0xf bank_mask:0xf
  s_nop 0
  v_add_f32_dpp v229, v229, v229 quad_perm:[2,3,0,1] row_mask:0xf bank_mask:0xf
  v_add_f32_dpp v226, v226, v226 row_half_mirror row_mask:0xf bank_mask:0xf
  s_nop 0
  v_add_f32_dpp v229, v229, v229 row_half_mirror row_mask:0xf bank_mask:0xf
  v_max3_f32 v232, v128, v226, v229
  v_cmp_gt_f32 vcc, v232, v128
  s_cbranch_vccz Lsk406
  v_sub_f32 v234, v128, v232
  v_mul_f32 v234, s74, v234
  v_exp_f32 v234, v234
  v_mov_b32 v128, v232
  RESC 104, 234
  v_mul_f32 v129, v234, v129
Lsk406:
  v_mul_f32 v233, s74, v128
  v_fma_f32 v235, v226, s74, -v233
  v_fma_f32 v236, v229, s74, -v233
  v_exp_f32 v235, v235
  v_exp_f32 v236, v236
  v_cvt_pk_bf16_f32 v238, v235, 0
  v_cvt_pk_bf16_f32 v239, 0, v235
  v_cvt_pk_bf16_f32 v240, v236, 0
  v_cvt_pk_bf16_f32 v241, 0, v236
  v_add_f32 v129, v129, v239
  v_add_f32 v129, v129, v241
  s_waitcnt lgkmcnt(3)
  PV 56, 238, 104
  s_waitcnt lgkmcnt(0)
  PV 68, 240, 104
  s_waitcnt vmcnt(45)
  s_mov_b32 s76, 0x5400
  LDT v, 214, 44
  s_mov_b32 s76, 0x6000
  LDT a, 96, 40
  ACR 56, 168
  ACR 68, 180
  QK2 56, 68, 80, 226
  ds_read_b128 v[56:59], v3 offset:18432
  ds_read_b128 v[60:63], v3 offset:19456
  ds_read_b128 v[64:67], v3 offset:20480
  ds_read_b128 v[68:71], v3 offset:21504
  ds_read_b128 v[72:75], v3 offset:22528
  ds_read_b128 v[76:79], v3 offset:23552
  v_add_f32 v226, v226, v227
  v_add_f32 v226, v226, v228
  v_add_f32 v229, v229, v230
  v_add_f32 v229, v229, v231
  v_add_f32_dpp v226, v226, v226 quad_perm:[1,0,3,2] row_mask:0xf bank_mask:0xf
  s_nop 0
  v_add_f32_dpp v229, v229, v229 quad_perm:[1,0,3,2] row_mask:0xf bank_mask:0xf
  v_add_f32_dpp v226, v226, v226 quad_perm:[2,3,0,1] row_mask:0xf bank_mask:0xf
  s_nop 0
  v_add_f32_dpp v229, v229, v229 quad_perm:[2,3,0,1] row_mask:0xf bank_mask:0xf
  v_add_f32_dpp v226, v226, v226 row_half_mirror row_mask:0xf bank_mask:0xf
  s_nop 0
  v_add_f32_dpp v229, v229, v229 row_half_mirror row_mask:0xf bank_mask:0xf
  v_max3_f32 v232, v128, v226, v229
  v_cmp_gt_f32 vcc, v232, v128
  s_cbranch_vccz Lsk407
  v_sub_f32 v234, v128, v232
  v_mul_f32 v234, s74, v234
  v_exp_f32 v234, v234
  v_mov_b32 v128, v232
  RESC 104, 234
  v_mul_f32 v129, v234, v129
Lsk407:
  v_mul_f32 v233, s74, v128
  v_fma_f32 v235, v226, s74, -v233
  v_fma_f32 v236, v229, s74, -v233
  v_exp_f32 v235, v235
  v_exp_f32 v236, v236
  v_cvt_pk_bf16_f32 v238, v235, 0
  v_cvt_pk_bf16_f32 v239, 0, v235
  v_cvt_pk_bf16_f32 v240, v236, 0
  v_cvt_pk_bf16_f32 v241, 0, v236
  v_add_f32 v129, v129, v239
  v_add_f32 v129, v129, v241
  s_waitcnt lgkmcnt(3)
  PV 56, 238, 104
  s_waitcnt lgkmcnt(0)
  PV 68, 240, 104
  s_waitcnt vmcnt(45)
  s_mov_b32 s76, 0x6c00
  LDT a, 108, 40
  s_mov_b32 s76, 0x7800
  LDT a, 120, 40
  s_add_u32 s76, s72, 0x3000
  buffer_load_dwordx4 v[92:95], v2, s[64:67], s76 offen sc1
  buffer_load_dwordx4 v[96:99], v2, s[64:67], s76 offen offset:128 sc1
  buffer_load_dwordx4 v[100:103], v2, s[64:67], s76 offen offset:256 sc1
  ACR 56, 192
  ACR 68, 204
  QK2 56, 68, 80, 226
  ds_read_b128 v[56:59], v3 offset:24576
  ds_read_b128 v[60:63], v3 offset:25600
  ds_read_b128 v[64:67], v3 offset:26624
  ds_read_b128 v[68:71], v3 offset:27648
  ds_read_b128 v[72:75], v3 offset:28672
  ds_read_b128 v[76:79], v3 offset:29696
  v_add_f32 v226, v226, v227
  v_add_f32 v226, v226, v228
  v_add_f32 v229, v229, v230
  v_add_f32 v229, v229, v231
  v_add_f32_dpp v226, v226, v226 quad_perm:[1,0,3,2] row_mask:0xf bank_mask:0xf
  s_nop 0
  v_add_f32_dpp v229, v229, v229 quad_perm:[1,0,3,2] row_mask:0xf bank_mask:0xf
  v_add_f32_dpp v226, v226, v226 quad_perm:[2,3,0,1] row_mask:0xf bank_mask:0xf
  s_nop 0
  v_add_f32_dpp v229, v229, v229 quad_perm:[2,3,0,1] row_mask:0xf bank_mask:0xf
  v_add_f32_dpp v226, v226, v226 row_half_mirror row_mask:0xf bank_mask:0xf
  s_nop 0
  v_add_f32_dpp v229, v229, v229 row_half_mirror row_mask:0xf bank_mask:0xf
  v_max3_f32 v232, v128, v226, v229
  v_cmp_gt_f32 vcc, v232, v128
  s_cbranch_vccz Lsk408
  v_sub_f32 v234, v128, v232
  v_mul_f32 v234, s74, v234
  v_exp_f32 v234, v234
  v_mov_b32 v128, v232
  RESC 104, 234
  v_mul_f32 v129, v234, v129
Lsk408:
  v_mul_f32 v233, s74, v128
  v_fma_f32 v235, v226, s74, -v233
  v_fma_f32 v236, v229, s74, -v233
  v_exp_f32 v235, v235
  v_exp_f32 v236, v236
  v_cvt_pk_bf16_f32 v238, v235, 0
  v_cvt_pk_bf16_f32 v239, 0, v235
  v_cvt_pk_bf16_f32 v240, v236, 0
  v_cvt_pk_bf16_f32 v241, 0, v236
  v_add_f32 v129, v129, v239
  v_add_f32 v129, v129, v241
  s_waitcnt lgkmcnt(3)
  PV 56, 238, 104
  s_waitcnt lgkmcnt(0)
  PV 68, 240, 104
  s_waitcnt vmcnt(48)
  s_mov_b32 s76, 0x8400
  LDT a, 132, 40
  ACR 56, 216
  ACR 68, 228
  QK2 56, 68, 80, 226
  ds_read_b128 v[56:59], v3 offset:30720
  ds_read_b128 v[60:63], v3 offset:31744
  ds_read_b128 v[64:67], v3 offset:32768
  ds_read_b128 v[68:71], v3 offset:33792
  ds_read_b128 v[72:75], v3 offset:34816
  ds_read_b128 v[76:79], v3 offset:35840
  v_add_f32 v226, v226, v227
  v_add_f32 v226, v226, v228
  v_add_f32 v229, v229, v230
  v_add_f32 v229, v229, v231
  v_add_f32_dpp v226, v226, v226 quad_perm:[1,0,3,2] row_mask:0xf bank_mask:0xf
  s_nop 0
  v_add_f32_dpp v229, v229, v229 quad_perm:[1,0,3,2] row_mask:0xf bank_mask:0xf
  v_add_f32_dpp v226, v226, v226 quad_perm:[2,3,0,1] row_mask:0xf bank_mask:0xf
  s_nop 0
  v_add_f32_dpp v229, v229, v229 quad_perm:[2,3,0,1] row_mask:0xf bank_mask:0xf
  v_add_f32_dpp v226, v226, v226 row_half_mirror row_mask:0xf bank_mask:0xf
  s_nop 0
  v_add_f32_dpp v229, v229, v229 row_half_mirror row_mask:0xf bank_mask:0xf
  v_max3_f32 v232, v128, v226, v229
  v_cmp_gt_f32 vcc, v232, v128
  s_cbranch_vccz Lsk409
  v_sub_f32 v234, v128, v232
  v_mul_f32 v234, s74, v234
  v_exp_f32 v234, v234
  v_mov_b32 v128, v232
  RESC 104, 234
  v_mul_f32 v129, v234, v129
Lsk409:
  v_mul_f32 v233, s74, v128
  v_fma_f32 v235, v226, s74, -v233
  v_fma_f32 v236, v229, s74, -v233
  v_exp_f32 v235, v235
  v_exp_f32 v236, v236
  v_cvt_pk_bf16_f32 v238, v235, 0
  v_cvt_pk_bf16_f32 v239, 0, v235
  v_cvt_pk_bf16_f32 v240, v236, 0
  v_cvt_pk_bf16_f32 v241, 0, v236
  v_add_f32 v129, v129, v239
  v_add_f32 v129, v129, v241
  s_waitcnt lgkmcnt(3)
  PV 56, 238, 104
  s_waitcnt lgkmcnt(0)
  PV 68, 240, 104
  s_waitcnt vmcnt(45)
  s_mov_b32 s76, 0x9000
  LDT a, 144, 40
  s_mov_b32 s76, 0x9c00
  LDT a, 156, 40
  ACR 56, 240
  v_dot2_f32_bf16 v226, v56, v80, 0
  v_dot2_f32_bf16 v227, v60, v84, 0
  v_dot2_f32_bf16 v228, v64, v88, 0
  s_nop 0
  v_dot2c_f32_bf16 v226, v57, v81
  v_dot2c_f32_bf16 v227, v61, v85
  v_dot2c_f32_bf16 v228, v65, v89
  v_dot2c_f32_bf16 v226, v58, v82
  v_dot2c_f32_bf16 v227, v62, v86
  v_dot2c_f32_bf16 v228, v66, v90
  v_dot2c_f32_bf16 v226, v59, v83
  v_dot2c_f32_bf16 v227, v63, v87
  v_dot2c_f32_bf16 v228, v67, v91
  ds_read_b128 v[56:59], v3 offset:36864
  ds_read_b128 v[60:63], v3 offset:37888
  ds_read_b128 v[64:67], v3 offset:38912
  v_add_f32 v226, v226, v227
  v_add_f32 v226, v226, v228
  s_nop 1
  v_add_f32_dpp v226, v226, v226 quad_perm:[1,0,3,2] row_mask:0xf bank_mask:0xf
  s_nop 1
  v_add_f32_dpp v226, v226, v226 quad_perm:[2,3,0,1] row_mask:0xf bank_mask:0xf
  s_nop 1
  v_add_f32_dpp v226, v226, v226 row_half_mirror row_mask:0xf bank_mask:0xf
  v_max_f32 v232, v128, v226
  v_cmp_gt_f32 vcc, v232, v128
  s_cbranch_vccz Lsk410
  v_sub_f32 v234, v128, v232
  v_mul_f32 v234, s74, v234
  v_exp_f32 v234, v234
  v_mov_b32 v128, v232
  RESC 104, 234
  v_mul_f32 v129, v234, v129
Lsk410:
  v_mul_f32 v233, s74, v128
  v_fma_f32 v235, v226, s74, -v233
  v_exp_f32 v235, v235
  s_nop 0
  v_cvt_pk_bf16_f32 v238, v235, 0
  v_cvt_pk_bf16_f32 v239, 0, v235
  v_add_f32 v129, v129, v239
  s_waitcnt lgkmcnt(0)
  PV 56, 238, 104
  s_waitcnt vmcnt(45)
  s_mov_b32 s76, 0xa800
  LDT a, 168, 40
  s_mov_b32 s76, 0xb400
  LDT a, 180, 40
  v_max_f32_dpp v226, v128, v128 row_ror:8 row_mask:0xf bank_mask:0xf
  v_mov_b32 v227, v226
  s_nop 1
  v_permlane16_swap_b32 v226, v227
  v_max_f32 v226, v226, v227
  v_mov_b32 v227, v226
  s_nop 1
  v_permlane32_swap_b32 v226, v227
  v_max_f32 v226, v226, v227
  v_sub_f32 v228, v128, v226
  v_mul_f32 v228, s74, v228
  v_exp_f32 v228, v228
  v_mul_f32 v226, s74, v226
  RESC 104, 228
  v_mul_f32 v129, v228, v129
  s_nop 1
  v_add_f32_dpp v129, v129, v129 row_ror:8 row_mask:0xf bank_mask:0xf
  v_mov_b32 v227, v129
  s_nop 1
  v_permlane16_swap_b32 v129, v227
  v_add_f32 v129, v129, v227
  v_mov_b32 v227, v129
  s_nop 1
  v_permlane32_swap_b32 v129, v227
  v_add_f32 v129, v129, v227
  v_permlane32_swap_b32 v104, v116
  v_permlane32_swap_b32 v105, v117
  v_permlane32_swap_b32 v106, v118
  v_permlane32_swap_b32 v107, v119
  v_permlane32_swap_b32 v108, v120
  v_permlane32_swap_b32 v109, v121
  v_permlane32_swap_b32 v110, v122
  v_permlane32_swap_b32 v111, v123
  v_permlane32_swap_b32 v112, v124
  v_permlane32_swap_b32 v113, v125
  v_permlane32_swap_b32 v114, v126
  v_permlane32_swap_b32 v115, v127
  v_add_f32 v104, v104, v116
  v_add_f32 v105, v105, v117
  v_add_f32 v106, v106, v118
  v_add_f32 v107, v107, v119
  v_add_f32 v108, v108, v120
  v_add_f32 v109, v109, v121
  v_add_f32 v110, v110, v122
  v_add_f32 v111, v111, v123
  v_add_f32 v112, v112, v124
  v_add_f32 v113, v113, v125
  v_add_f32 v114, v114, v126
  v_add_f32 v115, v115, v127
  v_permlane16_swap_b32 v104, v110
  v_permlane16_swap_b32 v105, v111
  v_permlane16_swap_b32 v106, v112
  v_permlane16_swap_b32 v107, v113
  v_permlane16_swap_b32 v108, v114
  v_permlane16_swap_b32 v109, v115
  v_add_f32 v104, v104, v110
  v_add_f32 v105, v105, v111
  v_add_f32 v106, v106, v112
  v_add_f32 v107, v107, v113
  v_add_f32 v108, v108, v114
  v_add_f32 v109, v109, v115
  v_add_f32_dpp v104, v104, v104 row_ror:8 row_mask:0xf bank_mask:0xf
  v_add_f32_dpp v105, v105, v105 row_ror:8 row_mask:0xf bank_mask:0xf
  v_add_f32_dpp v106, v106, v106 row_ror:8 row_mask:0xf bank_mask:0xf
  v_add_f32_dpp v107, v107, v107 row_ror:8 row_mask:0xf bank_mask:0xf
  v_add_f32_dpp v108, v108, v108 row_ror:8 row_mask:0xf bank_mask:0xf
  v_add_f32_dpp v109, v109, v109 row_ror:8 row_mask:0xf bank_mask:0xf
  v_add_u32 v229, 0, v7
  v_lshrrev_b32 v230, 3, v229
  v_and_b32 v229, 7, v229
  v_lshlrev_b32 v230, 6, v230
  v_add_u32 v229, v229, v230
  v_lshl_add_u32 v229, v229, 2, v4
  ds_write_b32 v229, v104
  v_add_u32 v229, 1, v7
  v_lshrrev_b32 v230, 3, v229
  v_and_b32 v229, 7, v229
  v_lshlrev_b32 v230, 6, v230
  v_add_u32 v229, v229, v230
  v_lshl_add_u32 v229, v229, 2, v4
  ds_write_b32 v229, v105
  v_add_u32 v229, 2, v7
  v_lshrrev_b32 v230, 3, v229
  v_and_b32 v229, 7, v229
  v_lshlrev_b32 v230, 6, v230
  v_add_u32 v229, v229, v230
  v_lshl_add_u32 v229, v229, 2, v4
  ds_write_b32 v229, v106
  v_add_u32 v229, 3, v7
  v_lshrrev_b32 v230, 3, v229
  v_and_b32 v229, 7, v229
  v_lshlrev_b32 v230, 6, v230
  v_add_u32 v229, v229, v230
  v_lshl_add_u32 v229, v229, 2, v4
  ds_write_b32 v229, v107
  v_add_u32 v229, 4, v7
  v_lshrrev_b32 v230, 3, v229
  v_and_b32 v229, 7, v229
  v_lshlrev_b32 v230, 6, v230
  v_add_u32 v229, v229, v230
  v_lshl_add_u32 v229, v229, 2, v4
  ds_write_b32 v229, v108
  v_add_u32 v229, 5, v7
  v_lshrrev_b32 v230, 3, v229
  v_and_b32 v229, 7, v229
  v_lshlrev_b32 v230, 6, v230
  v_add_u32 v229, v229, v230
  v_lshl_add_u32 v229, v229, 2, v4
  ds_write_b32 v229, v109
  v_mov_b32 v234, v226
  v_mov_b32 v235, v129
  v_mov_b32 v236, 0
  v_mov_b32 v237, 0
  v_and_b32 v229, 0xffffff1f, v4
  ds_write_b128 v229, v[234:237] offset:768
  s_waitcnt lgkmcnt(0)
  ds_read_b128 v[234:237], v5
  s_waitcnt lgkmcnt(0)
  s_add_u32 s76, s73, 0x27d000
  s_mov_b32 exec_lo, -1
  s_mov_b32 exec_hi, 0x1ffff
  buffer_store_dwordx4 v[234:237], v6, s[64:67], s76 offen sc1
  s_mov_b64 exec, -1
  s_waitcnt vmcnt(16)
  v_max3_u32 v226, v92, v93, v94
  v_max3_u32 v226, v226, v95, v96
  v_max3_u32 v226, v226, v97, v98
  v_max3_u32 v226, v226, v99, v100
  v_max3_u32 v226, v226, v101, v102
  v_max3_u32 v226, v226, v103, v103
  v_cmp_eq_u32 vcc, -1, v226
  s_cbranch_vccz Lqo411
  s_mov_b32 s75, 0x61a80
Lqr412:
  s_sleep 2
  s_add_u32 s77, s72, 0x3000
  buffer_load_dwordx4 v[92:95], v2, s[64:67], s77 offen sc1
  buffer_load_dwordx4 v[96:99], v2, s[64:67], s77 offen offset:128 sc1
  buffer_load_dwordx4 v[100:103], v2, s[64:67], s77 offen offset:256 sc1
  s_waitcnt vmcnt(0)
  v_max3_u32 v226, v92, v93, v94
  v_max3_u32 v226, v226, v95, v96
  v_max3_u32 v226, v226, v97, v98
  v_max3_u32 v226, v226, v99, v100
  v_max3_u32 v226, v226, v101, v102
  v_max3_u32 v226, v226, v103, v103
  v_cmp_eq_u32 vcc, -1, v226
  s_cbranch_vccz Lqo411
  s_sub_u32 s75, s75, 1
  s_cmp_lg_u32 s75, 0
  s_cbranch_scc1 Lqr412
Lqo411:
  v_mov_b32 v80, v92
  v_mov_b32 v81, v93
  v_mov_b32 v82, v94
  v_mov_b32 v83, v95
  v_mov_b32 v84, v96
  v_mov_b32 v85, v97
  v_mov_b32 v86, v98
  v_mov_b32 v87, v99
  v_mov_b32 v88, v100
  v_mov_b32 v89, v101
  v_mov_b32 v90, v102
  v_mov_b32 v91, v103
  v_mov_b32 v104, 0
  v_mov_b32 v105, 0
  v_mov_b32 v106, 0
  v_mov_b32 v107, 0
  v_mov_b32 v108, 0
  v_mov_b32 v109, 0
  v_mov_b32 v110, 0
  v_mov_b32 v111, 0
  v_mov_b32 v112, 0
  v_mov_b32 v113, 0
  v_mov_b32 v114, 0
  v_mov_b32 v115, 0
  v_mov_b32 v116, 0
  v_mov_b32 v117, 0
  v_mov_b32 v118, 0
  v_mov_b32 v119, 0
  v_mov_b32 v120, 0
  v_mov_b32 v121, 0
  v_mov_b32 v122, 0
  v_mov_b32 v123, 0
  v_mov_b32 v124, 0
  v_mov_b32 v125, 0
  v_mov_b32 v126, 0
  v_mov_b32 v127, 0
  v_mov_b32 v128, 0xf149f2ca
  v_mov_b32 v129, 0
  ACR 56, 0
  ACR 68, 12
  QK2 56, 68, 80, 226
  s_mov_b32 s76, 0xc000
  LDT a, 192, 40
  s_mov_b32 s76, 0xcc00
  LDT a, 204, 40
  s_mov_b32 s76, 0xd800
  LDT a, 216, 40
  s_mov_b32 s76, 0xe400
  LDT a, 228, 40
  s_mov_b32 s76, 0xf000
  LDT a, 240, 40
  v_add_f32 v226, v226, v227
  v_add_f32 v226, v226, v228
  v_add_f32 v229, v229, v230
  v_add_f32 v229, v229, v231
  v_add_f32_dpp v226, v226, v226 quad_perm:[1,0,3,2] row_mask:0xf bank_mask:0xf
  s_nop 0
  v_add_f32_dpp v229, v229, v229 quad_perm:[1,0,3,2] row_mask:0xf bank_mask:0xf
  v_add_f32_dpp v226, v226, v226 quad_perm:[2,3,0,1] row_mask:0xf bank_mask:0xf
  s_nop 0
  v_add_f32_dpp v229, v229, v229 quad_perm:[2,3,0,1] row_mask:0xf bank_mask:0xf
  v_add_f32_dpp v226, v226, v226 row_half_mirror row_mask:0xf bank_mask:0xf
  s_nop 0
  v_add_f32_dpp v229, v229, v229 row_half_mirror row_mask:0xf bank_mask:0xf
  v_max3_f32 v232, v128, v226, v229
  v_cmp_gt_f32 vcc, v232, v128
  s_cbranch_vccz Lsk413
  v_sub_f32 v234, v128, v232
  v_mul_f32 v234, s74, v234
  v_exp_f32 v234, v234
  v_mov_b32 v128, v232
  RESC 104, 234
  v_mul_f32 v129, v234, v129
Lsk413:
  v_mul_f32 v233, s74, v128
  v_fma_f32 v235, v226, s74, -v233
  v_fma_f32 v236, v229, s74, -v233
  v_exp_f32 v235, v235
  v_exp_f32 v236, v236
  v_cvt_pk_bf16_f32 v238, v235, 0
  v_cvt_pk_bf16_f32 v239, 0, v235
  v_cvt_pk_bf16_f32 v240, v236, 0
  v_cvt_pk_bf16_f32 v241, 0, v236
  v_add_f32 v129, v129, v239
  v_add_f32 v129, v129, v241
  PV 130, 238, 104
  PV 142, 240, 104
  ACR 56, 24
  ACR 68, 36
  QK2 56, 68, 80, 226
  v_add_f32 v226, v226, v227
  v_add_f32 v226, v226, v228
  v_add_f32 v229, v229, v230
  v_add_f32 v229, v229, v231
  v_add_f32_dpp v226, v226, v226 quad_perm:[1,0,3,2] row_mask:0xf bank_mask:0xf
  s_nop 0
  v_add_f32_dpp v229, v229, v229 quad_perm:[1,0,3,2] row_mask:0xf bank_mask:0xf
  v_add_f32_dpp v226, v226, v226 quad_perm:[2,3,0,1] row_mask:0xf bank_mask:0xf
  s_nop 0
  v_add_f32_dpp v229, v229, v229 quad_perm:[2,3,0,1] row_mask:0xf bank_mask:0xf
  v_add_f32_dpp v226, v226, v226 row_half_mirror row_mask:0xf bank_mask:0xf
  s_nop 0
  v_add_f32_dpp v229, v229, v229 row_half_mirror row_mask:0xf bank_mask:0xf
  v_max3_f32 v232, v128, v226, v229
  v_cmp_gt_f32 vcc, v232, v128
  s_cbranch_vccz Lsk414
  v_sub_f32 v234, v128, v232
  v_mul_f32 v234, s74, v234
  v_exp_f32 v234, v234
  v_mov_b32 v128, v232
  RESC 104, 234
  v_mul_f32 v129, v234, v129
Lsk414:
  v_mul_f32 v233, s74, v128
  v_fma_f32 v235, v226, s74, -v233
  v_fma_f32 v236, v229, s74, -v233
  v_exp_f32 v235, v235
  v_exp_f32 v236, v236
  v_cvt_pk_bf16_f32 v238, v235, 0
  v_cvt_pk_bf16_f32 v239, 0, v235
  v_cvt_pk_bf16_f32 v240, v236, 0
  v_cvt_pk_bf16_f32 v241, 0, v236
  v_add_f32 v129, v129, v239
  v_add_f32 v129, v129, v241
  PV 154, 238, 104
  PV 166, 240, 104
  ACR 56, 48
  ACR 68, 60
  QK2 56, 68, 80, 226
  v_add_f32 v226, v226, v227
  v_add_f32 v226, v226, v228
  v_add_f32 v229, v229, v230
  v_add_f32 v229, v229, v231
  v_add_f32_dpp v226, v226, v226 quad_perm:[1,0,3,2] row_mask:0xf bank_mask:0xf
  s_nop 0
  v_add_f32_dpp v229, v229, v229 quad_perm:[1,0,3,2] row_mask:0xf bank_mask:0xf
  v_add_f32_dpp v226, v226, v226 quad_perm:[2,3,0,1] row_mask:0xf bank_mask:0xf
  s_nop 0
  v_add_f32_dpp v229, v229, v229 quad_perm:[2,3,0,1] row_mask:0xf bank_mask:0xf
  v_add_f32_dpp v226, v226, v226 row_half_mirror row_mask:0xf bank_mask:0xf
  s_nop 0
  v_add_f32_dpp v229, v229, v229 row_half_mirror row_mask:0xf bank_mask:0xf
  v_max3_f32 v232, v128, v226, v229
  v_cmp_gt_f32 vcc, v232, v128
  s_cbranch_vccz Lsk415
  v_sub_f32 v234, v128, v232
  v_mul_f32 v234, s74, v234
  v_exp_f32 v234, v234
  v_mov_b32 v128, v232
  RESC 104, 234
  v_mul_f32 v129, v234, v129
Lsk415:
  v_mul_f32 v233, s74, v128
  v_fma_f32 v235, v226, s74, -v233
  v_fma_f32 v236, v229, s74, -v233
  v_exp_f32 v235, v235
  v_exp_f32 v236, v236
  v_cvt_pk_bf16_f32 v238, v235, 0
  v_cvt_pk_bf16_f32 v239, 0, v235
  v_cvt_pk_bf16_f32 v240, v236, 0
  v_cvt_pk_bf16_f32 v241, 0, v236
  v_add_f32 v129, v129, v239
  v_add_f32 v129, v129, v241
  PV 178, 238, 104
  PV 190, 240, 104
  ACR 56, 72
  ACR 68, 84
  QK2 56, 68, 80, 226
  v_add_f32 v226, v226, v227
  v_add_f32 v226, v226, v228
  v_add_f32 v229, v229, v230
  v_add_f32 v229, v229, v231
  v_add_f32_dpp v226, v226, v226 quad_perm:[1,0,3,2] row_mask:0xf bank_mask:0xf
  s_nop 0
  v_add_f32_dpp v229, v229, v229 quad_perm:[1,0,3,2] row_mask:0xf bank_mask:0xf
  v_add_f32_dpp v226, v226, v226 quad_perm:[2,3,0,1] row_mask:0xf bank_mask:0xf
  s_nop 0
  v_add_f32_dpp v229, v229, v229 quad_perm:[2,3,0,1] row_mask:0xf bank_mask:0xf
  v_add_f32_dpp v226, v226, v226 row_half_mirror row_mask:0xf bank_mask:0xf
  s_nop 0
  v_add_f32_dpp v229, v229, v229 row_half_mirror row_mask:0xf bank_mask:0xf
  v_max3_f32 v232, v128, v226, v229
  v_cmp_gt_f32 vcc, v232, v128
  s_cbranch_vccz Lsk416
  v_sub_f32 v234, v128, v232
  v_mul_f32 v234, s74, v234
  v_exp_f32 v234, v234
  v_mov_b32 v128, v232
  RESC 104, 234
  v_mul_f32 v129, v234, v129
Lsk416:
  v_mul_f32 v233, s74, v128
  v_fma_f32 v235, v226, s74, -v233
  v_fma_f32 v236, v229, s74, -v233
  v_exp_f32 v235, v235
  v_exp_f32 v236, v236
  v_cvt_pk_bf16_f32 v238, v235, 0
  v_cvt_pk_bf16_f32 v239, 0, v235
  v_cvt_pk_bf16_f32 v240, v236, 0
  v_cvt_pk_bf16_f32 v241, 0, v236
  v_add_f32 v129, v129, v239
  v_add_f32 v129, v129, v241
  PV 202, 238, 104
  PV 214, 240, 104
  ACR 56, 96
  ACR 68, 108
  QK2 56, 68, 80, 226
  v_add_f32 v226, v226, v227
  v_add_f32 v226, v226, v228
  v_add_f32 v229, v229, v230
  v_add_f32 v229, v229, v231
  v_add_f32_dpp v226, v226, v226 quad_perm:[1,0,3,2] row_mask:0xf bank_mask:0xf
  s_nop 0
  v_add_f32_dpp v229, v229, v229 quad_perm:[1,0,3,2] row_mask:0xf bank_mask:0xf
  v_add_f32_dpp v226, v226, v226 quad_perm:[2,3,0,1] row_mask:0xf bank_mask:0xf
  s_nop 0
  v_add_f32_dpp v229, v229, v229 quad_perm:[2,3,0,1] row_mask:0xf bank_mask:0xf
  v_add_f32_dpp v226, v226, v226 row_half_mirror row_mask:0xf bank_mask:0xf
  s_nop 0
  v_add_f32_dpp v229, v229, v229 row_half_mirror row_mask:0xf bank_mask:0xf
  v_max3_f32 v232, v128, v226, v229
  v_cmp_gt_f32 vcc, v232, v128
  s_cbranch_vccz Lsk417
  v_sub_f32 v234, v128, v232
  v_mul_f32 v234, s74, v234
  v_exp_f32 v234, v234
  v_mov_b32 v128, v232
  RESC 104, 234
  v_mul_f32 v129, v234, v129
Lsk417:
  v_mul_f32 v233, s74, v128
  v_fma_f32 v235, v226, s74, -v233
  v_fma_f32 v236, v229, s74, -v233
  v_exp_f32 v235, v235
  v_exp_f32 v236, v236
  v_cvt_pk_bf16_f32 v238, v235, 0
  v_cvt_pk_bf16_f32 v239, 0, v235
  v_cvt_pk_bf16_f32 v240, v236, 0
  v_cvt_pk_bf16_f32 v241, 0, v236
  v_add_f32 v129, v129, v239
  v_add_f32 v129, v129, v241
  PV 20, 238, 104
  ds_write_b128 v3, v[20:23] offset:0
  ds_write_b128 v3, v[24:27] offset:1024
  ds_write_b128 v3, v[28:31] offset:2048
  s_mov_b32 s76, 0x9000
  LDT v, 20, 44
  PV 32, 240, 104
  ds_write_b128 v3, v[32:35] offset:3072
  ds_write_b128 v3, v[36:39] offset:4096
  ds_write_b128 v3, v[40:43] offset:5120
  s_mov_b32 s76, 0x9c00
  LDT v, 32, 44
  ACR 56, 120
  s_waitcnt vmcnt(34)
  ACR 68, 132
  QK2 56, 68, 80, 226
  v_add_f32 v226, v226, v227
  v_add_f32 v226, v226, v228
  v_add_f32 v229, v229, v230
  v_add_f32 v229, v229, v231
  v_add_f32_dpp v226, v226, v226 quad_perm:[1,0,3,2] row_mask:0xf bank_mask:0xf
  s_nop 0
  v_add_f32_dpp v229, v229, v229 quad_perm:[1,0,3,2] row_mask:0xf bank_mask:0xf
  v_add_f32_dpp v226, v226, v226 quad_perm:[2,3,0,1] row_mask:0xf bank_mask:0xf
  s_nop 0
  v_add_f32_dpp v229, v229, v229 quad_perm:[2,3,0,1] row_mask:0xf bank_mask:0xf
  v_add_f32_dpp v226, v226, v226 row_half_mirror row_mask:0xf bank_mask:0xf
  s_nop 0
  v_add_f32_dpp v229, v229, v229 row_half_mirror row_mask:0xf bank_mask:0xf
  v_max3_f32 v232, v128, v226, v229
  v_cmp_gt_f32 vcc, v232, v128
  s_cbranch_vccz Lsk418
  v_sub_f32 v234, v128, v232
  v_mul_f32 v234, s74, v234
  v_exp_f32 v234, v234
  v_mov_b32 v128, v232
  RESC 104, 234
  v_mul_f32 v129, v234, v129
Lsk418:
  v_mul_f32 v233, s74, v128
  v_fma_f32 v235, v226, s74, -v233
  v_fma_f32 v236, v229, s74, -v233
  v_exp_f32 v235, v235
  v_exp_f32 v236, v236
  v_cvt_pk_bf16_f32 v238, v235, 0
  v_cvt_pk_bf16_f32 v239, 0, v235
  v_cvt_pk_bf16_f32 v240, v236, 0
  v_cvt_pk_bf16_f32 v241, 0, v236
  v_add_f32 v129, v129, v239
  v_add_f32 v129, v129, v241
  PV 8, 238, 104
  ds_write_b128 v3, v[8:11] offset:6144
  ds_write_b128 v3, v[12:15] offset:7168
  ds_write_b128 v3, v[16:19] offset:8192
  s_mov_b32 s76, 0xa800
  LDT v, 8, 44
  PV 44, 240, 104
  ds_write_b128 v3, v[44:47] offset:9216
  ds_write_b128 v3, v[48:51] offset:10240
  ds_write_b128 v3, v[52:55] offset:11264
  s_mov_b32 s76, 0xb400
  LDT v, 44, 44
  s_waitcnt vmcnt(37)
  ACR 56, 144
  s_waitcnt vmcnt(34)
  ACR 68, 156
  QK2 56, 68, 80, 226
  v_add_f32 v226, v226, v227
  v_add_f32 v226, v226, v228
  v_add_f32 v229, v229, v230
  v_add_f32 v229, v229, v231
  v_add_f32_dpp v226, v226, v226 quad_perm:[1,0,3,2] row_mask:0xf bank_mask:0xf
  s_nop 0
  v_add_f32_dpp v229, v229, v229 quad_perm:[1,0,3,2] row_mask:0xf bank_mask:0xf
  v_add_f32_dpp v226, v226, v226 quad_perm:[2,3,0,1] row_mask:0xf bank_mask:0xf
  s_nop 0
  v_add_f32_dpp v229, v229, v229 quad_perm:[2,3,0,1] row_mask:0xf bank_mask:0xf
  v_add_f32_dpp v226, v226, v226 row_half_mirror row_mask:0xf bank_mask:0xf
  s_nop 0
  v_add_f32_dpp v229, v229, v229 row_half_mirror row_mask:0xf bank_mask:0xf
  v_max3_f32 v232, v128, v226, v229
  v_cmp_gt_f32 vcc, v232, v128
  s_cbranch_vccz Lsk419
  v_sub_f32 v234, v128, v232
  v_mul_f32 v234, s74, v234
  v_exp_f32 v234, v234
  v_mov_b32 v128, v232
  RESC 104, 234
  v_mul_f32 v129, v234, v129
Lsk419:
  v_mul_f32 v233, s74, v128
  v_fma_f32 v235, v226, s74, -v233
  v_fma_f32 v236, v229, s74, -v233
  v_exp_f32 v235, v235
  v_exp_f32 v236, v236
  v_cvt_pk_bf16_f32 v238, v235, 0
  v_cvt_pk_bf16_f32 v239, 0, v235
  v_cvt_pk_bf16_f32 v240, v236, 0
  v_cvt_pk_bf16_f32 v241, 0, v236
  v_add_f32 v129, v129, v239
  v_add_f32 v129, v129, v241
  s_waitcnt vmcnt(9)
  PV 20, 238, 104
  ds_write_b128 v3, v[20:23] offset:12288
  ds_write_b128 v3, v[24:27] offset:13312
  ds_write_b128 v3, v[28:31] offset:14336
  s_mov_b32 s76, 0xc000
  LDT v, 20, 44
  s_waitcnt vmcnt(9)
  PV 32, 240, 104
  ds_write_b128 v3, v[32:35] offset:15360
  s_waitcnt lgkmcnt(8)
  ds_write_b128 v3, v[36:39] offset:16384
  ds_write_b128 v3, v[40:43] offset:17408
  s_mov_b32 s76, 0xcc00
  LDT v, 32, 44
  ACR 56, 168
  ACR 68, 180
  QK2 56, 68, 80, 226
  v_add_f32 v226, v226, v227
  v_add_f32 v226, v226, v228
  v_add_f32 v229, v229, v230
  v_add_f32 v229, v229, v231
  v_add_f32_dpp v226, v226, v226 quad_perm:[1,0,3,2] row_mask:0xf bank_mask:0xf
  s_nop 0
  v_add_f32_dpp v229, v229, v229 quad_perm:[1,0,3,2] row_mask:0xf bank_mask:0xf
  v_add_f32_dpp v226, v226, v226 quad_perm:[2,3,0,1] row_mask:0xf bank_mask:0xf
  s_nop 0
  v_add_f32_dpp v229, v229, v229 quad_perm:[2,3,0,1] row_mask:0xf bank_mask:0xf
  v_add_f32_dpp v226, v226, v226 row_half_mirror row_mask:0xf bank_mask:0xf
  s_nop 0
  v_add_f32_dpp v229, v229, v229 row_half_mirror row_mask:0xf bank_mask:0xf
  v_max3_f32 v232, v128, v226, v229
  v_cmp_gt_f32 vcc, v232, v128
  s_cbranch_vccz Lsk420
  v_sub_f32 v234, v128, v232
  v_mul_f32 v234, s74, v234
  v_exp_f32 v234, v234
  v_mov_b32 v128, v232
  RESC 104, 234
  v_mul_f32 v129, v234, v129
Lsk420:
  v_mul_f32 v233, s74, v128
  v_fma_f32 v235, v226, s74, -v233
  v_fma_f32 v236, v229, s74, -v233
  v_exp_f32 v235, v235
  v_exp_f32 v236, v236
  v_cvt_pk_bf16_f32 v238, v235, 0
  v_cvt_pk_bf16_f32 v239, 0, v235
  v_cvt_pk_bf16_f32 v240, v236, 0
  v_cvt_pk_bf16_f32 v241, 0, v236
  v_add_f32 v129, v129, v239
  v_add_f32 v129, v129, v241
  s_waitcnt vmcnt(9)
  PV 8, 238, 104
  ds_write_b128 v3, v[8:11] offset:18432
  ds_write_b128 v3, v[12:15] offset:19456
  ds_write_b128 v3, v[16:19] offset:20480
  s_mov_b32 s76, 0xd800
  LDT v, 8, 44
  s_waitcnt vmcnt(9)
  PV 44, 240, 104
  ds_write_b128 v3, v[44:47] offset:21504
  ds_write_b128 v3, v[48:51] offset:22528
  ds_write_b128 v3, v[52:55] offset:23552
  s_waitcnt lgkmcnt(8)
  s_mov_b32 s76, 0xe400
  LDT v, 44, 44
  ACR 56, 192
  ACR 68, 204
  QK2 56, 68, 80, 226
  v_add_f32 v226, v226, v227
  v_add_f32 v226, v226, v228
  v_add_f32 v229, v229, v230
  v_add_f32 v229, v229, v231
  v_add_f32_dpp v226, v226, v226 quad_perm:[1,0,3,2] row_mask:0xf bank_mask:0xf
  s_nop 0
  v_add_f32_dpp v229, v229, v229 quad_perm:[1,0,3,2] row_mask:0xf bank_mask:0xf
  v_add_f32_dpp v226, v226, v226 quad_perm:[2,3,0,1] row_mask:0xf bank_mask:0xf
  s_nop 0
  v_add_f32_dpp v229, v229, v229 quad_perm:[2,3,0,1] row_mask:0xf bank_mask:0xf
  v_add_f32_dpp v226, v226, v226 row_half_mirror row_mask:0xf bank_mask:0xf
  s_nop 0
  v_add_f32_dpp v229, v229, v229 row_half_mirror row_mask:0xf bank_mask:0xf
  v_max3_f32 v232, v128, v226, v229
  v_cmp_gt_f32 vcc, v232, v128
  s_cbranch_vccz Lsk421
  v_sub_f32 v234, v128, v232
  v_mul_f32 v234, s74, v234
  v_exp_f32 v234, v234
  v_mov_b32 v128, v232
  RESC 104, 234
  v_mul_f32 v129, v234, v129
Lsk421:
  v_mul_f32 v233, s74, v128
  v_fma_f32 v235, v226, s74, -v233
  v_fma_f32 v236, v229, s74, -v233
  v_exp_f32 v235, v235
  v_exp_f32 v236, v236
  v_cvt_pk_bf16_f32 v238, v235, 0
  v_cvt_pk_bf16_f32 v239, 0, v235
  v_cvt_pk_bf16_f32 v240, v236, 0
  v_cvt_pk_bf16_f32 v241, 0, v236
  v_add_f32 v129, v129, v239
  v_add_f32 v129, v129, v241
  s_waitcnt vmcnt(9)
  PV 20, 238, 104
  ds_write_b128 v3, v[20:23] offset:24576
  ds_write_b128 v3, v[24:27] offset:25600
  ds_write_b128 v3, v[28:31] offset:26624
  s_mov_b32 s76, 0xfc00
  LDC v, 20, 40
  s_waitcnt vmcnt(9)
  PV 32, 240, 104
  ds_write_b128 v3, v[32:35] offset:27648
  ds_write_b128 v3, v[36:39] offset:28672
  ds_write_b128 v3, v[40:43] offset:29696
  s_mov_b32 s76, 0xf000
  LDT v, 32, 44
  ACR 56, 216
  ACR 68, 228
  QK2 56, 68, 80, 226
  v_add_f32 v226, v226, v227
  v_add_f32 v226, v226, v228
  v_add_f32 v229, v229, v230
  v_add_f32 v229, v229, v231
  v_add_f32_dpp v226, v226, v226 quad_perm:[1,0,3,2] row_mask:0xf bank_mask:0xf
  s_nop 0
  v_add_f32_dpp v229, v229, v229 quad_perm:[1,0,3,2] row_mask:0xf bank_mask:0xf
  v_add_f32_dpp v226, v226, v226 quad_perm:[2,3,0,1] row_mask:0xf bank_mask:0xf
  s_nop 0
  v_add_f32_dpp v229, v229, v229 quad_perm:[2,3,0,1] row_mask:0xf bank_mask:0xf
  v_add_f32_dpp v226, v226, v226 row_half_mirror row_mask:0xf bank_mask:0xf
  s_nop 0
  v_add_f32_dpp v229, v229, v229 row_half_mirror row_mask:0xf bank_mask:0xf
  v_max3_f32 v232, v128, v226, v229
  v_cmp_gt_f32 vcc, v232, v128
  s_cbranch_vccz Lsk422
  v_sub_f32 v234, v128, v232
  v_mul_f32 v234, s74, v234
  v_exp_f32 v234, v234
  v_mov_b32 v128, v232
  RESC 104, 234
  v_mul_f32 v129, v234, v129
Lsk422:
  v_mul_f32 v233, s74, v128
  v_fma_f32 v235, v226, s74, -v233
  v_fma_f32 v236, v229, s74, -v233
  v_exp_f32 v235, v235
  v_exp_f32 v236, v236
  v_cvt_pk_bf16_f32 v238, v235, 0
  v_cvt_pk_bf16_f32 v239, 0, v235
  v_cvt_pk_bf16_f32 v240, v236, 0
  v_cvt_pk_bf16_f32 v241, 0, v236
  v_add_f32 v129, v129, v239
  v_add_f32 v129, v129, v241
  s_waitcnt vmcnt(9)
  PV 8, 238, 104
  ds_write_b128 v3, v[8:11] offset:30720
  ds_write_b128 v3, v[12:15] offset:31744
  s_waitcnt lgkmcnt(8)
  ds_write_b128 v3, v[16:19] offset:32768
  s_mov_b32 s76, 0xfc00
  LDC v, 8, 44
  s_waitcnt vmcnt(9)
  PV 44, 240, 104
  ds_write_b128 v3, v[44:47] offset:33792
  ds_write_b128 v3, v[48:51] offset:34816
  ds_write_b128 v3, v[52:55] offset:35840
  s_mov_b32 s76, 0x10800
  LDC v, 44, 40
  s_add_u32 s76, s72, 0xc000
  buffer_load_dwordx4 v[92:95], v2, s[64:67], s76 offen sc1
  buffer_load_dwordx4 v[96:99], v2, s[64:67], s76 offen offset:128 sc1
  buffer_load_dwordx4 v[100:103], v2, s[64:67], s76 offen offset:256 sc1
  ACR 56, 240
  s_waitcnt vmcnt(12)
  QK2 56, 20, 80, 226
  s_mov_b32 s76, 0x11400
  LDC v, 20, 40
  v_add_f32 v226, v226, v227
  v_add_f32 v226, v226, v228
  v_add_f32 v229, v229, v230
  v_add_f32 v229, v229, v231
  v_add_f32_dpp v226, v226, v226 quad_perm:[1,0,3,2] row_mask:0xf bank_mask:0xf
  s_nop 0
  v_add_f32_dpp v229, v229, v229 quad_perm:[1,0,3,2] row_mask:0xf bank_mask:0xf
  v_add_f32_dpp v226, v226, v226 quad_perm:[2,3,0,1] row_mask:0xf bank_mask:0xf
  s_nop 0
  v_add_f32_dpp v229, v229, v229 quad_perm:[2,3,0,1] row_mask:0xf bank_mask:0xf
  v_add_f32_dpp v226, v226, v226 row_half_mirror row_mask:0xf bank_mask:0xf
  s_nop 0
  v_add_f32_dpp v229, v229, v229 row_half_mirror row_mask:0xf bank_mask:0xf
  v_max3_f32 v232, v128, v226, v229
  v_cmp_gt_f32 vcc, v232, v128
  s_cbranch_vccz Lsk423
  v_sub_f32 v234, v128, v232
  v_mul_f32 v234, s74, v234
  v_exp_f32 v234, v234
  v_mov_b32 v128, v232
  RESC 104, 234
  v_mul_f32 v129, v234, v129
Lsk423:
  v_mul_f32 v233, s74, v128
  v_fma_f32 v235, v226, s74, -v233
  v_fma_f32 v236, v229, s74, -v233
  v_exp_f32 v235, v235
  v_exp_f32 v236, v236
  v_cvt_pk_bf16_f32 v238, v235, 0
  v_cvt_pk_bf16_f32 v239, 0, v235
  v_cvt_pk_bf16_f32 v240, v236, 0
  v_cvt_pk_bf16_f32 v241, 0, v236
  v_add_f32 v129, v129, v239
  v_add_f32 v129, v129, v241
  s_waitcnt vmcnt(12)
  PV 32, 238, 104
  ds_write_b128 v3, v[32:35] offset:36864
  ds_write_b128 v3, v[36:39] offset:37888
  ds_write_b128 v3, v[40:43] offset:38912
  s_mov_b32 s76, 0x10800
  LDC v, 32, 44
  s_waitcnt vmcnt(12)
  PV 8, 240, 104
  s_mov_b32 s76, 0x11400
  LDC v, 8, 44
  s_waitcnt vmcnt(12)
  s_waitcnt vmcnt(6)
  QK2 44, 20, 80, 226
  s_mov_b32 s76, 0x12000
  LDC v, 20, 40
  s_mov_b32 s76, 0x12000
  LDC v, 44, 44
  v_add_f32 v226, v226, v227
  v_add_f32 v226, v226, v228
  v_add_f32 v229, v229, v230
  v_add_f32 v229, v229, v231
  v_add_f32_dpp v226, v226, v226 quad_perm:[1,0,3,2] row_mask:0xf bank_mask:0xf
  s_nop 0
  v_add_f32_dpp v229, v229, v229 quad_perm:[1,0,3,2] row_mask:0xf bank_mask:0xf
  v_add_f32_dpp v226, v226, v226 quad_perm:[2,3,0,1] row_mask:0xf bank_mask:0xf
  s_nop 0
  v_add_f32_dpp v229, v229, v229 quad_perm:[2,3,0,1] row_mask:0xf bank_mask:0xf
  v_add_f32_dpp v226, v226, v226 row_half_mirror row_mask:0xf bank_mask:0xf
  s_nop 0
  v_add_f32_dpp v229, v229, v229 row_half_mirror row_mask:0xf bank_mask:0xf
  v_max3_f32 v232, v128, v226, v229
  v_cmp_gt_f32 vcc, v232, v128
  s_cbranch_vccz Lsk424
  v_sub_f32 v234, v128, v232
  v_mul_f32 v234, s74, v234
  v_exp_f32 v234, v234
  v_mov_b32 v128, v232
  RESC 104, 234
  v_mul_f32 v129, v234, v129
Lsk424:
  v_mul_f32 v233, s74, v128
  v_fma_f32 v235, v226, s74, -v233
  v_fma_f32 v236, v229, s74, -v233
  v_exp_f32 v235, v235
  v_exp_f32 v236, v236
  v_cvt_pk_bf16_f32 v238, v235, 0
  v_cvt_pk_bf16_f32 v239, 0, v235
  v_cvt_pk_bf16_f32 v240, v236, 0
  v_cvt_pk_bf16_f32 v241, 0, v236
  v_add_f32 v129, v129, v239
  v_add_f32 v129, v129, v241
  s_waitcnt vmcnt(9)
  PV 32, 238, 104
  s_mov_b32 s76, 0x12c00
  LDT v, 32, 32
  s_waitcnt vmcnt(9)
  PV 8, 240, 104
  s_mov_b32 s76, 0x13800
  LDT v, 8, 32
  s_waitcnt vmcnt(9)
  v_dot2_f32_bf16 v226, v20, v80, 0
  v_dot2_f32_bf16 v227, v24, v84, 0
  v_dot2_f32_bf16 v228, v28, v88, 0
  s_nop 0
  v_dot2c_f32_bf16 v226, v21, v81
  v_dot2c_f32_bf16 v227, v25, v85
  v_dot2c_f32_bf16 v228, v29, v89
  v_dot2c_f32_bf16 v226, v22, v82
  v_dot2c_f32_bf16 v227, v26, v86
  v_dot2c_f32_bf16 v228, v30, v90
  v_dot2c_f32_bf16 v226, v23, v83
  v_dot2c_f32_bf16 v227, v27, v87
  v_dot2c_f32_bf16 v228, v31, v91
  s_mov_b32 s76, 0x12c00
  LDT v, 20, 36
  v_add_f32 v226, v226, v227
  v_add_f32 v226, v226, v228
  s_nop 1
  v_add_f32_dpp v226, v226, v226 quad_perm:[1,0,3,2] row_mask:0xf bank_mask:0xf
  s_nop 1
  v_add_f32_dpp v226, v226, v226 quad_perm:[2,3,0,1] row_mask:0xf bank_mask:0xf
  s_nop 1
  v_add_f32_dpp v226, v226, v226 row_half_mirror row_mask:0xf bank_mask:0xf
  v_max_f32 v232, v128, v226
  v_cmp_gt_f32 vcc, v232, v128
  s_cbranch_vccz Lsk425
  v_sub_f32 v234, v128, v232
  v_mul_f32 v234, s74, v234
  v_exp_f32 v234, v234
  v_mov_b32 v128, v232
  RESC 104, 234
  v_mul_f32 v129, v234, v129
Lsk425:
  v_mul_f32 v233, s74, v128
  v_fma_f32 v235, v226, s74, -v233
  v_exp_f32 v235, v235
  s_nop 0
  v_cvt_pk_bf16_f32 v238, v235, 0
  v_cvt_pk_bf16_f32 v239, 0, v235
  v_add_f32 v129, v129, v239
  s_waitcnt vmcnt(9)
  PV 44, 238, 104
  s_mov_b32 s76, 0x13800
  LDT v, 44, 36
  v_max_f32_dpp v226, v128, v128 row_ror:8 row_mask:0xf bank_mask:0xf
  v_mov_b32 v227, v226
  s_nop 1
  v_permlane16_swap_b32 v226, v227
  v_max_f32 v226, v226, v227
  v_mov_b32 v227, v226
  s_nop 1
  v_permlane32_swap_b32 v226, v227
  v_max_f32 v226, v226, v227
  v_sub_f32 v228, v128, v226
  v_mul_f32 v228, s74, v228
  v_exp_f32 v228, v228
  v_mul_f32 v226, s74, v226
  RESC 104, 228
  v_mul_f32 v129, v228, v129
  s_nop 1
  v_add_f32_dpp v129, v129, v129 row_ror:8 row_mask:0xf bank_mask:0xf
  v_mov_b32 v227, v129
  s_nop 1
  v_permlane16_swap_b32 v129, v227
  v_add_f32 v129, v129, v227
  v_mov_b32 v227, v129
  s_nop 1
  v_permlane32_swap_b32 v129, v227
  v_add_f32 v129, v129, v227
  v_permlane32_swap_b32 v104, v116
  v_permlane32_swap_b32 v105, v117
  v_permlane32_swap_b32 v106, v118
  v_permlane32_swap_b32 v107, v119
  v_permlane32_swap_b32 v108, v120
  v_permlane32_swap_b32 v109, v121
  v_permlane32_swap_b32 v110, v122
  v_permlane32_swap_b32 v111, v123
  v_permlane32_swap_b32 v112, v124
  v_permlane32_swap_b32 v113, v125
  v_permlane32_swap_b32 v114, v126
  v_permlane32_swap_b32 v115, v127
  v_add_f32 v104, v104, v116
  v_add_f32 v105, v105, v117
  v_add_f32 v106, v106, v118
  v_add_f32 v107, v107, v119
  v_add_f32 v108, v108, v120
  v_add_f32 v109, v109, v121
  v_add_f32 v110, v110, v122
  v_add_f32 v111, v111, v123
  v_add_f32 v112, v112, v124
  v_add_f32 v113, v113, v125
  v_add_f32 v114, v114, v126
  v_add_f32 v115, v115, v127
  v_permlane16_swap_b32 v104, v110
  v_permlane16_swap_b32 v105, v111
  v_permlane16_swap_b32 v106, v112
  v_permlane16_swap_b32 v107, v113
  v_permlane16_swap_b32 v108, v114
  v_permlane16_swap_b32 v109, v115
  v_add_f32 v104, v104, v110
  v_add_f32 v105, v105, v111
  v_add_f32 v106, v106, v112
  v_add_f32 v107, v107, v113
  v_add_f32 v108, v108, v114
  v_add_f32 v109, v109, v115
  v_add_f32_dpp v104, v104, v104 row_ror:8 row_mask:0xf bank_mask:0xf
  v_add_f32_dpp v105, v105, v105 row_ror:8 row_mask:0xf bank_mask:0xf
  v_add_f32_dpp v106, v106, v106 row_ror:8 row_mask:0xf bank_mask:0xf
  v_add_f32_dpp v107, v107, v107 row_ror:8 row_mask:0xf bank_mask:0xf
  v_add_f32_dpp v108, v108, v108 row_ror:8 row_mask:0xf bank_mask:0xf
  v_add_f32_dpp v109, v109, v109 row_ror:8 row_mask:0xf bank_mask:0xf
  v_add_u32 v229, 0, v7
  v_lshrrev_b32 v230, 3, v229
  v_and_b32 v229, 7, v229
  v_lshlrev_b32 v230, 6, v230
  v_add_u32 v229, v229, v230
  v_lshl_add_u32 v229, v229, 2, v4
  ds_write_b32 v229, v104
  s_waitcnt lgkmcnt(8)
  v_add_u32 v229, 1, v7
  v_lshrrev_b32 v230, 3, v229
  v_and_b32 v229, 7, v229
  v_lshlrev_b32 v230, 6, v230
  v_add_u32 v229, v229, v230
  v_lshl_add_u32 v229, v229, 2, v4
  ds_write_b32 v229, v105
  v_add_u32 v229, 2, v7
  v_lshrrev_b32 v230, 3, v229
  v_and_b32 v229, 7, v229
  v_lshlrev_b32 v230, 6, v230
  v_add_u32 v229, v229, v230
  v_lshl_add_u32 v229, v229, 2, v4
  ds_write_b32 v229, v106
  v_add_u32 v229, 3, v7
  v_lshrrev_b32 v230, 3, v229
  v_and_b32 v229, 7, v229
  v_lshlrev_b32 v230, 6, v230
  v_add_u32 v229, v229, v230
  v_lshl_add_u32 v229, v229, 2, v4
  ds_write_b32 v229, v107
  v_add_u32 v229, 4, v7
  v_lshrrev_b32 v230, 3, v229
  v_and_b32 v229, 7, v229
  v_lshlrev_b32 v230, 6, v230
  v_add_u32 v229, v229, v230
  v_lshl_add_u32 v229, v229, 2, v4
  ds_write_b32 v229, v108
  v_add_u32 v229, 5, v7
  v_lshrrev_b32 v230, 3, v229
  v_and_b32 v229, 7, v229
  v_lshlrev_b32 v230, 6, v230
  v_add_u32 v229, v229, v230
  v_lshl_add_u32 v229, v229, 2, v4
  ds_write_b32 v229, v109
  v_mov_b32 v234, v226
  v_mov_b32 v235, v129
  v_mov_b32 v236, 0
  v_mov_b32 v237, 0
  v_and_b32 v229, 0xffffff1f, v4
  ds_write_b128 v229, v[234:237] offset:768
  s_waitcnt lgkmcnt(0)
  ds_read_b128 v[234:237], v5
  s_waitcnt lgkmcnt(0)
  s_add_u32 s76, s73, 0x31c400
  s_mov_b32 exec_lo, -1
  s_mov_b32 exec_hi, 0x1ffff
  buffer_store_dwordx4 v[234:237], v6, s[64:67], s76 offen sc1
  s_mov_b64 exec, -1
  v_max3_u32 v226, v92, v93, v94
  v_max3_u32 v226, v226, v95, v96
  v_max3_u32 v226, v226, v97, v98
  v_max3_u32 v226, v226, v99, v100
  v_max3_u32 v226, v226, v101, v102
  v_max3_u32 v226, v226, v103, v103
  v_cmp_eq_u32 vcc, -1, v226
  s_cbranch_vccz Lqo426
  s_mov_b32 s75, 0x61a80
Lqr427:
  s_sleep 2
  s_add_u32 s77, s72, 0xc000
  buffer_load_dwordx4 v[92:95], v2, s[64:67], s77 offen sc1
  buffer_load_dwordx4 v[96:99], v2, s[64:67], s77 offen offset:128 sc1
  buffer_load_dwordx4 v[100:103], v2, s[64:67], s77 offen offset:256 sc1
  s_waitcnt vmcnt(0)
  v_max3_u32 v226, v92, v93, v94
  v_max3_u32 v226, v226, v95, v96
  v_max3_u32 v226, v226, v97, v98
  v_max3_u32 v226, v226, v99, v100
  v_max3_u32 v226, v226, v101, v102
  v_max3_u32 v226, v226, v103, v103
  v_cmp_eq_u32 vcc, -1, v226
  s_cbranch_vccz Lqo426
  s_sub_u32 s75, s75, 1
  s_cmp_lg_u32 s75, 0
  s_cbranch_scc1 Lqr427
Lqo426:
  v_mov_b32 v80, v92
  v_mov_b32 v81, v93
  v_mov_b32 v82, v94
  v_mov_b32 v83, v95
  v_mov_b32 v84, v96
  v_mov_b32 v85, v97
  v_mov_b32 v86, v98
  v_mov_b32 v87, v99
  v_mov_b32 v88, v100
  v_mov_b32 v89, v101
  v_mov_b32 v90, v102
  v_mov_b32 v91, v103
  v_mov_b32 v104, 0
  v_mov_b32 v105, 0
  v_mov_b32 v106, 0
  v_mov_b32 v107, 0
  v_mov_b32 v108, 0
  v_mov_b32 v109, 0
  v_mov_b32 v110, 0
  v_mov_b32 v111, 0
  v_mov_b32 v112, 0
  v_mov_b32 v113, 0
  v_mov_b32 v114, 0
  v_mov_b32 v115, 0
  v_mov_b32 v116, 0
  v_mov_b32 v117, 0
  v_mov_b32 v118, 0
  v_mov_b32 v119, 0
  v_mov_b32 v120, 0
  v_mov_b32 v121, 0
  v_mov_b32 v122, 0
  v_mov_b32 v123, 0
  v_mov_b32 v124, 0
  v_mov_b32 v125, 0
  v_mov_b32 v126, 0
  v_mov_b32 v127, 0
  v_mov_b32 v128, 0xf149f2ca
  v_mov_b32 v129, 0
  s_waitcnt vmcnt(10)
  s_waitcnt vmcnt(7)
  QK2 32, 8, 80, 226
  s_mov_b32 s76, 0x14400
  LDT v, 8, 32
  s_mov_b32 s76, 0x15000
  LDT v, 32, 32
  v_add_f32 v226, v226, v227
  v_add_f32 v226, v226, v228
  v_add_f32 v229, v229, v230
  v_add_f32 v229, v229, v231
  v_add_f32_dpp v226, v226, v226 quad_perm:[1,0,3,2] row_mask:0xf bank_mask:0xf
  s_nop 0
  v_add_f32_dpp v229, v229, v229 quad_perm:[1,0,3,2] row_mask:0xf bank_mask:0xf
  v_add_f32_dpp v226, v226, v226 quad_perm:[2,3,0,1] row_mask:0xf bank_mask:0xf
  s_nop 0
  v_add_f32_dpp v229, v229, v229 quad_perm:[2,3,0,1] row_mask:0xf bank_mask:0xf
  v_add_f32_dpp v226, v226, v226 row_half_mirror row_mask:0xf bank_mask:0xf
  s_nop 0
  v_add_f32_dpp v229, v229, v229 row_half_mirror row_mask:0xf bank_mask:0xf
  v_max3_f32 v232, v128, v226, v229
  v_cmp_gt_f32 vcc, v232, v128
  s_cbranch_vccz Lsk428
  v_sub_f32 v234, v128, v232
  v_mul_f32 v234, s74, v234
  v_exp_f32 v234, v234
  v_mov_b32 v128, v232
  RESC 104, 234
  v_mul_f32 v129, v234, v129
Lsk428:
  v_mul_f32 v233, s74, v128
  v_fma_f32 v235, v226, s74, -v233
  v_fma_f32 v236, v229, s74, -v233
  v_exp_f32 v235, v235
  v_exp_f32 v236, v236
  v_cvt_pk_bf16_f32 v238, v235, 0
  v_cvt_pk_bf16_f32 v239, 0, v235
  v_cvt_pk_bf16_f32 v240, v236, 0
  v_cvt_pk_bf16_f32 v241, 0, v236
  v_add_f32 v129, v129, v239
  v_add_f32 v129, v129, v241
  s_waitcnt vmcnt(10)
  PV 20, 238, 104
  s_mov_b32 s76, 0x14400
  LDT v, 20, 36
  s_waitcnt vmcnt(10)
  PV 44, 240, 104
  s_mov_b32 s76, 0x15000
  LDT v, 44, 36
  s_waitcnt vmcnt(9)
  s_waitcnt vmcnt(6)
  QK2 8, 32, 80, 226
  s_mov_b32 s76, 0x15c00
  LDT v, 8, 32
  s_mov_b32 s76, 0x16800
  LDT v, 32, 32
  v_add_f32 v226, v226, v227
  v_add_f32 v226, v226, v228
  v_add_f32 v229, v229, v230
  v_add_f32 v229, v229, v231
  v_add_f32_dpp v226, v226, v226 quad_perm:[1,0,3,2] row_mask:0xf bank_mask:0xf
  s_nop 0
  v_add_f32_dpp v229, v229, v229 quad_perm:[1,0,3,2] row_mask:0xf bank_mask:0xf
  v_add_f32_dpp v226, v226, v226 quad_perm:[2,3,0,1] row_mask:0xf bank_mask:0xf
  s_nop 0
  v_add_f32_dpp v229, v229, v229 quad_perm:[2,3,0,1] row_mask:0xf bank_mask:0xf
  v_add_f32_dpp v226, v226, v226 row_half_mirror row_mask:0xf bank_mask:0xf
  s_nop 0
  v_add_f32_dpp v229, v229, v229 row_half_mirror row_mask:0xf bank_mask:0xf
  v_max3_f32 v232, v128, v226, v229
  v_cmp_gt_f32 vcc, v232, v128
  s_cbranch_vccz Lsk429
  v_sub_f32 v234, v128, v232
  v_mul_f32 v234, s74, v234
  v_exp_f32 v234, v234
  v_mov_b32 v128, v232
  RESC 104, 234
  v_mul_f32 v129, v234, v129
Lsk429:
  v_mul_f32 v233, s74, v128
  v_fma_f32 v235, v226, s74, -v233
  v_fma_f32 v236, v229, s74, -v233
  v_exp_f32 v235, v235
  v_exp_f32 v236, v236
  v_cvt_pk_bf16_f32 v238, v235, 0
  v_cvt_pk_bf16_f32 v239, 0, v235
  v_cvt_pk_bf16_f32 v240, v236, 0
  v_cvt_pk_bf16_f32 v241, 0, v236
  v_add_f32 v129, v129, v239
  v_add_f32 v129, v129, v241
  s_waitcnt vmcnt(9)
  PV 20, 238, 104
  s_mov_b32 s76, 0x15c00
  LDT v, 20, 36
  s_waitcnt vmcnt(9)
  PV 44, 240, 104
  s_mov_b32 s76, 0x16800
  LDT v, 44, 36
  s_waitcnt vmcnt(9)
  s_waitcnt vmcnt(6)
  QK2 8, 32, 80, 226
  s_mov_b32 s76, 0x17400
  LDT v, 8, 32
  s_mov_b32 s76, 0x18000
  LDT v, 32, 32
  v_add_f32 v226, v226, v227
  v_add_f32 v226, v226, v228
  v_add_f32 v229, v229, v230
  v_add_f32 v229, v229, v231
  v_add_f32_dpp v226, v226, v226 quad_perm:[1,0,3,2] row_mask:0xf bank_mask:0xf
  s_nop 0
  v_add_f32_dpp v229, v229, v229 quad_perm:[1,0,3,2] row_mask:0xf bank_mask:0xf
  v_add_f32_dpp v226, v226, v226 quad_perm:[2,3,0,1] row_mask:0xf bank_mask:0xf
  s_nop 0
  v_add_f32_dpp v229, v229, v229 quad_perm:[2,3,0,1] row_mask:0xf bank_mask:0xf
  v_add_f32_dpp v226, v226, v226 row_half_mirror row_mask:0xf bank_mask:0xf
  s_nop 0
  v_add_f32_dpp v229, v229, v229 row_half_mirror row_mask:0xf bank_mask:0xf
  v_max3_f32 v232, v128, v226, v229
  v_cmp_gt_f32 vcc, v232, v128
  s_cbranch_vccz Lsk430
  v_sub_f32 v234, v128, v232
  v_mul_f32 v234, s74, v234
  v_exp_f32 v234, v234
  v_mov_b32 v128, v232
  RESC 104, 234
  v_mul_f32 v129, v234, v129
Lsk430:
  v_mul_f32 v233, s74, v128
  v_fma_f32 v235, v226, s74, -v233
  v_fma_f32 v236, v229, s74, -v233
  v_exp_f32 v235, v235
  v_exp_f32 v236, v236
  v_cvt_pk_bf16_f32 v238, v235, 0
  v_cvt_pk_bf16_f32 v239, 0, v235
  v_cvt_pk_bf16_f32 v240, v236, 0
  v_cvt_pk_bf16_f32 v241, 0, v236
  v_add_f32 v129, v129, v239
  v_add_f32 v129, v129, v241
  s_waitcnt vmcnt(9)
  PV 20, 238, 104
  s_mov_b32 s76, 0x17400
  LDT v, 20, 36
  s_waitcnt vmcnt(9)
  PV 44, 240, 104
  s_mov_b32 s76, 0x18000
  LDT v, 44, 36
  s_waitcnt vmcnt(9)
  s_waitcnt vmcnt(6)
  QK2 8, 32, 80, 226
  s_mov_b32 s76, 0x18c00
  LDT v, 8, 32
  s_mov_b32 s76, 0x19800
  LDT v, 32, 32
  v_add_f32 v226, v226, v227
  v_add_f32 v226, v226, v228
  v_add_f32 v229, v229, v230
  v_add_f32 v229, v229, v231
  v_add_f32_dpp v226, v226, v226 quad_perm:[1,0,3,2] row_mask:0xf bank_mask:0xf
  s_nop 0
  v_add_f32_dpp v229, v229, v229 quad_perm:[1,0,3,2] row_mask:0xf bank_mask:0xf
  v_add_f32_dpp v226, v226, v226 quad_perm:[2,3,0,1] row_mask:0xf bank_mask:0xf
  s_nop 0
  v_add_f32_dpp v229, v229, v229 quad_perm:[2,3,0,1] row_mask:0xf bank_mask:0xf
  v_add_f32_dpp v226, v226, v226 row_half_mirror row_mask:0xf bank_mask:0xf
  s_nop 0
  v_add_f32_dpp v229, v229, v229 row_half_mirror row_mask:0xf bank_mask:0xf
  v_max3_f32 v232, v128, v226, v229
  v_cmp_gt_f32 vcc, v232, v128
  s_cbranch_vccz Lsk431
  v_sub_f32 v234, v128, v232
  v_mul_f32 v234, s74, v234
  v_exp_f32 v234, v234
  v_mov_b32 v128, v232
  RESC 104, 234
  v_mul_f32 v129, v234, v129
Lsk431:
  v_mul_f32 v233, s74, v128
  v_fma_f32 v235, v226, s74, -v233
  v_fma_f32 v236, v229, s74, -v233
  v_exp_f32 v235, v235
  v_exp_f32 v236, v236
  v_cvt_pk_bf16_f32 v238, v235, 0
  v_cvt_pk_bf16_f32 v239, 0, v235
  v_cvt_pk_bf16_f32 v240, v236, 0
  v_cvt_pk_bf16_f32 v241, 0, v236
  v_add_f32 v129, v129, v239
  v_add_f32 v129, v129, v241
  s_waitcnt vmcnt(9)
  PV 20, 238, 104
  s_mov_b32 s76, 0x18c00
  LDT v, 20, 36
  s_waitcnt vmcnt(9)
  PV 44, 240, 104
  s_mov_b32 s76, 0x19800
  LDT v, 44, 36
  s_waitcnt vmcnt(9)
  s_waitcnt vmcnt(6)
  QK2 8, 32, 80, 226
  s_mov_b32 s76, 0x1a400
  LDT v, 8, 32
  s_mov_b32 s76, 0x1b000
  LDT v, 32, 32
  v_add_f32 v226, v226, v227
  v_add_f32 v226, v226, v228
  v_add_f32 v229, v229, v230
  v_add_f32 v229, v229, v231
  v_add_f32_dpp v226, v226, v226 quad_perm:[1,0,3,2] row_mask:0xf bank_mask:0xf
  s_nop 0
  v_add_f32_dpp v229, v229, v229 quad_perm:[1,0,3,2] row_mask:0xf bank_mask:0xf
  v_add_f32_dpp v226, v226, v226 quad_perm:[2,3,0,1] row_mask:0xf bank_mask:0xf
  s_nop 0
  v_add_f32_dpp v229, v229, v229 quad_perm:[2,3,0,1] row_mask:0xf bank_mask:0xf
  v_add_f32_dpp v226, v226, v226 row_half_mirror row_mask:0xf bank_mask:0xf
  s_nop 0
  v_add_f32_dpp v229, v229, v229 row_half_mirror row_mask:0xf bank_mask:0xf
  v_max3_f32 v232, v128, v226, v229
  v_cmp_gt_f32 vcc, v232, v128
  s_cbranch_vccz Lsk432
  v_sub_f32 v234, v128, v232
  v_mul_f32 v234, s74, v234
  v_exp_f32 v234, v234
  v_mov_b32 v128, v232
  RESC 104, 234
  v_mul_f32 v129, v234, v129
Lsk432:
  v_mul_f32 v233, s74, v128
  v_fma_f32 v235, v226, s74, -v233
  v_fma_f32 v236, v229, s74, -v233
  v_exp_f32 v235, v235
  v_exp_f32 v236, v236
  v_cvt_pk_bf16_f32 v238, v235, 0
  v_cvt_pk_bf16_f32 v239, 0, v235
  v_cvt_pk_bf16_f32 v240, v236, 0
  v_cvt_pk_bf16_f32 v241, 0, v236
  v_add_f32 v129, v129, v239
  v_add_f32 v129, v129, v241
  s_waitcnt vmcnt(9)
  PV 20, 238, 104
  s_mov_b32 s76, 0x1a400
  LDT v, 20, 36
  s_waitcnt vmcnt(9)
  PV 44, 240, 104
  s_mov_b32 s76, 0x1b000
  LDT v, 44, 36
  s_add_u32 s76, s72, 0x6000
  buffer_load_dwordx4 v[92:95], v2, s[64:67], s76 offen sc1
  buffer_load_dwordx4 v[96:99], v2, s[64:67], s76 offen offset:128 sc1
  buffer_load_dwordx4 v[100:103], v2, s[64:67], s76 offen offset:256 sc1
  s_waitcnt vmcnt(12)
  s_waitcnt vmcnt(9)
  QK2 8, 32, 80, 226
  s_mov_b32 s76, 0x1bc00
  LDT v, 8, 32
  s_mov_b32 s76, 0x1c800
  LDT v, 32, 32
  v_add_f32 v226, v226, v227
  v_add_f32 v226, v226, v228
  v_add_f32 v229, v229, v230
  v_add_f32 v229, v229, v231
  v_add_f32_dpp v226, v226, v226 quad_perm:[1,0,3,2] row_mask:0xf bank_mask:0xf
  s_nop 0
  v_add_f32_dpp v229, v229, v229 quad_perm:[1,0,3,2] row_mask:0xf bank_mask:0xf
  v_add_f32_dpp v226, v226, v226 quad_perm:[2,3,0,1] row_mask:0xf bank_mask:0xf
  s_nop 0
  v_add_f32_dpp v229, v229, v229 quad_perm:[2,3,0,1] row_mask:0xf bank_mask:0xf
  v_add_f32_dpp v226, v226, v226 row_half_mirror row_mask:0xf bank_mask:0xf
  s_nop 0
  v_add_f32_dpp v229, v229, v229 row_half_mirror row_mask:0xf bank_mask:0xf
  v_max3_f32 v232, v128, v226, v229
  v_cmp_gt_f32 vcc, v232, v128
  s_cbranch_vccz Lsk433
  v_sub_f32 v234, v128, v232
  v_mul_f32 v234, s74, v234
  v_exp_f32 v234, v234
  v_mov_b32 v128, v232
  RESC 104, 234
  v_mul_f32 v129, v234, v129
Lsk433:
  v_mul_f32 v233, s74, v128
  v_fma_f32 v235, v226, s74, -v233
  v_fma_f32 v236, v229, s74, -v233
  v_exp_f32 v235, v235
  v_exp_f32 v236, v236
  v_cvt_pk_bf16_f32 v238, v235, 0
  v_cvt_pk_bf16_f32 v239, 0, v235
  v_cvt_pk_bf16_f32 v240, v236, 0
  v_cvt_pk_bf16_f32 v241, 0, v236
  v_add_f32 v129, v129, v239
  v_add_f32 v129, v129, v241
  s_waitcnt vmcnt(12)
  PV 20, 238, 104
  s_mov_b32 s76, 0x1bc00
  LDT v, 20, 36
  s_waitcnt vmcnt(12)
  PV 44, 240, 104
  s_mov_b32 s76, 0x1c800
  LDT v, 44, 36
  s_waitcnt vmcnt(9)
  s_waitcnt vmcnt(6)
  QK2 8, 32, 80, 226
  s_mov_b32 s76, 0x1d400
  LDT v, 8, 32
  s_mov_b32 s76, 0x1d400
  LDT v, 32, 36
  v_add_f32 v226, v226, v227
  v_add_f32 v226, v226, v228
  v_add_f32 v229, v229, v230
  v_add_f32 v229, v229, v231
  v_add_f32_dpp v226, v226, v226 quad_perm:[1,0,3,2] row_mask:0xf bank_mask:0xf
  s_nop 0
  v_add_f32_dpp v229, v229, v229 quad_perm:[1,0,3,2] row_mask:0xf bank_mask:0xf
  v_add_f32_dpp v226, v226, v226 quad_perm:[2,3,0,1] row_mask:0xf bank_mask:0xf
  s_nop 0
  v_add_f32_dpp v229, v229, v229 quad_perm:[2,3,0,1] row_mask:0xf bank_mask:0xf
  v_add_f32_dpp v226, v226, v226 row_half_mirror row_mask:0xf bank_mask:0xf
  s_nop 0
  v_add_f32_dpp v229, v229, v229 row_half_mirror row_mask:0xf bank_mask:0xf
  v_max3_f32 v232, v128, v226, v229
  v_cmp_gt_f32 vcc, v232, v128
  s_cbranch_vccz Lsk434
  v_sub_f32 v234, v128, v232
  v_mul_f32 v234, s74, v234
  v_exp_f32 v234, v234
  v_mov_b32 v128, v232
  RESC 104, 234
  v_mul_f32 v129, v234, v129
Lsk434:
  v_mul_f32 v233, s74, v128
  v_fma_f32 v235, v226, s74, -v233
  v_fma_f32 v236, v229, s74, -v233
  v_exp_f32 v235, v235
  v_exp_f32 v236, v236
  v_cvt_pk_bf16_f32 v238, v235, 0
  v_cvt_pk_bf16_f32 v239, 0, v235
  v_cvt_pk_bf16_f32 v240, v236, 0
  v_cvt_pk_bf16_f32 v241, 0, v236
  v_add_f32 v129, v129, v239
  v_add_f32 v129, v129, v241
  s_waitcnt vmcnt(9)
  PV 20, 238, 104
  s_mov_b32 s76, 0x18c00
  LDT v, 20, 48
  s_waitcnt vmcnt(9)
  PV 44, 240, 104
  s_mov_b32 s76, 0x19800
  LDT v, 44, 48
  s_waitcnt vmcnt(9)
  v_dot2_f32_bf16 v226, v8, v80, 0
  v_dot2_f32_bf16 v227, v12, v84, 0
  v_dot2_f32_bf16 v228, v16, v88, 0
  s_nop 0
  v_dot2c_f32_bf16 v226, v9, v81
  v_dot2c_f32_bf16 v227, v13, v85
  v_dot2c_f32_bf16 v228, v17, v89
  v_dot2c_f32_bf16 v226, v10, v82
  v_dot2c_f32_bf16 v227, v14, v86
  v_dot2c_f32_bf16 v228, v18, v90
  v_dot2c_f32_bf16 v226, v11, v83
  v_dot2c_f32_bf16 v227, v15, v87
  v_dot2c_f32_bf16 v228, v19, v91
  s_mov_b32 s76, 0x18c00
  LDT v, 8, 52
  v_add_f32 v226, v226, v227
  v_add_f32 v226, v226, v228
  s_nop 1
  v_add_f32_dpp v226, v226, v226 quad_perm:[1,0,3,2] row_mask:0xf bank_mask:0xf
  s_nop 1
  v_add_f32_dpp v226, v226, v226 quad_perm:[2,3,0,1] row_mask:0xf bank_mask:0xf
  s_nop 1
  v_add_f32_dpp v226, v226, v226 row_half_mirror row_mask:0xf bank_mask:0xf
  v_add_f32 v226, s80, v226
  v_max_f32 v232, v128, v226
  v_cmp_gt_f32 vcc, v232, v128
  s_cbranch_vccz Lsk435
  v_sub_f32 v234, v128, v232
  v_mul_f32 v234, s74, v234
  v_exp_f32 v234, v234
  v_mov_b32 v128, v232
  RESC 104, 234
  v_mul_f32 v129, v234, v129
Lsk435:
  v_mul_f32 v233, s74, v128
  v_fma_f32 v235, v226, s74, -v233
  v_exp_f32 v235, v235
  s_nop 0
  v_cvt_pk_bf16_f32 v238, v235, 0
  v_cvt_pk_bf16_f32 v239, 0, v235
  v_add_f32 v129, v129, v239
  s_waitcnt vmcnt(9)
  PV 32, 238, 104
  s_mov_b32 s76, 0x19800
  LDT v, 32, 52
  v_max_f32_dpp v226, v128, v128 row_ror:8 row_mask:0xf bank_mask:0xf
  v_mov_b32 v227, v226
  s_nop 1
  v_permlane16_swap_b32 v226, v227
  v_max_f32 v226, v226, v227
  v_mov_b32 v227, v226
  s_nop 1
  v_permlane32_swap_b32 v226, v227
  v_max_f32 v226, v226, v227
  v_sub_f32 v228, v128, v226
  v_mul_f32 v228, s74, v228
  v_exp_f32 v228, v228
  v_mul_f32 v226, s74, v226
  RESC 104, 228
  v_mul_f32 v129, v228, v129
  s_nop 1
  v_add_f32_dpp v129, v129, v129 row_ror:8 row_mask:0xf bank_mask:0xf
  v_mov_b32 v227, v129
  s_nop 1
  v_permlane16_swap_b32 v129, v227
  v_add_f32 v129, v129, v227
  v_mov_b32 v227, v129
  s_nop 1
  v_permlane32_swap_b32 v129, v227
  v_add_f32 v129, v129, v227
  v_permlane32_swap_b32 v104, v116
  v_permlane32_swap_b32 v105, v117
  v_permlane32_swap_b32 v106, v118
  v_permlane32_swap_b32 v107, v119
  v_permlane32_swap_b32 v108, v120
  v_permlane32_swap_b32 v109, v121
  v_permlane32_swap_b32 v110, v122
  v_permlane32_swap_b32 v111, v123
  v_permlane32_swap_b32 v112, v124
  v_permlane32_swap_b32 v113, v125
  v_permlane32_swap_b32 v114, v126
  v_permlane32_swap_b32 v115, v127
  v_add_f32 v104, v104, v116
  v_add_f32 v105, v105, v117
  v_add_f32 v106, v106, v118
  v_add_f32 v107, v107, v119
  v_add_f32 v108, v108, v120
  v_add_f32 v109, v109, v121
  v_add_f32 v110, v110, v122
  v_add_f32 v111, v111, v123
  v_add_f32 v112, v112, v124
  v_add_f32 v113, v113, v125
  v_add_f32 v114, v114, v126
  v_add_f32 v115, v115, v127
  v_permlane16_swap_b32 v104, v110
  v_permlane16_swap_b32 v105, v111
  v_permlane16_swap_b32 v106, v112
  v_permlane16_swap_b32 v107, v113
  v_permlane16_swap_b32 v108, v114
  v_permlane16_swap_b32 v109, v115
  v_add_f32 v104, v104, v110
  v_add_f32 v105, v105, v111
  v_add_f32 v106, v106, v112
  v_add_f32 v107, v107, v113
  v_add_f32 v108, v108, v114
  v_add_f32 v109, v109, v115
  v_add_f32_dpp v104, v104, v104 row_ror:8 row_mask:0xf bank_mask:0xf
  v_add_f32_dpp v105, v105, v105 row_ror:8 row_mask:0xf bank_mask:0xf
  v_add_f32_dpp v106, v106, v106 row_ror:8 row_mask:0xf bank_mask:0xf
  v_add_f32_dpp v107, v107, v107 row_ror:8 row_mask:0xf bank_mask:0xf
  v_add_f32_dpp v108, v108, v108 row_ror:8 row_mask:0xf bank_mask:0xf
  v_add_f32_dpp v109, v109, v109 row_ror:8 row_mask:0xf bank_mask:0xf
  v_add_u32 v229, 0, v7
  v_lshrrev_b32 v230, 3, v229
  v_and_b32 v229, 7, v229
  v_lshlrev_b32 v230, 6, v230
  v_add_u32 v229, v229, v230
  v_lshl_add_u32 v229, v229, 2, v4
  ds_write_b32 v229, v104
  v_add_u32 v229, 1, v7
  v_lshrrev_b32 v230, 3, v229
  v_and_b32 v229, 7, v229
  v_lshlrev_b32 v230, 6, v230
  v_add_u32 v229, v229, v230
  v_lshl_add_u32 v229, v229, 2, v4
  ds_write_b32 v229, v105
  v_add_u32 v229, 2, v7
  v_lshrrev_b32 v230, 3, v229
  v_and_b32 v229, 7, v229
  v_lshlrev_b32 v230, 6, v230
  v_add_u32 v229, v229, v230
  v_lshl_add_u32 v229, v229, 2, v4
  ds_write_b32 v229, v106
  v_add_u32 v229, 3, v7
  v_lshrrev_b32 v230, 3, v229
  v_and_b32 v229, 7, v229
  v_lshlrev_b32 v230, 6, v230
  v_add_u32 v229, v229, v230
  v_lshl_add_u32 v229, v229, 2, v4
  ds_write_b32 v229, v107
  v_add_u32 v229, 4, v7
  v_lshrrev_b32 v230, 3, v229
  v_and_b32 v229, 7, v229
  v_lshlrev_b32 v230, 6, v230
  v_add_u32 v229, v229, v230
  v_lshl_add_u32 v229, v229, 2, v4
  ds_write_b32 v229, v108
  v_add_u32 v229, 5, v7
  v_lshrrev_b32 v230, 3, v229
  v_and_b32 v229, 7, v229
  v_lshlrev_b32 v230, 6, v230
  v_add_u32 v229, v229, v230
  v_lshl_add_u32 v229, v229, 2, v4
  ds_write_b32 v229, v109
  v_mov_b32 v234, v226
  v_mov_b32 v235, v129
  v_mov_b32 v236, 0
  v_mov_b32 v237, 0
  v_and_b32 v229, 0xffffff1f, v4
  ds_write_b128 v229, v[234:237] offset:768
  s_waitcnt lgkmcnt(0)
  ds_read_b128 v[234:237], v5
  s_waitcnt lgkmcnt(0)
  s_add_u32 s76, s73, 0x3bb800
  s_mov_b32 exec_lo, -1
  s_mov_b32 exec_hi, 0x1ffff
  buffer_store_dwordx4 v[234:237], v6, s[64:67], s76 offen sc1
  s_mov_b64 exec, -1
  v_max3_u32 v226, v92, v93, v94
  v_max3_u32 v226, v226, v95, v96
  v_max3_u32 v226, v226, v97, v98
  v_max3_u32 v226, v226, v99, v100
  v_max3_u32 v226, v226, v101, v102
  v_max3_u32 v226, v226, v103, v103
  v_cmp_eq_u32 vcc, -1, v226
  s_cbranch_vccz Lqo436
  s_mov_b32 s75, 0x61a80
Lqr437:
  s_sleep 2
  s_add_u32 s77, s72, 0x6000
  buffer_load_dwordx4 v[92:95], v2, s[64:67], s77 offen sc1
  buffer_load_dwordx4 v[96:99], v2, s[64:67], s77 offen offset:128 sc1
  buffer_load_dwordx4 v[100:103], v2, s[64:67], s77 offen offset:256 sc1
  s_waitcnt vmcnt(0)
  v_max3_u32 v226, v92, v93, v94
  v_max3_u32 v226, v226, v95, v96
  v_max3_u32 v226, v226, v97, v98
  v_max3_u32 v226, v226, v99, v100
  v_max3_u32 v226, v226, v101, v102
  v_max3_u32 v226, v226, v103, v103
  v_cmp_eq_u32 vcc, -1, v226
  s_cbranch_vccz Lqo436
  s_sub_u32 s75, s75, 1
  s_cmp_lg_u32 s75, 0
  s_cbranch_scc1 Lqr437
Lqo436:
  v_mov_b32 v80, v92
  v_mov_b32 v81, v93
  v_mov_b32 v82, v94
  v_mov_b32 v83, v95
  v_mov_b32 v84, v96
  v_mov_b32 v85, v97
  v_mov_b32 v86, v98
  v_mov_b32 v87, v99
  v_mov_b32 v88, v100
  v_mov_b32 v89, v101
  v_mov_b32 v90, v102
  v_mov_b32 v91, v103
  v_mov_b32 v104, 0
  v_mov_b32 v105, 0
  v_mov_b32 v106, 0
  v_mov_b32 v107, 0
  v_mov_b32 v108, 0
  v_mov_b32 v109, 0
  v_mov_b32 v110, 0
  v_mov_b32 v111, 0
  v_mov_b32 v112, 0
  v_mov_b32 v113, 0
  v_mov_b32 v114, 0
  v_mov_b32 v115, 0
  v_mov_b32 v116, 0
  v_mov_b32 v117, 0
  v_mov_b32 v118, 0
  v_mov_b32 v119, 0
  v_mov_b32 v120, 0
  v_mov_b32 v121, 0
  v_mov_b32 v122, 0
  v_mov_b32 v123, 0
  v_mov_b32 v124, 0
  v_mov_b32 v125, 0
  v_mov_b32 v126, 0
  v_mov_b32 v127, 0
  v_mov_b32 v128, 0xf149f2ca
  v_mov_b32 v129, 0
  s_waitcnt vmcnt(10)
  s_waitcnt vmcnt(7)
  QK2 20, 44, 80, 226
  s_mov_b32 s76, 0x1a400
  LDT v, 20, 48
  s_mov_b32 s76, 0x1b000
  LDT v, 44, 48
  v_add_f32 v226, v226, v227
  v_add_f32 v226, v226, v228
  v_add_f32 v229, v229, v230
  v_add_f32 v229, v229, v231
  v_add_f32_dpp v226, v226, v226 quad_perm:[1,0,3,2] row_mask:0xf bank_mask:0xf
  s_nop 0
  v_add_f32_dpp v229, v229, v229 quad_perm:[1,0,3,2] row_mask:0xf bank_mask:0xf
  v_add_f32_dpp v226, v226, v226 quad_perm:[2,3,0,1] row_mask:0xf bank_mask:0xf
  s_nop 0
  v_add_f32_dpp v229, v229, v229 quad_perm:[2,3,0,1] row_mask:0xf bank_mask:0xf
  v_add_f32_dpp v226, v226, v226 row_half_mirror row_mask:0xf bank_mask:0xf
  s_nop 0
  v_add_f32_dpp v229, v229, v229 row_half_mirror row_mask:0xf bank_mask:0xf
  v_max3_f32 v232, v128, v226, v229
  v_cmp_gt_f32 vcc, v232, v128
  s_cbranch_vccz Lsk438
  v_sub_f32 v234, v128, v232
  v_mul_f32 v234, s74, v234
  v_exp_f32 v234, v234
  v_mov_b32 v128, v232
  RESC 104, 234
  v_mul_f32 v129, v234, v129
Lsk438:
  v_mul_f32 v233, s74, v128
  v_fma_f32 v235, v226, s74, -v233
  v_fma_f32 v236, v229, s74, -v233
  v_exp_f32 v235, v235
  v_exp_f32 v236, v236
  v_cvt_pk_bf16_f32 v238, v235, 0
  v_cvt_pk_bf16_f32 v239, 0, v235
  v_cvt_pk_bf16_f32 v240, v236, 0
  v_cvt_pk_bf16_f32 v241, 0, v236
  v_add_f32 v129, v129, v239
  v_add_f32 v129, v129, v241
  s_waitcnt vmcnt(10)
  PV 8, 238, 104
  s_mov_b32 s76, 0x1a400
  LDT v, 8, 52
  s_waitcnt vmcnt(10)
  PV 32, 240, 104
  s_mov_b32 s76, 0x1b000
  LDT v, 32, 52
  s_add_u32 s76, s72, 0xf000
  buffer_load_dwordx4 v[92:95], v2, s[64:67], s76 offen sc1
  buffer_load_dwordx4 v[96:99], v2, s[64:67], s76 offen offset:128 sc1
  buffer_load_dwordx4 v[100:103], v2, s[64:67], s76 offen offset:256 sc1
  s_waitcnt vmcnt(12)
  s_waitcnt vmcnt(9)
  QK2 20, 44, 80, 226
  s_mov_b32 s76, 0x1bc00
  LDT v, 20, 48
  s_mov_b32 s76, 0x1c800
  LDT v, 44, 48
  v_add_f32 v226, v226, v227
  v_add_f32 v226, v226, v228
  v_add_f32 v229, v229, v230
  v_add_f32 v229, v229, v231
  v_add_f32_dpp v226, v226, v226 quad_perm:[1,0,3,2] row_mask:0xf bank_mask:0xf
  s_nop 0
  v_add_f32_dpp v229, v229, v229 quad_perm:[1,0,3,2] row_mask:0xf bank_mask:0xf
  v_add_f32_dpp v226, v226, v226 quad_perm:[2,3,0,1] row_mask:0xf bank_mask:0xf
  s_nop 0
  v_add_f32_dpp v229, v229, v229 quad_perm:[2,3,0,1] row_mask:0xf bank_mask:0xf
  v_add_f32_dpp v226, v226, v226 row_half_mirror row_mask:0xf bank_mask:0xf
  s_nop 0
  v_add_f32_dpp v229, v229, v229 row_half_mirror row_mask:0xf bank_mask:0xf
  v_max3_f32 v232, v128, v226, v229
  v_cmp_gt_f32 vcc, v232, v128
  s_cbranch_vccz Lsk439
  v_sub_f32 v234, v128, v232
  v_mul_f32 v234, s74, v234
  v_exp_f32 v234, v234
  v_mov_b32 v128, v232
  RESC 104, 234
  v_mul_f32 v129, v234, v129
Lsk439:
  v_mul_f32 v233, s74, v128
  v_fma_f32 v235, v226, s74, -v233
  v_fma_f32 v236, v229, s74, -v233
  v_exp_f32 v235, v235
  v_exp_f32 v236, v236
  v_cvt_pk_bf16_f32 v238, v235, 0
  v_cvt_pk_bf16_f32 v239, 0, v235
  v_cvt_pk_bf16_f32 v240, v236, 0
  v_cvt_pk_bf16_f32 v241, 0, v236
  v_add_f32 v129, v129, v239
  v_add_f32 v129, v129, v241
  s_waitcnt vmcnt(12)
  PV 8, 238, 104
  s_mov_b32 s76, 0x1bc00
  LDT v, 8, 52
  s_waitcnt vmcnt(12)
  PV 32, 240, 104
  s_mov_b32 s76, 0x1c800
  LDT v, 32, 52
  s_waitcnt vmcnt(9)
  s_waitcnt vmcnt(6)
  QK2 20, 44, 80, 226
  s_mov_b32 s76, 0x1d400
  LDT v, 20, 48
  s_mov_b32 s76, 0x1d400
  LDT v, 44, 52
  v_add_f32 v226, v226, v227
  v_add_f32 v226, v226, v228
  v_add_f32 v229, v229, v230
  v_add_f32 v229, v229, v231
  v_add_f32_dpp v226, v226, v226 quad_perm:[1,0,3,2] row_mask:0xf bank_mask:0xf
  s_nop 0
  v_add_f32_dpp v229, v229, v229 quad_perm:[1,0,3,2] row_mask:0xf bank_mask:0xf
  v_add_f32_dpp v226, v226, v226 quad_perm:[2,3,0,1] row_mask:0xf bank_mask:0xf
  s_nop 0
  v_add_f32_dpp v229, v229, v229 quad_perm:[2,3,0,1] row_mask:0xf bank_mask:0xf
  v_add_f32_dpp v226, v226, v226 row_half_mirror row_mask:0xf bank_mask:0xf
  s_nop 0
  v_add_f32_dpp v229, v229, v229 row_half_mirror row_mask:0xf bank_mask:0xf
  v_max3_f32 v232, v128, v226, v229
  v_cmp_gt_f32 vcc, v232, v128
  s_cbranch_vccz Lsk440
  v_sub_f32 v234, v128, v232
  v_mul_f32 v234, s74, v234
  v_exp_f32 v234, v234
  v_mov_b32 v128, v232
  RESC 104, 234
  v_mul_f32 v129, v234, v129
Lsk440:
  v_mul_f32 v233, s74, v128
  v_fma_f32 v235, v226, s74, -v233
  v_fma_f32 v236, v229, s74, -v233
  v_exp_f32 v235, v235
  v_exp_f32 v236, v236
  v_cvt_pk_bf16_f32 v238, v235, 0
  v_cvt_pk_bf16_f32 v239, 0, v235
  v_cvt_pk_bf16_f32 v240, v236, 0
  v_cvt_pk_bf16_f32 v241, 0, v236
  v_add_f32 v129, v129, v239
  v_add_f32 v129, v129, v241
  s_waitcnt vmcnt(9)
  PV 8, 238, 104
  s_mov_b32 s76, 0xfc00
  LDT v, 8, 40
  s_waitcnt vmcnt(9)
  PV 32, 240, 104
  s_mov_b32 s76, 0x10800
  LDT v, 32, 40
  s_waitcnt vmcnt(9)
  v_dot2_f32_bf16 v226, v20, v80, 0
  v_dot2_f32_bf16 v227, v24, v84, 0
  v_dot2_f32_bf16 v228, v28, v88, 0
  s_nop 0
  v_dot2c_f32_bf16 v226, v21, v81
  v_dot2c_f32_bf16 v227, v25, v85
  v_dot2c_f32_bf16 v228, v29, v89
  v_dot2c_f32_bf16 v226, v22, v82
  v_dot2c_f32_bf16 v227, v26, v86
  v_dot2c_f32_bf16 v228, v30, v90
  v_dot2c_f32_bf16 v226, v23, v83
  v_dot2c_f32_bf16 v227, v27, v87
  v_dot2c_f32_bf16 v228, v31, v91
  s_mov_b32 s76, 0xfc00
  LDT v, 20, 44
  v_add_f32 v226, v226, v227
  v_add_f32 v226, v226, v228
  s_nop 1
  v_add_f32_dpp v226, v226, v226 quad_perm:[1,0,3,2] row_mask:0xf bank_mask:0xf
  s_nop 1
  v_add_f32_dpp v226, v226, v226 quad_perm:[2,3,0,1] row_mask:0xf bank_mask:0xf
  s_nop 1
  v_add_f32_dpp v226, v226, v226 row_half_mirror row_mask:0xf bank_mask:0xf
  v_add_f32 v226, s82, v226
  v_max_f32 v232, v128, v226
  v_cmp_gt_f32 vcc, v232, v128
  s_cbranch_vccz Lsk441
  v_sub_f32 v234, v128, v232
  v_mul_f32 v234, s74, v234
  v_exp_f32 v234, v234
  v_mov_b32 v128, v232
  RESC 104, 234
  v_mul_f32 v129, v234, v129
Lsk441:
  v_mul_f32 v233, s74, v128
  v_fma_f32 v235, v226, s74, -v233
  v_exp_f32 v235, v235
  s_nop 0
  v_cvt_pk_bf16_f32 v238, v235, 0
  v_cvt_pk_bf16_f32 v239, 0, v235
  v_add_f32 v129, v129, v239
  s_waitcnt vmcnt(9)
  PV 44, 238, 104
  s_mov_b32 s76, 0x10800
  LDT v, 44, 44
  v_max_f32_dpp v226, v128, v128 row_ror:8 row_mask:0xf bank_mask:0xf
  v_mov_b32 v227, v226
  s_nop 1
  v_permlane16_swap_b32 v226, v227
  v_max_f32 v226, v226, v227
  v_mov_b32 v227, v226
  s_nop 1
  v_permlane32_swap_b32 v226, v227
  v_max_f32 v226, v226, v227
  v_sub_f32 v228, v128, v226
  v_mul_f32 v228, s74, v228
  v_exp_f32 v228, v228
  v_mul_f32 v226, s74, v226
  RESC 104, 228
  v_mul_f32 v129, v228, v129
  s_nop 1
  v_add_f32_dpp v129, v129, v129 row_ror:8 row_mask:0xf bank_mask:0xf
  v_mov_b32 v227, v129
  s_nop 1
  v_permlane16_swap_b32 v129, v227
  v_add_f32 v129, v129, v227
  v_mov_b32 v227, v129
  s_nop 1
  v_permlane32_swap_b32 v129, v227
  v_add_f32 v129, v129, v227
  v_permlane32_swap_b32 v104, v116
  v_permlane32_swap_b32 v105, v117
  v_permlane32_swap_b32 v106, v118
  v_permlane32_swap_b32 v107, v119
  v_permlane32_swap_b32 v108, v120
  v_permlane32_swap_b32 v109, v121
  v_permlane32_swap_b32 v110, v122
  v_permlane32_swap_b32 v111, v123
  v_permlane32_swap_b32 v112, v124
  v_permlane32_swap_b32 v113, v125
  v_permlane32_swap_b32 v114, v126
  v_permlane32_swap_b32 v115, v127
  v_add_f32 v104, v104, v116
  v_add_f32 v105, v105, v117
  v_add_f32 v106, v106, v118
  v_add_f32 v107, v107, v119
  v_add_f32 v108, v108, v120
  v_add_f32 v109, v109, v121
  v_add_f32 v110, v110, v122
  v_add_f32 v111, v111, v123
  v_add_f32 v112, v112, v124
  v_add_f32 v113, v113, v125
  v_add_f32 v114, v114, v126
  v_add_f32 v115, v115, v127
  v_permlane16_swap_b32 v104, v110
  v_permlane16_swap_b32 v105, v111
  v_permlane16_swap_b32 v106, v112
  v_permlane16_swap_b32 v107, v113
  v_permlane16_swap_b32 v108, v114
  v_permlane16_swap_b32 v109, v115
  v_add_f32 v104, v104, v110
  v_add_f32 v105, v105, v111
  v_add_f32 v106, v106, v112
  v_add_f32 v107, v107, v113
  v_add_f32 v108, v108, v114
  v_add_f32 v109, v109, v115
  v_add_f32_dpp v104, v104, v104 row_ror:8 row_mask:0xf bank_mask:0xf
  v_add_f32_dpp v105, v105, v105 row_ror:8 row_mask:0xf bank_mask:0xf
  v_add_f32_dpp v106, v106, v106 row_ror:8 row_mask:0xf bank_mask:0xf
  v_add_f32_dpp v107, v107, v107 row_ror:8 row_mask:0xf bank_mask:0xf
  v_add_f32_dpp v108, v108, v108 row_ror:8 row_mask:0xf bank_mask:0xf
  v_add_f32_dpp v109, v109, v109 row_ror:8 row_mask:0xf bank_mask:0xf
  v_add_u32 v229, 0, v7
  v_lshrrev_b32 v230, 3, v229
  v_and_b32 v229, 7, v229
  v_lshlrev_b32 v230, 6, v230
  v_add_u32 v229, v229, v230
  v_lshl_add_u32 v229, v229, 2, v4
  ds_write_b32 v229, v104
  v_add_u32 v229, 1, v7
  v_lshrrev_b32 v230, 3, v229
  v_and_b32 v229, 7, v229
  v_lshlrev_b32 v230, 6, v230
  v_add_u32 v229, v229, v230
  v_lshl_add_u32 v229, v229, 2, v4
  ds_write_b32 v229, v105
  v_add_u32 v229, 2, v7
  v_lshrrev_b32 v230, 3, v229
  v_and_b32 v229, 7, v229
  v_lshlrev_b32 v230, 6, v230
  v_add_u32 v229, v229, v230
  v_lshl_add_u32 v229, v229, 2, v4
  ds_write_b32 v229, v106
  v_add_u32 v229, 3, v7
  v_lshrrev_b32 v230, 3, v229
  v_and_b32 v229, 7, v229
  v_lshlrev_b32 v230, 6, v230
  v_add_u32 v229, v229, v230
  v_lshl_add_u32 v229, v229, 2, v4
  ds_write_b32 v229, v107
  v_add_u32 v229, 4, v7
  v_lshrrev_b32 v230, 3, v229
  v_and_b32 v229, 7, v229
  v_lshlrev_b32 v230, 6, v230
  v_add_u32 v229, v229, v230
  v_lshl_add_u32 v229, v229, 2, v4
  ds_write_b32 v229, v108
  v_add_u32 v229, 5, v7
  v_lshrrev_b32 v230, 3, v229
  v_and_b32 v229, 7, v229
  v_lshlrev_b32 v230, 6, v230
  v_add_u32 v229, v229, v230
  v_lshl_add_u32 v229, v229, 2, v4
  ds_write_b32 v229, v109
  v_mov_b32 v234, v226
  v_mov_b32 v235, v129
  v_mov_b32 v236, 0
  v_mov_b32 v237, 0
  v_and_b32 v229, 0xffffff1f, v4
  ds_write_b128 v229, v[234:237] offset:768
  s_waitcnt lgkmcnt(0)
  ds_read_b128 v[234:237], v5
  s_waitcnt lgkmcnt(0)
  s_add_u32 s76, s73, 0x45ac00
  s_mov_b32 exec_lo, -1
  s_mov_b32 exec_hi, 0x1ffff
  buffer_store_dwordx4 v[234:237], v6, s[64:67], s76 offen sc1
  s_mov_b64 exec, -1
  v_max3_u32 v226, v92, v93, v94
  v_max3_u32 v226, v226, v95, v96
  v_max3_u32 v226, v226, v97, v98
  v_max3_u32 v226, v226, v99, v100
  v_max3_u32 v226, v226, v101, v102
  v_max3_u32 v226, v226, v103, v103
  v_cmp_eq_u32 vcc, -1, v226
  s_cbranch_vccz Lqo442
  s_mov_b32 s75, 0x61a80
Lqr443:
  s_sleep 2
  s_add_u32 s77, s72, 0xf000
  buffer_load_dwordx4 v[92:95], v2, s[64:67], s77 offen sc1
  buffer_load_dwordx4 v[96:99], v2, s[64:67], s77 offen offset:128 sc1
  buffer_load_dwordx4 v[100:103], v2, s[64:67], s77 offen offset:256 sc1
  s_waitcnt vmcnt(0)
  v_max3_u32 v226, v92, v93, v94
  v_max3_u32 v226, v226, v95, v96
  v_max3_u32 v226, v226, v97, v98
  v_max3_u32 v226, v226, v99, v100
  v_max3_u32 v226, v226, v101, v102
  v_max3_u32 v226, v226, v103, v103
  v_cmp_eq_u32 vcc, -1, v226
  s_cbranch_vccz Lqo442
  s_sub_u32 s75, s75, 1
  s_cmp_lg_u32 s75, 0
  s_cbranch_scc1 Lqr443
Lqo442:
  v_mov_b32 v80, v92
  v_mov_b32 v81, v93
  v_mov_b32 v82, v94
  v_mov_b32 v83, v95
  v_mov_b32 v84, v96
  v_mov_b32 v85, v97
  v_mov_b32 v86, v98
  v_mov_b32 v87, v99
  v_mov_b32 v88, v100
  v_mov_b32 v89, v101
  v_mov_b32 v90, v102
  v_mov_b32 v91, v103
  v_mov_b32 v104, 0
  v_mov_b32 v105, 0
  v_mov_b32 v106, 0
  v_mov_b32 v107, 0
  v_mov_b32 v108, 0
  v_mov_b32 v109, 0
  v_mov_b32 v110, 0
  v_mov_b32 v111, 0
  v_mov_b32 v112, 0
  v_mov_b32 v113, 0
  v_mov_b32 v114, 0
  v_mov_b32 v115, 0
  v_mov_b32 v116, 0
  v_mov_b32 v117, 0
  v_mov_b32 v118, 0
  v_mov_b32 v119, 0
  v_mov_b32 v120, 0
  v_mov_b32 v121, 0
  v_mov_b32 v122, 0
  v_mov_b32 v123, 0
  v_mov_b32 v124, 0
  v_mov_b32 v125, 0
  v_mov_b32 v126, 0
  v_mov_b32 v127, 0
  v_mov_b32 v128, 0xf149f2ca
  v_mov_b32 v129, 0
  s_waitcnt vmcnt(10)
  s_waitcnt vmcnt(7)
  QK2 8, 32, 80, 226
  s_mov_b32 s76, 0x11400
  LDT v, 8, 40
  s_mov_b32 s76, 0x12000
  LDT v, 32, 40
  v_add_f32 v226, v226, v227
  v_add_f32 v226, v226, v228
  v_add_f32 v229, v229, v230
  v_add_f32 v229, v229, v231
  v_add_f32_dpp v226, v226, v226 quad_perm:[1,0,3,2] row_mask:0xf bank_mask:0xf
  s_nop 0
  v_add_f32_dpp v229, v229, v229 quad_perm:[1,0,3,2] row_mask:0xf bank_mask:0xf
  v_add_f32_dpp v226, v226, v226 quad_perm:[2,3,0,1] row_mask:0xf bank_mask:0xf
  s_nop 0
  v_add_f32_dpp v229, v229, v229 quad_perm:[2,3,0,1] row_mask:0xf bank_mask:0xf
  v_add_f32_dpp v226, v226, v226 row_half_mirror row_mask:0xf bank_mask:0xf
  s_nop 0
  v_add_f32_dpp v229, v229, v229 row_half_mirror row_mask:0xf bank_mask:0xf
  v_max3_f32 v232, v128, v226, v229
  v_cmp_gt_f32 vcc, v232, v128
  s_cbranch_vccz Lsk444
  v_sub_f32 v234, v128, v232
  v_mul_f32 v234, s74, v234
  v_exp_f32 v234, v234
  v_mov_b32 v128, v232
  RESC 104, 234
  v_mul_f32 v129, v234, v129
Lsk444:
  v_mul_f32 v233, s74, v128
  v_fma_f32 v235, v226, s74, -v233
  v_fma_f32 v236, v229, s74, -v233
  v_exp_f32 v235, v235
  v_exp_f32 v236, v236
  v_cvt_pk_bf16_f32 v238, v235, 0
  v_cvt_pk_bf16_f32 v239, 0, v235
  v_cvt_pk_bf16_f32 v240, v236, 0
  v_cvt_pk_bf16_f32 v241, 0, v236
  v_add_f32 v129, v129, v239
  v_add_f32 v129, v129, v241
  s_waitcnt vmcnt(10)
  PV 20, 238, 104
  s_mov_b32 s76, 0x11400
  LDT v, 20, 44
  s_waitcnt vmcnt(10)
  PV 44, 240, 104
  s_mov_b32 s76, 0x12000
  LDT v, 44, 44
  s_waitcnt vmcnt(9)
  s_waitcnt vmcnt(6)
  QK2 8, 32, 80, 226
  s_mov_b32 s76, 0x6000
  LDT v, 8, 52
  s_mov_b32 s76, 0x6c00
  LDT v, 32, 52
  v_add_f32 v226, v226, v227
  v_add_f32 v226, v226, v228
  v_add_f32 v229, v229, v230
  v_add_f32 v229, v229, v231
  v_add_f32_dpp v226, v226, v226 quad_perm:[1,0,3,2] row_mask:0xf bank_mask:0xf
  s_nop 0
  v_add_f32_dpp v229, v229, v229 quad_perm:[1,0,3,2] row_mask:0xf bank_mask:0xf
  v_add_f32_dpp v226, v226, v226 quad_perm:[2,3,0,1] row_mask:0xf bank_mask:0xf
  s_nop 0
  v_add_f32_dpp v229, v229, v229 quad_perm:[2,3,0,1] row_mask:0xf bank_mask:0xf
  v_add_f32_dpp v226, v226, v226 row_half_mirror row_mask:0xf bank_mask:0xf
  s_nop 0
  v_add_f32_dpp v229, v229, v229 row_half_mirror row_mask:0xf bank_mask:0xf
  v_max3_f32 v232, v128, v226, v229
  v_cmp_gt_f32 vcc, v232, v128
  s_cbranch_vccz Lsk445
  v_sub_f32 v234, v128, v232
  v_mul_f32 v234, s74, v234
  v_exp_f32 v234, v234
  v_mov_b32 v128, v232
  RESC 104, 234
  v_mul_f32 v129, v234, v129
Lsk445:
  v_mul_f32 v233, s74, v128
  v_fma_f32 v235, v226, s74, -v233
  v_fma_f32 v236, v229, s74, -v233
  v_exp_f32 v235, v235
  v_exp_f32 v236, v236
  v_cvt_pk_bf16_f32 v238, v235, 0
  v_cvt_pk_bf16_f32 v239, 0, v235
  v_cvt_pk_bf16_f32 v240, v236, 0
  v_cvt_pk_bf16_f32 v241, 0, v236
  v_add_f32 v129, v129, v239
  v_add_f32 v129, v129, v241
  s_waitcnt vmcnt(9)
  PV 20, 238, 104
  s_mov_b32 s76, 0x7800
  LDT v, 20, 52
  s_waitcnt vmcnt(9)
  PV 44, 240, 104
  s_mov_b32 s76, 0x8400
  LDT v, 44, 52
  ACR 56, 0
  ACR 68, 12
  QK2 56, 68, 80, 226
  s_mov_b32 s76, 0
  LDT a, 0, 48
  s_mov_b32 s76, 0xc00
  LDT a, 12, 48
  v_add_f32 v226, v226, v227
  v_add_f32 v226, v226, v228
  v_add_f32 v229, v229, v230
  v_add_f32 v229, v229, v231
  v_add_f32_dpp v226, v226, v226 quad_perm:[1,0,3,2] row_mask:0xf bank_mask:0xf
  s_nop 0
  v_add_f32_dpp v229, v229, v229 quad_perm:[1,0,3,2] row_mask:0xf bank_mask:0xf
  v_add_f32_dpp v226, v226, v226 quad_perm:[2,3,0,1] row_mask:0xf bank_mask:0xf
  s_nop 0
  v_add_f32_dpp v229, v229, v229 quad_perm:[2,3,0,1] row_mask:0xf bank_mask:0xf
  v_add_f32_dpp v226, v226, v226 row_half_mirror row_mask:0xf bank_mask:0xf
  s_nop 0
  v_add_f32_dpp v229, v229, v229 row_half_mirror row_mask:0xf bank_mask:0xf
  v_max3_f32 v232, v128, v226, v229
  v_cmp_gt_f32 vcc, v232, v128
  s_cbranch_vccz Lsk446
  v_sub_f32 v234, v128, v232
  v_mul_f32 v234, s74, v234
  v_exp_f32 v234, v234
  v_mov_b32 v128, v232
  RESC 104, 234
  v_mul_f32 v129, v234, v129
Lsk446:
  v_mul_f32 v233, s74, v128
  v_fma_f32 v235, v226, s74, -v233
  v_fma_f32 v236, v229, s74, -v233
  v_exp_f32 v235, v235
  v_exp_f32 v236, v236
  v_cvt_pk_bf16_f32 v238, v235, 0
  v_cvt_pk_bf16_f32 v239, 0, v235
  v_cvt_pk_bf16_f32 v240, v236, 0
  v_cvt_pk_bf16_f32 v241, 0, v236
  v_add_f32 v129, v129, v239
  v_add_f32 v129, v129, v241
  PV 130, 238, 104
  s_mov_b32 s76, 0
  LDT v, 130, 52
  PV 142, 240, 104
  s_mov_b32 s76, 0xc00
  LDT v, 142, 52
  ACR 56, 24
  ACR 68, 36
  QK2 56, 68, 80, 226
  s_mov_b32 s76, 0x1800
  LDT a, 24, 48
  s_mov_b32 s76, 0x2400
  LDT a, 36, 48
  v_add_f32 v226, v226, v227
  v_add_f32 v226, v226, v228
  v_add_f32 v229, v229, v230
  v_add_f32 v229, v229, v231
  v_add_f32_dpp v226, v226, v226 quad_perm:[1,0,3,2] row_mask:0xf bank_mask:0xf
  s_nop 0
  v_add_f32_dpp v229, v229, v229 quad_perm:[1,0,3,2] row_mask:0xf bank_mask:0xf
  v_add_f32_dpp v226, v226, v226 quad_perm:[2,3,0,1] row_mask:0xf bank_mask:0xf
  s_nop 0
  v_add_f32_dpp v229, v229, v229 quad_perm:[2,3,0,1] row_mask:0xf bank_mask:0xf
  v_add_f32_dpp v226, v226, v226 row_half_mirror row_mask:0xf bank_mask:0xf
  s_nop 0
  v_add_f32_dpp v229, v229, v229 row_half_mirror row_mask:0xf bank_mask:0xf
  v_max3_f32 v232, v128, v226, v229
  v_cmp_gt_f32 vcc, v232, v128
  s_cbranch_vccz Lsk447
  v_sub_f32 v234, v128, v232
  v_mul_f32 v234, s74, v234
  v_exp_f32 v234, v234
  v_mov_b32 v128, v232
  RESC 104, 234
  v_mul_f32 v129, v234, v129
Lsk447:
  v_mul_f32 v233, s74, v128
  v_fma_f32 v235, v226, s74, -v233
  v_fma_f32 v236, v229, s74, -v233
  v_exp_f32 v235, v235
  v_exp_f32 v236, v236
  v_cvt_pk_bf16_f32 v238, v235, 0
  v_cvt_pk_bf16_f32 v239, 0, v235
  v_cvt_pk_bf16_f32 v240, v236, 0
  v_cvt_pk_bf16_f32 v241, 0, v236
  v_add_f32 v129, v129, v239
  v_add_f32 v129, v129, v241
  PV 154, 238, 104
  s_mov_b32 s76, 0x1800
  LDT v, 154, 52
  PV 166, 240, 104
  s_mov_b32 s76, 0x2400
  LDT v, 166, 52
  ACR 56, 48
  ACR 68, 60
  QK2 56, 68, 80, 226
  s_mov_b32 s76, 0x3000
  LDT a, 48, 48
  s_mov_b32 s76, 0x3c00
  LDT a, 60, 48
  v_add_f32 v226, v226, v227
  v_add_f32 v226, v226, v228
  v_add_f32 v229, v229, v230
  v_add_f32 v229, v229, v231
  v_add_f32_dpp v226, v226, v226 quad_perm:[1,0,3,2] row_mask:0xf bank_mask:0xf
  s_nop 0
  v_add_f32_dpp v229, v229, v229 quad_perm:[1,0,3,2] row_mask:0xf bank_mask:0xf
  v_add_f32_dpp v226, v226, v226 quad_perm:[2,3,0,1] row_mask:0xf bank_mask:0xf
  s_nop 0
  v_add_f32_dpp v229, v229, v229 quad_perm:[2,3,0,1] row_mask:0xf bank_mask:0xf
  v_add_f32_dpp v226, v226, v226 row_half_mirror row_mask:0xf bank_mask:0xf
  s_nop 0
  v_add_f32_dpp v229, v229, v229 row_half_mirror row_mask:0xf bank_mask:0xf
  v_max3_f32 v232, v128, v226, v229
  v_cmp_gt_f32 vcc, v232, v128
  s_cbranch_vccz Lsk448
  v_sub_f32 v234, v128, v232
  v_mul_f32 v234, s74, v234
  v_exp_f32 v234, v234
  v_mov_b32 v128, v232
  RESC 104, 234
  v_mul_f32 v129, v234, v129
Lsk448:
  v_mul_f32 v233, s74, v128
  v_fma_f32 v235, v226, s74, -v233
  v_fma_f32 v236, v229, s74, -v233
  v_exp_f32 v235, v235
  v_exp_f32 v236, v236
  v_cvt_pk_bf16_f32 v238, v235, 0
  v_cvt_pk_bf16_f32 v239, 0, v235
  v_cvt_pk_bf16_f32 v240, v236, 0
  v_cvt_pk_bf16_f32 v241, 0, v236
  v_add_f32 v129, v129, v239
  v_add_f32 v129, v129, v241
  PV 178, 238, 104
  s_mov_b32 s76, 0x3000
  LDT v, 178, 52
  PV 190, 240, 104
  s_mov_b32 s76, 0x3c00
  LDT v, 190, 52
  ACR 56, 72
  ACR 68, 84
  QK2 56, 68, 80, 226
  s_mov_b32 s76, 0x4800
  LDT a, 72, 48
  v_add_f32 v226, v226, v227
  v_add_f32 v226, v226, v228
  v_add_f32 v229, v229, v230
  v_add_f32 v229, v229, v231
  v_add_f32_dpp v226, v226, v226 quad_perm:[1,0,3,2] row_mask:0xf bank_mask:0xf
  s_nop 0
  v_add_f32_dpp v229, v229, v229 quad_perm:[1,0,3,2] row_mask:0xf bank_mask:0xf
  v_add_f32_dpp v226, v226, v226 quad_perm:[2,3,0,1] row_mask:0xf bank_mask:0xf
  s_nop 0
  v_add_f32_dpp v229, v229, v229 quad_perm:[2,3,0,1] row_mask:0xf bank_mask:0xf
  v_add_f32_dpp v226, v226, v226 row_half_mirror row_mask:0xf bank_mask:0xf
  s_nop 0
  v_add_f32_dpp v229, v229, v229 row_half_mirror row_mask:0xf bank_mask:0xf
  v_max3_f32 v232, v128, v226, v229
  v_cmp_gt_f32 vcc, v232, v128
  s_cbranch_vccz Lsk449
  v_sub_f32 v234, v128, v232
  v_mul_f32 v234, s74, v234
  v_exp_f32 v234, v234
  v_mov_b32 v128, v232
  RESC 104, 234
  v_mul_f32 v129, v234, v129
Lsk449:
  v_mul_f32 v233, s74, v128
  v_fma_f32 v235, v226, s74, -v233
  v_fma_f32 v236, v229, s74, -v233
  v_exp_f32 v235, v235
  v_exp_f32 v236, v236
  v_cvt_pk_bf16_f32 v238, v235, 0
  v_cvt_pk_bf16_f32 v239, 0, v235
  v_cvt_pk_bf16_f32 v240, v236, 0
  v_cvt_pk_bf16_f32 v241, 0, v236
  v_add_f32 v129, v129, v239
  v_add_f32 v129, v129, v241
  PV 202, 238, 104
  PV 214, 240, 104
  ACR 56, 96
  ACR 68, 108
  QK2 56, 68, 80, 226
  ds_read_b128 v[56:59], v3 offset:0
  ds_read_b128 v[60:63], v3 offset:1024
  ds_read_b128 v[64:67], v3 offset:2048
  ds_read_b128 v[68:71], v3 offset:3072
  ds_read_b128 v[72:75], v3 offset:4096
  ds_read_b128 v[76:79], v3 offset:5120
  v_add_f32 v226, v226, v227
  v_add_f32 v226, v226, v228
  v_add_f32 v229, v229, v230
  v_add_f32 v229, v229, v231
  v_add_f32_dpp v226, v226, v226 quad_perm:[1,0,3,2] row_mask:0xf bank_mask:0xf
  s_nop 0
  v_add_f32_dpp v229, v229, v229 quad_perm:[1,0,3,2] row_mask:0xf bank_mask:0xf
  v_add_f32_dpp v226, v226, v226 quad_perm:[2,3,0,1] row_mask:0xf bank_mask:0xf
  s_nop 0
  v_add_f32_dpp v229, v229, v229 quad_perm:[2,3,0,1] row_mask:0xf bank_mask:0xf
  v_add_f32_dpp v226, v226, v226 row_half_mirror row_mask:0xf bank_mask:0xf
  s_nop 0
  v_add_f32_dpp v229, v229, v229 row_half_mirror row_mask:0xf bank_mask:0xf
  v_max3_f32 v232, v128, v226, v229
  v_cmp_gt_f32 vcc, v232, v128
  s_cbranch_vccz Lsk450
  v_sub_f32 v234, v128, v232
  v_mul_f32 v234, s74, v234
  v_exp_f32 v234, v234
  v_mov_b32 v128, v232
  RESC 104, 234
  v_mul_f32 v129, v234, v129
Lsk450:
  v_mul_f32 v233, s74, v128
  v_fma_f32 v235, v226, s74, -v233
  v_fma_f32 v236, v229, s74, -v233
  v_exp_f32 v235, v235
  v_exp_f32 v236, v236
  v_cvt_pk_bf16_f32 v238, v235, 0
  v_cvt_pk_bf16_f32 v239, 0, v235
  v_cvt_pk_bf16_f32 v240, v236, 0
  v_cvt_pk_bf16_f32 v241, 0, v236
  v_add_f32 v129, v129, v239
  v_add_f32 v129, v129, v241
  s_waitcnt lgkmcnt(3)
  PV 56, 238, 104
  s_waitcnt lgkmcnt(0)
  PV 68, 240, 104
  ACR 56, 120
  ACR 68, 132
  QK2 56, 68, 80, 226
  ds_read_b128 v[56:59], v3 offset:6144
  ds_read_b128 v[60:63], v3 offset:7168
  ds_read_b128 v[64:67], v3 offset:8192
  ds_read_b128 v[68:71], v3 offset:9216
  ds_read_b128 v[72:75], v3 offset:10240
  ds_read_b128 v[76:79], v3 offset:11264
  v_add_f32 v226, v226, v227
  v_add_f32 v226, v226, v228
  v_add_f32 v229, v229, v230
  v_add_f32 v229, v229, v231
  v_add_f32_dpp v226, v226, v226 quad_perm:[1,0,3,2] row_mask:0xf bank_mask:0xf
  s_nop 0
  v_add_f32_dpp v229, v229, v229 quad_perm:[1,0,3,2] row_mask:0xf bank_mask:0xf
  v_add_f32_dpp v226, v226, v226 quad_perm:[2,3,0,1] row_mask:0xf bank_mask:0xf
  s_nop 0
  v_add_f32_dpp v229, v229, v229 quad_perm:[2,3,0,1] row_mask:0xf bank_mask:0xf
  v_add_f32_dpp v226, v226, v226 row_half_mirror row_mask:0xf bank_mask:0xf
  s_nop 0
  v_add_f32_dpp v229, v229, v229 row_half_mirror row_mask:0xf bank_mask:0xf
  v_max3_f32 v232, v128, v226, v229
  v_cmp_gt_f32 vcc, v232, v128
  s_cbranch_vccz Lsk451
  v_sub_f32 v234, v128, v232
  v_mul_f32 v234, s74, v234
  v_exp_f32 v234, v234
  v_mov_b32 v128, v232
  RESC 104, 234
  v_mul_f32 v129, v234, v129
Lsk451:
  v_mul_f32 v233, s74, v128
  v_fma_f32 v235, v226, s74, -v233
  v_fma_f32 v236, v229, s74, -v233
  v_exp_f32 v235, v235
  v_exp_f32 v236, v236
  v_cvt_pk_bf16_f32 v238, v235, 0
  v_cvt_pk_bf16_f32 v239, 0, v235
  v_cvt_pk_bf16_f32 v240, v236, 0
  v_cvt_pk_bf16_f32 v241, 0, v236
  v_add_f32 v129, v129, v239
  v_add_f32 v129, v129, v241
  s_waitcnt lgkmcnt(3)
  PV 56, 238, 104
  s_waitcnt lgkmcnt(0)
  PV 68, 240, 104
  s_waitcnt vmcnt(45)
  s_mov_b32 s76, 0x5400
  LDT a, 84, 48
  s_mov_b32 s76, 0x4800
  LDT v, 202, 52
  ACR 56, 144
  ACR 68, 156
  QK2 56, 68, 80, 226
  ds_read_b128 v[56:59], v3 offset:12288
  ds_read_b128 v[60:63], v3 offset:13312
  ds_read_b128 v[64:67], v3 offset:14336
  ds_read_b128 v[68:71], v3 offset:15360
  ds_read_b128 v[72:75], v3 offset:16384
  ds_read_b128 v[76:79], v3 offset:17408
  v_add_f32 v226, v226, v227
  v_add_f32 v226, v226, v228
  v_add_f32 v229, v229, v230
  v_add_f32 v229, v229, v231
  v_add_f32_dpp v226, v226, v226 quad_perm:[1,0,3,2] row_mask:0xf bank_mask:0xf
  s_nop 0
  v_add_f32_dpp v229, v229, v229 quad_perm:[1,0,3,2] row_mask:0xf bank_mask:0xf
  v_add_f32_dpp v226, v226, v226 quad_perm:[2,3,0,1] row_mask:0xf bank_mask:0xf
  s_nop 0
  v_add_f32_dpp v229, v229, v229 quad_perm:[2,3,0,1] row_mask:0xf bank_mask:0xf
  v_add_f32_dpp v226, v226, v226 row_half_mirror row_mask:0xf bank_mask:0xf
  s_nop 0
  v_add_f32_dpp v229, v229, v229 row_half_mirror row_mask:0xf bank_mask:0xf
  v_max3_f32 v232, v128, v226, v229
  v_cmp_gt_f32 vcc, v232, v128
  s_cbranch_vccz Lsk452
  v_sub_f32 v234, v128, v232
  v_mul_f32 v234, s74, v234
  v_exp_f32 v234, v234
  v_mov_b32 v128, v232
  RESC 104, 234
  v_mul_f32 v129, v234, v129
Lsk452:
  v_mul_f32 v233, s74, v128
  v_fma_f32 v235, v226, s74, -v233
  v_fma_f32 v236, v229, s74, -v233
  v_exp_f32 v235, v235
  v_exp_f32 v236, v236
  v_cvt_pk_bf16_f32 v238, v235, 0
  v_cvt_pk_bf16_f32 v239, 0, v235
  v_cvt_pk_bf16_f32 v240, v236, 0
  v_cvt_pk_bf16_f32 v241, 0, v236
  v_add_f32 v129, v129, v239
  v_add_f32 v129, v129, v241
  s_waitcnt lgkmcnt(3)
  PV 56, 238, 104
  s_waitcnt lgkmcnt(0)
  PV 68, 240, 104
  s_waitcnt vmcnt(45)
  s_mov_b32 s76, 0x5400
  LDT v, 214, 52
  s_mov_b32 s76, 0x6000
  LDT a, 96, 48
  ACR 56, 168
  ACR 68, 180
  QK2 56, 68, 80, 226
  ds_read_b128 v[56:59], v3 offset:18432
  ds_read_b128 v[60:63], v3 offset:19456
  ds_read_b128 v[64:67], v3 offset:20480
  ds_read_b128 v[68:71], v3 offset:21504
  ds_read_b128 v[72:75], v3 offset:22528
  ds_read_b128 v[76:79], v3 offset:23552
  v_add_f32 v226, v226, v227
  v_add_f32 v226, v226, v228
  v_add_f32 v229, v229, v230
  v_add_f32 v229, v229, v231
  v_add_f32_dpp v226, v226, v226 quad_perm:[1,0,3,2] row_mask:0xf bank_mask:0xf
  s_nop 0
  v_add_f32_dpp v229, v229, v229 quad_perm:[1,0,3,2] row_mask:0xf bank_mask:0xf
  v_add_f32_dpp v226, v226, v226 quad_perm:[2,3,0,1] row_mask:0xf bank_mask:0xf
  s_nop 0
  v_add_f32_dpp v229, v229, v229 quad_perm:[2,3,0,1] row_mask:0xf bank_mask:0xf
  v_add_f32_dpp v226, v226, v226 row_half_mirror row_mask:0xf bank_mask:0xf
  s_nop 0
  v_add_f32_dpp v229, v229, v229 row_half_mirror row_mask:0xf bank_mask:0xf
  v_max3_f32 v232, v128, v226, v229
  v_cmp_gt_f32 vcc, v232, v128
  s_cbranch_vccz Lsk453
  v_sub_f32 v234, v128, v232
  v_mul_f32 v234, s74, v234
  v_exp_f32 v234, v234
  v_mov_b32 v128, v232
  RESC 104, 234
  v_mul_f32 v129, v234, v129
Lsk453:
  v_mul_f32 v233, s74, v128
  v_fma_f32 v235, v226, s74, -v233
  v_fma_f32 v236, v229, s74, -v233
  v_exp_f32 v235, v235
  v_exp_f32 v236, v236
  v_cvt_pk_bf16_f32 v238, v235, 0
  v_cvt_pk_bf16_f32 v239, 0, v235
  v_cvt_pk_bf16_f32 v240, v236, 0
  v_cvt_pk_bf16_f32 v241, 0, v236
  v_add_f32 v129, v129, v239
  v_add_f32 v129, v129, v241
  s_waitcnt lgkmcnt(3)
  PV 56, 238, 104
  s_waitcnt lgkmcnt(0)
  PV 68, 240, 104
  s_waitcnt vmcnt(45)
  s_mov_b32 s76, 0x6c00
  LDT a, 108, 48
  s_mov_b32 s76, 0x7800
  LDT a, 120, 48
  s_add_u32 s76, s72, 0x6000
  buffer_load_dwordx4 v[92:95], v2, s[64:67], s76 offen sc1
  buffer_load_dwordx4 v[96:99], v2, s[64:67], s76 offen offset:128 sc1
  buffer_load_dwordx4 v[100:103], v2, s[64:67], s76 offen offset:256 sc1
  ACR 56, 192
  ACR 68, 204
  QK2 56, 68, 80, 226
  ds_read_b128 v[56:59], v3 offset:24576
  ds_read_b128 v[60:63], v3 offset:25600
  ds_read_b128 v[64:67], v3 offset:26624
  ds_read_b128 v[68:71], v3 offset:27648
  ds_read_b128 v[72:75], v3 offset:28672
  ds_read_b128 v[76:79], v3 offset:29696
  v_add_f32 v226, v226, v227
  v_add_f32 v226, v226, v228
  v_add_f32 v229, v229, v230
  v_add_f32 v229, v229, v231
  v_add_f32_dpp v226, v226, v226 quad_perm:[1,0,3,2] row_mask:0xf bank_mask:0xf
  s_nop 0
  v_add_f32_dpp v229, v229, v229 quad_perm:[1,0,3,2] row_mask:0xf bank_mask:0xf
  v_add_f32_dpp v226, v226, v226 quad_perm:[2,3,0,1] row_mask:0xf bank_mask:0xf
  s_nop 0
  v_add_f32_dpp v229, v229, v229 quad_perm:[2,3,0,1] row_mask:0xf bank_mask:0xf
  v_add_f32_dpp v226, v226, v226 row_half_mirror row_mask:0xf bank_mask:0xf
  s_nop 0
  v_add_f32_dpp v229, v229, v229 row_half_mirror row_mask:0xf bank_mask:0xf
  v_max3_f32 v232, v128, v226, v229
  v_cmp_gt_f32 vcc, v232, v128
  s_cbranch_vccz Lsk454
  v_sub_f32 v234, v128, v232
  v_mul_f32 v234, s74, v234
  v_exp_f32 v234, v234
  v_mov_b32 v128, v232
  RESC 104, 234
  v_mul_f32 v129, v234, v129
Lsk454:
  v_mul_f32 v233, s74, v128
  v_fma_f32 v235, v226, s74, -v233
  v_fma_f32 v236, v229, s74, -v233
  v_exp_f32 v235, v235
  v_exp_f32 v236, v236
  v_cvt_pk_bf16_f32 v238, v235, 0
  v_cvt_pk_bf16_f32 v239, 0, v235
  v_cvt_pk_bf16_f32 v240, v236, 0
  v_cvt_pk_bf16_f32 v241, 0, v236
  v_add_f32 v129, v129, v239
  v_add_f32 v129, v129, v241
  s_waitcnt lgkmcnt(3)
  PV 56, 238, 104
  s_waitcnt lgkmcnt(0)
  PV 68, 240, 104
  s_waitcnt vmcnt(48)
  s_mov_b32 s76, 0x8400
  LDT a, 132, 48
  ACR 56, 216
  ACR 68, 228
  QK2 56, 68, 80, 226
  ds_read_b128 v[56:59], v3 offset:30720
  ds_read_b128 v[60:63], v3 offset:31744
  ds_read_b128 v[64:67], v3 offset:32768
  ds_read_b128 v[68:71], v3 offset:33792
  ds_read_b128 v[72:75], v3 offset:34816
  ds_read_b128 v[76:79], v3 offset:35840
  v_add_f32 v226, v226, v227
  v_add_f32 v226, v226, v228
  v_add_f32 v229, v229, v230
  v_add_f32 v229, v229, v231
  v_add_f32_dpp v226, v226, v226 quad_perm:[1,0,3,2] row_mask:0xf bank_mask:0xf
  s_nop 0
  v_add_f32_dpp v229, v229, v229 quad_perm:[1,0,3,2] row_mask:0xf bank_mask:0xf
  v_add_f32_dpp v226, v226, v226 quad_perm:[2,3,0,1] row_mask:0xf bank_mask:0xf
  s_nop 0
  v_add_f32_dpp v229, v229, v229 quad_perm:[2,3,0,1] row_mask:0xf bank_mask:0xf
  v_add_f32_dpp v226, v226, v226 row_half_mirror row_mask:0xf bank_mask:0xf
  s_nop 0
  v_add_f32_dpp v229, v229, v229 row_half_mirror row_mask:0xf bank_mask:0xf
  v_max3_f32 v232, v128, v226, v229
  v_cmp_gt_f32 vcc, v232, v128
  s_cbranch_vccz Lsk455
  v_sub_f32 v234, v128, v232
  v_mul_f32 v234, s74, v234
  v_exp_f32 v234, v234
  v_mov_b32 v128, v232
  RESC 104, 234
  v_mul_f32 v129, v234, v129
Lsk455:
  v_mul_f32 v233, s74, v128
  v_fma_f32 v235, v226, s74, -v233
  v_fma_f32 v236, v229, s74, -v233
  v_exp_f32 v235, v235
  v_exp_f32 v236, v236
  v_cvt_pk_bf16_f32 v238, v235, 0
  v_cvt_pk_bf16_f32 v239, 0, v235
  v_cvt_pk_bf16_f32 v240, v236, 0
  v_cvt_pk_bf16_f32 v241, 0, v236
  v_add_f32 v129, v129, v239
  v_add_f32 v129, v129, v241
  s_waitcnt lgkmcnt(3)
  PV 56, 238, 104
  s_waitcnt lgkmcnt(0)
  PV 68, 240, 104
  s_waitcnt vmcnt(45)
  s_mov_b32 s76, 0x9000
  LDT a, 144, 48
  s_mov_b32 s76, 0x9c00
  LDT a, 156, 48
  ACR 56, 240
  v_dot2_f32_bf16 v226, v56, v80, 0
  v_dot2_f32_bf16 v227, v60, v84, 0
  v_dot2_f32_bf16 v228, v64, v88, 0
  s_nop 0
  v_dot2c_f32_bf16 v226, v57, v81
  v_dot2c_f32_bf16 v227, v61, v85
  v_dot2c_f32_bf16 v228, v65, v89
  v_dot2c_f32_bf16 v226, v58, v82
  v_dot2c_f32_bf16 v227, v62, v86
  v_dot2c_f32_bf16 v228, v66, v90
  v_dot2c_f32_bf16 v226, v59, v83
  v_dot2c_f32_bf16 v227, v63, v87
  v_dot2c_f32_bf16 v228, v67, v91
  ds_read_b128 v[56:59], v3 offset:36864
  ds_read_b128 v[60:63], v3 offset:37888
  ds_read_b128 v[64:67], v3 offset:38912
  v_add_f32 v226, v226, v227
  v_add_f32 v226, v226, v228
  s_nop 1
  v_add_f32_dpp v226, v226, v226 quad_perm:[1,0,3,2] row_mask:0xf bank_mask:0xf
  s_nop 1
  v_add_f32_dpp v226, v226, v226 quad_perm:[2,3,0,1] row_mask:0xf bank_mask:0xf
  s_nop 1
  v_add_f32_dpp v226, v226, v226 row_half_mirror row_mask:0xf bank_mask:0xf
  v_max_f32 v232, v128, v226
  v_cmp_gt_f32 vcc, v232, v128
  s_cbranch_vccz Lsk456
  v_sub_f32 v234, v128, v232
  v_mul_f32 v234, s74, v234
  v_exp_f32 v234, v234
  v_mov_b32 v128, v232
  RESC 104, 234
  v_mul_f32 v129, v234, v129
Lsk456:
  v_mul_f32 v233, s74, v128
  v_fma_f32 v235, v226, s74, -v233
  v_exp_f32 v235, v235
  s_nop 0
  v_cvt_pk_bf16_f32 v238, v235, 0
  v_cvt_pk_bf16_f32 v239, 0, v235
  v_add_f32 v129, v129, v239
  s_waitcnt lgkmcnt(0)
  PV 56, 238, 104
  s_waitcnt vmcnt(45)
  s_mov_b32 s76, 0xa800
  LDT a, 168, 48
  s_mov_b32 s76, 0xb400
  LDT a, 180, 48
  v_max_f32_dpp v226, v128, v128 row_ror:8 row_mask:0xf bank_mask:0xf
  v_mov_b32 v227, v226
  s_nop 1
  v_permlane16_swap_b32 v226, v227
  v_max_f32 v226, v226, v227
  v_mov_b32 v227, v226
  s_nop 1
  v_permlane32_swap_b32 v226, v227
  v_max_f32 v226, v226, v227
  v_sub_f32 v228, v128, v226
  v_mul_f32 v228, s74, v228
  v_exp_f32 v228, v228
  v_mul_f32 v226, s74, v226
  RESC 104, 228
  v_mul_f32 v129, v228, v129
  s_nop 1
  v_add_f32_dpp v129, v129, v129 row_ror:8 row_mask:0xf bank_mask:0xf
  v_mov_b32 v227, v129
  s_nop 1
  v_permlane16_swap_b32 v129, v227
  v_add_f32 v129, v129, v227
  v_mov_b32 v227, v129
  s_nop 1
  v_permlane32_swap_b32 v129, v227
  v_add_f32 v129, v129, v227
  v_permlane32_swap_b32 v104, v116
  v_permlane32_swap_b32 v105, v117
  v_permlane32_swap_b32 v106, v118
  v_permlane32_swap_b32 v107, v119
  v_permlane32_swap_b32 v108, v120
  v_permlane32_swap_b32 v109, v121
  v_permlane32_swap_b32 v110, v122
  v_permlane32_swap_b32 v111, v123
  v_permlane32_swap_b32 v112, v124
  v_permlane32_swap_b32 v113, v125
  v_permlane32_swap_b32 v114, v126
  v_permlane32_swap_b32 v115, v127
  v_add_f32 v104, v104, v116
  v_add_f32 v105, v105, v117
  v_add_f32 v106, v106, v118
  v_add_f32 v107, v107, v119
  v_add_f32 v108, v108, v120
  v_add_f32 v109, v109, v121
  v_add_f32 v110, v110, v122
  v_add_f32 v111, v111, v123
  v_add_f32 v112, v112, v124
  v_add_f32 v113, v113, v125
  v_add_f32 v114, v114, v126
  v_add_f32 v115, v115, v127
  v_permlane16_swap_b32 v104, v110
  v_permlane16_swap_b32 v105, v111
  v_permlane16_swap_b32 v106, v112
  v_permlane16_swap_b32 v107, v113
  v_permlane16_swap_b32 v108, v114
  v_permlane16_swap_b32 v109, v115
  v_add_f32 v104, v104, v110
  v_add_f32 v105, v105, v111
  v_add_f32 v106, v106, v112
  v_add_f32 v107, v107, v113
  v_add_f32 v108, v108, v114
  v_add_f32 v109, v109, v115
  v_add_f32_dpp v104, v104, v104 row_ror:8 row_mask:0xf bank_mask:0xf
  v_add_f32_dpp v105, v105, v105 row_ror:8 row_mask:0xf bank_mask:0xf
  v_add_f32_dpp v106, v106, v106 row_ror:8 row_mask:0xf bank_mask:0xf
  v_add_f32_dpp v107, v107, v107 row_ror:8 row_mask:0xf bank_mask:0xf
  v_add_f32_dpp v108, v108, v108 row_ror:8 row_mask:0xf bank_mask:0xf
  v_add_f32_dpp v109, v109, v109 row_ror:8 row_mask:0xf bank_mask:0xf
  v_add_u32 v229, 0, v7
  v_lshrrev_b32 v230, 3, v229
  v_and_b32 v229, 7, v229
  v_lshlrev_b32 v230, 6, v230
  v_add_u32 v229, v229, v230
  v_lshl_add_u32 v229, v229, 2, v4
  ds_write_b32 v229, v104
  v_add_u32 v229, 1, v7
  v_lshrrev_b32 v230, 3, v229
  v_and_b32 v229, 7, v229
  v_lshlrev_b32 v230, 6, v230
  v_add_u32 v229, v229, v230
  v_lshl_add_u32 v229, v229, 2, v4
  ds_write_b32 v229, v105
  v_add_u32 v229, 2, v7
  v_lshrrev_b32 v230, 3, v229
  v_and_b32 v229, 7, v229
  v_lshlrev_b32 v230, 6, v230
  v_add_u32 v229, v229, v230
  v_lshl_add_u32 v229, v229, 2, v4
  ds_write_b32 v229, v106
  v_add_u32 v229, 3, v7
  v_lshrrev_b32 v230, 3, v229
  v_and_b32 v229, 7, v229
  v_lshlrev_b32 v230, 6, v230
  v_add_u32 v229, v229, v230
  v_lshl_add_u32 v229, v229, 2, v4
  ds_write_b32 v229, v107
  v_add_u32 v229, 4, v7
  v_lshrrev_b32 v230, 3, v229
  v_and_b32 v229, 7, v229
  v_lshlrev_b32 v230, 6, v230
  v_add_u32 v229, v229, v230
  v_lshl_add_u32 v229, v229, 2, v4
  ds_write_b32 v229, v108
  v_add_u32 v229, 5, v7
  v_lshrrev_b32 v230, 3, v229
  v_and_b32 v229, 7, v229
  v_lshlrev_b32 v230, 6, v230
  v_add_u32 v229, v229, v230
  v_lshl_add_u32 v229, v229, 2, v4
  ds_write_b32 v229, v109
  v_mov_b32 v234, v226
  v_mov_b32 v235, v129
  v_mov_b32 v236, 0
  v_mov_b32 v237, 0
  v_and_b32 v229, 0xffffff1f, v4
  ds_write_b128 v229, v[234:237] offset:768
  s_waitcnt lgkmcnt(0)
  ds_read_b128 v[234:237], v5
  s_waitcnt lgkmcnt(0)
  s_add_u32 s76, s73, 0x4fa000
  s_mov_b32 exec_lo, -1
  s_mov_b32 exec_hi, 0x1ffff
  buffer_store_dwordx4 v[234:237], v6, s[64:67], s76 offen sc1
  s_mov_b64 exec, -1
  s_waitcnt vmcnt(16)
  v_max3_u32 v226, v92, v93, v94
  v_max3_u32 v226, v226, v95, v96
  v_max3_u32 v226, v226, v97, v98
  v_max3_u32 v226, v226, v99, v100
  v_max3_u32 v226, v226, v101, v102
  v_max3_u32 v226, v226, v103, v103
  v_cmp_eq_u32 vcc, -1, v226
  s_cbranch_vccz Lqo457
  s_mov_b32 s75, 0x61a80
Lqr458:
  s_sleep 2
  s_add_u32 s77, s72, 0x6000
  buffer_load_dwordx4 v[92:95], v2, s[64:67], s77 offen sc1
  buffer_load_dwordx4 v[96:99], v2, s[64:67], s77 offen offset:128 sc1
  buffer_load_dwordx4 v[100:103], v2, s[64:67], s77 offen offset:256 sc1
  s_waitcnt vmcnt(0)
  v_max3_u32 v226, v92, v93, v94
  v_max3_u32 v226, v226, v95, v96
  v_max3_u32 v226, v226, v97, v98
  v_max3_u32 v226, v226, v99, v100
  v_max3_u32 v226, v226, v101, v102
  v_max3_u32 v226, v226, v103, v103
  v_cmp_eq_u32 vcc, -1, v226
  s_cbranch_vccz Lqo457
  s_sub_u32 s75, s75, 1
  s_cmp_lg_u32 s75, 0
  s_cbranch_scc1 Lqr458
Lqo457:
  v_mov_b32 v80, v92
  v_mov_b32 v81, v93
  v_mov_b32 v82, v94
  v_mov_b32 v83, v95
  v_mov_b32 v84, v96
  v_mov_b32 v85, v97
  v_mov_b32 v86, v98
  v_mov_b32 v87, v99
  v_mov_b32 v88, v100
  v_mov_b32 v89, v101
  v_mov_b32 v90, v102
  v_mov_b32 v91, v103
  v_mov_b32 v104, 0
  v_mov_b32 v105, 0
  v_mov_b32 v106, 0
  v_mov_b32 v107, 0
  v_mov_b32 v108, 0
  v_mov_b32 v109, 0
  v_mov_b32 v110, 0
  v_mov_b32 v111, 0
  v_mov_b32 v112, 0
  v_mov_b32 v113, 0
  v_mov_b32 v114, 0
  v_mov_b32 v115, 0
  v_mov_b32 v116, 0
  v_mov_b32 v117, 0
  v_mov_b32 v118, 0
  v_mov_b32 v119, 0
  v_mov_b32 v120, 0
  v_mov_b32 v121, 0
  v_mov_b32 v122, 0
  v_mov_b32 v123, 0
  v_mov_b32 v124, 0
  v_mov_b32 v125, 0
  v_mov_b32 v126, 0
  v_mov_b32 v127, 0
  v_mov_b32 v128, 0xf149f2ca
  v_mov_b32 v129, 0
  ACR 56, 0
  ACR 68, 12
  QK2 56, 68, 80, 226
  s_mov_b32 s76, 0xc000
  LDT a, 192, 48
  s_mov_b32 s76, 0xcc00
  LDT a, 204, 48
  s_mov_b32 s76, 0xd800
  LDT a, 216, 48
  s_mov_b32 s76, 0xe400
  LDT a, 228, 48
  s_mov_b32 s76, 0xf000
  LDT a, 240, 48
  v_add_f32 v226, v226, v227
  v_add_f32 v226, v226, v228
  v_add_f32 v229, v229, v230
  v_add_f32 v229, v229, v231
  v_add_f32_dpp v226, v226, v226 quad_perm:[1,0,3,2] row_mask:0xf bank_mask:0xf
  s_nop 0
  v_add_f32_dpp v229, v229, v229 quad_perm:[1,0,3,2] row_mask:0xf bank_mask:0xf
  v_add_f32_dpp v226, v226, v226 quad_perm:[2,3,0,1] row_mask:0xf bank_mask:0xf
  s_nop 0
  v_add_f32_dpp v229, v229, v229 quad_perm:[2,3,0,1] row_mask:0xf bank_mask:0xf
  v_add_f32_dpp v226, v226, v226 row_half_mirror row_mask:0xf bank_mask:0xf
  s_nop 0
  v_add_f32_dpp v229, v229, v229 row_half_mirror row_mask:0xf bank_mask:0xf
  v_max3_f32 v232, v128, v226, v229
  v_cmp_gt_f32 vcc, v232, v128
  s_cbranch_vccz Lsk459
  v_sub_f32 v234, v128, v232
  v_mul_f32 v234, s74, v234
  v_exp_f32 v234, v234
  v_mov_b32 v128, v232
  RESC 104, 234
  v_mul_f32 v129, v234, v129
Lsk459:
  v_mul_f32 v233, s74, v128
  v_fma_f32 v235, v226, s74, -v233
  v_fma_f32 v236, v229, s74, -v233
  v_exp_f32 v235, v235
  v_exp_f32 v236, v236
  v_cvt_pk_bf16_f32 v238, v235, 0
  v_cvt_pk_bf16_f32 v239, 0, v235
  v_cvt_pk_bf16_f32 v240, v236, 0
  v_cvt_pk_bf16_f32 v241, 0, v236
  v_add_f32 v129, v129, v239
  v_add_f32 v129, v129, v241
  PV 130, 238, 104
  PV 142, 240, 104
  ACR 56, 24
  ACR 68, 36
  QK2 56, 68, 80, 226
  v_add_f32 v226, v226, v227
  v_add_f32 v226, v226, v228
  v_add_f32 v229, v229, v230
  v_add_f32 v229, v229, v231
  v_add_f32_dpp v226, v226, v226 quad_perm:[1,0,3,2] row_mask:0xf bank_mask:0xf
  s_nop 0
  v_add_f32_dpp v229, v229, v229 quad_perm:[1,0,3,2] row_mask:0xf bank_mask:0xf
  v_add_f32_dpp v226, v226, v226 quad_perm:[2,3,0,1] row_mask:0xf bank_mask:0xf
  s_nop 0
  v_add_f32_dpp v229, v229, v229 quad_perm:[2,3,0,1] row_mask:0xf bank_mask:0xf
  v_add_f32_dpp v226, v226, v226 row_half_mirror row_mask:0xf bank_mask:0xf
  s_nop 0
  v_add_f32_dpp v229, v229, v229 row_half_mirror row_mask:0xf bank_mask:0xf
  v_max3_f32 v232, v128, v226, v229
  v_cmp_gt_f32 vcc, v232, v128
  s_cbranch_vccz Lsk460
  v_sub_f32 v234, v128, v232
  v_mul_f32 v234, s74, v234
  v_exp_f32 v234, v234
  v_mov_b32 v128, v232
  RESC 104, 234
  v_mul_f32 v129, v234, v129
Lsk460:
  v_mul_f32 v233, s74, v128
  v_fma_f32 v235, v226, s74, -v233
  v_fma_f32 v236, v229, s74, -v233
  v_exp_f32 v235, v235
  v_exp_f32 v236, v236
  v_cvt_pk_bf16_f32 v238, v235, 0
  v_cvt_pk_bf16_f32 v239, 0, v235
  v_cvt_pk_bf16_f32 v240, v236, 0
  v_cvt_pk_bf16_f32 v241, 0, v236
  v_add_f32 v129, v129, v239
  v_add_f32 v129, v129, v241
  PV 154, 238, 104
  PV 166, 240, 104
  ACR 56, 48
  ACR 68, 60
  QK2 56, 68, 80, 226
  v_add_f32 v226, v226, v227
  v_add_f32 v226, v226, v228
  v_add_f32 v229, v229, v230
  v_add_f32 v229, v229, v231
  v_add_f32_dpp v226, v226, v226 quad_perm:[1,0,3,2] row_mask:0xf bank_mask:0xf
  s_nop 0
  v_add_f32_dpp v229, v229, v229 quad_perm:[1,0,3,2] row_mask:0xf bank_mask:0xf
  v_add_f32_dpp v226, v226, v226 quad_perm:[2,3,0,1] row_mask:0xf bank_mask:0xf
  s_nop 0
  v_add_f32_dpp v229, v229, v229 quad_perm:[2,3,0,1] row_mask:0xf bank_mask:0xf
  v_add_f32_dpp v226, v226, v226 row_half_mirror row_mask:0xf bank_mask:0xf
  s_nop 0
  v_add_f32_dpp v229, v229, v229 row_half_mirror row_mask:0xf bank_mask:0xf
  v_max3_f32 v232, v128, v226, v229
  v_cmp_gt_f32 vcc, v232, v128
  s_cbranch_vccz Lsk461
  v_sub_f32 v234, v128, v232
  v_mul_f32 v234, s74, v234
  v_exp_f32 v234, v234
  v_mov_b32 v128, v232
  RESC 104, 234
  v_mul_f32 v129, v234, v129
Lsk461:
  v_mul_f32 v233, s74, v128
  v_fma_f32 v235, v226, s74, -v233
  v_fma_f32 v236, v229, s74, -v233
  v_exp_f32 v235, v235
  v_exp_f32 v236, v236
  v_cvt_pk_bf16_f32 v238, v235, 0
  v_cvt_pk_bf16_f32 v239, 0, v235
  v_cvt_pk_bf16_f32 v240, v236, 0
  v_cvt_pk_bf16_f32 v241, 0, v236
  v_add_f32 v129, v129, v239
  v_add_f32 v129, v129, v241
  PV 178, 238, 104
  PV 190, 240, 104
  ACR 56, 72
  ACR 68, 84
  QK2 56, 68, 80, 226
  v_add_f32 v226, v226, v227
  v_add_f32 v226, v226, v228
  v_add_f32 v229, v229, v230
  v_add_f32 v229, v229, v231
  v_add_f32_dpp v226, v226, v226 quad_perm:[1,0,3,2] row_mask:0xf bank_mask:0xf
  s_nop 0
  v_add_f32_dpp v229, v229, v229 quad_perm:[1,0,3,2] row_mask:0xf bank_mask:0xf
  v_add_f32_dpp v226, v226, v226 quad_perm:[2,3,0,1] row_mask:0xf bank_mask:0xf
  s_nop 0
  v_add_f32_dpp v229, v229, v229 quad_perm:[2,3,0,1] row_mask:0xf bank_mask:0xf
  v_add_f32_dpp v226, v226, v226 row_half_mirror row_mask:0xf bank_mask:0xf
  s_nop 0
  v_add_f32_dpp v229, v229, v229 row_half_mirror row_mask:0xf bank_mask:0xf
  v_max3_f32 v232, v128, v226, v229
  v_cmp_gt_f32 vcc, v232, v128
  s_cbranch_vccz Lsk462
  v_sub_f32 v234, v128, v232
  v_mul_f32 v234, s74, v234
  v_exp_f32 v234, v234
  v_mov_b32 v128, v232
  RESC 104, 234
  v_mul_f32 v129, v234, v129
Lsk462:
  v_mul_f32 v233, s74, v128
  v_fma_f32 v235, v226, s74, -v233
  v_fma_f32 v236, v229, s74, -v233
  v_exp_f32 v235, v235
  v_exp_f32 v236, v236
  v_cvt_pk_bf16_f32 v238, v235, 0
  v_cvt_pk_bf16_f32 v239, 0, v235
  v_cvt_pk_bf16_f32 v240, v236, 0
  v_cvt_pk_bf16_f32 v241, 0, v236
  v_add_f32 v129, v129, v239
  v_add_f32 v129, v129, v241
  PV 202, 238, 104
  PV 214, 240, 104
  ACR 56, 96
  ACR 68, 108
  QK2 56, 68, 80, 226
  v_add_f32 v226, v226, v227
  v_add_f32 v226, v226, v228
  v_add_f32 v229, v229, v230
  v_add_f32 v229, v229, v231
  v_add_f32_dpp v226, v226, v226 quad_perm:[1,0,3,2] row_mask:0xf bank_mask:0xf
  s_nop 0
  v_add_f32_dpp v229, v229, v229 quad_perm:[1,0,3,2] row_mask:0xf bank_mask:0xf
  v_add_f32_dpp v226, v226, v226 quad_perm:[2,3,0,1] row_mask:0xf bank_mask:0xf
  s_nop 0
  v_add_f32_dpp v229, v229, v229 quad_perm:[2,3,0,1] row_mask:0xf bank_mask:0xf
  v_add_f32_dpp v226, v226, v226 row_half_mirror row_mask:0xf bank_mask:0xf
  s_nop 0
  v_add_f32_dpp v229, v229, v229 row_half_mirror row_mask:0xf bank_mask:0xf
  v_max3_f32 v232, v128, v226, v229
  v_cmp_gt_f32 vcc, v232, v128
  s_cbranch_vccz Lsk463
  v_sub_f32 v234, v128, v232
  v_mul_f32 v234, s74, v234
  v_exp_f32 v234, v234
  v_mov_b32 v128, v232
  RESC 104, 234
  v_mul_f32 v129, v234, v129
Lsk463:
  v_mul_f32 v233, s74, v128
  v_fma_f32 v235, v226, s74, -v233
  v_fma_f32 v236, v229, s74, -v233
  v_exp_f32 v235, v235
  v_exp_f32 v236, v236
  v_cvt_pk_bf16_f32 v238, v235, 0
  v_cvt_pk_bf16_f32 v239, 0, v235
  v_cvt_pk_bf16_f32 v240, v236, 0
  v_cvt_pk_bf16_f32 v241, 0, v236
  v_add_f32 v129, v129, v239
  v_add_f32 v129, v129, v241
  PV 8, 238, 104
  ds_write_b128 v3, v[8:11] offset:0
  ds_write_b128 v3, v[12:15] offset:1024
  ds_write_b128 v3, v[16:19] offset:2048
  s_mov_b32 s76, 0x9000
  LDT v, 8, 52
  PV 32, 240, 104
  ds_write_b128 v3, v[32:35] offset:3072
  ds_write_b128 v3, v[36:39] offset:4096
  ds_write_b128 v3, v[40:43] offset:5120
  s_mov_b32 s76, 0x9c00
  LDT v, 32, 52
  ACR 56, 120
  s_waitcnt vmcnt(34)
  ACR 68, 132
  QK2 56, 68, 80, 226
  v_add_f32 v226, v226, v227
  v_add_f32 v226, v226, v228
  v_add_f32 v229, v229, v230
  v_add_f32 v229, v229, v231
  v_add_f32_dpp v226, v226, v226 quad_perm:[1,0,3,2] row_mask:0xf bank_mask:0xf
  s_nop 0
  v_add_f32_dpp v229, v229, v229 quad_perm:[1,0,3,2] row_mask:0xf bank_mask:0xf
  v_add_f32_dpp v226, v226, v226 quad_perm:[2,3,0,1] row_mask:0xf bank_mask:0xf
  s_nop 0
  v_add_f32_dpp v229, v229, v229 quad_perm:[2,3,0,1] row_mask:0xf bank_mask:0xf
  v_add_f32_dpp v226, v226, v226 row_half_mirror row_mask:0xf bank_mask:0xf
  s_nop 0
  v_add_f32_dpp v229, v229, v229 row_half_mirror row_mask:0xf bank_mask:0xf
  v_max3_f32 v232, v128, v226, v229
  v_cmp_gt_f32 vcc, v232, v128
  s_cbranch_vccz Lsk464
  v_sub_f32 v234, v128, v232
  v_mul_f32 v234, s74, v234
  v_exp_f32 v234, v234
  v_mov_b32 v128, v232
  RESC 104, 234
  v_mul_f32 v129, v234, v129
Lsk464:
  v_mul_f32 v233, s74, v128
  v_fma_f32 v235, v226, s74, -v233
  v_fma_f32 v236, v229, s74, -v233
  v_exp_f32 v235, v235
  v_exp_f32 v236, v236
  v_cvt_pk_bf16_f32 v238, v235, 0
  v_cvt_pk_bf16_f32 v239, 0, v235
  v_cvt_pk_bf16_f32 v240, v236, 0
  v_cvt_pk_bf16_f32 v241, 0, v236
  v_add_f32 v129, v129, v239
  v_add_f32 v129, v129, v241
  PV 20, 238, 104
  ds_write_b128 v3, v[20:23] offset:6144
  ds_write_b128 v3, v[24:27] offset:7168
  ds_write_b128 v3, v[28:31] offset:8192
  s_mov_b32 s76, 0xa800
  LDT v, 20, 52
  PV 44, 240, 104
  ds_write_b128 v3, v[44:47] offset:9216
  ds_write_b128 v3, v[48:51] offset:10240
  ds_write_b128 v3, v[52:55] offset:11264
  s_mov_b32 s76, 0xb400
  LDT v, 44, 52
  s_waitcnt vmcnt(37)
  ACR 56, 144
  s_waitcnt vmcnt(34)
  ACR 68, 156
  QK2 56, 68, 80, 226
  v_add_f32 v226, v226, v227
  v_add_f32 v226, v226, v228
  v_add_f32 v229, v229, v230
  v_add_f32 v229, v229, v231
  v_add_f32_dpp v226, v226, v226 quad_perm:[1,0,3,2] row_mask:0xf bank_mask:0xf
  s_nop 0
  v_add_f32_dpp v229, v229, v229 quad_perm:[1,0,3,2] row_mask:0xf bank_mask:0xf
  v_add_f32_dpp v226, v226, v226 quad_perm:[2,3,0,1] row_mask:0xf bank_mask:0xf
  s_nop 0
  v_add_f32_dpp v229, v229, v229 quad_perm:[2,3,0,1] row_mask:0xf bank_mask:0xf
  v_add_f32_dpp v226, v226, v226 row_half_mirror row_mask:0xf bank_mask:0xf
  s_nop 0
  v_add_f32_dpp v229, v229, v229 row_half_mirror row_mask:0xf bank_mask:0xf
  v_max3_f32 v232, v128, v226, v229
  v_cmp_gt_f32 vcc, v232, v128
  s_cbranch_vccz Lsk465
  v_sub_f32 v234, v128, v232
  v_mul_f32 v234, s74, v234
  v_exp_f32 v234, v234
  v_mov_b32 v128, v232
  RESC 104, 234
  v_mul_f32 v129, v234, v129
Lsk465:
  v_mul_f32 v233, s74, v128
  v_fma_f32 v235, v226, s74, -v233
  v_fma_f32 v236, v229, s74, -v233
  v_exp_f32 v235, v235
  v_exp_f32 v236, v236
  v_cvt_pk_bf16_f32 v238, v235, 0
  v_cvt_pk_bf16_f32 v239, 0, v235
  v_cvt_pk_bf16_f32 v240, v236, 0
  v_cvt_pk_bf16_f32 v241, 0, v236
  v_add_f32 v129, v129, v239
  v_add_f32 v129, v129, v241
  s_waitcnt vmcnt(9)
  PV 8, 238, 104
  ds_write_b128 v3, v[8:11] offset:12288
  ds_write_b128 v3, v[12:15] offset:13312
  ds_write_b128 v3, v[16:19] offset:14336
  s_mov_b32 s76, 0xc000
  LDT v, 8, 52
  s_waitcnt vmcnt(9)
  PV 32, 240, 104
  ds_write_b128 v3, v[32:35] offset:15360
  s_waitcnt lgkmcnt(8)
  ds_write_b128 v3, v[36:39] offset:16384
  ds_write_b128 v3, v[40:43] offset:17408
  s_mov_b32 s76, 0xcc00
  LDT v, 32, 52
  ACR 56, 168
  ACR 68, 180
  QK2 56, 68, 80, 226
  v_add_f32 v226, v226, v227
  v_add_f32 v226, v226, v228
  v_add_f32 v229, v229, v230
  v_add_f32 v229, v229, v231
  v_add_f32_dpp v226, v226, v226 quad_perm:[1,0,3,2] row_mask:0xf bank_mask:0xf
  s_nop 0
  v_add_f32_dpp v229, v229, v229 quad_perm:[1,0,3,2] row_mask:0xf bank_mask:0xf
  v_add_f32_dpp v226, v226, v226 quad_perm:[2,3,0,1] row_mask:0xf bank_mask:0xf
  s_nop 0
  v_add_f32_dpp v229, v229, v229 quad_perm:[2,3,0,1] row_mask:0xf bank_mask:0xf
  v_add_f32_dpp v226, v226, v226 row_half_mirror row_mask:0xf bank_mask:0xf
  s_nop 0
  v_add_f32_dpp v229, v229, v229 row_half_mirror row_mask:0xf bank_mask:0xf
  v_max3_f32 v232, v128, v226, v229
  v_cmp_gt_f32 vcc, v232, v128
  s_cbranch_vccz Lsk466
  v_sub_f32 v234, v128, v232
  v_mul_f32 v234, s74, v234
  v_exp_f32 v234, v234
  v_mov_b32 v128, v232
  RESC 104, 234
  v_mul_f32 v129, v234, v129
Lsk466:
  v_mul_f32 v233, s74, v128
  v_fma_f32 v235, v226, s74, -v233
  v_fma_f32 v236, v229, s74, -v233
  v_exp_f32 v235, v235
  v_exp_f32 v236, v236
  v_cvt_pk_bf16_f32 v238, v235, 0
  v_cvt_pk_bf16_f32 v239, 0, v235
  v_cvt_pk_bf16_f32 v240, v236, 0
  v_cvt_pk_bf16_f32 v241, 0, v236
  v_add_f32 v129, v129, v239
  v_add_f32 v129, v129, v241
  s_waitcnt vmcnt(9)
  PV 20, 238, 104
  ds_write_b128 v3, v[20:23] offset:18432
  ds_write_b128 v3, v[24:27] offset:19456
  ds_write_b128 v3, v[28:31] offset:20480
  s_mov_b32 s76, 0xd800
  LDT v, 20, 52
  s_waitcnt vmcnt(9)
  PV 44, 240, 104
  ds_write_b128 v3, v[44:47] offset:21504
  ds_write_b128 v3, v[48:51] offset:22528
  ds_write_b128 v3, v[52:55] offset:23552
  s_waitcnt lgkmcnt(8)
  s_mov_b32 s76, 0xe400
  LDT v, 44, 52
  ACR 56, 192
  ACR 68, 204
  QK2 56, 68, 80, 226
  v_add_f32 v226, v226, v227
  v_add_f32 v226, v226, v228
  v_add_f32 v229, v229, v230
  v_add_f32 v229, v229, v231
  v_add_f32_dpp v226, v226, v226 quad_perm:[1,0,3,2] row_mask:0xf bank_mask:0xf
  s_nop 0
  v_add_f32_dpp v229, v229, v229 quad_perm:[1,0,3,2] row_mask:0xf bank_mask:0xf
  v_add_f32_dpp v226, v226, v226 quad_perm:[2,3,0,1] row_mask:0xf bank_mask:0xf
  s_nop 0
  v_add_f32_dpp v229, v229, v229 quad_perm:[2,3,0,1] row_mask:0xf bank_mask:0xf
  v_add_f32_dpp v226, v226, v226 row_half_mirror row_mask:0xf bank_mask:0xf
  s_nop 0
  v_add_f32_dpp v229, v229, v229 row_half_mirror row_mask:0xf bank_mask:0xf
  v_max3_f32 v232, v128, v226, v229
  v_cmp_gt_f32 vcc, v232, v128
  s_cbranch_vccz Lsk467
  v_sub_f32 v234, v128, v232
  v_mul_f32 v234, s74, v234
  v_exp_f32 v234, v234
  v_mov_b32 v128, v232
  RESC 104, 234
  v_mul_f32 v129, v234, v129
Lsk467:
  v_mul_f32 v233, s74, v128
  v_fma_f32 v235, v226, s74, -v233
  v_fma_f32 v236, v229, s74, -v233
  v_exp_f32 v235, v235
  v_exp_f32 v236, v236
  v_cvt_pk_bf16_f32 v238, v235, 0
  v_cvt_pk_bf16_f32 v239, 0, v235
  v_cvt_pk_bf16_f32 v240, v236, 0
  v_cvt_pk_bf16_f32 v241, 0, v236
  v_add_f32 v129, v129, v239
  v_add_f32 v129, v129, v241
  s_waitcnt vmcnt(9)
  PV 8, 238, 104
  ds_write_b128 v3, v[8:11] offset:24576
  ds_write_b128 v3, v[12:15] offset:25600
  ds_write_b128 v3, v[16:19] offset:26624
  s_mov_b32 s76, 0xfc00
  LDC v, 8, 48
  s_waitcnt vmcnt(9)
  PV 32, 240, 104
  ds_write_b128 v3, v[32:35] offset:27648
  ds_write_b128 v3, v[36:39] offset:28672
  ds_write_b128 v3, v[40:43] offset:29696
  s_mov_b32 s76, 0xf000
  LDT v, 32, 52
  ACR 56, 216
  ACR 68, 228
  QK2 56, 68, 80, 226
  v_add_f32 v226, v226, v227
  v_add_f32 v226, v226, v228
  v_add_f32 v229, v229, v230
  v_add_f32 v229, v229, v231
  v_add_f32_dpp v226, v226, v226 quad_perm:[1,0,3,2] row_mask:0xf bank_mask:0xf
  s_nop 0
  v_add_f32_dpp v229, v229, v229 quad_perm:[1,0,3,2] row_mask:0xf bank_mask:0xf
  v_add_f32_dpp v226, v226, v226 quad_perm:[2,3,0,1] row_mask:0xf bank_mask:0xf
  s_nop 0
  v_add_f32_dpp v229, v229, v229 quad_perm:[2,3,0,1] row_mask:0xf bank_mask:0xf
  v_add_f32_dpp v226, v226, v226 row_half_mirror row_mask:0xf bank_mask:0xf
  s_nop 0
  v_add_f32_dpp v229, v229, v229 row_half_mirror row_mask:0xf bank_mask:0xf
  v_max3_f32 v232, v128, v226, v229
  v_cmp_gt_f32 vcc, v232, v128
  s_cbranch_vccz Lsk468
  v_sub_f32 v234, v128, v232
  v_mul_f32 v234, s74, v234
  v_exp_f32 v234, v234
  v_mov_b32 v128, v232
  RESC 104, 234
  v_mul_f32 v129, v234, v129
Lsk468:
  v_mul_f32 v233, s74, v128
  v_fma_f32 v235, v226, s74, -v233
  v_fma_f32 v236, v229, s74, -v233
  v_exp_f32 v235, v235
  v_exp_f32 v236, v236
  v_cvt_pk_bf16_f32 v238, v235, 0
  v_cvt_pk_bf16_f32 v239, 0, v235
  v_cvt_pk_bf16_f32 v240, v236, 0
  v_cvt_pk_bf16_f32 v241, 0, v236
  v_add_f32 v129, v129, v239
  v_add_f32 v129, v129, v241
  s_waitcnt vmcnt(9)
  PV 20, 238, 104
  ds_write_b128 v3, v[20:23] offset:30720
  ds_write_b128 v3, v[24:27] offset:31744
  s_waitcnt lgkmcnt(8)
  ds_write_b128 v3, v[28:31] offset:32768
  s_mov_b32 s76, 0xfc00
  LDC v, 20, 52
  s_waitcnt vmcnt(9)
  PV 44, 240, 104
  ds_write_b128 v3, v[44:47] offset:33792
  ds_write_b128 v3, v[48:51] offset:34816
  ds_write_b128 v3, v[52:55] offset:35840
  s_mov_b32 s76, 0x10800
  LDC v, 44, 48
  s_add_u32 s76, s72, 0xf000
  buffer_load_dwordx4 v[92:95], v2, s[64:67], s76 offen sc1
  buffer_load_dwordx4 v[96:99], v2, s[64:67], s76 offen offset:128 sc1
  buffer_load_dwordx4 v[100:103], v2, s[64:67], s76 offen offset:256 sc1
  ACR 56, 240
  s_waitcnt vmcnt(12)
  QK2 56, 8, 80, 226
  s_mov_b32 s76, 0x11400
  LDC v, 8, 48
  v_add_f32 v226, v226, v227
  v_add_f32 v226, v226, v228
  v_add_f32 v229, v229, v230
  v_add_f32 v229, v229, v231
  v_add_f32_dpp v226, v226, v226 quad_perm:[1,0,3,2] row_mask:0xf bank_mask:0xf
  s_nop 0
  v_add_f32_dpp v229, v229, v229 quad_perm:[1,0,3,2] row_mask:0xf bank_mask:0xf
  v_add_f32_dpp v226, v226, v226 quad_perm:[2,3,0,1] row_mask:0xf bank_mask:0xf
  s_nop 0
  v_add_f32_dpp v229, v229, v229 quad_perm:[2,3,0,1] row_mask:0xf bank_mask:0xf
  v_add_f32_dpp v226, v226, v226 row_half_mirror row_mask:0xf bank_mask:0xf
  s_nop 0
  v_add_f32_dpp v229, v229, v229 row_half_mirror row_mask:0xf bank_mask:0xf
  v_max3_f32 v232, v128, v226, v229
  v_cmp_gt_f32 vcc, v232, v128
  s_cbranch_vccz Lsk469
  v_sub_f32 v234, v128, v232
  v_mul_f32 v234, s74, v234
  v_exp_f32 v234, v234
  v_mov_b32 v128, v232
  RESC 104, 234
  v_mul_f32 v129, v234, v129
Lsk469:
  v_mul_f32 v233, s74, v128
  v_fma_f32 v235, v226, s74, -v233
  v_fma_f32 v236, v229, s74, -v233
  v_exp_f32 v235, v235
  v_exp_f32 v236, v236
  v_cvt_pk_bf16_f32 v238, v235, 0
  v_cvt_pk_bf16_f32 v239, 0, v235
  v_cvt_pk_bf16_f32 v240, v236, 0
  v_cvt_pk_bf16_f32 v241, 0, v236
  v_add_f32 v129, v129, v239
  v_add_f32 v129, v129, v241
  s_waitcnt vmcnt(12)
  PV 32, 238, 104
  ds_write_b128 v3, v[32:35] offset:36864
  ds_write_b128 v3, v[36:39] offset:37888
  ds_write_b128 v3, v[40:43] offset:38912
  s_mov_b32 s76, 0x10800
  LDC v, 32, 52
  s_waitcnt vmcnt(12)
  PV 20, 240, 104
  s_mov_b32 s76, 0x11400
  LDC v, 20, 52
  s_waitcnt vmcnt(12)
  s_waitcnt vmcnt(6)
  QK2 44, 8, 80, 226
  s_mov_b32 s76, 0x12000
  LDC v, 8, 48
  s_mov_b32 s76, 0x12000
  LDC v, 44, 52
  v_add_f32 v226, v226, v227
  v_add_f32 v226, v226, v228
  v_add_f32 v229, v229, v230
  v_add_f32 v229, v229, v231
  v_add_f32_dpp v226, v226, v226 quad_perm:[1,0,3,2] row_mask:0xf bank_mask:0xf
  s_nop 0
  v_add_f32_dpp v229, v229, v229 quad_perm:[1,0,3,2] row_mask:0xf bank_mask:0xf
  v_add_f32_dpp v226, v226, v226 quad_perm:[2,3,0,1] row_mask:0xf bank_mask:0xf
  s_nop 0
  v_add_f32_dpp v229, v229, v229 quad_perm:[2,3,0,1] row_mask:0xf bank_mask:0xf
  v_add_f32_dpp v226, v226, v226 row_half_mirror row_mask:0xf bank_mask:0xf
  s_nop 0
  v_add_f32_dpp v229, v229, v229 row_half_mirror row_mask:0xf bank_mask:0xf
  v_max3_f32 v232, v128, v226, v229
  v_cmp_gt_f32 vcc, v232, v128
  s_cbranch_vccz Lsk470
  v_sub_f32 v234, v128, v232
  v_mul_f32 v234, s74, v234
  v_exp_f32 v234, v234
  v_mov_b32 v128, v232
  RESC 104, 234
  v_mul_f32 v129, v234, v129
Lsk470:
  v_mul_f32 v233, s74, v128
  v_fma_f32 v235, v226, s74, -v233
  v_fma_f32 v236, v229, s74, -v233
  v_exp_f32 v235, v235
  v_exp_f32 v236, v236
  v_cvt_pk_bf16_f32 v238, v235, 0
  v_cvt_pk_bf16_f32 v239, 0, v235
  v_cvt_pk_bf16_f32 v240, v236, 0
  v_cvt_pk_bf16_f32 v241, 0, v236
  v_add_f32 v129, v129, v239
  v_add_f32 v129, v129, v241
  s_waitcnt vmcnt(9)
  PV 32, 238, 104
  s_mov_b32 s76, 0x12c00
  LDT v, 32, 40
  s_waitcnt vmcnt(9)
  PV 20, 240, 104
  s_mov_b32 s76, 0x13800
  LDT v, 20, 40
  s_waitcnt vmcnt(9)
  v_dot2_f32_bf16 v226, v8, v80, 0
  v_dot2_f32_bf16 v227, v12, v84, 0
  v_dot2_f32_bf16 v228, v16, v88, 0
  s_nop 0
  v_dot2c_f32_bf16 v226, v9, v81
  v_dot2c_f32_bf16 v227, v13, v85
  v_dot2c_f32_bf16 v228, v17, v89
  v_dot2c_f32_bf16 v226, v10, v82
  v_dot2c_f32_bf16 v227, v14, v86
  v_dot2c_f32_bf16 v228, v18, v90
  v_dot2c_f32_bf16 v226, v11, v83
  v_dot2c_f32_bf16 v227, v15, v87
  v_dot2c_f32_bf16 v228, v19, v91
  s_mov_b32 s76, 0x12c00
  LDT v, 8, 44
  v_add_f32 v226, v226, v227
  v_add_f32 v226, v226, v228
  s_nop 1
  v_add_f32_dpp v226, v226, v226 quad_perm:[1,0,3,2] row_mask:0xf bank_mask:0xf
  s_nop 1
  v_add_f32_dpp v226, v226, v226 quad_perm:[2,3,0,1] row_mask:0xf bank_mask:0xf
  s_nop 1
  v_add_f32_dpp v226, v226, v226 row_half_mirror row_mask:0xf bank_mask:0xf
  v_max_f32 v232, v128, v226
  v_cmp_gt_f32 vcc, v232, v128
  s_cbranch_vccz Lsk471
  v_sub_f32 v234, v128, v232
  v_mul_f32 v234, s74, v234
  v_exp_f32 v234, v234
  v_mov_b32 v128, v232
  RESC 104, 234
  v_mul_f32 v129, v234, v129
Lsk471:
  v_mul_f32 v233, s74, v128
  v_fma_f32 v235, v226, s74, -v233
  v_exp_f32 v235, v235
  s_nop 0
  v_cvt_pk_bf16_f32 v238, v235, 0
  v_cvt_pk_bf16_f32 v239, 0, v235
  v_add_f32 v129, v129, v239
  s_waitcnt vmcnt(9)
  PV 44, 238, 104
  s_mov_b32 s76, 0x13800
  LDT v, 44, 44
  v_max_f32_dpp v226, v128, v128 row_ror:8 row_mask:0xf bank_mask:0xf
  v_mov_b32 v227, v226
  s_nop 1
  v_permlane16_swap_b32 v226, v227
  v_max_f32 v226, v226, v227
  v_mov_b32 v227, v226
  s_nop 1
  v_permlane32_swap_b32 v226, v227
  v_max_f32 v226, v226, v227
  v_sub_f32 v228, v128, v226
  v_mul_f32 v228, s74, v228
  v_exp_f32 v228, v228
  v_mul_f32 v226, s74, v226
  RESC 104, 228
  v_mul_f32 v129, v228, v129
  s_nop 1
  v_add_f32_dpp v129, v129, v129 row_ror:8 row_mask:0xf bank_mask:0xf
  v_mov_b32 v227, v129
  s_nop 1
  v_permlane16_swap_b32 v129, v227
  v_add_f32 v129, v129, v227
  v_mov_b32 v227, v129
  s_nop 1
  v_permlane32_swap_b32 v129, v227
  v_add_f32 v129, v129, v227
  v_permlane32_swap_b32 v104, v116
  v_permlane32_swap_b32 v105, v117
  v_permlane32_swap_b32 v106, v118
  v_permlane32_swap_b32 v107, v119
  v_permlane32_swap_b32 v108, v120
  v_permlane32_swap_b32 v109, v121
  v_permlane32_swap_b32 v110, v122
  v_permlane32_swap_b32 v111, v123
  v_permlane32_swap_b32 v112, v124
  v_permlane32_swap_b32 v113, v125
  v_permlane32_swap_b32 v114, v126
  v_permlane32_swap_b32 v115, v127
  v_add_f32 v104, v104, v116
  v_add_f32 v105, v105, v117
  v_add_f32 v106, v106, v118
  v_add_f32 v107, v107, v119
  v_add_f32 v108, v108, v120
  v_add_f32 v109, v109, v121
  v_add_f32 v110, v110, v122
  v_add_f32 v111, v111, v123
  v_add_f32 v112, v112, v124
  v_add_f32 v113, v113, v125
  v_add_f32 v114, v114, v126
  v_add_f32 v115, v115, v127
  v_permlane16_swap_b32 v104, v110
  v_permlane16_swap_b32 v105, v111
  v_permlane16_swap_b32 v106, v112
  v_permlane16_swap_b32 v107, v113
  v_permlane16_swap_b32 v108, v114
  v_permlane16_swap_b32 v109, v115
  v_add_f32 v104, v104, v110
  v_add_f32 v105, v105, v111
  v_add_f32 v106, v106, v112
  v_add_f32 v107, v107, v113
  v_add_f32 v108, v108, v114
  v_add_f32 v109, v109, v115
  v_add_f32_dpp v104, v104, v104 row_ror:8 row_mask:0xf bank_mask:0xf
  v_add_f32_dpp v105, v105, v105 row_ror:8 row_mask:0xf bank_mask:0xf
  v_add_f32_dpp v106, v106, v106 row_ror:8 row_mask:0xf bank_mask:0xf
  v_add_f32_dpp v107, v107, v107 row_ror:8 row_mask:0xf bank_mask:0xf
  v_add_f32_dpp v108, v108, v108 row_ror:8 row_mask:0xf bank_mask:0xf
  v_add_f32_dpp v109, v109, v109 row_ror:8 row_mask:0xf bank_mask:0xf
  v_add_u32 v229, 0, v7
  v_lshrrev_b32 v230, 3, v229
  v_and_b32 v229, 7, v229
  v_lshlrev_b32 v230, 6, v230
  v_add_u32 v229, v229, v230
  v_lshl_add_u32 v229, v229, 2, v4
  ds_write_b32 v229, v104
  s_waitcnt lgkmcnt(8)
  v_add_u32 v229, 1, v7
  v_lshrrev_b32 v230, 3, v229
  v_and_b32 v229, 7, v229
  v_lshlrev_b32 v230, 6, v230
  v_add_u32 v229, v229, v230
  v_lshl_add_u32 v229, v229, 2, v4
  ds_write_b32 v229, v105
  v_add_u32 v229, 2, v7
  v_lshrrev_b32 v230, 3, v229
  v_and_b32 v229, 7, v229
  v_lshlrev_b32 v230, 6, v230
  v_add_u32 v229, v229, v230
  v_lshl_add_u32 v229, v229, 2, v4
  ds_write_b32 v229, v106
  v_add_u32 v229, 3, v7
  v_lshrrev_b32 v230, 3, v229
  v_and_b32 v229, 7, v229
  v_lshlrev_b32 v230, 6, v230
  v_add_u32 v229, v229, v230
  v_lshl_add_u32 v229, v229, 2, v4
  ds_write_b32 v229, v107
  v_add_u32 v229, 4, v7
  v_lshrrev_b32 v230, 3, v229
  v_and_b32 v229, 7, v229
  v_lshlrev_b32 v230, 6, v230
  v_add_u32 v229, v229, v230
  v_lshl_add_u32 v229, v229, 2, v4
  ds_write_b32 v229, v108
  v_add_u32 v229, 5, v7
  v_lshrrev_b32 v230, 3, v229
  v_and_b32 v229, 7, v229
  v_lshlrev_b32 v230, 6, v230
  v_add_u32 v229, v229, v230
  v_lshl_add_u32 v229, v229, 2, v4
  ds_write_b32 v229, v109
  v_mov_b32 v234, v226
  v_mov_b32 v235, v129
  v_mov_b32 v236, 0
  v_mov_b32 v237, 0
  v_and_b32 v229, 0xffffff1f, v4
  ds_write_b128 v229, v[234:237] offset:768
  s_waitcnt lgkmcnt(0)
  ds_read_b128 v[234:237], v5
  s_waitcnt lgkmcnt(0)
  s_add_u32 s76, s73, 0x599400
  s_mov_b32 exec_lo, -1
  s_mov_b32 exec_hi, 0x1ffff
  buffer_store_dwordx4 v[234:237], v6, s[64:67], s76 offen sc1
  s_mov_b64 exec, -1
  v_max3_u32 v226, v92, v93, v94
  v_max3_u32 v226, v226, v95, v96
  v_max3_u32 v226, v226, v97, v98
  v_max3_u32 v226, v226, v99, v100
  v_max3_u32 v226, v226, v101, v102
  v_max3_u32 v226, v226, v103, v103
  v_cmp_eq_u32 vcc, -1, v226
  s_cbranch_vccz Lqo472
  s_mov_b32 s75, 0x61a80
Lqr473:
  s_sleep 2
  s_add_u32 s77, s72, 0xf000
  buffer_load_dwordx4 v[92:95], v2, s[64:67], s77 offen sc1
  buffer_load_dwordx4 v[96:99], v2, s[64:67], s77 offen offset:128 sc1
  buffer_load_dwordx4 v[100:103], v2, s[64:67], s77 offen offset:256 sc1
  s_waitcnt vmcnt(0)
  v_max3_u32 v226, v92, v93, v94
  v_max3_u32 v226, v226, v95, v96
  v_max3_u32 v226, v226, v97, v98
  v_max3_u32 v226, v226, v99, v100
  v_max3_u32 v226, v226, v101, v102
  v_max3_u32 v226, v226, v103, v103
  v_cmp_eq_u32 vcc, -1, v226
  s_cbranch_vccz Lqo472
  s_sub_u32 s75, s75, 1
  s_cmp_lg_u32 s75, 0
  s_cbranch_scc1 Lqr473
Lqo472:
  v_mov_b32 v80, v92
  v_mov_b32 v81, v93
  v_mov_b32 v82, v94
  v_mov_b32 v83, v95
  v_mov_b32 v84, v96
  v_mov_b32 v85, v97
  v_mov_b32 v86, v98
  v_mov_b32 v87, v99
  v_mov_b32 v88, v100
  v_mov_b32 v89, v101
  v_mov_b32 v90, v102
  v_mov_b32 v91, v103
  v_mov_b32 v104, 0
  v_mov_b32 v105, 0
  v_mov_b32 v106, 0
  v_mov_b32 v107, 0
  v_mov_b32 v108, 0
  v_mov_b32 v109, 0
  v_mov_b32 v110, 0
  v_mov_b32 v111, 0
  v_mov_b32 v112, 0
  v_mov_b32 v113, 0
  v_mov_b32 v114, 0
  v_mov_b32 v115, 0
  v_mov_b32 v116, 0
  v_mov_b32 v117, 0
  v_mov_b32 v118, 0
  v_mov_b32 v119, 0
  v_mov_b32 v120, 0
  v_mov_b32 v121, 0
  v_mov_b32 v122, 0
  v_mov_b32 v123, 0
  v_mov_b32 v124, 0
  v_mov_b32 v125, 0
  v_mov_b32 v126, 0
  v_mov_b32 v127, 0
  v_mov_b32 v128, 0xf149f2ca
  v_mov_b32 v129, 0
  s_waitcnt vmcnt(10)
  s_waitcnt vmcnt(7)
  QK2 32, 20, 80, 226
  s_mov_b32 s76, 0x14400
  LDT v, 20, 40
  s_mov_b32 s76, 0x15000
  LDT v, 32, 40
  v_add_f32 v226, v226, v227
  v_add_f32 v226, v226, v228
  v_add_f32 v229, v229, v230
  v_add_f32 v229, v229, v231
  v_add_f32_dpp v226, v226, v226 quad_perm:[1,0,3,2] row_mask:0xf bank_mask:0xf
  s_nop 0
  v_add_f32_dpp v229, v229, v229 quad_perm:[1,0,3,2] row_mask:0xf bank_mask:0xf
  v_add_f32_dpp v226, v226, v226 quad_perm:[2,3,0,1] row_mask:0xf bank_mask:0xf
  s_nop 0
  v_add_f32_dpp v229, v229, v229 quad_perm:[2,3,0,1] row_mask:0xf bank_mask:0xf
  v_add_f32_dpp v226, v226, v226 row_half_mirror row_mask:0xf bank_mask:0xf
  s_nop 0
  v_add_f32_dpp v229, v229, v229 row_half_mirror row_mask:0xf bank_mask:0xf
  v_max3_f32 v232, v128, v226, v229
  v_cmp_gt_f32 vcc, v232, v128
  s_cbranch_vccz Lsk474
  v_sub_f32 v234, v128, v232
  v_mul_f32 v234, s74, v234
  v_exp_f32 v234, v234
  v_mov_b32 v128, v232
  RESC 104, 234
  v_mul_f32 v129, v234, v129
Lsk474:
  v_mul_f32 v233, s74, v128
  v_fma_f32 v235, v226, s74, -v233
  v_fma_f32 v236, v229, s74, -v233
  v_exp_f32 v235, v235
  v_exp_f32 v236, v236
  v_cvt_pk_bf16_f32 v238, v235, 0
  v_cvt_pk_bf16_f32 v239, 0, v235
  v_cvt_pk_bf16_f32 v240, v236, 0
  v_cvt_pk_bf16_f32 v241, 0, v236
  v_add_f32 v129, v129, v239
  v_add_f32 v129, v129, v241
  s_waitcnt vmcnt(10)
  PV 8, 238, 104
  s_mov_b32 s76, 0x14400
  LDT v, 8, 44
  s_waitcnt vmcnt(10)
  PV 44, 240, 104
  s_mov_b32 s76, 0x15000
  LDT v, 44, 44
  s_add_u32 s76, s72, 0x9000
  buffer_load_dwordx4 v[92:95], v2, s[64:67], s76 offen sc1
  buffer_load_dwordx4 v[96:99], v2, s[64:67], s76 offen offset:128 sc1
  buffer_load_dwordx4 v[100:103], v2, s[64:67], s76 offen offset:256 sc1
  s_waitcnt vmcnt(12)
  s_waitcnt vmcnt(9)
  QK2 20, 32, 80, 226
  s_mov_b32 s76, 0x15c00
  LDT v, 20, 40
  s_mov_b32 s76, 0x16800
  LDT v, 32, 40
  v_add_f32 v226, v226, v227
  v_add_f32 v226, v226, v228
  v_add_f32 v229, v229, v230
  v_add_f32 v229, v229, v231
  v_add_f32_dpp v226, v226, v226 quad_perm:[1,0,3,2] row_mask:0xf bank_mask:0xf
  s_nop 0
  v_add_f32_dpp v229, v229, v229 quad_perm:[1,0,3,2] row_mask:0xf bank_mask:0xf
  v_add_f32_dpp v226, v226, v226 quad_perm:[2,3,0,1] row_mask:0xf bank_mask:0xf
  s_nop 0
  v_add_f32_dpp v229, v229, v229 quad_perm:[2,3,0,1] row_mask:0xf bank_mask:0xf
  v_add_f32_dpp v226, v226, v226 row_half_mirror row_mask:0xf bank_mask:0xf
  s_nop 0
  v_add_f32_dpp v229, v229, v229 row_half_mirror row_mask:0xf bank_mask:0xf
  v_max3_f32 v232, v128, v226, v229
  v_cmp_gt_f32 vcc, v232, v128
  s_cbranch_vccz Lsk475
  v_sub_f32 v234, v128, v232
  v_mul_f32 v234, s74, v234
  v_exp_f32 v234, v234
  v_mov_b32 v128, v232
  RESC 104, 234
  v_mul_f32 v129, v234, v129
Lsk475:
  v_mul_f32 v233, s74, v128
  v_fma_f32 v235, v226, s74, -v233
  v_fma_f32 v236, v229, s74, -v233
  v_exp_f32 v235, v235
  v_exp_f32 v236, v236
  v_cvt_pk_bf16_f32 v238, v235, 0
  v_cvt_pk_bf16_f32 v239, 0, v235
  v_cvt_pk_bf16_f32 v240, v236, 0
  v_cvt_pk_bf16_f32 v241, 0, v236
  v_add_f32 v129, v129, v239
  v_add_f32 v129, v129, v241
  s_waitcnt vmcnt(12)
  PV 8, 238, 104
  s_mov_b32 s76, 0x15c00
  LDT v, 8, 44
  s_waitcnt vmcnt(12)
  PV 44, 240, 104
  s_mov_b32 s76, 0x16800
  LDT v, 44, 44
  s_waitcnt vmcnt(9)
  s_waitcnt vmcnt(6)
  QK2 20, 32, 80, 226
  s_mov_b32 s76, 0x17400
  LDT v, 20, 40
  s_mov_b32 s76, 0x18000
  LDT v, 32, 40
  v_add_f32 v226, v226, v227
  v_add_f32 v226, v226, v228
  v_add_f32 v229, v229, v230
  v_add_f32 v229, v229, v231
  v_add_f32_dpp v226, v226, v226 quad_perm:[1,0,3,2] row_mask:0xf bank_mask:0xf
  s_nop 0
  v_add_f32_dpp v229, v229, v229 quad_perm:[1,0,3,2] row_mask:0xf bank_mask:0xf
  v_add_f32_dpp v226, v226, v226 quad_perm:[2,3,0,1] row_mask:0xf bank_mask:0xf
  s_nop 0
  v_add_f32_dpp v229, v229, v229 quad_perm:[2,3,0,1] row_mask:0xf bank_mask:0xf
  v_add_f32_dpp v226, v226, v226 row_half_mirror row_mask:0xf bank_mask:0xf
  s_nop 0
  v_add_f32_dpp v229, v229, v229 row_half_mirror row_mask:0xf bank_mask:0xf
  v_max3_f32 v232, v128, v226, v229
  v_cmp_gt_f32 vcc, v232, v128
  s_cbranch_vccz Lsk476
  v_sub_f32 v234, v128, v232
  v_mul_f32 v234, s74, v234
  v_exp_f32 v234, v234
  v_mov_b32 v128, v232
  RESC 104, 234
  v_mul_f32 v129, v234, v129
Lsk476:
  v_mul_f32 v233, s74, v128
  v_fma_f32 v235, v226, s74, -v233
  v_fma_f32 v236, v229, s74, -v233
  v_exp_f32 v235, v235
  v_exp_f32 v236, v236
  v_cvt_pk_bf16_f32 v238, v235, 0
  v_cvt_pk_bf16_f32 v239, 0, v235
  v_cvt_pk_bf16_f32 v240, v236, 0
  v_cvt_pk_bf16_f32 v241, 0, v236
  v_add_f32 v129, v129, v239
  v_add_f32 v129, v129, v241
  s_waitcnt vmcnt(9)
  PV 8, 238, 104
  s_mov_b32 s76, 0x17400
  LDT v, 8, 44
  s_waitcnt vmcnt(9)
  PV 44, 240, 104
  s_mov_b32 s76, 0x18000
  LDT v, 44, 44
  s_waitcnt vmcnt(9)
  s_waitcnt vmcnt(6)
  QK2 20, 32, 80, 226
  s_mov_b32 s76, 0x12c00
  LDT v, 20, 56
  s_mov_b32 s76, 0x13800
  LDT v, 32, 56
  v_add_f32 v226, v226, v227
  v_add_f32 v226, v226, v228
  v_add_f32 v229, v229, v230
  v_add_f32 v229, v229, v231
  v_add_f32_dpp v226, v226, v226 quad_perm:[1,0,3,2] row_mask:0xf bank_mask:0xf
  s_nop 0
  v_add_f32_dpp v229, v229, v229 quad_perm:[1,0,3,2] row_mask:0xf bank_mask:0xf
  v_add_f32_dpp v226, v226, v226 quad_perm:[2,3,0,1] row_mask:0xf bank_mask:0xf
  s_nop 0
  v_add_f32_dpp v229, v229, v229 quad_perm:[2,3,0,1] row_mask:0xf bank_mask:0xf
  v_add_f32_dpp v226, v226, v226 row_half_mirror row_mask:0xf bank_mask:0xf
  s_nop 0
  v_add_f32_dpp v229, v229, v229 row_half_mirror row_mask:0xf bank_mask:0xf
  v_max3_f32 v232, v128, v226, v229
  v_cmp_gt_f32 vcc, v232, v128
  s_cbranch_vccz Lsk477
  v_sub_f32 v234, v128, v232
  v_mul_f32 v234, s74, v234
  v_exp_f32 v234, v234
  v_mov_b32 v128, v232
  RESC 104, 234
  v_mul_f32 v129, v234, v129
Lsk477:
  v_mul_f32 v233, s74, v128
  v_fma_f32 v235, v226, s74, -v233
  v_fma_f32 v236, v229, s74, -v233
  v_exp_f32 v235, v235
  v_exp_f32 v236, v236
  v_cvt_pk_bf16_f32 v238, v235, 0
  v_cvt_pk_bf16_f32 v239, 0, v235
  v_cvt_pk_bf16_f32 v240, v236, 0
  v_cvt_pk_bf16_f32 v241, 0, v236
  v_add_f32 v129, v129, v239
  v_add_f32 v129, v129, v241
  s_waitcnt vmcnt(9)
  PV 8, 238, 104
  s_mov_b32 s76, 0x12c00
  LDT v, 8, 60
  s_waitcnt vmcnt(9)
  PV 44, 240, 104
  s_mov_b32 s76, 0x13800
  LDT v, 44, 60
  v_max_f32_dpp v226, v128, v128 row_ror:8 row_mask:0xf bank_mask:0xf
  v_mov_b32 v227, v226
  s_nop 1
  v_permlane16_swap_b32 v226, v227
  v_max_f32 v226, v226, v227
  v_mov_b32 v227, v226
  s_nop 1
  v_permlane32_swap_b32 v226, v227
  v_max_f32 v226, v226, v227
  v_sub_f32 v228, v128, v226
  v_mul_f32 v228, s74, v228
  v_exp_f32 v228, v228
  v_mul_f32 v226, s74, v226
  RESC 104, 228
  v_mul_f32 v129, v228, v129
  s_nop 1
  v_add_f32_dpp v129, v129, v129 row_ror:8 row_mask:0xf bank_mask:0xf
  v_mov_b32 v227, v129
  s_nop 1
  v_permlane16_swap_b32 v129, v227
  v_add_f32 v129, v129, v227
  v_mov_b32 v227, v129
  s_nop 1
  v_permlane32_swap_b32 v129, v227
  v_add_f32 v129, v129, v227
  v_permlane32_swap_b32 v104, v116
  v_permlane32_swap_b32 v105, v117
  v_permlane32_swap_b32 v106, v118
  v_permlane32_swap_b32 v107, v119
  v_permlane32_swap_b32 v108, v120
  v_permlane32_swap_b32 v109, v121
  v_permlane32_swap_b32 v110, v122
  v_permlane32_swap_b32 v111, v123
  v_permlane32_swap_b32 v112, v124
  v_permlane32_swap_b32 v113, v125
  v_permlane32_swap_b32 v114, v126
  v_permlane32_swap_b32 v115, v127
  v_add_f32 v104, v104, v116
  v_add_f32 v105, v105, v117
  v_add_f32 v106, v106, v118
  v_add_f32 v107, v107, v119
  v_add_f32 v108, v108, v120
  v_add_f32 v109, v109, v121
  v_add_f32 v110, v110, v122
  v_add_f32 v111, v111, v123
  v_add_f32 v112, v112, v124
  v_add_f32 v113, v113, v125
  v_add_f32 v114, v114, v126
  v_add_f32 v115, v115, v127
  v_permlane16_swap_b32 v104, v110
  v_permlane16_swap_b32 v105, v111
  v_permlane16_swap_b32 v106, v112
  v_permlane16_swap_b32 v107, v113
  v_permlane16_swap_b32 v108, v114
  v_permlane16_swap_b32 v109, v115
  v_add_f32 v104, v104, v110
  v_add_f32 v105, v105, v111
  v_add_f32 v106, v106, v112
  v_add_f32 v107, v107, v113
  v_add_f32 v108, v108, v114
  v_add_f32 v109, v109, v115
  v_add_f32_dpp v104, v104, v104 row_ror:8 row_mask:0xf bank_mask:0xf
  v_add_f32_dpp v105, v105, v105 row_ror:8 row_mask:0xf bank_mask:0xf
  v_add_f32_dpp v106, v106, v106 row_ror:8 row_mask:0xf bank_mask:0xf
  v_add_f32_dpp v107, v107, v107 row_ror:8 row_mask:0xf bank_mask:0xf
  v_add_f32_dpp v108, v108, v108 row_ror:8 row_mask:0xf bank_mask:0xf
  v_add_f32_dpp v109, v109, v109 row_ror:8 row_mask:0xf bank_mask:0xf
  v_add_u32 v229, 0, v7
  v_lshrrev_b32 v230, 3, v229
  v_and_b32 v229, 7, v229
  v_lshlrev_b32 v230, 6, v230
  v_add_u32 v229, v229, v230
  v_lshl_add_u32 v229, v229, 2, v4
  ds_write_b32 v229, v104
  v_add_u32 v229, 1, v7
  v_lshrrev_b32 v230, 3, v229
  v_and_b32 v229, 7, v229
  v_lshlrev_b32 v230, 6, v230
  v_add_u32 v229, v229, v230
  v_lshl_add_u32 v229, v229, 2, v4
  ds_write_b32 v229, v105
  v_add_u32 v229, 2, v7
  v_lshrrev_b32 v230, 3, v229
  v_and_b32 v229, 7, v229
  v_lshlrev_b32 v230, 6, v230
  v_add_u32 v229, v229, v230
  v_lshl_add_u32 v229, v229, 2, v4
  ds_write_b32 v229, v106
  v_add_u32 v229, 3, v7
  v_lshrrev_b32 v230, 3, v229
  v_and_b32 v229, 7, v229
  v_lshlrev_b32 v230, 6, v230
  v_add_u32 v229, v229, v230
  v_lshl_add_u32 v229, v229, 2, v4
  ds_write_b32 v229, v107
  v_add_u32 v229, 4, v7
  v_lshrrev_b32 v230, 3, v229
  v_and_b32 v229, 7, v229
  v_lshlrev_b32 v230, 6, v230
  v_add_u32 v229, v229, v230
  v_lshl_add_u32 v229, v229, 2, v4
  ds_write_b32 v229, v108
  v_add_u32 v229, 5, v7
  v_lshrrev_b32 v230, 3, v229
  v_and_b32 v229, 7, v229
  v_lshlrev_b32 v230, 6, v230
  v_add_u32 v229, v229, v230
  v_lshl_add_u32 v229, v229, 2, v4
  ds_write_b32 v229, v109
  v_mov_b32 v234, v226
  v_mov_b32 v235, v129
  v_mov_b32 v236, 0
  v_mov_b32 v237, 0
  v_and_b32 v229, 0xffffff1f, v4
  ds_write_b128 v229, v[234:237] offset:768
  s_waitcnt lgkmcnt(0)
  ds_read_b128 v[234:237], v5
  s_waitcnt lgkmcnt(0)
  s_add_u32 s76, s73, 0x638800
  s_mov_b32 exec_lo, -1
  s_mov_b32 exec_hi, 0x1ffff
  buffer_store_dwordx4 v[234:237], v6, s[64:67], s76 offen sc1
  s_mov_b64 exec, -1
  v_max3_u32 v226, v92, v93, v94
  v_max3_u32 v226, v226, v95, v96
  v_max3_u32 v226, v226, v97, v98
  v_max3_u32 v226, v226, v99, v100
  v_max3_u32 v226, v226, v101, v102
  v_max3_u32 v226, v226, v103, v103
  v_cmp_eq_u32 vcc, -1, v226
  s_cbranch_vccz Lqo478
  s_mov_b32 s75, 0x61a80
Lqr479:
  s_sleep 2
  s_add_u32 s77, s72, 0x9000
  buffer_load_dwordx4 v[92:95], v2, s[64:67], s77 offen sc1
  buffer_load_dwordx4 v[96:99], v2, s[64:67], s77 offen offset:128 sc1
  buffer_load_dwordx4 v[100:103], v2, s[64:67], s77 offen offset:256 sc1
  s_waitcnt vmcnt(0)
  v_max3_u32 v226, v92, v93, v94
  v_max3_u32 v226, v226, v95, v96
  v_max3_u32 v226, v226, v97, v98
  v_max3_u32 v226, v226, v99, v100
  v_max3_u32 v226, v226, v101, v102
  v_max3_u32 v226, v226, v103, v103
  v_cmp_eq_u32 vcc, -1, v226
  s_cbranch_vccz Lqo478
  s_sub_u32 s75, s75, 1
  s_cmp_lg_u32 s75, 0
  s_cbranch_scc1 Lqr479
Lqo478:
  v_mov_b32 v80, v92
  v_mov_b32 v81, v93
  v_mov_b32 v82, v94
  v_mov_b32 v83, v95
  v_mov_b32 v84, v96
  v_mov_b32 v85, v97
  v_mov_b32 v86, v98
  v_mov_b32 v87, v99
  v_mov_b32 v88, v100
  v_mov_b32 v89, v101
  v_mov_b32 v90, v102
  v_mov_b32 v91, v103
  v_mov_b32 v104, 0
  v_mov_b32 v105, 0
  v_mov_b32 v106, 0
  v_mov_b32 v107, 0
  v_mov_b32 v108, 0
  v_mov_b32 v109, 0
  v_mov_b32 v110, 0
  v_mov_b32 v111, 0
  v_mov_b32 v112, 0
  v_mov_b32 v113, 0
  v_mov_b32 v114, 0
  v_mov_b32 v115, 0
  v_mov_b32 v116, 0
  v_mov_b32 v117, 0
  v_mov_b32 v118, 0
  v_mov_b32 v119, 0
  v_mov_b32 v120, 0
  v_mov_b32 v121, 0
  v_mov_b32 v122, 0
  v_mov_b32 v123, 0
  v_mov_b32 v124, 0
  v_mov_b32 v125, 0
  v_mov_b32 v126, 0
  v_mov_b32 v127, 0
  v_mov_b32 v128, 0xf149f2ca
  v_mov_b32 v129, 0
  s_waitcnt vmcnt(10)
  s_waitcnt vmcnt(7)
  QK2 20, 32, 80, 226
  s_mov_b32 s76, 0x14400
  LDT v, 20, 56
  s_mov_b32 s76, 0x15000
  LDT v, 32, 56
  v_add_f32 v226, v226, v227
  v_add_f32 v226, v226, v228
  v_add_f32 v229, v229, v230
  v_add_f32 v229, v229, v231
  v_add_f32_dpp v226, v226, v226 quad_perm:[1,0,3,2] row_mask:0xf bank_mask:0xf
  s_nop 0
  v_add_f32_dpp v229, v229, v229 quad_perm:[1,0,3,2] row_mask:0xf bank_mask:0xf
  v_add_f32_dpp v226, v226, v226 quad_perm:[2,3,0,1] row_mask:0xf bank_mask:0xf
  s_nop 0
  v_add_f32_dpp v229, v229, v229 quad_perm:[2,3,0,1] row_mask:0xf bank_mask:0xf
  v_add_f32_dpp v226, v226, v226 row_half_mirror row_mask:0xf bank_mask:0xf
  s_nop 0
  v_add_f32_dpp v229, v229, v229 row_half_mirror row_mask:0xf bank_mask:0xf
  v_max3_f32 v232, v128, v226, v229
  v_cmp_gt_f32 vcc, v232, v128
  s_cbranch_vccz Lsk480
  v_sub_f32 v234, v128, v232
  v_mul_f32 v234, s74, v234
  v_exp_f32 v234, v234
  v_mov_b32 v128, v232
  RESC 104, 234
  v_mul_f32 v129, v234, v129
Lsk480:
  v_mul_f32 v233, s74, v128
  v_fma_f32 v235, v226, s74, -v233
  v_fma_f32 v236, v229, s74, -v233
  v_exp_f32 v235, v235
  v_exp_f32 v236, v236
  v_cvt_pk_bf16_f32 v238, v235, 0
  v_cvt_pk_bf16_f32 v239, 0, v235
  v_cvt_pk_bf16_f32 v240, v236, 0
  v_cvt_pk_bf16_f32 v241, 0, v236
  v_add_f32 v129, v129, v239
  v_add_f32 v129, v129, v241
  s_waitcnt vmcnt(10)
  PV 8, 238, 104
  s_mov_b32 s76, 0x14400
  LDT v, 8, 60
  s_waitcnt vmcnt(10)
  PV 44, 240, 104
  s_mov_b32 s76, 0x15000
  LDT v, 44, 60
  s_waitcnt vmcnt(9)
  s_waitcnt vmcnt(6)
  QK2 20, 32, 80, 226
  s_mov_b32 s76, 0x15c00
  LDT v, 20, 56
  s_mov_b32 s76, 0x16800
  LDT v, 32, 56
  v_add_f32 v226, v226, v227
  v_add_f32 v226, v226, v228
  v_add_f32 v229, v229, v230
  v_add_f32 v229, v229, v231
  v_add_f32_dpp v226, v226, v226 quad_perm:[1,0,3,2] row_mask:0xf bank_mask:0xf
  s_nop 0
  v_add_f32_dpp v229, v229, v229 quad_perm:[1,0,3,2] row_mask:0xf bank_mask:0xf
  v_add_f32_dpp v226, v226, v226 quad_perm:[2,3,0,1] row_mask:0xf bank_mask:0xf
  s_nop 0
  v_add_f32_dpp v229, v229, v229 quad_perm:[2,3,0,1] row_mask:0xf bank_mask:0xf
  v_add_f32_dpp v226, v226, v226 row_half_mirror row_mask:0xf bank_mask:0xf
  s_nop 0
  v_add_f32_dpp v229, v229, v229 row_half_mirror row_mask:0xf bank_mask:0xf
  v_max3_f32 v232, v128, v226, v229
  v_cmp_gt_f32 vcc, v232, v128
  s_cbranch_vccz Lsk481
  v_sub_f32 v234, v128, v232
  v_mul_f32 v234, s74, v234
  v_exp_f32 v234, v234
  v_mov_b32 v128, v232
  RESC 104, 234
  v_mul_f32 v129, v234, v129
Lsk481:
  v_mul_f32 v233, s74, v128
  v_fma_f32 v235, v226, s74, -v233
  v_fma_f32 v236, v229, s74, -v233
  v_exp_f32 v235, v235
  v_exp_f32 v236, v236
  v_cvt_pk_bf16_f32 v238, v235, 0
  v_cvt_pk_bf16_f32 v239, 0, v235
  v_cvt_pk_bf16_f32 v240, v236, 0
  v_cvt_pk_bf16_f32 v241, 0, v236
  v_add_f32 v129, v129, v239
  v_add_f32 v129, v129, v241
  s_waitcnt vmcnt(9)
  PV 8, 238, 104
  s_mov_b32 s76, 0x15c00
  LDT v, 8, 60
  s_waitcnt vmcnt(9)
  PV 44, 240, 104
  s_mov_b32 s76, 0x16800
  LDT v, 44, 60
  s_waitcnt vmcnt(9)
  s_waitcnt vmcnt(6)
  QK2 20, 32, 80, 226
  s_mov_b32 s76, 0x17400
  LDT v, 20, 56
  s_mov_b32 s76, 0x18000
  LDT v, 32, 56
  v_add_f32 v226, v226, v227
  v_add_f32 v226, v226, v228
  v_add_f32 v229, v229, v230
  v_add_f32 v229, v229, v231
  v_add_f32_dpp v226, v226, v226 quad_perm:[1,0,3,2] row_mask:0xf bank_mask:0xf
  s_nop 0
  v_add_f32_dpp v229, v229, v229 quad_perm:[1,0,3,2] row_mask:0xf bank_mask:0xf
  v_add_f32_dpp v226, v226, v226 quad_perm:[2,3,0,1] row_mask:0xf bank_mask:0xf
  s_nop 0
  v_add_f32_dpp v229, v229, v229 quad_perm:[2,3,0,1] row_mask:0xf bank_mask:0xf
  v_add_f32_dpp v226, v226, v226 row_half_mirror row_mask:0xf bank_mask:0xf
  s_nop 0
  v_add_f32_dpp v229, v229, v229 row_half_mirror row_mask:0xf bank_mask:0xf
  v_max3_f32 v232, v128, v226, v229
  v_cmp_gt_f32 vcc, v232, v128
  s_cbranch_vccz Lsk482
  v_sub_f32 v234, v128, v232
  v_mul_f32 v234, s74, v234
  v_exp_f32 v234, v234
  v_mov_b32 v128, v232
  RESC 104, 234
  v_mul_f32 v129, v234, v129
Lsk482:
  v_mul_f32 v233, s74, v128
  v_fma_f32 v235, v226, s74, -v233
  v_fma_f32 v236, v229, s74, -v233
  v_exp_f32 v235, v235
  v_exp_f32 v236, v236
  v_cvt_pk_bf16_f32 v238, v235, 0
  v_cvt_pk_bf16_f32 v239, 0, v235
  v_cvt_pk_bf16_f32 v240, v236, 0
  v_cvt_pk_bf16_f32 v241, 0, v236
  v_add_f32 v129, v129, v239
  v_add_f32 v129, v129, v241
  s_waitcnt vmcnt(9)
  PV 8, 238, 104
  s_mov_b32 s76, 0x17400
  LDT v, 8, 60
  s_waitcnt vmcnt(9)
  PV 44, 240, 104
  s_mov_b32 s76, 0x18000
  LDT v, 44, 60
  s_waitcnt vmcnt(9)
  s_waitcnt vmcnt(6)
  QK2 20, 32, 80, 226
  s_mov_b32 s76, 0x18c00
  LDT v, 20, 56
  s_mov_b32 s76, 0x19800
  LDT v, 32, 56
  v_add_f32 v226, v226, v227
  v_add_f32 v226, v226, v228
  v_add_f32 v229, v229, v230
  v_add_f32 v229, v229, v231
  v_add_f32_dpp v226, v226, v226 quad_perm:[1,0,3,2] row_mask:0xf bank_mask:0xf
  s_nop 0
  v_add_f32_dpp v229, v229, v229 quad_perm:[1,0,3,2] row_mask:0xf bank_mask:0xf
  v_add_f32_dpp v226, v226, v226 quad_perm:[2,3,0,1] row_mask:0xf bank_mask:0xf
  s_nop 0
  v_add_f32_dpp v229, v229, v229 quad_perm:[2,3,0,1] row_mask:0xf bank_mask:0xf
  v_add_f32_dpp v226, v226, v226 row_half_mirror row_mask:0xf bank_mask:0xf
  s_nop 0
  v_add_f32_dpp v229, v229, v229 row_half_mirror row_mask:0xf bank_mask:0xf
  v_max3_f32 v232, v128, v226, v229
  v_cmp_gt_f32 vcc, v232, v128
  s_cbranch_vccz Lsk483
  v_sub_f32 v234, v128, v232
  v_mul_f32 v234, s74, v234
  v_exp_f32 v234, v234
  v_mov_b32 v128, v232
  RESC 104, 234
  v_mul_f32 v129, v234, v129
Lsk483:
  v_mul_f32 v233, s74, v128
  v_fma_f32 v235, v226, s74, -v233
  v_fma_f32 v236, v229, s74, -v233
  v_exp_f32 v235, v235
  v_exp_f32 v236, v236
  v_cvt_pk_bf16_f32 v238, v235, 0
  v_cvt_pk_bf16_f32 v239, 0, v235
  v_cvt_pk_bf16_f32 v240, v236, 0
  v_cvt_pk_bf16_f32 v241, 0, v236
  v_add_f32 v129, v129, v239
  v_add_f32 v129, v129, v241
  s_waitcnt vmcnt(9)
  PV 8, 238, 104
  s_mov_b32 s76, 0x18c00
  LDT v, 8, 60
  s_waitcnt vmcnt(9)
  PV 44, 240, 104
  s_mov_b32 s76, 0x19800
  LDT v, 44, 60
  s_waitcnt vmcnt(9)
  s_waitcnt vmcnt(6)
  QK2 20, 32, 80, 226
  s_mov_b32 s76, 0x1a400
  LDT v, 20, 56
  s_mov_b32 s76, 0x1b000
  LDT v, 32, 56
  v_add_f32 v226, v226, v227
  v_add_f32 v226, v226, v228
  v_add_f32 v229, v229, v230
  v_add_f32 v229, v229, v231
  v_add_f32_dpp v226, v226, v226 quad_perm:[1,0,3,2] row_mask:0xf bank_mask:0xf
  s_nop 0
  v_add_f32_dpp v229, v229, v229 quad_perm:[1,0,3,2] row_mask:0xf bank_mask:0xf
  v_add_f32_dpp v226, v226, v226 quad_perm:[2,3,0,1] row_mask:0xf bank_mask:0xf
  s_nop 0
  v_add_f32_dpp v229, v229, v229 quad_perm:[2,3,0,1] row_mask:0xf bank_mask:0xf
  v_add_f32_dpp v226, v226, v226 row_half_mirror row_mask:0xf bank_mask:0xf
  s_nop 0
  v_add_f32_dpp v229, v229, v229 row_half_mirror row_mask:0xf bank_mask:0xf
  v_max3_f32 v232, v128, v226, v229
  v_cmp_gt_f32 vcc, v232, v128
  s_cbranch_vccz Lsk484
  v_sub_f32 v234, v128, v232
  v_mul_f32 v234, s74, v234
  v_exp_f32 v234, v234
  v_mov_b32 v128, v232
  RESC 104, 234
  v_mul_f32 v129, v234, v129
Lsk484:
  v_mul_f32 v233, s74, v128
  v_fma_f32 v235, v226, s74, -v233
  v_fma_f32 v236, v229, s74, -v233
  v_exp_f32 v235, v235
  v_exp_f32 v236, v236
  v_cvt_pk_bf16_f32 v238, v235, 0
  v_cvt_pk_bf16_f32 v239, 0, v235
  v_cvt_pk_bf16_f32 v240, v236, 0
  v_cvt_pk_bf16_f32 v241, 0, v236
  v_add_f32 v129, v129, v239
  v_add_f32 v129, v129, v241
  s_waitcnt vmcnt(9)
  PV 8, 238, 104
  s_mov_b32 s76, 0x1a400
  LDT v, 8, 60
  s_waitcnt vmcnt(9)
  PV 44, 240, 104
  s_mov_b32 s76, 0x1b000
  LDT v, 44, 60
  s_add_u32 s76, s72, 0x12000
  buffer_load_dwordx4 v[92:95], v2, s[64:67], s76 offen sc1
  buffer_load_dwordx4 v[96:99], v2, s[64:67], s76 offen offset:128 sc1
  buffer_load_dwordx4 v[100:103], v2, s[64:67], s76 offen offset:256 sc1
  s_waitcnt vmcnt(12)
  s_waitcnt vmcnt(9)
  QK2 20, 32, 80, 226
  s_mov_b32 s76, 0x1bc00
  LDT v, 20, 56
  s_mov_b32 s76, 0x1c800
  LDT v, 32, 56
  v_add_f32 v226, v226, v227
  v_add_f32 v226, v226, v228
  v_add_f32 v229, v229, v230
  v_add_f32 v229, v229, v231
  v_add_f32_dpp v226, v226, v226 quad_perm:[1,0,3,2] row_mask:0xf bank_mask:0xf
  s_nop 0
  v_add_f32_dpp v229, v229, v229 quad_perm:[1,0,3,2] row_mask:0xf bank_mask:0xf
  v_add_f32_dpp v226, v226, v226 quad_perm:[2,3,0,1] row_mask:0xf bank_mask:0xf
  s_nop 0
  v_add_f32_dpp v229, v229, v229 quad_perm:[2,3,0,1] row_mask:0xf bank_mask:0xf
  v_add_f32_dpp v226, v226, v226 row_half_mirror row_mask:0xf bank_mask:0xf
  s_nop 0
  v_add_f32_dpp v229, v229, v229 row_half_mirror row_mask:0xf bank_mask:0xf
  v_max3_f32 v232, v128, v226, v229
  v_cmp_gt_f32 vcc, v232, v128
  s_cbranch_vccz Lsk485
  v_sub_f32 v234, v128, v232
  v_mul_f32 v234, s74, v234
  v_exp_f32 v234, v234
  v_mov_b32 v128, v232
  RESC 104, 234
  v_mul_f32 v129, v234, v129
Lsk485:
  v_mul_f32 v233, s74, v128
  v_fma_f32 v235, v226, s74, -v233
  v_fma_f32 v236, v229, s74, -v233
  v_exp_f32 v235, v235
  v_exp_f32 v236, v236
  v_cvt_pk_bf16_f32 v238, v235, 0
  v_cvt_pk_bf16_f32 v239, 0, v235
  v_cvt_pk_bf16_f32 v240, v236, 0
  v_cvt_pk_bf16_f32 v241, 0, v236
  v_add_f32 v129, v129, v239
  v_add_f32 v129, v129, v241
  s_waitcnt vmcnt(12)
  PV 8, 238, 104
  s_mov_b32 s76, 0x1bc00
  LDT v, 8, 60
  s_waitcnt vmcnt(12)
  PV 44, 240, 104
  s_mov_b32 s76, 0x1c800
  LDT v, 44, 60
  s_waitcnt vmcnt(9)
  s_waitcnt vmcnt(6)
  QK2 20, 32, 80, 226
  s_mov_b32 s76, 0x1d400
  LDT v, 20, 56
  s_mov_b32 s76, 0x1d400
  LDT v, 32, 60
  v_add_f32 v226, v226, v227
  v_add_f32 v226, v226, v228
  v_add_f32 v229, v229, v230
  v_add_f32 v229, v229, v231
  v_add_f32_dpp v226, v226, v226 quad_perm:[1,0,3,2] row_mask:0xf bank_mask:0xf
  s_nop 0
  v_add_f32_dpp v229, v229, v229 quad_perm:[1,0,3,2] row_mask:0xf bank_mask:0xf
  v_add_f32_dpp v226, v226, v226 quad_perm:[2,3,0,1] row_mask:0xf bank_mask:0xf
  s_nop 0
  v_add_f32_dpp v229, v229, v229 quad_perm:[2,3,0,1] row_mask:0xf bank_mask:0xf
  v_add_f32_dpp v226, v226, v226 row_half_mirror row_mask:0xf bank_mask:0xf
  s_nop 0
  v_add_f32_dpp v229, v229, v229 row_half_mirror row_mask:0xf bank_mask:0xf
  v_max3_f32 v232, v128, v226, v229
  v_cmp_gt_f32 vcc, v232, v128
  s_cbranch_vccz Lsk486
  v_sub_f32 v234, v128, v232
  v_mul_f32 v234, s74, v234
  v_exp_f32 v234, v234
  v_mov_b32 v128, v232
  RESC 104, 234
  v_mul_f32 v129, v234, v129
Lsk486:
  v_mul_f32 v233, s74, v128
  v_fma_f32 v235, v226, s74, -v233
  v_fma_f32 v236, v229, s74, -v233
  v_exp_f32 v235, v235
  v_exp_f32 v236, v236
  v_cvt_pk_bf16_f32 v238, v235, 0
  v_cvt_pk_bf16_f32 v239, 0, v235
  v_cvt_pk_bf16_f32 v240, v236, 0
  v_cvt_pk_bf16_f32 v241, 0, v236
  v_add_f32 v129, v129, v239
  v_add_f32 v129, v129, v241
  s_waitcnt vmcnt(9)
  PV 8, 238, 104
  s_mov_b32 s76, 0xfc00
  LDT v, 8, 48
  s_waitcnt vmcnt(9)
  PV 44, 240, 104
  s_mov_b32 s76, 0x10800
  LDT v, 44, 48
  s_waitcnt vmcnt(9)
  v_dot2_f32_bf16 v226, v20, v80, 0
  v_dot2_f32_bf16 v227, v24, v84, 0
  v_dot2_f32_bf16 v228, v28, v88, 0
  s_nop 0
  v_dot2c_f32_bf16 v226, v21, v81
  v_dot2c_f32_bf16 v227, v25, v85
  v_dot2c_f32_bf16 v228, v29, v89
  v_dot2c_f32_bf16 v226, v22, v82
  v_dot2c_f32_bf16 v227, v26, v86
  v_dot2c_f32_bf16 v228, v30, v90
  v_dot2c_f32_bf16 v226, v23, v83
  v_dot2c_f32_bf16 v227, v27, v87
  v_dot2c_f32_bf16 v228, v31, v91
  s_mov_b32 s76, 0xfc00
  LDT v, 20, 52
  v_add_f32 v226, v226, v227
  v_add_f32 v226, v226, v228
  s_nop 1
  v_add_f32_dpp v226, v226, v226 quad_perm:[1,0,3,2] row_mask:0xf bank_mask:0xf
  s_nop 1
  v_add_f32_dpp v226, v226, v226 quad_perm:[2,3,0,1] row_mask:0xf bank_mask:0xf
  s_nop 1
  v_add_f32_dpp v226, v226, v226 row_half_mirror row_mask:0xf bank_mask:0xf
  v_add_f32 v226, s83, v226
  v_max_f32 v232, v128, v226
  v_cmp_gt_f32 vcc, v232, v128
  s_cbranch_vccz Lsk487
  v_sub_f32 v234, v128, v232
  v_mul_f32 v234, s74, v234
  v_exp_f32 v234, v234
  v_mov_b32 v128, v232
  RESC 104, 234
  v_mul_f32 v129, v234, v129
Lsk487:
  v_mul_f32 v233, s74, v128
  v_fma_f32 v235, v226, s74, -v233
  v_exp_f32 v235, v235
  s_nop 0
  v_cvt_pk_bf16_f32 v238, v235, 0
  v_cvt_pk_bf16_f32 v239, 0, v235
  v_add_f32 v129, v129, v239
  s_waitcnt vmcnt(9)
  PV 32, 238, 104
  s_mov_b32 s76, 0x10800
  LDT v, 32, 52
  v_max_f32_dpp v226, v128, v128 row_ror:8 row_mask:0xf bank_mask:0xf
  v_mov_b32 v227, v226
  s_nop 1
  v_permlane16_swap_b32 v226, v227
  v_max_f32 v226, v226, v227
  v_mov_b32 v227, v226
  s_nop 1
  v_permlane32_swap_b32 v226, v227
  v_max_f32 v226, v226, v227
  v_sub_f32 v228, v128, v226
  v_mul_f32 v228, s74, v228
  v_exp_f32 v228, v228
  v_mul_f32 v226, s74, v226
  RESC 104, 228
  v_mul_f32 v129, v228, v129
  s_nop 1
  v_add_f32_dpp v129, v129, v129 row_ror:8 row_mask:0xf bank_mask:0xf
  v_mov_b32 v227, v129
  s_nop 1
  v_permlane16_swap_b32 v129, v227
  v_add_f32 v129, v129, v227
  v_mov_b32 v227, v129
  s_nop 1
  v_permlane32_swap_b32 v129, v227
  v_add_f32 v129, v129, v227
  v_permlane32_swap_b32 v104, v116
  v_permlane32_swap_b32 v105, v117
  v_permlane32_swap_b32 v106, v118
  v_permlane32_swap_b32 v107, v119
  v_permlane32_swap_b32 v108, v120
  v_permlane32_swap_b32 v109, v121
  v_permlane32_swap_b32 v110, v122
  v_permlane32_swap_b32 v111, v123
  v_permlane32_swap_b32 v112, v124
  v_permlane32_swap_b32 v113, v125
  v_permlane32_swap_b32 v114, v126
  v_permlane32_swap_b32 v115, v127
  v_add_f32 v104, v104, v116
  v_add_f32 v105, v105, v117
  v_add_f32 v106, v106, v118
  v_add_f32 v107, v107, v119
  v_add_f32 v108, v108, v120
  v_add_f32 v109, v109, v121
  v_add_f32 v110, v110, v122
  v_add_f32 v111, v111, v123
  v_add_f32 v112, v112, v124
  v_add_f32 v113, v113, v125
  v_add_f32 v114, v114, v126
  v_add_f32 v115, v115, v127
  v_permlane16_swap_b32 v104, v110
  v_permlane16_swap_b32 v105, v111
  v_permlane16_swap_b32 v106, v112
  v_permlane16_swap_b32 v107, v113
  v_permlane16_swap_b32 v108, v114
  v_permlane16_swap_b32 v109, v115
  v_add_f32 v104, v104, v110
  v_add_f32 v105, v105, v111
  v_add_f32 v106, v106, v112
  v_add_f32 v107, v107, v113
  v_add_f32 v108, v108, v114
  v_add_f32 v109, v109, v115
  v_add_f32_dpp v104, v104, v104 row_ror:8 row_mask:0xf bank_mask:0xf
  v_add_f32_dpp v105, v105, v105 row_ror:8 row_mask:0xf bank_mask:0xf
  v_add_f32_dpp v106, v106, v106 row_ror:8 row_mask:0xf bank_mask:0xf
  v_add_f32_dpp v107, v107, v107 row_ror:8 row_mask:0xf bank_mask:0xf
  v_add_f32_dpp v108, v108, v108 row_ror:8 row_mask:0xf bank_mask:0xf
  v_add_f32_dpp v109, v109, v109 row_ror:8 row_mask:0xf bank_mask:0xf
  v_add_u32 v229, 0, v7
  v_lshrrev_b32 v230, 3, v229
  v_and_b32 v229, 7, v229
  v_lshlrev_b32 v230, 6, v230
  v_add_u32 v229, v229, v230
  v_lshl_add_u32 v229, v229, 2, v4
  ds_write_b32 v229, v104
  v_add_u32 v229, 1, v7
  v_lshrrev_b32 v230, 3, v229
  v_and_b32 v229, 7, v229
  v_lshlrev_b32 v230, 6, v230
  v_add_u32 v229, v229, v230
  v_lshl_add_u32 v229, v229, 2, v4
  ds_write_b32 v229, v105
  v_add_u32 v229, 2, v7
  v_lshrrev_b32 v230, 3, v229
  v_and_b32 v229, 7, v229
  v_lshlrev_b32 v230, 6, v230
  v_add_u32 v229, v229, v230
  v_lshl_add_u32 v229, v229, 2, v4
  ds_write_b32 v229, v106
  v_add_u32 v229, 3, v7
  v_lshrrev_b32 v230, 3, v229
  v_and_b32 v229, 7, v229
  v_lshlrev_b32 v230, 6, v230
  v_add_u32 v229, v229, v230
  v_lshl_add_u32 v229, v229, 2, v4
  ds_write_b32 v229, v107
  v_add_u32 v229, 4, v7
  v_lshrrev_b32 v230, 3, v229
  v_and_b32 v229, 7, v229
  v_lshlrev_b32 v230, 6, v230
  v_add_u32 v229, v229, v230
  v_lshl_add_u32 v229, v229, 2, v4
  ds_write_b32 v229, v108
  v_add_u32 v229, 5, v7
  v_lshrrev_b32 v230, 3, v229
  v_and_b32 v229, 7, v229
  v_lshlrev_b32 v230, 6, v230
  v_add_u32 v229, v229, v230
  v_lshl_add_u32 v229, v229, 2, v4
  ds_write_b32 v229, v109
  v_mov_b32 v234, v226
  v_mov_b32 v235, v129
  v_mov_b32 v236, 0
  v_mov_b32 v237, 0
  v_and_b32 v229, 0xffffff1f, v4
  ds_write_b128 v229, v[234:237] offset:768
  s_waitcnt lgkmcnt(0)
  ds_read_b128 v[234:237], v5
  s_waitcnt lgkmcnt(0)
  s_add_u32 s76, s73, 0x6d7c00
  s_mov_b32 exec_lo, -1
  s_mov_b32 exec_hi, 0x1ffff
  buffer_store_dwordx4 v[234:237], v6, s[64:67], s76 offen sc1
  s_mov_b64 exec, -1
  v_max3_u32 v226, v92, v93, v94
  v_max3_u32 v226, v226, v95, v96
  v_max3_u32 v226, v226, v97, v98
  v_max3_u32 v226, v226, v99, v100
  v_max3_u32 v226, v226, v101, v102
  v_max3_u32 v226, v226, v103, v103
  v_cmp_eq_u32 vcc, -1, v226
  s_cbranch_vccz Lqo488
  s_mov_b32 s75, 0x61a80
Lqr489:
  s_sleep 2
  s_add_u32 s77, s72, 0x12000
  buffer_load_dwordx4 v[92:95], v2, s[64:67], s77 offen sc1
  buffer_load_dwordx4 v[96:99], v2, s[64:67], s77 offen offset:128 sc1
  buffer_load_dwordx4 v[100:103], v2, s[64:67], s77 offen offset:256 sc1
  s_waitcnt vmcnt(0)
  v_max3_u32 v226, v92, v93, v94
  v_max3_u32 v226, v226, v95, v96
  v_max3_u32 v226, v226, v97, v98
  v_max3_u32 v226, v226, v99, v100
  v_max3_u32 v226, v226, v101, v102
  v_max3_u32 v226, v226, v103, v103
  v_cmp_eq_u32 vcc, -1, v226
  s_cbranch_vccz Lqo488
  s_sub_u32 s75, s75, 1
  s_cmp_lg_u32 s75, 0
  s_cbranch_scc1 Lqr489
Lqo488:
  v_mov_b32 v80, v92
  v_mov_b32 v81, v93
  v_mov_b32 v82, v94
  v_mov_b32 v83, v95
  v_mov_b32 v84, v96
  v_mov_b32 v85, v97
  v_mov_b32 v86, v98
  v_mov_b32 v87, v99
  v_mov_b32 v88, v100
  v_mov_b32 v89, v101
  v_mov_b32 v90, v102
  v_mov_b32 v91, v103
  v_mov_b32 v104, 0
  v_mov_b32 v105, 0
  v_mov_b32 v106, 0
  v_mov_b32 v107, 0
  v_mov_b32 v108, 0
  v_mov_b32 v109, 0
  v_mov_b32 v110, 0
  v_mov_b32 v111, 0
  v_mov_b32 v112, 0
  v_mov_b32 v113, 0
  v_mov_b32 v114, 0
  v_mov_b32 v115, 0
  v_mov_b32 v116, 0
  v_mov_b32 v117, 0
  v_mov_b32 v118, 0
  v_mov_b32 v119, 0
  v_mov_b32 v120, 0
  v_mov_b32 v121, 0
  v_mov_b32 v122, 0
  v_mov_b32 v123, 0
  v_mov_b32 v124, 0
  v_mov_b32 v125, 0
  v_mov_b32 v126, 0
  v_mov_b32 v127, 0
  v_mov_b32 v128, 0xf149f2ca
  v_mov_b32 v129, 0
  s_waitcnt vmcnt(10)
  s_waitcnt vmcnt(7)
  QK2 8, 44, 80, 226
  s_mov_b32 s76, 0x11400
  LDT v, 8, 48
  s_mov_b32 s76, 0x12000
  LDT v, 44, 48
  v_add_f32 v226, v226, v227
  v_add_f32 v226, v226, v228
  v_add_f32 v229, v229, v230
  v_add_f32 v229, v229, v231
  v_add_f32_dpp v226, v226, v226 quad_perm:[1,0,3,2] row_mask:0xf bank_mask:0xf
  s_nop 0
  v_add_f32_dpp v229, v229, v229 quad_perm:[1,0,3,2] row_mask:0xf bank_mask:0xf
  v_add_f32_dpp v226, v226, v226 quad_perm:[2,3,0,1] row_mask:0xf bank_mask:0xf
  s_nop 0
  v_add_f32_dpp v229, v229, v229 quad_perm:[2,3,0,1] row_mask:0xf bank_mask:0xf
  v_add_f32_dpp v226, v226, v226 row_half_mirror row_mask:0xf bank_mask:0xf
  s_nop 0
  v_add_f32_dpp v229, v229, v229 row_half_mirror row_mask:0xf bank_mask:0xf
  v_max3_f32 v232, v128, v226, v229
  v_cmp_gt_f32 vcc, v232, v128
  s_cbranch_vccz Lsk490
  v_sub_f32 v234, v128, v232
  v_mul_f32 v234, s74, v234
  v_exp_f32 v234, v234
  v_mov_b32 v128, v232
  RESC 104, 234
  v_mul_f32 v129, v234, v129
Lsk490:
  v_mul_f32 v233, s74, v128
  v_fma_f32 v235, v226, s74, -v233
  v_fma_f32 v236, v229, s74, -v233
  v_exp_f32 v235, v235
  v_exp_f32 v236, v236
  v_cvt_pk_bf16_f32 v238, v235, 0
  v_cvt_pk_bf16_f32 v239, 0, v235
  v_cvt_pk_bf16_f32 v240, v236, 0
  v_cvt_pk_bf16_f32 v241, 0, v236
  v_add_f32 v129, v129, v239
  v_add_f32 v129, v129, v241
  s_waitcnt vmcnt(10)
  PV 20, 238, 104
  s_mov_b32 s76, 0x11400
  LDT v, 20, 52
  s_waitcnt vmcnt(10)
  PV 32, 240, 104
  s_mov_b32 s76, 0x12000
  LDT v, 32, 52
  s_waitcnt vmcnt(9)
  s_waitcnt vmcnt(6)
  QK2 8, 44, 80, 226
  s_mov_b32 s76, 0x6000
  LDT v, 8, 60
  s_mov_b32 s76, 0x6c00
  LDT v, 44, 60
  v_add_f32 v226, v226, v227
  v_add_f32 v226, v226, v228
  v_add_f32 v229, v229, v230
  v_add_f32 v229, v229, v231
  v_add_f32_dpp v226, v226, v226 quad_perm:[1,0,3,2] row_mask:0xf bank_mask:0xf
  s_nop 0
  v_add_f32_dpp v229, v229, v229 quad_perm:[1,0,3,2] row_mask:0xf bank_mask:0xf
  v_add_f32_dpp v226, v226, v226 quad_perm:[2,3,0,1] row_mask:0xf bank_mask:0xf
  s_nop 0
  v_add_f32_dpp v229, v229, v229 quad_perm:[2,3,0,1] row_mask:0xf bank_mask:0xf
  v_add_f32_dpp v226, v226, v226 row_half_mirror row_mask:0xf bank_mask:0xf
  s_nop 0
  v_add_f32_dpp v229, v229, v229 row_half_mirror row_mask:0xf bank_mask:0xf
  v_max3_f32 v232, v128, v226, v229
  v_cmp_gt_f32 vcc, v232, v128
  s_cbranch_vccz Lsk491
  v_sub_f32 v234, v128, v232
  v_mul_f32 v234, s74, v234
  v_exp_f32 v234, v234
  v_mov_b32 v128, v232
  RESC 104, 234
  v_mul_f32 v129, v234, v129
Lsk491:
  v_mul_f32 v233, s74, v128
  v_fma_f32 v235, v226, s74, -v233
  v_fma_f32 v236, v229, s74, -v233
  v_exp_f32 v235, v235
  v_exp_f32 v236, v236
  v_cvt_pk_bf16_f32 v238, v235, 0
  v_cvt_pk_bf16_f32 v239, 0, v235
  v_cvt_pk_bf16_f32 v240, v236, 0
  v_cvt_pk_bf16_f32 v241, 0, v236
  v_add_f32 v129, v129, v239
  v_add_f32 v129, v129, v241
  s_waitcnt vmcnt(9)
  PV 20, 238, 104
  s_mov_b32 s76, 0x7800
  LDT v, 20, 60
  s_waitcnt vmcnt(9)
  PV 32, 240, 104
  s_mov_b32 s76, 0x8400
  LDT v, 32, 60
  ACR 56, 0
  ACR 68, 12
  QK2 56, 68, 80, 226
  s_mov_b32 s76, 0
  LDT a, 0, 56
  s_mov_b32 s76, 0xc00
  LDT a, 12, 56
  v_add_f32 v226, v226, v227
  v_add_f32 v226, v226, v228
  v_add_f32 v229, v229, v230
  v_add_f32 v229, v229, v231
  v_add_f32_dpp v226, v226, v226 quad_perm:[1,0,3,2] row_mask:0xf bank_mask:0xf
  s_nop 0
  v_add_f32_dpp v229, v229, v229 quad_perm:[1,0,3,2] row_mask:0xf bank_mask:0xf
  v_add_f32_dpp v226, v226, v226 quad_perm:[2,3,0,1] row_mask:0xf bank_mask:0xf
  s_nop 0
  v_add_f32_dpp v229, v229, v229 quad_perm:[2,3,0,1] row_mask:0xf bank_mask:0xf
  v_add_f32_dpp v226, v226, v226 row_half_mirror row_mask:0xf bank_mask:0xf
  s_nop 0
  v_add_f32_dpp v229, v229, v229 row_half_mirror row_mask:0xf bank_mask:0xf
  v_max3_f32 v232, v128, v226, v229
  v_cmp_gt_f32 vcc, v232, v128
  s_cbranch_vccz Lsk492
  v_sub_f32 v234, v128, v232
  v_mul_f32 v234, s74, v234
  v_exp_f32 v234, v234
  v_mov_b32 v128, v232
  RESC 104, 234
  v_mul_f32 v129, v234, v129
Lsk492:
  v_mul_f32 v233, s74, v128
  v_fma_f32 v235, v226, s74, -v233
  v_fma_f32 v236, v229, s74, -v233
  v_exp_f32 v235, v235
  v_exp_f32 v236, v236
  v_cvt_pk_bf16_f32 v238, v235, 0
  v_cvt_pk_bf16_f32 v239, 0, v235
  v_cvt_pk_bf16_f32 v240, v236, 0
  v_cvt_pk_bf16_f32 v241, 0, v236
  v_add_f32 v129, v129, v239
  v_add_f32 v129, v129, v241
  PV 130, 238, 104
  s_mov_b32 s76, 0
  LDT v, 130, 60
  PV 142, 240, 104
  s_mov_b32 s76, 0xc00
  LDT v, 142, 60
  ACR 56, 24
  ACR 68, 36
  QK2 56, 68, 80, 226
  s_mov_b32 s76, 0x1800
  LDT a, 24, 56
  s_mov_b32 s76, 0x2400
  LDT a, 36, 56
  v_add_f32 v226, v226, v227
  v_add_f32 v226, v226, v228
  v_add_f32 v229, v229, v230
  v_add_f32 v229, v229, v231
  v_add_f32_dpp v226, v226, v226 quad_perm:[1,0,3,2] row_mask:0xf bank_mask:0xf
  s_nop 0
  v_add_f32_dpp v229, v229, v229 quad_perm:[1,0,3,2] row_mask:0xf bank_mask:0xf
  v_add_f32_dpp v226, v226, v226 quad_perm:[2,3,0,1] row_mask:0xf bank_mask:0xf
  s_nop 0
  v_add_f32_dpp v229, v229, v229 quad_perm:[2,3,0,1] row_mask:0xf bank_mask:0xf
  v_add_f32_dpp v226, v226, v226 row_half_mirror row_mask:0xf bank_mask:0xf
  s_nop 0
  v_add_f32_dpp v229, v229, v229 row_half_mirror row_mask:0xf bank_mask:0xf
  v_max3_f32 v232, v128, v226, v229
  v_cmp_gt_f32 vcc, v232, v128
  s_cbranch_vccz Lsk493
  v_sub_f32 v234, v128, v232
  v_mul_f32 v234, s74, v234
  v_exp_f32 v234, v234
  v_mov_b32 v128, v232
  RESC 104, 234
  v_mul_f32 v129, v234, v129
Lsk493:
  v_mul_f32 v233, s74, v128
  v_fma_f32 v235, v226, s74, -v233
  v_fma_f32 v236, v229, s74, -v233
  v_exp_f32 v235, v235
  v_exp_f32 v236, v236
  v_cvt_pk_bf16_f32 v238, v235, 0
  v_cvt_pk_bf16_f32 v239, 0, v235
  v_cvt_pk_bf16_f32 v240, v236, 0
  v_cvt_pk_bf16_f32 v241, 0, v236
  v_add_f32 v129, v129, v239
  v_add_f32 v129, v129, v241
  PV 154, 238, 104
  s_mov_b32 s76, 0x1800
  LDT v, 154, 60
  PV 166, 240, 104
  s_mov_b32 s76, 0x2400
  LDT v, 166, 60
  ACR 56, 48
  ACR 68, 60
  QK2 56, 68, 80, 226
  s_mov_b32 s76, 0x3000
  LDT a, 48, 56
  s_mov_b32 s76, 0x3c00
  LDT a, 60, 56
  v_add_f32 v226, v226, v227
  v_add_f32 v226, v226, v228
  v_add_f32 v229, v229, v230
  v_add_f32 v229, v229, v231
  v_add_f32_dpp v226, v226, v226 quad_perm:[1,0,3,2] row_mask:0xf bank_mask:0xf
  s_nop 0
  v_add_f32_dpp v229, v229, v229 quad_perm:[1,0,3,2] row_mask:0xf bank_mask:0xf
  v_add_f32_dpp v226, v226, v226 quad_perm:[2,3,0,1] row_mask:0xf bank_mask:0xf
  s_nop 0
  v_add_f32_dpp v229, v229, v229 quad_perm:[2,3,0,1] row_mask:0xf bank_mask:0xf
  v_add_f32_dpp v226, v226, v226 row_half_mirror row_mask:0xf bank_mask:0xf
  s_nop 0
  v_add_f32_dpp v229, v229, v229 row_half_mirror row_mask:0xf bank_mask:0xf
  v_max3_f32 v232, v128, v226, v229
  v_cmp_gt_f32 vcc, v232, v128
  s_cbranch_vccz Lsk494
  v_sub_f32 v234, v128, v232
  v_mul_f32 v234, s74, v234
  v_exp_f32 v234, v234
  v_mov_b32 v128, v232
  RESC 104, 234
  v_mul_f32 v129, v234, v129
Lsk494:
  v_mul_f32 v233, s74, v128
  v_fma_f32 v235, v226, s74, -v233
  v_fma_f32 v236, v229, s74, -v233
  v_exp_f32 v235, v235
  v_exp_f32 v236, v236
  v_cvt_pk_bf16_f32 v238, v235, 0
  v_cvt_pk_bf16_f32 v239, 0, v235
  v_cvt_pk_bf16_f32 v240, v236, 0
  v_cvt_pk_bf16_f32 v241, 0, v236
  v_add_f32 v129, v129, v239
  v_add_f32 v129, v129, v241
  PV 178, 238, 104
  s_mov_b32 s76, 0x3000
  LDT v, 178, 60
  PV 190, 240, 104
  s_mov_b32 s76, 0x3c00
  LDT v, 190, 60
  ACR 56, 72
  ACR 68, 84
  QK2 56, 68, 80, 226
  s_mov_b32 s76, 0x4800
  LDT a, 72, 56
  v_add_f32 v226, v226, v227
  v_add_f32 v226, v226, v228
  v_add_f32 v229, v229, v230
  v_add_f32 v229, v229, v231
  v_add_f32_dpp v226, v226, v226 quad_perm:[1,0,3,2] row_mask:0xf bank_mask:0xf
  s_nop 0
  v_add_f32_dpp v229, v229, v229 quad_perm:[1,0,3,2] row_mask:0xf bank_mask:0xf
  v_add_f32_dpp v226, v226, v226 quad_perm:[2,3,0,1] row_mask:0xf bank_mask:0xf
  s_nop 0
  v_add_f32_dpp v229, v229, v229 quad_perm:[2,3,0,1] row_mask:0xf bank_mask:0xf
  v_add_f32_dpp v226, v226, v226 row_half_mirror row_mask:0xf bank_mask:0xf
  s_nop 0
  v_add_f32_dpp v229, v229, v229 row_half_mirror row_mask:0xf bank_mask:0xf
  v_max3_f32 v232, v128, v226, v229
  v_cmp_gt_f32 vcc, v232, v128
  s_cbranch_vccz Lsk495
  v_sub_f32 v234, v128, v232
  v_mul_f32 v234, s74, v234
  v_exp_f32 v234, v234
  v_mov_b32 v128, v232
  RESC 104, 234
  v_mul_f32 v129, v234, v129
Lsk495:
  v_mul_f32 v233, s74, v128
  v_fma_f32 v235, v226, s74, -v233
  v_fma_f32 v236, v229, s74, -v233
  v_exp_f32 v235, v235
  v_exp_f32 v236, v236
  v_cvt_pk_bf16_f32 v238, v235, 0
  v_cvt_pk_bf16_f32 v239, 0, v235
  v_cvt_pk_bf16_f32 v240, v236, 0
  v_cvt_pk_bf16_f32 v241, 0, v236
  v_add_f32 v129, v129, v239
  v_add_f32 v129, v129, v241
  PV 202, 238, 104
  PV 214, 240, 104
  ACR 56, 96
  ACR 68, 108
  QK2 56, 68, 80, 226
  ds_read_b128 v[56:59], v3 offset:0
  ds_read_b128 v[60:63], v3 offset:1024
  ds_read_b128 v[64:67], v3 offset:2048
  ds_read_b128 v[68:71], v3 offset:3072
  ds_read_b128 v[72:75], v3 offset:4096
  ds_read_b128 v[76:79], v3 offset:5120
  v_add_f32 v226, v226, v227
  v_add_f32 v226, v226, v228
  v_add_f32 v229, v229, v230
  v_add_f32 v229, v229, v231
  v_add_f32_dpp v226, v226, v226 quad_perm:[1,0,3,2] row_mask:0xf bank_mask:0xf
  s_nop 0
  v_add_f32_dpp v229, v229, v229 quad_perm:[1,0,3,2] row_mask:0xf bank_mask:0xf
  v_add_f32_dpp v226, v226, v226 quad_perm:[2,3,0,1] row_mask:0xf bank_mask:0xf
  s_nop 0
  v_add_f32_dpp v229, v229, v229 quad_perm:[2,3,0,1] row_mask:0xf bank_mask:0xf
  v_add_f32_dpp v226, v226, v226 row_half_mirror row_mask:0xf bank_mask:0xf
  s_nop 0
  v_add_f32_dpp v229, v229, v229 row_half_mirror row_mask:0xf bank_mask:0xf
  v_max3_f32 v232, v128, v226, v229
  v_cmp_gt_f32 vcc, v232, v128
  s_cbranch_vccz Lsk496
  v_sub_f32 v234, v128, v232
  v_mul_f32 v234, s74, v234
  v_exp_f32 v234, v234
  v_mov_b32 v128, v232
  RESC 104, 234
  v_mul_f32 v129, v234, v129
Lsk496:
  v_mul_f32 v233, s74, v128
  v_fma_f32 v235, v226, s74, -v233
  v_fma_f32 v236, v229, s74, -v233
  v_exp_f32 v235, v235
  v_exp_f32 v236, v236
  v_cvt_pk_bf16_f32 v238, v235, 0
  v_cvt_pk_bf16_f32 v239, 0, v235
  v_cvt_pk_bf16_f32 v240, v236, 0
  v_cvt_pk_bf16_f32 v241, 0, v236
  v_add_f32 v129, v129, v239
  v_add_f32 v129, v129, v241
  s_waitcnt lgkmcnt(3)
  PV 56, 238, 104
  s_waitcnt lgkmcnt(0)
  PV 68, 240, 104
  ACR 56, 120
  ACR 68, 132
  QK2 56, 68, 80, 226
  ds_read_b128 v[56:59], v3 offset:6144
  ds_read_b128 v[60:63], v3 offset:7168
  ds_read_b128 v[64:67], v3 offset:8192
  ds_read_b128 v[68:71], v3 offset:9216
  ds_read_b128 v[72:75], v3 offset:10240
  ds_read_b128 v[76:79], v3 offset:11264
  v_add_f32 v226, v226, v227
  v_add_f32 v226, v226, v228
  v_add_f32 v229, v229, v230
  v_add_f32 v229, v229, v231
  v_add_f32_dpp v226, v226, v226 quad_perm:[1,0,3,2] row_mask:0xf bank_mask:0xf
  s_nop 0
  v_add_f32_dpp v229, v229, v229 quad_perm:[1,0,3,2] row_mask:0xf bank_mask:0xf
  v_add_f32_dpp v226, v226, v226 quad_perm:[2,3,0,1] row_mask:0xf bank_mask:0xf
  s_nop 0
  v_add_f32_dpp v229, v229, v229 quad_perm:[2,3,0,1] row_mask:0xf bank_mask:0xf
  v_add_f32_dpp v226, v226, v226 row_half_mirror row_mask:0xf bank_mask:0xf
  s_nop 0
  v_add_f32_dpp v229, v229, v229 row_half_mirror row_mask:0xf bank_mask:0xf
  v_max3_f32 v232, v128, v226, v229
  v_cmp_gt_f32 vcc, v232, v128
  s_cbranch_vccz Lsk497
  v_sub_f32 v234, v128, v232
  v_mul_f32 v234, s74, v234
  v_exp_f32 v234, v234
  v_mov_b32 v128, v232
  RESC 104, 234
  v_mul_f32 v129, v234, v129
Lsk497:
  v_mul_f32 v233, s74, v128
  v_fma_f32 v235, v226, s74, -v233
  v_fma_f32 v236, v229, s74, -v233
  v_exp_f32 v235, v235
  v_exp_f32 v236, v236
  v_cvt_pk_bf16_f32 v238, v235, 0
  v_cvt_pk_bf16_f32 v239, 0, v235
  v_cvt_pk_bf16_f32 v240, v236, 0
  v_cvt_pk_bf16_f32 v241, 0, v236
  v_add_f32 v129, v129, v239
  v_add_f32 v129, v129, v241
  s_waitcnt lgkmcnt(3)
  PV 56, 238, 104
  s_waitcnt lgkmcnt(0)
  PV 68, 240, 104
  s_waitcnt vmcnt(45)
  s_mov_b32 s76, 0x5400
  LDT a, 84, 56
  s_mov_b32 s76, 0x4800
  LDT v, 202, 60
  ACR 56, 144
  ACR 68, 156
  QK2 56, 68, 80, 226
  ds_read_b128 v[56:59], v3 offset:12288
  ds_read_b128 v[60:63], v3 offset:13312
  ds_read_b128 v[64:67], v3 offset:14336
  ds_read_b128 v[68:71], v3 offset:15360
  ds_read_b128 v[72:75], v3 offset:16384
  ds_read_b128 v[76:79], v3 offset:17408
  v_add_f32 v226, v226, v227
  v_add_f32 v226, v226, v228
  v_add_f32 v229, v229, v230
  v_add_f32 v229, v229, v231
  v_add_f32_dpp v226, v226, v226 quad_perm:[1,0,3,2] row_mask:0xf bank_mask:0xf
  s_nop 0
  v_add_f32_dpp v229, v229, v229 quad_perm:[1,0,3,2] row_mask:0xf bank_mask:0xf
  v_add_f32_dpp v226, v226, v226 quad_perm:[2,3,0,1] row_mask:0xf bank_mask:0xf
  s_nop 0
  v_add_f32_dpp v229, v229, v229 quad_perm:[2,3,0,1] row_mask:0xf bank_mask:0xf
  v_add_f32_dpp v226, v226, v226 row_half_mirror row_mask:0xf bank_mask:0xf
  s_nop 0
  v_add_f32_dpp v229, v229, v229 row_half_mirror row_mask:0xf bank_mask:0xf
  v_max3_f32 v232, v128, v226, v229
  v_cmp_gt_f32 vcc, v232, v128
  s_cbranch_vccz Lsk498
  v_sub_f32 v234, v128, v232
  v_mul_f32 v234, s74, v234
  v_exp_f32 v234, v234
  v_mov_b32 v128, v232
  RESC 104, 234
  v_mul_f32 v129, v234, v129
Lsk498:
  v_mul_f32 v233, s74, v128
  v_fma_f32 v235, v226, s74, -v233
  v_fma_f32 v236, v229, s74, -v233
  v_exp_f32 v235, v235
  v_exp_f32 v236, v236
  v_cvt_pk_bf16_f32 v238, v235, 0
  v_cvt_pk_bf16_f32 v239, 0, v235
  v_cvt_pk_bf16_f32 v240, v236, 0
  v_cvt_pk_bf16_f32 v241, 0, v236
  v_add_f32 v129, v129, v239
  v_add_f32 v129, v129, v241
  s_waitcnt lgkmcnt(3)
  PV 56, 238, 104
  s_waitcnt lgkmcnt(0)
  PV 68, 240, 104
  s_waitcnt vmcnt(45)
  s_mov_b32 s76, 0x5400
  LDT v, 214, 60
  s_mov_b32 s76, 0x6000
  LDT a, 96, 56
  ACR 56, 168
  ACR 68, 180
  QK2 56, 68, 80, 226
  ds_read_b128 v[56:59], v3 offset:18432
  ds_read_b128 v[60:63], v3 offset:19456
  ds_read_b128 v[64:67], v3 offset:20480
  ds_read_b128 v[68:71], v3 offset:21504
  ds_read_b128 v[72:75], v3 offset:22528
  ds_read_b128 v[76:79], v3 offset:23552
  v_add_f32 v226, v226, v227
  v_add_f32 v226, v226, v228
  v_add_f32 v229, v229, v230
  v_add_f32 v229, v229, v231
  v_add_f32_dpp v226, v226, v226 quad_perm:[1,0,3,2] row_mask:0xf bank_mask:0xf
  s_nop 0
  v_add_f32_dpp v229, v229, v229 quad_perm:[1,0,3,2] row_mask:0xf bank_mask:0xf
  v_add_f32_dpp v226, v226, v226 quad_perm:[2,3,0,1] row_mask:0xf bank_mask:0xf
  s_nop 0
  v_add_f32_dpp v229, v229, v229 quad_perm:[2,3,0,1] row_mask:0xf bank_mask:0xf
  v_add_f32_dpp v226, v226, v226 row_half_mirror row_mask:0xf bank_mask:0xf
  s_nop 0
  v_add_f32_dpp v229, v229, v229 row_half_mirror row_mask:0xf bank_mask:0xf
  v_max3_f32 v232, v128, v226, v229
  v_cmp_gt_f32 vcc, v232, v128
  s_cbranch_vccz Lsk499
  v_sub_f32 v234, v128, v232
  v_mul_f32 v234, s74, v234
  v_exp_f32 v234, v234
  v_mov_b32 v128, v232
  RESC 104, 234
  v_mul_f32 v129, v234, v129
Lsk499:
  v_mul_f32 v233, s74, v128
  v_fma_f32 v235, v226, s74, -v233
  v_fma_f32 v236, v229, s74, -v233
  v_exp_f32 v235, v235
  v_exp_f32 v236, v236
  v_cvt_pk_bf16_f32 v238, v235, 0
  v_cvt_pk_bf16_f32 v239, 0, v235
  v_cvt_pk_bf16_f32 v240, v236, 0
  v_cvt_pk_bf16_f32 v241, 0, v236
  v_add_f32 v129, v129, v239
  v_add_f32 v129, v129, v241
  s_waitcnt lgkmcnt(3)
  PV 56, 238, 104
  s_waitcnt lgkmcnt(0)
  PV 68, 240, 104
  s_waitcnt vmcnt(45)
  s_mov_b32 s76, 0x6c00
  LDT a, 108, 56
  s_mov_b32 s76, 0x7800
  LDT a, 120, 56
  s_add_u32 s76, s72, 0x9000
  buffer_load_dwordx4 v[92:95], v2, s[64:67], s76 offen sc1
  buffer_load_dwordx4 v[96:99], v2, s[64:67], s76 offen offset:128 sc1
  buffer_load_dwordx4 v[100:103], v2, s[64:67], s76 offen offset:256 sc1
  ACR 56, 192
  ACR 68, 204
  QK2 56, 68, 80, 226
  ds_read_b128 v[56:59], v3 offset:24576
  ds_read_b128 v[60:63], v3 offset:25600
  ds_read_b128 v[64:67], v3 offset:26624
  ds_read_b128 v[68:71], v3 offset:27648
  ds_read_b128 v[72:75], v3 offset:28672
  ds_read_b128 v[76:79], v3 offset:29696
  v_add_f32 v226, v226, v227
  v_add_f32 v226, v226, v228
  v_add_f32 v229, v229, v230
  v_add_f32 v229, v229, v231
  v_add_f32_dpp v226, v226, v226 quad_perm:[1,0,3,2] row_mask:0xf bank_mask:0xf
  s_nop 0
  v_add_f32_dpp v229, v229, v229 quad_perm:[1,0,3,2] row_mask:0xf bank_mask:0xf
  v_add_f32_dpp v226, v226, v226 quad_perm:[2,3,0,1] row_mask:0xf bank_mask:0xf
  s_nop 0
  v_add_f32_dpp v229, v229, v229 quad_perm:[2,3,0,1] row_mask:0xf bank_mask:0xf
  v_add_f32_dpp v226, v226, v226 row_half_mirror row_mask:0xf bank_mask:0xf
  s_nop 0
  v_add_f32_dpp v229, v229, v229 row_half_mirror row_mask:0xf bank_mask:0xf
  v_max3_f32 v232, v128, v226, v229
  v_cmp_gt_f32 vcc, v232, v128
  s_cbranch_vccz Lsk500
  v_sub_f32 v234, v128, v232
  v_mul_f32 v234, s74, v234
  v_exp_f32 v234, v234
  v_mov_b32 v128, v232
  RESC 104, 234
  v_mul_f32 v129, v234, v129
Lsk500:
  v_mul_f32 v233, s74, v128
  v_fma_f32 v235, v226, s74, -v233
  v_fma_f32 v236, v229, s74, -v233
  v_exp_f32 v235, v235
  v_exp_f32 v236, v236
  v_cvt_pk_bf16_f32 v238, v235, 0
  v_cvt_pk_bf16_f32 v239, 0, v235
  v_cvt_pk_bf16_f32 v240, v236, 0
  v_cvt_pk_bf16_f32 v241, 0, v236
  v_add_f32 v129, v129, v239
  v_add_f32 v129, v129, v241
  s_waitcnt lgkmcnt(3)
  PV 56, 238, 104
  s_waitcnt lgkmcnt(0)
  PV 68, 240, 104
  s_waitcnt vmcnt(48)
  s_mov_b32 s76, 0x8400
  LDT a, 132, 56
  ACR 56, 216
  ACR 68, 228
  QK2 56, 68, 80, 226
  ds_read_b128 v[56:59], v3 offset:30720
  ds_read_b128 v[60:63], v3 offset:31744
  ds_read_b128 v[64:67], v3 offset:32768
  ds_read_b128 v[68:71], v3 offset:33792
  ds_read_b128 v[72:75], v3 offset:34816
  ds_read_b128 v[76:79], v3 offset:35840
  v_add_f32 v226, v226, v227
  v_add_f32 v226, v226, v228
  v_add_f32 v229, v229, v230
  v_add_f32 v229, v229, v231
  v_add_f32_dpp v226, v226, v226 quad_perm:[1,0,3,2] row_mask:0xf bank_mask:0xf
  s_nop 0
  v_add_f32_dpp v229, v229, v229 quad_perm:[1,0,3,2] row_mask:0xf bank_mask:0xf
  v_add_f32_dpp v226, v226, v226 quad_perm:[2,3,0,1] row_mask:0xf bank_mask:0xf
  s_nop 0
  v_add_f32_dpp v229, v229, v229 quad_perm:[2,3,0,1] row_mask:0xf bank_mask:0xf
  v_add_f32_dpp v226, v226, v226 row_half_mirror row_mask:0xf bank_mask:0xf
  s_nop 0
  v_add_f32_dpp v229, v229, v229 row_half_mirror row_mask:0xf bank_mask:0xf
  v_max3_f32 v232, v128, v226, v229
  v_cmp_gt_f32 vcc, v232, v128
  s_cbranch_vccz Lsk501
  v_sub_f32 v234, v128, v232
  v_mul_f32 v234, s74, v234
  v_exp_f32 v234, v234
  v_mov_b32 v128, v232
  RESC 104, 234
  v_mul_f32 v129, v234, v129
Lsk501:
  v_mul_f32 v233, s74, v128
  v_fma_f32 v235, v226, s74, -v233
  v_fma_f32 v236, v229, s74, -v233
  v_exp_f32 v235, v235
  v_exp_f32 v236, v236
  v_cvt_pk_bf16_f32 v238, v235, 0
  v_cvt_pk_bf16_f32 v239, 0, v235
  v_cvt_pk_bf16_f32 v240, v236, 0
  v_cvt_pk_bf16_f32 v241, 0, v236
  v_add_f32 v129, v129, v239
  v_add_f32 v129, v129, v241
  s_waitcnt lgkmcnt(3)
  PV 56, 238, 104
  s_waitcnt lgkmcnt(0)
  PV 68, 240, 104
  s_waitcnt vmcnt(45)
  s_mov_b32 s76, 0x9000
  LDT a, 144, 56
  s_mov_b32 s76, 0x9c00
  LDT a, 156, 56
  ACR 56, 240
  v_dot2_f32_bf16 v226, v56, v80, 0
  v_dot2_f32_bf16 v227, v60, v84, 0
  v_dot2_f32_bf16 v228, v64, v88, 0
  s_nop 0
  v_dot2c_f32_bf16 v226, v57, v81
  v_dot2c_f32_bf16 v227, v61, v85
  v_dot2c_f32_bf16 v228, v65, v89
  v_dot2c_f32_bf16 v226, v58, v82
  v_dot2c_f32_bf16 v227, v62, v86
  v_dot2c_f32_bf16 v228, v66, v90
  v_dot2c_f32_bf16 v226, v59, v83
  v_dot2c_f32_bf16 v227, v63, v87
  v_dot2c_f32_bf16 v228, v67, v91
  ds_read_b128 v[56:59], v3 offset:36864
  ds_read_b128 v[60:63], v3 offset:37888
  ds_read_b128 v[64:67], v3 offset:38912
  v_add_f32 v226, v226, v227
  v_add_f32 v226, v226, v228
  s_nop 1
  v_add_f32_dpp v226, v226, v226 quad_perm:[1,0,3,2] row_mask:0xf bank_mask:0xf
  s_nop 1
  v_add_f32_dpp v226, v226, v226 quad_perm:[2,3,0,1] row_mask:0xf bank_mask:0xf
  s_nop 1
  v_add_f32_dpp v226, v226, v226 row_half_mirror row_mask:0xf bank_mask:0xf
  v_max_f32 v232, v128, v226
  v_cmp_gt_f32 vcc, v232, v128
  s_cbranch_vccz Lsk502
  v_sub_f32 v234, v128, v232
  v_mul_f32 v234, s74, v234
  v_exp_f32 v234, v234
  v_mov_b32 v128, v232
  RESC 104, 234
  v_mul_f32 v129, v234, v129
Lsk502:
  v_mul_f32 v233, s74, v128
  v_fma_f32 v235, v226, s74, -v233
  v_exp_f32 v235, v235
  s_nop 0
  v_cvt_pk_bf16_f32 v238, v235, 0
  v_cvt_pk_bf16_f32 v239, 0, v235
  v_add_f32 v129, v129, v239
  s_waitcnt lgkmcnt(0)
  PV 56, 238, 104
  s_waitcnt vmcnt(45)
  s_mov_b32 s76, 0xa800
  LDT a, 168, 56
  s_mov_b32 s76, 0xb400
  LDT a, 180, 56
  v_max_f32_dpp v226, v128, v128 row_ror:8 row_mask:0xf bank_mask:0xf
  v_mov_b32 v227, v226
  s_nop 1
  v_permlane16_swap_b32 v226, v227
  v_max_f32 v226, v226, v227
  v_mov_b32 v227, v226
  s_nop 1
  v_permlane32_swap_b32 v226, v227
  v_max_f32 v226, v226, v227
  v_sub_f32 v228, v128, v226
  v_mul_f32 v228, s74, v228
  v_exp_f32 v228, v228
  v_mul_f32 v226, s74, v226
  RESC 104, 228
  v_mul_f32 v129, v228, v129
  s_nop 1
  v_add_f32_dpp v129, v129, v129 row_ror:8 row_mask:0xf bank_mask:0xf
  v_mov_b32 v227, v129
  s_nop 1
  v_permlane16_swap_b32 v129, v227
  v_add_f32 v129, v129, v227
  v_mov_b32 v227, v129
  s_nop 1
  v_permlane32_swap_b32 v129, v227
  v_add_f32 v129, v129, v227
  v_permlane32_swap_b32 v104, v116
  v_permlane32_swap_b32 v105, v117
  v_permlane32_swap_b32 v106, v118
  v_permlane32_swap_b32 v107, v119
  v_permlane32_swap_b32 v108, v120
  v_permlane32_swap_b32 v109, v121
  v_permlane32_swap_b32 v110, v122
  v_permlane32_swap_b32 v111, v123
  v_permlane32_swap_b32 v112, v124
  v_permlane32_swap_b32 v113, v125
  v_permlane32_swap_b32 v114, v126
  v_permlane32_swap_b32 v115, v127
  v_add_f32 v104, v104, v116
  v_add_f32 v105, v105, v117
  v_add_f32 v106, v106, v118
  v_add_f32 v107, v107, v119
  v_add_f32 v108, v108, v120
  v_add_f32 v109, v109, v121
  v_add_f32 v110, v110, v122
  v_add_f32 v111, v111, v123
  v_add_f32 v112, v112, v124
  v_add_f32 v113, v113, v125
  v_add_f32 v114, v114, v126
  v_add_f32 v115, v115, v127
  v_permlane16_swap_b32 v104, v110
  v_permlane16_swap_b32 v105, v111
  v_permlane16_swap_b32 v106, v112
  v_permlane16_swap_b32 v107, v113
  v_permlane16_swap_b32 v108, v114
  v_permlane16_swap_b32 v109, v115
  v_add_f32 v104, v104, v110
  v_add_f32 v105, v105, v111
  v_add_f32 v106, v106, v112
  v_add_f32 v107, v107, v113
  v_add_f32 v108, v108, v114
  v_add_f32 v109, v109, v115
  v_add_f32_dpp v104, v104, v104 row_ror:8 row_mask:0xf bank_mask:0xf
  v_add_f32_dpp v105, v105, v105 row_ror:8 row_mask:0xf bank_mask:0xf
  v_add_f32_dpp v106, v106, v106 row_ror:8 row_mask:0xf bank_mask:0xf
  v_add_f32_dpp v107, v107, v107 row_ror:8 row_mask:0xf bank_mask:0xf
  v_add_f32_dpp v108, v108, v108 row_ror:8 row_mask:0xf bank_mask:0xf
  v_add_f32_dpp v109, v109, v109 row_ror:8 row_mask:0xf bank_mask:0xf
  v_add_u32 v229, 0, v7
  v_lshrrev_b32 v230, 3, v229
  v_and_b32 v229, 7, v229
  v_lshlrev_b32 v230, 6, v230
  v_add_u32 v229, v229, v230
  v_lshl_add_u32 v229, v229, 2, v4
  ds_write_b32 v229, v104
  v_add_u32 v229, 1, v7
  v_lshrrev_b32 v230, 3, v229
  v_and_b32 v229, 7, v229
  v_lshlrev_b32 v230, 6, v230
  v_add_u32 v229, v229, v230
  v_lshl_add_u32 v229, v229, 2, v4
  ds_write_b32 v229, v105
  v_add_u32 v229, 2, v7
  v_lshrrev_b32 v230, 3, v229
  v_and_b32 v229, 7, v229
  v_lshlrev_b32 v230, 6, v230
  v_add_u32 v229, v229, v230
  v_lshl_add_u32 v229, v229, 2, v4
  ds_write_b32 v229, v106
  v_add_u32 v229, 3, v7
  v_lshrrev_b32 v230, 3, v229
  v_and_b32 v229, 7, v229
  v_lshlrev_b32 v230, 6, v230
  v_add_u32 v229, v229, v230
  v_lshl_add_u32 v229, v229, 2, v4
  ds_write_b32 v229, v107
  v_add_u32 v229, 4, v7
  v_lshrrev_b32 v230, 3, v229
  v_and_b32 v229, 7, v229
  v_lshlrev_b32 v230, 6, v230
  v_add_u32 v229, v229, v230
  v_lshl_add_u32 v229, v229, 2, v4
  ds_write_b32 v229, v108
  v_add_u32 v229, 5, v7
  v_lshrrev_b32 v230, 3, v229
  v_and_b32 v229, 7, v229
  v_lshlrev_b32 v230, 6, v230
  v_add_u32 v229, v229, v230
  v_lshl_add_u32 v229, v229, 2, v4
  ds_write_b32 v229, v109
  v_mov_b32 v234, v226
  v_mov_b32 v235, v129
  v_mov_b32 v236, 0
  v_mov_b32 v237, 0
  v_and_b32 v229, 0xffffff1f, v4
  ds_write_b128 v229, v[234:237] offset:768
  s_waitcnt lgkmcnt(0)
  ds_read_b128 v[234:237], v5
  s_waitcnt lgkmcnt(0)
  s_add_u32 s76, s73, 0x777000
  s_mov_b32 exec_lo, -1
  s_mov_b32 exec_hi, 0x1ffff
  buffer_store_dwordx4 v[234:237], v6, s[64:67], s76 offen sc1
  s_mov_b64 exec, -1
  s_waitcnt vmcnt(16)
  v_max3_u32 v226, v92, v93, v94
  v_max3_u32 v226, v226, v95, v96
  v_max3_u32 v226, v226, v97, v98
  v_max3_u32 v226, v226, v99, v100
  v_max3_u32 v226, v226, v101, v102
  v_max3_u32 v226, v226, v103, v103
  v_cmp_eq_u32 vcc, -1, v226
  s_cbranch_vccz Lqo503
  s_mov_b32 s75, 0x61a80
Lqr504:
  s_sleep 2
  s_add_u32 s77, s72, 0x9000
  buffer_load_dwordx4 v[92:95], v2, s[64:67], s77 offen sc1
  buffer_load_dwordx4 v[96:99], v2, s[64:67], s77 offen offset:128 sc1
  buffer_load_dwordx4 v[100:103], v2, s[64:67], s77 offen offset:256 sc1
  s_waitcnt vmcnt(0)
  v_max3_u32 v226, v92, v93, v94
  v_max3_u32 v226, v226, v95, v96
  v_max3_u32 v226, v226, v97, v98
  v_max3_u32 v226, v226, v99, v100
  v_max3_u32 v226, v226, v101, v102
  v_max3_u32 v226, v226, v103, v103
  v_cmp_eq_u32 vcc, -1, v226
  s_cbranch_vccz Lqo503
  s_sub_u32 s75, s75, 1
  s_cmp_lg_u32 s75, 0
  s_cbranch_scc1 Lqr504
Lqo503:
  v_mov_b32 v80, v92
  v_mov_b32 v81, v93
  v_mov_b32 v82, v94
  v_mov_b32 v83, v95
  v_mov_b32 v84, v96
  v_mov_b32 v85, v97
  v_mov_b32 v86, v98
  v_mov_b32 v87, v99
  v_mov_b32 v88, v100
  v_mov_b32 v89, v101
  v_mov_b32 v90, v102
  v_mov_b32 v91, v103
  v_mov_b32 v104, 0
  v_mov_b32 v105, 0
  v_mov_b32 v106, 0
  v_mov_b32 v107, 0
  v_mov_b32 v108, 0
  v_mov_b32 v109, 0
  v_mov_b32 v110, 0
  v_mov_b32 v111, 0
  v_mov_b32 v112, 0
  v_mov_b32 v113, 0
  v_mov_b32 v114, 0
  v_mov_b32 v115, 0
  v_mov_b32 v116, 0
  v_mov_b32 v117, 0
  v_mov_b32 v118, 0
  v_mov_b32 v119, 0
  v_mov_b32 v120, 0
  v_mov_b32 v121, 0
  v_mov_b32 v122, 0
  v_mov_b32 v123, 0
  v_mov_b32 v124, 0
  v_mov_b32 v125, 0
  v_mov_b32 v126, 0
  v_mov_b32 v127, 0
  v_mov_b32 v128, 0xf149f2ca
  v_mov_b32 v129, 0
  ACR 56, 0
  ACR 68, 12
  QK2 56, 68, 80, 226
  s_mov_b32 s76, 0xc000
  LDT a, 192, 56
  s_mov_b32 s76, 0xcc00
  LDT a, 204, 56
  s_mov_b32 s76, 0xd800
  LDT a, 216, 56
  s_mov_b32 s76, 0xe400
  LDT a, 228, 56
  s_mov_b32 s76, 0xf000
  LDT a, 240, 56
  v_add_f32 v226, v226, v227
  v_add_f32 v226, v226, v228
  v_add_f32 v229, v229, v230
  v_add_f32 v229, v229, v231
  v_add_f32_dpp v226, v226, v226 quad_perm:[1,0,3,2] row_mask:0xf bank_mask:0xf
  s_nop 0
  v_add_f32_dpp v229, v229, v229 quad_perm:[1,0,3,2] row_mask:0xf bank_mask:0xf
  v_add_f32_dpp v226, v226, v226 quad_perm:[2,3,0,1] row_mask:0xf bank_mask:0xf
  s_nop 0
  v_add_f32_dpp v229, v229, v229 quad_perm:[2,3,0,1] row_mask:0xf bank_mask:0xf
  v_add_f32_dpp v226, v226, v226 row_half_mirror row_mask:0xf bank_mask:0xf
  s_nop 0
  v_add_f32_dpp v229, v229, v229 row_half_mirror row_mask:0xf bank_mask:0xf
  v_max3_f32 v232, v128, v226, v229
  v_cmp_gt_f32 vcc, v232, v128
  s_cbranch_vccz Lsk505
  v_sub_f32 v234, v128, v232
  v_mul_f32 v234, s74, v234
  v_exp_f32 v234, v234
  v_mov_b32 v128, v232
  RESC 104, 234
  v_mul_f32 v129, v234, v129
Lsk505:
  v_mul_f32 v233, s74, v128
  v_fma_f32 v235, v226, s74, -v233
  v_fma_f32 v236, v229, s74, -v233
  v_exp_f32 v235, v235
  v_exp_f32 v236, v236
  v_cvt_pk_bf16_f32 v238, v235, 0
  v_cvt_pk_bf16_f32 v239, 0, v235
  v_cvt_pk_bf16_f32 v240, v236, 0
  v_cvt_pk_bf16_f32 v241, 0, v236
  v_add_f32 v129, v129, v239
  v_add_f32 v129, v129, v241
  PV 130, 238, 104
  PV 142, 240, 104
  ACR 56, 24
  ACR 68, 36
  QK2 56, 68, 80, 226
  v_add_f32 v226, v226, v227
  v_add_f32 v226, v226, v228
  v_add_f32 v229, v229, v230
  v_add_f32 v229, v229, v231
  v_add_f32_dpp v226, v226, v226 quad_perm:[1,0,3,2] row_mask:0xf bank_mask:0xf
  s_nop 0
  v_add_f32_dpp v229, v229, v229 quad_perm:[1,0,3,2] row_mask:0xf bank_mask:0xf
  v_add_f32_dpp v226, v226, v226 quad_perm:[2,3,0,1] row_mask:0xf bank_mask:0xf
  s_nop 0
  v_add_f32_dpp v229, v229, v229 quad_perm:[2,3,0,1] row_mask:0xf bank_mask:0xf
  v_add_f32_dpp v226, v226, v226 row_half_mirror row_mask:0xf bank_mask:0xf
  s_nop 0
  v_add_f32_dpp v229, v229, v229 row_half_mirror row_mask:0xf bank_mask:0xf
  v_max3_f32 v232, v128, v226, v229
  v_cmp_gt_f32 vcc, v232, v128
  s_cbranch_vccz Lsk506
  v_sub_f32 v234, v128, v232
  v_mul_f32 v234, s74, v234
  v_exp_f32 v234, v234
  v_mov_b32 v128, v232
  RESC 104, 234
  v_mul_f32 v129, v234, v129
Lsk506:
  v_mul_f32 v233, s74, v128
  v_fma_f32 v235, v226, s74, -v233
  v_fma_f32 v236, v229, s74, -v233
  v_exp_f32 v235, v235
  v_exp_f32 v236, v236
  v_cvt_pk_bf16_f32 v238, v235, 0
  v_cvt_pk_bf16_f32 v239, 0, v235
  v_cvt_pk_bf16_f32 v240, v236, 0
  v_cvt_pk_bf16_f32 v241, 0, v236
  v_add_f32 v129, v129, v239
  v_add_f32 v129, v129, v241
  PV 154, 238, 104
  PV 166, 240, 104
  ACR 56, 48
  ACR 68, 60
  QK2 56, 68, 80, 226
  v_add_f32 v226, v226, v227
  v_add_f32 v226, v226, v228
  v_add_f32 v229, v229, v230
  v_add_f32 v229, v229, v231
  v_add_f32_dpp v226, v226, v226 quad_perm:[1,0,3,2] row_mask:0xf bank_mask:0xf
  s_nop 0
  v_add_f32_dpp v229, v229, v229 quad_perm:[1,0,3,2] row_mask:0xf bank_mask:0xf
  v_add_f32_dpp v226, v226, v226 quad_perm:[2,3,0,1] row_mask:0xf bank_mask:0xf
  s_nop 0
  v_add_f32_dpp v229, v229, v229 quad_perm:[2,3,0,1] row_mask:0xf bank_mask:0xf
  v_add_f32_dpp v226, v226, v226 row_half_mirror row_mask:0xf bank_mask:0xf
  s_nop 0
  v_add_f32_dpp v229, v229, v229 row_half_mirror row_mask:0xf bank_mask:0xf
  v_max3_f32 v232, v128, v226, v229
  v_cmp_gt_f32 vcc, v232, v128
  s_cbranch_vccz Lsk507
  v_sub_f32 v234, v128, v232
  v_mul_f32 v234, s74, v234
  v_exp_f32 v234, v234
  v_mov_b32 v128, v232
  RESC 104, 234
  v_mul_f32 v129, v234, v129
Lsk507:
  v_mul_f32 v233, s74, v128
  v_fma_f32 v235, v226, s74, -v233
  v_fma_f32 v236, v229, s74, -v233
  v_exp_f32 v235, v235
  v_exp_f32 v236, v236
  v_cvt_pk_bf16_f32 v238, v235, 0
  v_cvt_pk_bf16_f32 v239, 0, v235
  v_cvt_pk_bf16_f32 v240, v236, 0
  v_cvt_pk_bf16_f32 v241, 0, v236
  v_add_f32 v129, v129, v239
  v_add_f32 v129, v129, v241
  PV 178, 238, 104
  PV 190, 240, 104
  ACR 56, 72
  ACR 68, 84
  QK2 56, 68, 80, 226
  v_add_f32 v226, v226, v227
  v_add_f32 v226, v226, v228
  v_add_f32 v229, v229, v230
  v_add_f32 v229, v229, v231
  v_add_f32_dpp v226, v226, v226 quad_perm:[1,0,3,2] row_mask:0xf bank_mask:0xf
  s_nop 0
  v_add_f32_dpp v229, v229, v229 quad_perm:[1,0,3,2] row_mask:0xf bank_mask:0xf
  v_add_f32_dpp v226, v226, v226 quad_perm:[2,3,0,1] row_mask:0xf bank_mask:0xf
  s_nop 0
  v_add_f32_dpp v229, v229, v229 quad_perm:[2,3,0,1] row_mask:0xf bank_mask:0xf
  v_add_f32_dpp v226, v226, v226 row_half_mirror row_mask:0xf bank_mask:0xf
  s_nop 0
  v_add_f32_dpp v229, v229, v229 row_half_mirror row_mask:0xf bank_mask:0xf
  v_max3_f32 v232, v128, v226, v229
  v_cmp_gt_f32 vcc, v232, v128
  s_cbranch_vccz Lsk508
  v_sub_f32 v234, v128, v232
  v_mul_f32 v234, s74, v234
  v_exp_f32 v234, v234
  v_mov_b32 v128, v232
  RESC 104, 234
  v_mul_f32 v129, v234, v129
Lsk508:
  v_mul_f32 v233, s74, v128
  v_fma_f32 v235, v226, s74, -v233
  v_fma_f32 v236, v229, s74, -v233
  v_exp_f32 v235, v235
  v_exp_f32 v236, v236
  v_cvt_pk_bf16_f32 v238, v235, 0
  v_cvt_pk_bf16_f32 v239, 0, v235
  v_cvt_pk_bf16_f32 v240, v236, 0
  v_cvt_pk_bf16_f32 v241, 0, v236
  v_add_f32 v129, v129, v239
  v_add_f32 v129, v129, v241
  PV 202, 238, 104
  PV 214, 240, 104
  ACR 56, 96
  ACR 68, 108
  QK2 56, 68, 80, 226
  v_add_f32 v226, v226, v227
  v_add_f32 v226, v226, v228
  v_add_f32 v229, v229, v230
  v_add_f32 v229, v229, v231
  v_add_f32_dpp v226, v226, v226 quad_perm:[1,0,3,2] row_mask:0xf bank_mask:0xf
  s_nop 0
  v_add_f32_dpp v229, v229, v229 quad_perm:[1,0,3,2] row_mask:0xf bank_mask:0xf
  v_add_f32_dpp v226, v226, v226 quad_perm:[2,3,0,1] row_mask:0xf bank_mask:0xf
  s_nop 0
  v_add_f32_dpp v229, v229, v229 quad_perm:[2,3,0,1] row_mask:0xf bank_mask:0xf
  v_add_f32_dpp v226, v226, v226 row_half_mirror row_mask:0xf bank_mask:0xf
  s_nop 0
  v_add_f32_dpp v229, v229, v229 row_half_mirror row_mask:0xf bank_mask:0xf
  v_max3_f32 v232, v128, v226, v229
  v_cmp_gt_f32 vcc, v232, v128
  s_cbranch_vccz Lsk509
  v_sub_f32 v234, v128, v232
  v_mul_f32 v234, s74, v234
  v_exp_f32 v234, v234
  v_mov_b32 v128, v232
  RESC 104, 234
  v_mul_f32 v129, v234, v129
Lsk509:
  v_mul_f32 v233, s74, v128
  v_fma_f32 v235, v226, s74, -v233
  v_fma_f32 v236, v229, s74, -v233
  v_exp_f32 v235, v235
  v_exp_f32 v236, v236
  v_cvt_pk_bf16_f32 v238, v235, 0
  v_cvt_pk_bf16_f32 v239, 0, v235
  v_cvt_pk_bf16_f32 v240, v236, 0
  v_cvt_pk_bf16_f32 v241, 0, v236
  v_add_f32 v129, v129, v239
  v_add_f32 v129, v129, v241
  PV 8, 238, 104
  ds_write_b128 v3, v[8:11] offset:0
  ds_write_b128 v3, v[12:15] offset:1024
  ds_write_b128 v3, v[16:19] offset:2048
  s_mov_b32 s76, 0x9000
  LDT v, 8, 60
  PV 44, 240, 104
  ds_write_b128 v3, v[44:47] offset:3072
  ds_write_b128 v3, v[48:51] offset:4096
  ds_write_b128 v3, v[52:55] offset:5120
  s_mov_b32 s76, 0x9c00
  LDT v, 44, 60
  ACR 56, 120
  s_waitcnt vmcnt(34)
  ACR 68, 132
  QK2 56, 68, 80, 226
  v_add_f32 v226, v226, v227
  v_add_f32 v226, v226, v228
  v_add_f32 v229, v229, v230
  v_add_f32 v229, v229, v231
  v_add_f32_dpp v226, v226, v226 quad_perm:[1,0,3,2] row_mask:0xf bank_mask:0xf
  s_nop 0
  v_add_f32_dpp v229, v229, v229 quad_perm:[1,0,3,2] row_mask:0xf bank_mask:0xf
  v_add_f32_dpp v226, v226, v226 quad_perm:[2,3,0,1] row_mask:0xf bank_mask:0xf
  s_nop 0
  v_add_f32_dpp v229, v229, v229 quad_perm:[2,3,0,1] row_mask:0xf bank_mask:0xf
  v_add_f32_dpp v226, v226, v226 row_half_mirror row_mask:0xf bank_mask:0xf
  s_nop 0
  v_add_f32_dpp v229, v229, v229 row_half_mirror row_mask:0xf bank_mask:0xf
  v_max3_f32 v232, v128, v226, v229
  v_cmp_gt_f32 vcc, v232, v128
  s_cbranch_vccz Lsk510
  v_sub_f32 v234, v128, v232
  v_mul_f32 v234, s74, v234
  v_exp_f32 v234, v234
  v_mov_b32 v128, v232
  RESC 104, 234
  v_mul_f32 v129, v234, v129
Lsk510:
  v_mul_f32 v233, s74, v128
  v_fma_f32 v235, v226, s74, -v233
  v_fma_f32 v236, v229, s74, -v233
  v_exp_f32 v235, v235
  v_exp_f32 v236, v236
  v_cvt_pk_bf16_f32 v238, v235, 0
  v_cvt_pk_bf16_f32 v239, 0, v235
  v_cvt_pk_bf16_f32 v240, v236, 0
  v_cvt_pk_bf16_f32 v241, 0, v236
  v_add_f32 v129, v129, v239
  v_add_f32 v129, v129, v241
  PV 20, 238, 104
  ds_write_b128 v3, v[20:23] offset:6144
  ds_write_b128 v3, v[24:27] offset:7168
  ds_write_b128 v3, v[28:31] offset:8192
  s_mov_b32 s76, 0xa800
  LDT v, 20, 60
  PV 32, 240, 104
  ds_write_b128 v3, v[32:35] offset:9216
  ds_write_b128 v3, v[36:39] offset:10240
  ds_write_b128 v3, v[40:43] offset:11264
  s_mov_b32 s76, 0xb400
  LDT v, 32, 60
  s_waitcnt vmcnt(37)
  ACR 56, 144
  s_waitcnt vmcnt(34)
  ACR 68, 156
  QK2 56, 68, 80, 226
  v_add_f32 v226, v226, v227
  v_add_f32 v226, v226, v228
  v_add_f32 v229, v229, v230
  v_add_f32 v229, v229, v231
  v_add_f32_dpp v226, v226, v226 quad_perm:[1,0,3,2] row_mask:0xf bank_mask:0xf
  s_nop 0
  v_add_f32_dpp v229, v229, v229 quad_perm:[1,0,3,2] row_mask:0xf bank_mask:0xf
  v_add_f32_dpp v226, v226, v226 quad_perm:[2,3,0,1] row_mask:0xf bank_mask:0xf
  s_nop 0
  v_add_f32_dpp v229, v229, v229 quad_perm:[2,3,0,1] row_mask:0xf bank_mask:0xf
  v_add_f32_dpp v226, v226, v226 row_half_mirror row_mask:0xf bank_mask:0xf
  s_nop 0
  v_add_f32_dpp v229, v229, v229 row_half_mirror row_mask:0xf bank_mask:0xf
  v_max3_f32 v232, v128, v226, v229
  v_cmp_gt_f32 vcc, v232, v128
  s_cbranch_vccz Lsk511
  v_sub_f32 v234, v128, v232
  v_mul_f32 v234, s74, v234
  v_exp_f32 v234, v234
  v_mov_b32 v128, v232
  RESC 104, 234
  v_mul_f32 v129, v234, v129
Lsk511:
  v_mul_f32 v233, s74, v128
  v_fma_f32 v235, v226, s74, -v233
  v_fma_f32 v236, v229, s74, -v233
  v_exp_f32 v235, v235
  v_exp_f32 v236, v236
  v_cvt_pk_bf16_f32 v238, v235, 0
  v_cvt_pk_bf16_f32 v239, 0, v235
  v_cvt_pk_bf16_f32 v240, v236, 0
  v_cvt_pk_bf16_f32 v241, 0, v236
  v_add_f32 v129, v129, v239
  v_add_f32 v129, v129, v241
  s_waitcnt vmcnt(9)
  PV 8, 238, 104
  ds_write_b128 v3, v[8:11] offset:12288
  ds_write_b128 v3, v[12:15] offset:13312
  ds_write_b128 v3, v[16:19] offset:14336
  s_mov_b32 s76, 0xc000
  LDT v, 8, 60
  s_waitcnt vmcnt(9)
  PV 44, 240, 104
  ds_write_b128 v3, v[44:47] offset:15360
  s_waitcnt lgkmcnt(8)
  ds_write_b128 v3, v[48:51] offset:16384
  ds_write_b128 v3, v[52:55] offset:17408
  s_mov_b32 s76, 0xcc00
  LDT v, 44, 60
  ACR 56, 168
  ACR 68, 180
  QK2 56, 68, 80, 226
  v_add_f32 v226, v226, v227
  v_add_f32 v226, v226, v228
  v_add_f32 v229, v229, v230
  v_add_f32 v229, v229, v231
  v_add_f32_dpp v226, v226, v226 quad_perm:[1,0,3,2] row_mask:0xf bank_mask:0xf
  s_nop 0
  v_add_f32_dpp v229, v229, v229 quad_perm:[1,0,3,2] row_mask:0xf bank_mask:0xf
  v_add_f32_dpp v226, v226, v226 quad_perm:[2,3,0,1] row_mask:0xf bank_mask:0xf
  s_nop 0
  v_add_f32_dpp v229, v229, v229 quad_perm:[2,3,0,1] row_mask:0xf bank_mask:0xf
  v_add_f32_dpp v226, v226, v226 row_half_mirror row_mask:0xf bank_mask:0xf
  s_nop 0
  v_add_f32_dpp v229, v229, v229 row_half_mirror row_mask:0xf bank_mask:0xf
  v_max3_f32 v232, v128, v226, v229
  v_cmp_gt_f32 vcc, v232, v128
  s_cbranch_vccz Lsk512
  v_sub_f32 v234, v128, v232
  v_mul_f32 v234, s74, v234
  v_exp_f32 v234, v234
  v_mov_b32 v128, v232
  RESC 104, 234
  v_mul_f32 v129, v234, v129
Lsk512:
  v_mul_f32 v233, s74, v128
  v_fma_f32 v235, v226, s74, -v233
  v_fma_f32 v236, v229, s74, -v233
  v_exp_f32 v235, v235
  v_exp_f32 v236, v236
  v_cvt_pk_bf16_f32 v238, v235, 0
  v_cvt_pk_bf16_f32 v239, 0, v235
  v_cvt_pk_bf16_f32 v240, v236, 0
  v_cvt_pk_bf16_f32 v241, 0, v236
  v_add_f32 v129, v129, v239
  v_add_f32 v129, v129, v241
  s_waitcnt vmcnt(9)
  PV 20, 238, 104
  ds_write_b128 v3, v[20:23] offset:18432
  ds_write_b128 v3, v[24:27] offset:19456
  ds_write_b128 v3, v[28:31] offset:20480
  s_mov_b32 s76, 0xd800
  LDT v, 20, 60
  s_waitcnt vmcnt(9)
  PV 32, 240, 104
  ds_write_b128 v3, v[32:35] offset:21504
  ds_write_b128 v3, v[36:39] offset:22528
  ds_write_b128 v3, v[40:43] offset:23552
  s_waitcnt lgkmcnt(8)
  s_mov_b32 s76, 0xe400
  LDT v, 32, 60
  ACR 56, 192
  ACR 68, 204
  QK2 56, 68, 80, 226
  v_add_f32 v226, v226, v227
  v_add_f32 v226, v226, v228
  v_add_f32 v229, v229, v230
  v_add_f32 v229, v229, v231
  v_add_f32_dpp v226, v226, v226 quad_perm:[1,0,3,2] row_mask:0xf bank_mask:0xf
  s_nop 0
  v_add_f32_dpp v229, v229, v229 quad_perm:[1,0,3,2] row_mask:0xf bank_mask:0xf
  v_add_f32_dpp v226, v226, v226 quad_perm:[2,3,0,1] row_mask:0xf bank_mask:0xf
  s_nop 0
  v_add_f32_dpp v229, v229, v229 quad_perm:[2,3,0,1] row_mask:0xf bank_mask:0xf
  v_add_f32_dpp v226, v226, v226 row_half_mirror row_mask:0xf bank_mask:0xf
  s_nop 0
  v_add_f32_dpp v229, v229, v229 row_half_mirror row_mask:0xf bank_mask:0xf
  v_max3_f32 v232, v128, v226, v229
  v_cmp_gt_f32 vcc, v232, v128
  s_cbranch_vccz Lsk513
  v_sub_f32 v234, v128, v232
  v_mul_f32 v234, s74, v234
  v_exp_f32 v234, v234
  v_mov_b32 v128, v232
  RESC 104, 234
  v_mul_f32 v129, v234, v129
Lsk513:
  v_mul_f32 v233, s74, v128
  v_fma_f32 v235, v226, s74, -v233
  v_fma_f32 v236, v229, s74, -v233
  v_exp_f32 v235, v235
  v_exp_f32 v236, v236
  v_cvt_pk_bf16_f32 v238, v235, 0
  v_cvt_pk_bf16_f32 v239, 0, v235
  v_cvt_pk_bf16_f32 v240, v236, 0
  v_cvt_pk_bf16_f32 v241, 0, v236
  v_add_f32 v129, v129, v239
  v_add_f32 v129, v129, v241
  s_waitcnt vmcnt(9)
  PV 8, 238, 104
  ds_write_b128 v3, v[8:11] offset:24576
  ds_write_b128 v3, v[12:15] offset:25600
  ds_write_b128 v3, v[16:19] offset:26624
  s_mov_b32 s76, 0xfc00
  LDC v, 8, 56
  s_waitcnt vmcnt(9)
  PV 44, 240, 104
  ds_write_b128 v3, v[44:47] offset:27648
  ds_write_b128 v3, v[48:51] offset:28672
  ds_write_b128 v3, v[52:55] offset:29696
  s_mov_b32 s76, 0xf000
  LDT v, 44, 60
  ACR 56, 216
  ACR 68, 228
  QK2 56, 68, 80, 226
  v_add_f32 v226, v226, v227
  v_add_f32 v226, v226, v228
  v_add_f32 v229, v229, v230
  v_add_f32 v229, v229, v231
  v_add_f32_dpp v226, v226, v226 quad_perm:[1,0,3,2] row_mask:0xf bank_mask:0xf
  s_nop 0
  v_add_f32_dpp v229, v229, v229 quad_perm:[1,0,3,2] row_mask:0xf bank_mask:0xf
  v_add_f32_dpp v226, v226, v226 quad_perm:[2,3,0,1] row_mask:0xf bank_mask:0xf
  s_nop 0
  v_add_f32_dpp v229, v229, v229 quad_perm:[2,3,0,1] row_mask:0xf bank_mask:0xf
  v_add_f32_dpp v226, v226, v226 row_half_mirror row_mask:0xf bank_mask:0xf
  s_nop 0
  v_add_f32_dpp v229, v229, v229 row_half_mirror row_mask:0xf bank_mask:0xf
  v_max3_f32 v232, v128, v226, v229
  v_cmp_gt_f32 vcc, v232, v128
  s_cbranch_vccz Lsk514
  v_sub_f32 v234, v128, v232
  v_mul_f32 v234, s74, v234
  v_exp_f32 v234, v234
  v_mov_b32 v128, v232
  RESC 104, 234
  v_mul_f32 v129, v234, v129
Lsk514:
  v_mul_f32 v233, s74, v128
  v_fma_f32 v235, v226, s74, -v233
  v_fma_f32 v236, v229, s74, -v233
  v_exp_f32 v235, v235
  v_exp_f32 v236, v236
  v_cvt_pk_bf16_f32 v238, v235, 0
  v_cvt_pk_bf16_f32 v239, 0, v235
  v_cvt_pk_bf16_f32 v240, v236, 0
  v_cvt_pk_bf16_f32 v241, 0, v236
  v_add_f32 v129, v129, v239
  v_add_f32 v129, v129, v241
  s_waitcnt vmcnt(9)
  PV 20, 238, 104
  ds_write_b128 v3, v[20:23] offset:30720
  ds_write_b128 v3, v[24:27] offset:31744
  s_waitcnt lgkmcnt(8)
  ds_write_b128 v3, v[28:31] offset:32768
  s_mov_b32 s76, 0xfc00
  LDC v, 20, 60
  s_waitcnt vmcnt(9)
  PV 32, 240, 104
  ds_write_b128 v3, v[32:35] offset:33792
  ds_write_b128 v3, v[36:39] offset:34816
  ds_write_b128 v3, v[40:43] offset:35840
  s_mov_b32 s76, 0x10800
  LDC v, 32, 56
  s_add_u32 s76, s72, 0xf000
  buffer_load_dwordx4 v[92:95], v2, s[64:67], s76 offen sc1
  buffer_load_dwordx4 v[96:99], v2, s[64:67], s76 offen offset:128 sc1
  buffer_load_dwordx4 v[100:103], v2, s[64:67], s76 offen offset:256 sc1
  ACR 56, 240
  s_waitcnt vmcnt(12)
  QK2 56, 8, 80, 226
  s_mov_b32 s76, 0x11400
  LDC v, 8, 56
  v_add_f32 v226, v226, v227
  v_add_f32 v226, v226, v228
  v_add_f32 v229, v229, v230
  v_add_f32 v229, v229, v231
  v_add_f32_dpp v226, v226, v226 quad_perm:[1,0,3,2] row_mask:0xf bank_mask:0xf
  s_nop 0
  v_add_f32_dpp v229, v229, v229 quad_perm:[1,0,3,2] row_mask:0xf bank_mask:0xf
  v_add_f32_dpp v226, v226, v226 quad_perm:[2,3,0,1] row_mask:0xf bank_mask:0xf
  s_nop 0
  v_add_f32_dpp v229, v229, v229 quad_perm:[2,3,0,1] row_mask:0xf bank_mask:0xf
  v_add_f32_dpp v226, v226, v226 row_half_mirror row_mask:0xf bank_mask:0xf
  s_nop 0
  v_add_f32_dpp v229, v229, v229 row_half_mirror row_mask:0xf bank_mask:0xf
  v_max3_f32 v232, v128, v226, v229
  v_cmp_gt_f32 vcc, v232, v128
  s_cbranch_vccz Lsk515
  v_sub_f32 v234, v128, v232
  v_mul_f32 v234, s74, v234
  v_exp_f32 v234, v234
  v_mov_b32 v128, v232
  RESC 104, 234
  v_mul_f32 v129, v234, v129
Lsk515:
  v_mul_f32 v233, s74, v128
  v_fma_f32 v235, v226, s74, -v233
  v_fma_f32 v236, v229, s74, -v233
  v_exp_f32 v235, v235
  v_exp_f32 v236, v236
  v_cvt_pk_bf16_f32 v238, v235, 0
  v_cvt_pk_bf16_f32 v239, 0, v235
  v_cvt_pk_bf16_f32 v240, v236, 0
  v_cvt_pk_bf16_f32 v241, 0, v236
  v_add_f32 v129, v129, v239
  v_add_f32 v129, v129, v241
  s_waitcnt vmcnt(12)
  PV 44, 238, 104
  ds_write_b128 v3, v[44:47] offset:36864
  ds_write_b128 v3, v[48:51] offset:37888
  ds_write_b128 v3, v[52:55] offset:38912
  s_mov_b32 s76, 0x10800
  LDC v, 44, 60
  s_waitcnt vmcnt(12)
  PV 20, 240, 104
  s_mov_b32 s76, 0x11400
  LDC v, 20, 60
  s_waitcnt vmcnt(12)
  s_waitcnt vmcnt(6)
  QK2 32, 8, 80, 226
  s_mov_b32 s76, 0x12000
  LDC v, 8, 56
  s_mov_b32 s76, 0x12000
  LDC v, 32, 60
  v_add_f32 v226, v226, v227
  v_add_f32 v226, v226, v228
  v_add_f32 v229, v229, v230
  v_add_f32 v229, v229, v231
  v_add_f32_dpp v226, v226, v226 quad_perm:[1,0,3,2] row_mask:0xf bank_mask:0xf
  s_nop 0
  v_add_f32_dpp v229, v229, v229 quad_perm:[1,0,3,2] row_mask:0xf bank_mask:0xf
  v_add_f32_dpp v226, v226, v226 quad_perm:[2,3,0,1] row_mask:0xf bank_mask:0xf
  s_nop 0
  v_add_f32_dpp v229, v229, v229 quad_perm:[2,3,0,1] row_mask:0xf bank_mask:0xf
  v_add_f32_dpp v226, v226, v226 row_half_mirror row_mask:0xf bank_mask:0xf
  s_nop 0
  v_add_f32_dpp v229, v229, v229 row_half_mirror row_mask:0xf bank_mask:0xf
  v_max3_f32 v232, v128, v226, v229
  v_cmp_gt_f32 vcc, v232, v128
  s_cbranch_vccz Lsk516
  v_sub_f32 v234, v128, v232
  v_mul_f32 v234, s74, v234
  v_exp_f32 v234, v234
  v_mov_b32 v128, v232
  RESC 104, 234
  v_mul_f32 v129, v234, v129
Lsk516:
  v_mul_f32 v233, s74, v128
  v_fma_f32 v235, v226, s74, -v233
  v_fma_f32 v236, v229, s74, -v233
  v_exp_f32 v235, v235
  v_exp_f32 v236, v236
  v_cvt_pk_bf16_f32 v238, v235, 0
  v_cvt_pk_bf16_f32 v239, 0, v235
  v_cvt_pk_bf16_f32 v240, v236, 0
  v_cvt_pk_bf16_f32 v241, 0, v236
  v_add_f32 v129, v129, v239
  v_add_f32 v129, v129, v241
  s_waitcnt vmcnt(9)
  PV 44, 238, 104
  s_mov_b32 s76, 0x18c00
  LDT v, 44, 40
  s_waitcnt vmcnt(9)
  PV 20, 240, 104
  s_mov_b32 s76, 0x19800
  LDT v, 20, 40
  s_waitcnt vmcnt(9)
  v_dot2_f32_bf16 v226, v8, v80, 0
  v_dot2_f32_bf16 v227, v12, v84, 0
  v_dot2_f32_bf16 v228, v16, v88, 0
  s_nop 0
  v_dot2c_f32_bf16 v226, v9, v81
  v_dot2c_f32_bf16 v227, v13, v85
  v_dot2c_f32_bf16 v228, v17, v89
  v_dot2c_f32_bf16 v226, v10, v82
  v_dot2c_f32_bf16 v227, v14, v86
  v_dot2c_f32_bf16 v228, v18, v90
  v_dot2c_f32_bf16 v226, v11, v83
  v_dot2c_f32_bf16 v227, v15, v87
  v_dot2c_f32_bf16 v228, v19, v91
  s_mov_b32 s76, 0x18c00
  LDT v, 8, 44
  v_add_f32 v226, v226, v227
  v_add_f32 v226, v226, v228
  s_nop 1
  v_add_f32_dpp v226, v226, v226 quad_perm:[1,0,3,2] row_mask:0xf bank_mask:0xf
  s_nop 1
  v_add_f32_dpp v226, v226, v226 quad_perm:[2,3,0,1] row_mask:0xf bank_mask:0xf
  s_nop 1
  v_add_f32_dpp v226, v226, v226 row_half_mirror row_mask:0xf bank_mask:0xf
  v_max_f32 v232, v128, v226
  v_cmp_gt_f32 vcc, v232, v128
  s_cbranch_vccz Lsk517
  v_sub_f32 v234, v128, v232
  v_mul_f32 v234, s74, v234
  v_exp_f32 v234, v234
  v_mov_b32 v128, v232
  RESC 104, 234
  v_mul_f32 v129, v234, v129
Lsk517:
  v_mul_f32 v233, s74, v128
  v_fma_f32 v235, v226, s74, -v233
  v_exp_f32 v235, v235
  s_nop 0
  v_cvt_pk_bf16_f32 v238, v235, 0
  v_cvt_pk_bf16_f32 v239, 0, v235
  v_add_f32 v129, v129, v239
  s_waitcnt vmcnt(9)
  PV 32, 238, 104
  s_mov_b32 s76, 0x19800
  LDT v, 32, 44
  v_max_f32_dpp v226, v128, v128 row_ror:8 row_mask:0xf bank_mask:0xf
  v_mov_b32 v227, v226
  s_nop 1
  v_permlane16_swap_b32 v226, v227
  v_max_f32 v226, v226, v227
  v_mov_b32 v227, v226
  s_nop 1
  v_permlane32_swap_b32 v226, v227
  v_max_f32 v226, v226, v227
  v_sub_f32 v228, v128, v226
  v_mul_f32 v228, s74, v228
  v_exp_f32 v228, v228
  v_mul_f32 v226, s74, v226
  RESC 104, 228
  v_mul_f32 v129, v228, v129
  s_nop 1
  v_add_f32_dpp v129, v129, v129 row_ror:8 row_mask:0xf bank_mask:0xf
  v_mov_b32 v227, v129
  s_nop 1
  v_permlane16_swap_b32 v129, v227
  v_add_f32 v129, v129, v227
  v_mov_b32 v227, v129
  s_nop 1
  v_permlane32_swap_b32 v129, v227
  v_add_f32 v129, v129, v227
  v_permlane32_swap_b32 v104, v116
  v_permlane32_swap_b32 v105, v117
  v_permlane32_swap_b32 v106, v118
  v_permlane32_swap_b32 v107, v119
  v_permlane32_swap_b32 v108, v120
  v_permlane32_swap_b32 v109, v121
  v_permlane32_swap_b32 v110, v122
  v_permlane32_swap_b32 v111, v123
  v_permlane32_swap_b32 v112, v124
  v_permlane32_swap_b32 v113, v125
  v_permlane32_swap_b32 v114, v126
  v_permlane32_swap_b32 v115, v127
  v_add_f32 v104, v104, v116
  v_add_f32 v105, v105, v117
  v_add_f32 v106, v106, v118
  v_add_f32 v107, v107, v119
  v_add_f32 v108, v108, v120
  v_add_f32 v109, v109, v121
  v_add_f32 v110, v110, v122
  v_add_f32 v111, v111, v123
  v_add_f32 v112, v112, v124
  v_add_f32 v113, v113, v125
  v_add_f32 v114, v114, v126
  v_add_f32 v115, v115, v127
  v_permlane16_swap_b32 v104, v110
  v_permlane16_swap_b32 v105, v111
  v_permlane16_swap_b32 v106, v112
  v_permlane16_swap_b32 v107, v113
  v_permlane16_swap_b32 v108, v114
  v_permlane16_swap_b32 v109, v115
  v_add_f32 v104, v104, v110
  v_add_f32 v105, v105, v111
  v_add_f32 v106, v106, v112
  v_add_f32 v107, v107, v113
  v_add_f32 v108, v108, v114
  v_add_f32 v109, v109, v115
  v_add_f32_dpp v104, v104, v104 row_ror:8 row_mask:0xf bank_mask:0xf
  v_add_f32_dpp v105, v105, v105 row_ror:8 row_mask:0xf bank_mask:0xf
  v_add_f32_dpp v106, v106, v106 row_ror:8 row_mask:0xf bank_mask:0xf
  v_add_f32_dpp v107, v107, v107 row_ror:8 row_mask:0xf bank_mask:0xf
  v_add_f32_dpp v108, v108, v108 row_ror:8 row_mask:0xf bank_mask:0xf
  v_add_f32_dpp v109, v109, v109 row_ror:8 row_mask:0xf bank_mask:0xf
  v_add_u32 v229, 0, v7
  v_lshrrev_b32 v230, 3, v229
  v_and_b32 v229, 7, v229
  v_lshlrev_b32 v230, 6, v230
  v_add_u32 v229, v229, v230
  v_lshl_add_u32 v229, v229, 2, v4
  ds_write_b32 v229, v104
  s_waitcnt lgkmcnt(8)
  v_add_u32 v229, 1, v7
  v_lshrrev_b32 v230, 3, v229
  v_and_b32 v229, 7, v229
  v_lshlrev_b32 v230, 6, v230
  v_add_u32 v229, v229, v230
  v_lshl_add_u32 v229, v229, 2, v4
  ds_write_b32 v229, v105
  v_add_u32 v229, 2, v7
  v_lshrrev_b32 v230, 3, v229
  v_and_b32 v229, 7, v229
  v_lshlrev_b32 v230, 6, v230
  v_add_u32 v229, v229, v230
  v_lshl_add_u32 v229, v229, 2, v4
  ds_write_b32 v229, v106
  v_add_u32 v229, 3, v7
  v_lshrrev_b32 v230, 3, v229
  v_and_b32 v229, 7, v229
  v_lshlrev_b32 v230, 6, v230
  v_add_u32 v229, v229, v230
  v_lshl_add_u32 v229, v229, 2, v4
  ds_write_b32 v229, v107
  v_add_u32 v229, 4, v7
  v_lshrrev_b32 v230, 3, v229
  v_and_b32 v229, 7, v229
  v_lshlrev_b32 v230, 6, v230
  v_add_u32 v229, v229, v230
  v_lshl_add_u32 v229, v229, 2, v4
  ds_write_b32 v229, v108
  v_add_u32 v229, 5, v7
  v_lshrrev_b32 v230, 3, v229
  v_and_b32 v229, 7, v229
  v_lshlrev_b32 v230, 6, v230
  v_add_u32 v229, v229, v230
  v_lshl_add_u32 v229, v229, 2, v4
  ds_write_b32 v229, v109
  v_mov_b32 v234, v226
  v_mov_b32 v235, v129
  v_mov_b32 v236, 0
  v_mov_b32 v237, 0
  v_and_b32 v229, 0xffffff1f, v4
  ds_write_b128 v229, v[234:237] offset:768
  s_waitcnt lgkmcnt(0)
  ds_read_b128 v[234:237], v5
  s_waitcnt lgkmcnt(0)
  s_add_u32 s76, s73, 0x816400
  s_mov_b32 exec_lo, -1
  s_mov_b32 exec_hi, 0x1ffff
  buffer_store_dwordx4 v[234:237], v6, s[64:67], s76 offen sc1
  s_mov_b64 exec, -1
  v_max3_u32 v226, v92, v93, v94
  v_max3_u32 v226, v226, v95, v96
  v_max3_u32 v226, v226, v97, v98
  v_max3_u32 v226, v226, v99, v100
  v_max3_u32 v226, v226, v101, v102
  v_max3_u32 v226, v226, v103, v103
  v_cmp_eq_u32 vcc, -1, v226
  s_cbranch_vccz Lqo518
  s_mov_b32 s75, 0x61a80
Lqr519:
  s_sleep 2
  s_add_u32 s77, s72, 0xf000
  buffer_load_dwordx4 v[92:95], v2, s[64:67], s77 offen sc1
  buffer_load_dwordx4 v[96:99], v2, s[64:67], s77 offen offset:128 sc1
  buffer_load_dwordx4 v[100:103], v2, s[64:67], s77 offen offset:256 sc1
  s_waitcnt vmcnt(0)
  v_max3_u32 v226, v92, v93, v94
  v_max3_u32 v226, v226, v95, v96
  v_max3_u32 v226, v226, v97, v98
  v_max3_u32 v226, v226, v99, v100
  v_max3_u32 v226, v226, v101, v102
  v_max3_u32 v226, v226, v103, v103
  v_cmp_eq_u32 vcc, -1, v226
  s_cbranch_vccz Lqo518
  s_sub_u32 s75, s75, 1
  s_cmp_lg_u32 s75, 0
  s_cbranch_scc1 Lqr519
Lqo518:
  v_mov_b32 v80, v92
  v_mov_b32 v81, v93
  v_mov_b32 v82, v94
  v_mov_b32 v83, v95
  v_mov_b32 v84, v96
  v_mov_b32 v85, v97
  v_mov_b32 v86, v98
  v_mov_b32 v87, v99
  v_mov_b32 v88, v100
  v_mov_b32 v89, v101
  v_mov_b32 v90, v102
  v_mov_b32 v91, v103
  v_mov_b32 v104, 0
  v_mov_b32 v105, 0
  v_mov_b32 v106, 0
  v_mov_b32 v107, 0
  v_mov_b32 v108, 0
  v_mov_b32 v109, 0
  v_mov_b32 v110, 0
  v_mov_b32 v111, 0
  v_mov_b32 v112, 0
  v_mov_b32 v113, 0
  v_mov_b32 v114, 0
  v_mov_b32 v115, 0
  v_mov_b32 v116, 0
  v_mov_b32 v117, 0
  v_mov_b32 v118, 0
  v_mov_b32 v119, 0
  v_mov_b32 v120, 0
  v_mov_b32 v121, 0
  v_mov_b32 v122, 0
  v_mov_b32 v123, 0
  v_mov_b32 v124, 0
  v_mov_b32 v125, 0
  v_mov_b32 v126, 0
  v_mov_b32 v127, 0
  v_mov_b32 v128, 0xf149f2ca
  v_mov_b32 v129, 0
  s_waitcnt vmcnt(10)
  s_waitcnt vmcnt(7)
  QK2 44, 20, 80, 226
  s_mov_b32 s76, 0x1a400
  LDT v, 20, 40
  s_mov_b32 s76, 0x1b000
  LDT v, 44, 40
  v_add_f32 v226, v226, v227
  v_add_f32 v226, v226, v228
  v_add_f32 v229, v229, v230
  v_add_f32 v229, v229, v231
  v_add_f32_dpp v226, v226, v226 quad_perm:[1,0,3,2] row_mask:0xf bank_mask:0xf
  s_nop 0
  v_add_f32_dpp v229, v229, v229 quad_perm:[1,0,3,2] row_mask:0xf bank_mask:0xf
  v_add_f32_dpp v226, v226, v226 quad_perm:[2,3,0,1] row_mask:0xf bank_mask:0xf
  s_nop 0
  v_add_f32_dpp v229, v229, v229 quad_perm:[2,3,0,1] row_mask:0xf bank_mask:0xf
  v_add_f32_dpp v226, v226, v226 row_half_mirror row_mask:0xf bank_mask:0xf
  s_nop 0
  v_add_f32_dpp v229, v229, v229 row_half_mirror row_mask:0xf bank_mask:0xf
  v_max3_f32 v232, v128, v226, v229
  v_cmp_gt_f32 vcc, v232, v128
  s_cbranch_vccz Lsk520
  v_sub_f32 v234, v128, v232
  v_mul_f32 v234, s74, v234
  v_exp_f32 v234, v234
  v_mov_b32 v128, v232
  RESC 104, 234
  v_mul_f32 v129, v234, v129
Lsk520:
  v_mul_f32 v233, s74, v128
  v_fma_f32 v235, v226, s74, -v233
  v_fma_f32 v236, v229, s74, -v233
  v_exp_f32 v235, v235
  v_exp_f32 v236, v236
  v_cvt_pk_bf16_f32 v238, v235, 0
  v_cvt_pk_bf16_f32 v239, 0, v235
  v_cvt_pk_bf16_f32 v240, v236, 0
  v_cvt_pk_bf16_f32 v241, 0, v236
  v_add_f32 v129, v129, v239
  v_add_f32 v129, v129, v241
  s_waitcnt vmcnt(10)
  PV 8, 238, 104
  s_mov_b32 s76, 0x1a400
  LDT v, 8, 44
  s_waitcnt vmcnt(10)
  PV 32, 240, 104
  s_mov_b32 s76, 0x1b000
  LDT v, 32, 44
  s_add_u32 s76, s72, 0x12000
  buffer_load_dwordx4 v[92:95], v2, s[64:67], s76 offen sc1
  buffer_load_dwordx4 v[96:99], v2, s[64:67], s76 offen offset:128 sc1
  buffer_load_dwordx4 v[100:103], v2, s[64:67], s76 offen offset:256 sc1
  s_waitcnt vmcnt(12)
  s_waitcnt vmcnt(9)
  QK2 20, 44, 80, 226
  s_mov_b32 s76, 0x1bc00
  LDT v, 20, 40
  s_mov_b32 s76, 0x1c800
  LDT v, 44, 40
  v_add_f32 v226, v226, v227
  v_add_f32 v226, v226, v228
  v_add_f32 v229, v229, v230
  v_add_f32 v229, v229, v231
  v_add_f32_dpp v226, v226, v226 quad_perm:[1,0,3,2] row_mask:0xf bank_mask:0xf
  s_nop 0
  v_add_f32_dpp v229, v229, v229 quad_perm:[1,0,3,2] row_mask:0xf bank_mask:0xf
  v_add_f32_dpp v226, v226, v226 quad_perm:[2,3,0,1] row_mask:0xf bank_mask:0xf
  s_nop 0
  v_add_f32_dpp v229, v229, v229 quad_perm:[2,3,0,1] row_mask:0xf bank_mask:0xf
  v_add_f32_dpp v226, v226, v226 row_half_mirror row_mask:0xf bank_mask:0xf
  s_nop 0
  v_add_f32_dpp v229, v229, v229 row_half_mirror row_mask:0xf bank_mask:0xf
  v_max3_f32 v232, v128, v226, v229
  v_cmp_gt_f32 vcc, v232, v128
  s_cbranch_vccz Lsk521
  v_sub_f32 v234, v128, v232
  v_mul_f32 v234, s74, v234
  v_exp_f32 v234, v234
  v_mov_b32 v128, v232
  RESC 104, 234
  v_mul_f32 v129, v234, v129
Lsk521:
  v_mul_f32 v233, s74, v128
  v_fma_f32 v235, v226, s74, -v233
  v_fma_f32 v236, v229, s74, -v233
  v_exp_f32 v235, v235
  v_exp_f32 v236, v236
  v_cvt_pk_bf16_f32 v238, v235, 0
  v_cvt_pk_bf16_f32 v239, 0, v235
  v_cvt_pk_bf16_f32 v240, v236, 0
  v_cvt_pk_bf16_f32 v241, 0, v236
  v_add_f32 v129, v129, v239
  v_add_f32 v129, v129, v241
  s_waitcnt vmcnt(12)
  PV 8, 238, 104
  s_mov_b32 s76, 0x1bc00
  LDT v, 8, 44
  s_waitcnt vmcnt(12)
  PV 32, 240, 104
  s_mov_b32 s76, 0x1c800
  LDT v, 32, 44
  s_waitcnt vmcnt(9)
  s_waitcnt vmcnt(6)
  QK2 20, 44, 80, 226
  s_mov_b32 s76, 0x1d400
  LDT v, 20, 40
  s_mov_b32 s76, 0x1d400
  LDT v, 44, 44
  v_add_f32 v226, v226, v227
  v_add_f32 v226, v226, v228
  v_add_f32 v229, v229, v230
  v_add_f32 v229, v229, v231
  v_add_f32_dpp v226, v226, v226 quad_perm:[1,0,3,2] row_mask:0xf bank_mask:0xf
  s_nop 0
  v_add_f32_dpp v229, v229, v229 quad_perm:[1,0,3,2] row_mask:0xf bank_mask:0xf
  v_add_f32_dpp v226, v226, v226 quad_perm:[2,3,0,1] row_mask:0xf bank_mask:0xf
  s_nop 0
  v_add_f32_dpp v229, v229, v229 quad_perm:[2,3,0,1] row_mask:0xf bank_mask:0xf
  v_add_f32_dpp v226, v226, v226 row_half_mirror row_mask:0xf bank_mask:0xf
  s_nop 0
  v_add_f32_dpp v229, v229, v229 row_half_mirror row_mask:0xf bank_mask:0xf
  v_max3_f32 v232, v128, v226, v229
  v_cmp_gt_f32 vcc, v232, v128
  s_cbranch_vccz Lsk522
  v_sub_f32 v234, v128, v232
  v_mul_f32 v234, s74, v234
  v_exp_f32 v234, v234
  v_mov_b32 v128, v232
  RESC 104, 234
  v_mul_f32 v129, v234, v129
Lsk522:
  v_mul_f32 v233, s74, v128
  v_fma_f32 v235, v226, s74, -v233
  v_fma_f32 v236, v229, s74, -v233
  v_exp_f32 v235, v235
  v_exp_f32 v236, v236
  v_cvt_pk_bf16_f32 v238, v235, 0
  v_cvt_pk_bf16_f32 v239, 0, v235
  v_cvt_pk_bf16_f32 v240, v236, 0
  v_cvt_pk_bf16_f32 v241, 0, v236
  v_add_f32 v129, v129, v239
  v_add_f32 v129, v129, v241
  s_waitcnt vmcnt(9)
  PV 8, 238, 104
  s_mov_b32 s76, 0x12c00
  LDT v, 8, 48
  s_waitcnt vmcnt(9)
  PV 32, 240, 104
  s_mov_b32 s76, 0x13800
  LDT v, 32, 48
  s_waitcnt vmcnt(9)
  v_dot2_f32_bf16 v226, v20, v80, 0
  v_dot2_f32_bf16 v227, v24, v84, 0
  v_dot2_f32_bf16 v228, v28, v88, 0
  s_nop 0
  v_dot2c_f32_bf16 v226, v21, v81
  v_dot2c_f32_bf16 v227, v25, v85
  v_dot2c_f32_bf16 v228, v29, v89
  v_dot2c_f32_bf16 v226, v22, v82
  v_dot2c_f32_bf16 v227, v26, v86
  v_dot2c_f32_bf16 v228, v30, v90
  v_dot2c_f32_bf16 v226, v23, v83
  v_dot2c_f32_bf16 v227, v27, v87
  v_dot2c_f32_bf16 v228, v31, v91
  s_mov_b32 s76, 0x12c00
  LDT v, 20, 52
  v_add_f32 v226, v226, v227
  v_add_f32 v226, v226, v228
  s_nop 1
  v_add_f32_dpp v226, v226, v226 quad_perm:[1,0,3,2] row_mask:0xf bank_mask:0xf
  s_nop 1
  v_add_f32_dpp v226, v226, v226 quad_perm:[2,3,0,1] row_mask:0xf bank_mask:0xf
  s_nop 1
  v_add_f32_dpp v226, v226, v226 row_half_mirror row_mask:0xf bank_mask:0xf
  v_add_f32 v226, s81, v226
  v_max_f32 v232, v128, v226
  v_cmp_gt_f32 vcc, v232, v128
  s_cbranch_vccz Lsk523
  v_sub_f32 v234, v128, v232
  v_mul_f32 v234, s74, v234
  v_exp_f32 v234, v234
  v_mov_b32 v128, v232
  RESC 104, 234
  v_mul_f32 v129, v234, v129
Lsk523:
  v_mul_f32 v233, s74, v128
  v_fma_f32 v235, v226, s74, -v233
  v_exp_f32 v235, v235
  s_nop 0
  v_cvt_pk_bf16_f32 v238, v235, 0
  v_cvt_pk_bf16_f32 v239, 0, v235
  v_add_f32 v129, v129, v239
  s_waitcnt vmcnt(9)
  PV 44, 238, 104
  s_mov_b32 s76, 0x13800
  LDT v, 44, 52
  v_max_f32_dpp v226, v128, v128 row_ror:8 row_mask:0xf bank_mask:0xf
  v_mov_b32 v227, v226
  s_nop 1
  v_permlane16_swap_b32 v226, v227
  v_max_f32 v226, v226, v227
  v_mov_b32 v227, v226
  s_nop 1
  v_permlane32_swap_b32 v226, v227
  v_max_f32 v226, v226, v227
  v_sub_f32 v228, v128, v226
  v_mul_f32 v228, s74, v228
  v_exp_f32 v228, v228
  v_mul_f32 v226, s74, v226
  RESC 104, 228
  v_mul_f32 v129, v228, v129
  s_nop 1
  v_add_f32_dpp v129, v129, v129 row_ror:8 row_mask:0xf bank_mask:0xf
  v_mov_b32 v227, v129
  s_nop 1
  v_permlane16_swap_b32 v129, v227
  v_add_f32 v129, v129, v227
  v_mov_b32 v227, v129
  s_nop 1
  v_permlane32_swap_b32 v129, v227
  v_add_f32 v129, v129, v227
  v_permlane32_swap_b32 v104, v116
  v_permlane32_swap_b32 v105, v117
  v_permlane32_swap_b32 v106, v118
  v_permlane32_swap_b32 v107, v119
  v_permlane32_swap_b32 v108, v120
  v_permlane32_swap_b32 v109, v121
  v_permlane32_swap_b32 v110, v122
  v_permlane32_swap_b32 v111, v123
  v_permlane32_swap_b32 v112, v124
  v_permlane32_swap_b32 v113, v125
  v_permlane32_swap_b32 v114, v126
  v_permlane32_swap_b32 v115, v127
  v_add_f32 v104, v104, v116
  v_add_f32 v105, v105, v117
  v_add_f32 v106, v106, v118
  v_add_f32 v107, v107, v119
  v_add_f32 v108, v108, v120
  v_add_f32 v109, v109, v121
  v_add_f32 v110, v110, v122
  v_add_f32 v111, v111, v123
  v_add_f32 v112, v112, v124
  v_add_f32 v113, v113, v125
  v_add_f32 v114, v114, v126
  v_add_f32 v115, v115, v127
  v_permlane16_swap_b32 v104, v110
  v_permlane16_swap_b32 v105, v111
  v_permlane16_swap_b32 v106, v112
  v_permlane16_swap_b32 v107, v113
  v_permlane16_swap_b32 v108, v114
  v_permlane16_swap_b32 v109, v115
  v_add_f32 v104, v104, v110
  v_add_f32 v105, v105, v111
  v_add_f32 v106, v106, v112
  v_add_f32 v107, v107, v113
  v_add_f32 v108, v108, v114
  v_add_f32 v109, v109, v115
  v_add_f32_dpp v104, v104, v104 row_ror:8 row_mask:0xf bank_mask:0xf
  v_add_f32_dpp v105, v105, v105 row_ror:8 row_mask:0xf bank_mask:0xf
  v_add_f32_dpp v106, v106, v106 row_ror:8 row_mask:0xf bank_mask:0xf
  v_add_f32_dpp v107, v107, v107 row_ror:8 row_mask:0xf bank_mask:0xf
  v_add_f32_dpp v108, v108, v108 row_ror:8 row_mask:0xf bank_mask:0xf
  v_add_f32_dpp v109, v109, v109 row_ror:8 row_mask:0xf bank_mask:0xf
  v_add_u32 v229, 0, v7
  v_lshrrev_b32 v230, 3, v229
  v_and_b32 v229, 7, v229
  v_lshlrev_b32 v230, 6, v230
  v_add_u32 v229, v229, v230
  v_lshl_add_u32 v229, v229, 2, v4
  ds_write_b32 v229, v104
  v_add_u32 v229, 1, v7
  v_lshrrev_b32 v230, 3, v229
  v_and_b32 v229, 7, v229
  v_lshlrev_b32 v230, 6, v230
  v_add_u32 v229, v229, v230
  v_lshl_add_u32 v229, v229, 2, v4
  ds_write_b32 v229, v105
  v_add_u32 v229, 2, v7
  v_lshrrev_b32 v230, 3, v229
  v_and_b32 v229, 7, v229
  v_lshlrev_b32 v230, 6, v230
  v_add_u32 v229, v229, v230
  v_lshl_add_u32 v229, v229, 2, v4
  ds_write_b32 v229, v106
  v_add_u32 v229, 3, v7
  v_lshrrev_b32 v230, 3, v229
  v_and_b32 v229, 7, v229
  v_lshlrev_b32 v230, 6, v230
  v_add_u32 v229, v229, v230
  v_lshl_add_u32 v229, v229, 2, v4
  ds_write_b32 v229, v107
  v_add_u32 v229, 4, v7
  v_lshrrev_b32 v230, 3, v229
  v_and_b32 v229, 7, v229
  v_lshlrev_b32 v230, 6, v230
  v_add_u32 v229, v229, v230
  v_lshl_add_u32 v229, v229, 2, v4
  ds_write_b32 v229, v108
  v_add_u32 v229, 5, v7
  v_lshrrev_b32 v230, 3, v229
  v_and_b32 v229, 7, v229
  v_lshlrev_b32 v230, 6, v230
  v_add_u32 v229, v229, v230
  v_lshl_add_u32 v229, v229, 2, v4
  ds_write_b32 v229, v109
  v_mov_b32 v234, v226
  v_mov_b32 v235, v129
  v_mov_b32 v236, 0
  v_mov_b32 v237, 0
  v_and_b32 v229, 0xffffff1f, v4
  ds_write_b128 v229, v[234:237] offset:768
  s_waitcnt lgkmcnt(0)
  ds_read_b128 v[234:237], v5
  s_waitcnt lgkmcnt(0)
  s_add_u32 s76, s73, 0x8b5800
  s_mov_b32 exec_lo, -1
  s_mov_b32 exec_hi, 0x1ffff
  buffer_store_dwordx4 v[234:237], v6, s[64:67], s76 offen sc1
  s_mov_b64 exec, -1
  v_max3_u32 v226, v92, v93, v94
  v_max3_u32 v226, v226, v95, v96
  v_max3_u32 v226, v226, v97, v98
  v_max3_u32 v226, v226, v99, v100
  v_max3_u32 v226, v226, v101, v102
  v_max3_u32 v226, v226, v103, v103
  v_cmp_eq_u32 vcc, -1, v226
  s_cbranch_vccz Lqo524
  s_mov_b32 s75, 0x61a80
Lqr525:
  s_sleep 2
  s_add_u32 s77, s72, 0x12000
  buffer_load_dwordx4 v[92:95], v2, s[64:67], s77 offen sc1
  buffer_load_dwordx4 v[96:99], v2, s[64:67], s77 offen offset:128 sc1
  buffer_load_dwordx4 v[100:103], v2, s[64:67], s77 offen offset:256 sc1
  s_waitcnt vmcnt(0)
  v_max3_u32 v226, v92, v93, v94
  v_max3_u32 v226, v226, v95, v96
  v_max3_u32 v226, v226, v97, v98
  v_max3_u32 v226, v226, v99, v100
  v_max3_u32 v226, v226, v101, v102
  v_max3_u32 v226, v226, v103, v103
  v_cmp_eq_u32 vcc, -1, v226
  s_cbranch_vccz Lqo524
  s_sub_u32 s75, s75, 1
  s_cmp_lg_u32 s75, 0
  s_cbranch_scc1 Lqr525
Lqo524:
  v_mov_b32 v80, v92
  v_mov_b32 v81, v93
  v_mov_b32 v82, v94
  v_mov_b32 v83, v95
  v_mov_b32 v84, v96
  v_mov_b32 v85, v97
  v_mov_b32 v86, v98
  v_mov_b32 v87, v99
  v_mov_b32 v88, v100
  v_mov_b32 v89, v101
  v_mov_b32 v90, v102
  v_mov_b32 v91, v103
  v_mov_b32 v104, 0
  v_mov_b32 v105, 0
  v_mov_b32 v106, 0
  v_mov_b32 v107, 0
  v_mov_b32 v108, 0
  v_mov_b32 v109, 0
  v_mov_b32 v110, 0
  v_mov_b32 v111, 0
  v_mov_b32 v112, 0
  v_mov_b32 v113, 0
  v_mov_b32 v114, 0
  v_mov_b32 v115, 0
  v_mov_b32 v116, 0
  v_mov_b32 v117, 0
  v_mov_b32 v118, 0
  v_mov_b32 v119, 0
  v_mov_b32 v120, 0
  v_mov_b32 v121, 0
  v_mov_b32 v122, 0
  v_mov_b32 v123, 0
  v_mov_b32 v124, 0
  v_mov_b32 v125, 0
  v_mov_b32 v126, 0
  v_mov_b32 v127, 0
  v_mov_b32 v128, 0xf149f2ca
  v_mov_b32 v129, 0
  s_waitcnt vmcnt(10)
  s_waitcnt vmcnt(7)
  QK2 8, 32, 80, 226
  s_mov_b32 s76, 0x14400
  LDT v, 8, 48
  s_mov_b32 s76, 0x15000
  LDT v, 32, 48
  v_add_f32 v226, v226, v227
  v_add_f32 v226, v226, v228
  v_add_f32 v229, v229, v230
  v_add_f32 v229, v229, v231
  v_add_f32_dpp v226, v226, v226 quad_perm:[1,0,3,2] row_mask:0xf bank_mask:0xf
  s_nop 0
  v_add_f32_dpp v229, v229, v229 quad_perm:[1,0,3,2] row_mask:0xf bank_mask:0xf
  v_add_f32_dpp v226, v226, v226 quad_perm:[2,3,0,1] row_mask:0xf bank_mask:0xf
  s_nop 0
  v_add_f32_dpp v229, v229, v229 quad_perm:[2,3,0,1] row_mask:0xf bank_mask:0xf
  v_add_f32_dpp v226, v226, v226 row_half_mirror row_mask:0xf bank_mask:0xf
  s_nop 0
  v_add_f32_dpp v229, v229, v229 row_half_mirror row_mask:0xf bank_mask:0xf
  v_max3_f32 v232, v128, v226, v229
  v_cmp_gt_f32 vcc, v232, v128
  s_cbranch_vccz Lsk526
  v_sub_f32 v234, v128, v232
  v_mul_f32 v234, s74, v234
  v_exp_f32 v234, v234
  v_mov_b32 v128, v232
  RESC 104, 234
  v_mul_f32 v129, v234, v129
Lsk526:
  v_mul_f32 v233, s74, v128
  v_fma_f32 v235, v226, s74, -v233
  v_fma_f32 v236, v229, s74, -v233
  v_exp_f32 v235, v235
  v_exp_f32 v236, v236
  v_cvt_pk_bf16_f32 v238, v235, 0
  v_cvt_pk_bf16_f32 v239, 0, v235
  v_cvt_pk_bf16_f32 v240, v236, 0
  v_cvt_pk_bf16_f32 v241, 0, v236
  v_add_f32 v129, v129, v239
  v_add_f32 v129, v129, v241
  s_waitcnt vmcnt(10)
  PV 20, 238, 104
  s_mov_b32 s76, 0x14400
  LDT v, 20, 52
  s_waitcnt vmcnt(10)
  PV 44, 240, 104
  s_mov_b32 s76, 0x15000
  LDT v, 44, 52
  s_waitcnt vmcnt(9)
  s_waitcnt vmcnt(6)
  QK2 8, 32, 80, 226
  s_mov_b32 s76, 0x15c00
  LDT v, 8, 48
  s_mov_b32 s76, 0x16800
  LDT v, 32, 48
  v_add_f32 v226, v226, v227
  v_add_f32 v226, v226, v228
  v_add_f32 v229, v229, v230
  v_add_f32 v229, v229, v231
  v_add_f32_dpp v226, v226, v226 quad_perm:[1,0,3,2] row_mask:0xf bank_mask:0xf
  s_nop 0
  v_add_f32_dpp v229, v229, v229 quad_perm:[1,0,3,2] row_mask:0xf bank_mask:0xf
  v_add_f32_dpp v226, v226, v226 quad_perm:[2,3,0,1] row_mask:0xf bank_mask:0xf
  s_nop 0
  v_add_f32_dpp v229, v229, v229 quad_perm:[2,3,0,1] row_mask:0xf bank_mask:0xf
  v_add_f32_dpp v226, v226, v226 row_half_mirror row_mask:0xf bank_mask:0xf
  s_nop 0
  v_add_f32_dpp v229, v229, v229 row_half_mirror row_mask:0xf bank_mask:0xf
  v_max3_f32 v232, v128, v226, v229
  v_cmp_gt_f32 vcc, v232, v128
  s_cbranch_vccz Lsk527
  v_sub_f32 v234, v128, v232
  v_mul_f32 v234, s74, v234
  v_exp_f32 v234, v234
  v_mov_b32 v128, v232
  RESC 104, 234
  v_mul_f32 v129, v234, v129
Lsk527:
  v_mul_f32 v233, s74, v128
  v_fma_f32 v235, v226, s74, -v233
  v_fma_f32 v236, v229, s74, -v233
  v_exp_f32 v235, v235
  v_exp_f32 v236, v236
  v_cvt_pk_bf16_f32 v238, v235, 0
  v_cvt_pk_bf16_f32 v239, 0, v235
  v_cvt_pk_bf16_f32 v240, v236, 0
  v_cvt_pk_bf16_f32 v241, 0, v236
  v_add_f32 v129, v129, v239
  v_add_f32 v129, v129, v241
  s_waitcnt vmcnt(9)
  PV 20, 238, 104
  s_mov_b32 s76, 0x15c00
  LDT v, 20, 52
  s_waitcnt vmcnt(9)
  PV 44, 240, 104
  s_mov_b32 s76, 0x16800
  LDT v, 44, 52
  s_waitcnt vmcnt(9)
  s_waitcnt vmcnt(6)
  QK2 8, 32, 80, 226
  s_mov_b32 s76, 0x17400
  LDT v, 8, 48
  s_mov_b32 s76, 0x18000
  LDT v, 32, 48
  v_add_f32 v226, v226, v227
  v_add_f32 v226, v226, v228
  v_add_f32 v229, v229, v230
  v_add_f32 v229, v229, v231
  v_add_f32_dpp v226, v226, v226 quad_perm:[1,0,3,2] row_mask:0xf bank_mask:0xf
  s_nop 0
  v_add_f32_dpp v229, v229, v229 quad_perm:[1,0,3,2] row_mask:0xf bank_mask:0xf
  v_add_f32_dpp v226, v226, v226 quad_perm:[2,3,0,1] row_mask:0xf bank_mask:0xf
  s_nop 0
  v_add_f32_dpp v229, v229, v229 quad_perm:[2,3,0,1] row_mask:0xf bank_mask:0xf
  v_add_f32_dpp v226, v226, v226 row_half_mirror row_mask:0xf bank_mask:0xf
  s_nop 0
  v_add_f32_dpp v229, v229, v229 row_half_mirror row_mask:0xf bank_mask:0xf
  v_max3_f32 v232, v128, v226, v229
  v_cmp_gt_f32 vcc, v232, v128
  s_cbranch_vccz Lsk528
  v_sub_f32 v234, v128, v232
  v_mul_f32 v234, s74, v234
  v_exp_f32 v234, v234
  v_mov_b32 v128, v232
  RESC 104, 234
  v_mul_f32 v129, v234, v129
Lsk528:
  v_mul_f32 v233, s74, v128
  v_fma_f32 v235, v226, s74, -v233
  v_fma_f32 v236, v229, s74, -v233
  v_exp_f32 v235, v235
  v_exp_f32 v236, v236
  v_cvt_pk_bf16_f32 v238, v235, 0
  v_cvt_pk_bf16_f32 v239, 0, v235
  v_cvt_pk_bf16_f32 v240, v236, 0
  v_cvt_pk_bf16_f32 v241, 0, v236
  v_add_f32 v129, v129, v239
  v_add_f32 v129, v129, v241
  s_waitcnt vmcnt(9)
  PV 20, 238, 104
  s_mov_b32 s76, 0x17400
  LDT v, 20, 52
  s_waitcnt vmcnt(9)
  PV 44, 240, 104
  s_mov_b32 s76, 0x18000
  LDT v, 44, 52
  s_waitcnt vmcnt(9)
  s_waitcnt vmcnt(6)
  QK2 8, 32, 80, 226
  s_mov_b32 s76, 0x18c00
  LDT v, 8, 48
  s_mov_b32 s76, 0x19800
  LDT v, 32, 48
  v_add_f32 v226, v226, v227
  v_add_f32 v226, v226, v228
  v_add_f32 v229, v229, v230
  v_add_f32 v229, v229, v231
  v_add_f32_dpp v226, v226, v226 quad_perm:[1,0,3,2] row_mask:0xf bank_mask:0xf
  s_nop 0
  v_add_f32_dpp v229, v229, v229 quad_perm:[1,0,3,2] row_mask:0xf bank_mask:0xf
  v_add_f32_dpp v226, v226, v226 quad_perm:[2,3,0,1] row_mask:0xf bank_mask:0xf
  s_nop 0
  v_add_f32_dpp v229, v229, v229 quad_perm:[2,3,0,1] row_mask:0xf bank_mask:0xf
  v_add_f32_dpp v226, v226, v226 row_half_mirror row_mask:0xf bank_mask:0xf
  s_nop 0
  v_add_f32_dpp v229, v229, v229 row_half_mirror row_mask:0xf bank_mask:0xf
  v_max3_f32 v232, v128, v226, v229
  v_cmp_gt_f32 vcc, v232, v128
  s_cbranch_vccz Lsk529
  v_sub_f32 v234, v128, v232
  v_mul_f32 v234, s74, v234
  v_exp_f32 v234, v234
  v_mov_b32 v128, v232
  RESC 104, 234
  v_mul_f32 v129, v234, v129
Lsk529:
  v_mul_f32 v233, s74, v128
  v_fma_f32 v235, v226, s74, -v233
  v_fma_f32 v236, v229, s74, -v233
  v_exp_f32 v235, v235
  v_exp_f32 v236, v236
  v_cvt_pk_bf16_f32 v238, v235, 0
  v_cvt_pk_bf16_f32 v239, 0, v235
  v_cvt_pk_bf16_f32 v240, v236, 0
  v_cvt_pk_bf16_f32 v241, 0, v236
  v_add_f32 v129, v129, v239
  v_add_f32 v129, v129, v241
  s_waitcnt vmcnt(9)
  PV 20, 238, 104
  s_mov_b32 s76, 0x18c00
  LDT v, 20, 52
  s_waitcnt vmcnt(9)
  PV 44, 240, 104
  s_mov_b32 s76, 0x19800
  LDT v, 44, 52
  s_waitcnt vmcnt(9)
  s_waitcnt vmcnt(6)
  QK2 8, 32, 80, 226
  s_mov_b32 s76, 0x1a400
  LDT v, 8, 48
  s_mov_b32 s76, 0x1b000
  LDT v, 32, 48
  v_add_f32 v226, v226, v227
  v_add_f32 v226, v226, v228
  v_add_f32 v229, v229, v230
  v_add_f32 v229, v229, v231
  v_add_f32_dpp v226, v226, v226 quad_perm:[1,0,3,2] row_mask:0xf bank_mask:0xf
  s_nop 0
  v_add_f32_dpp v229, v229, v229 quad_perm:[1,0,3,2] row_mask:0xf bank_mask:0xf
  v_add_f32_dpp v226, v226, v226 quad_perm:[2,3,0,1] row_mask:0xf bank_mask:0xf
  s_nop 0
  v_add_f32_dpp v229, v229, v229 quad_perm:[2,3,0,1] row_mask:0xf bank_mask:0xf
  v_add_f32_dpp v226, v226, v226 row_half_mirror row_mask:0xf bank_mask:0xf
  s_nop 0
  v_add_f32_dpp v229, v229, v229 row_half_mirror row_mask:0xf bank_mask:0xf
  v_max3_f32 v232, v128, v226, v229
  v_cmp_gt_f32 vcc, v232, v128
  s_cbranch_vccz Lsk530
  v_sub_f32 v234, v128, v232
  v_mul_f32 v234, s74, v234
  v_exp_f32 v234, v234
  v_mov_b32 v128, v232
  RESC 104, 234
  v_mul_f32 v129, v234, v129
Lsk530:
  v_mul_f32 v233, s74, v128
  v_fma_f32 v235, v226, s74, -v233
  v_fma_f32 v236, v229, s74, -v233
  v_exp_f32 v235, v235
  v_exp_f32 v236, v236
  v_cvt_pk_bf16_f32 v238, v235, 0
  v_cvt_pk_bf16_f32 v239, 0, v235
  v_cvt_pk_bf16_f32 v240, v236, 0
  v_cvt_pk_bf16_f32 v241, 0, v236
  v_add_f32 v129, v129, v239
  v_add_f32 v129, v129, v241
  s_waitcnt vmcnt(9)
  PV 20, 238, 104
  s_mov_b32 s76, 0x1a400
  LDT v, 20, 52
  s_waitcnt vmcnt(9)
  PV 44, 240, 104
  s_mov_b32 s76, 0x1b000
  LDT v, 44, 52
  s_add_u32 s76, s72, 0x15000
  buffer_load_dwordx4 v[92:95], v2, s[64:67], s76 offen sc1
  buffer_load_dwordx4 v[96:99], v2, s[64:67], s76 offen offset:128 sc1
  buffer_load_dwordx4 v[100:103], v2, s[64:67], s76 offen offset:256 sc1
  s_waitcnt vmcnt(12)
  s_waitcnt vmcnt(9)
  QK2 8, 32, 80, 226
  s_mov_b32 s76, 0x1bc00
  LDT v, 8, 48
  s_mov_b32 s76, 0x1c800
  LDT v, 32, 48
  v_add_f32 v226, v226, v227
  v_add_f32 v226, v226, v228
  v_add_f32 v229, v229, v230
  v_add_f32 v229, v229, v231
  v_add_f32_dpp v226, v226, v226 quad_perm:[1,0,3,2] row_mask:0xf bank_mask:0xf
  s_nop 0
  v_add_f32_dpp v229, v229, v229 quad_perm:[1,0,3,2] row_mask:0xf bank_mask:0xf
  v_add_f32_dpp v226, v226, v226 quad_perm:[2,3,0,1] row_mask:0xf bank_mask:0xf
  s_nop 0
  v_add_f32_dpp v229, v229, v229 quad_perm:[2,3,0,1] row_mask:0xf bank_mask:0xf
  v_add_f32_dpp v226, v226, v226 row_half_mirror row_mask:0xf bank_mask:0xf
  s_nop 0
  v_add_f32_dpp v229, v229, v229 row_half_mirror row_mask:0xf bank_mask:0xf
  v_max3_f32 v232, v128, v226, v229
  v_cmp_gt_f32 vcc, v232, v128
  s_cbranch_vccz Lsk531
  v_sub_f32 v234, v128, v232
  v_mul_f32 v234, s74, v234
  v_exp_f32 v234, v234
  v_mov_b32 v128, v232
  RESC 104, 234
  v_mul_f32 v129, v234, v129
Lsk531:
  v_mul_f32 v233, s74, v128
  v_fma_f32 v235, v226, s74, -v233
  v_fma_f32 v236, v229, s74, -v233
  v_exp_f32 v235, v235
  v_exp_f32 v236, v236
  v_cvt_pk_bf16_f32 v238, v235, 0
  v_cvt_pk_bf16_f32 v239, 0, v235
  v_cvt_pk_bf16_f32 v240, v236, 0
  v_cvt_pk_bf16_f32 v241, 0, v236
  v_add_f32 v129, v129, v239
  v_add_f32 v129, v129, v241
  s_waitcnt vmcnt(12)
  PV 20, 238, 104
  s_mov_b32 s76, 0x1bc00
  LDT v, 20, 52
  s_waitcnt vmcnt(12)
  PV 44, 240, 104
  s_mov_b32 s76, 0x1c800
  LDT v, 44, 52
  s_waitcnt vmcnt(9)
  s_waitcnt vmcnt(6)
  QK2 8, 32, 80, 226
  s_mov_b32 s76, 0x1d400
  LDT v, 8, 48
  s_mov_b32 s76, 0x1d400
  LDT v, 32, 52
  v_add_f32 v226, v226, v227
  v_add_f32 v226, v226, v228
  v_add_f32 v229, v229, v230
  v_add_f32 v229, v229, v231
  v_add_f32_dpp v226, v226, v226 quad_perm:[1,0,3,2] row_mask:0xf bank_mask:0xf
  s_nop 0
  v_add_f32_dpp v229, v229, v229 quad_perm:[1,0,3,2] row_mask:0xf bank_mask:0xf
  v_add_f32_dpp v226, v226, v226 quad_perm:[2,3,0,1] row_mask:0xf bank_mask:0xf
  s_nop 0
  v_add_f32_dpp v229, v229, v229 quad_perm:[2,3,0,1] row_mask:0xf bank_mask:0xf
  v_add_f32_dpp v226, v226, v226 row_half_mirror row_mask:0xf bank_mask:0xf
  s_nop 0
  v_add_f32_dpp v229, v229, v229 row_half_mirror row_mask:0xf bank_mask:0xf
  v_max3_f32 v232, v128, v226, v229
  v_cmp_gt_f32 vcc, v232, v128
  s_cbranch_vccz Lsk532
  v_sub_f32 v234, v128, v232
  v_mul_f32 v234, s74, v234
  v_exp_f32 v234, v234
  v_mov_b32 v128, v232
  RESC 104, 234
  v_mul_f32 v129, v234, v129
Lsk532:
  v_mul_f32 v233, s74, v128
  v_fma_f32 v235, v226, s74, -v233
  v_fma_f32 v236, v229, s74, -v233
  v_exp_f32 v235, v235
  v_exp_f32 v236, v236
  v_cvt_pk_bf16_f32 v238, v235, 0
  v_cvt_pk_bf16_f32 v239, 0, v235
  v_cvt_pk_bf16_f32 v240, v236, 0
  v_cvt_pk_bf16_f32 v241, 0, v236
  v_add_f32 v129, v129, v239
  v_add_f32 v129, v129, v241
  s_waitcnt vmcnt(9)
  PV 20, 238, 104
  s_mov_b32 s76, 0xfc00
  LDT v, 20, 56
  s_waitcnt vmcnt(9)
  PV 44, 240, 104
  s_mov_b32 s76, 0x10800
  LDT v, 44, 56
  s_waitcnt vmcnt(9)
  v_dot2_f32_bf16 v226, v8, v80, 0
  v_dot2_f32_bf16 v227, v12, v84, 0
  v_dot2_f32_bf16 v228, v16, v88, 0
  s_nop 0
  v_dot2c_f32_bf16 v226, v9, v81
  v_dot2c_f32_bf16 v227, v13, v85
  v_dot2c_f32_bf16 v228, v17, v89
  v_dot2c_f32_bf16 v226, v10, v82
  v_dot2c_f32_bf16 v227, v14, v86
  v_dot2c_f32_bf16 v228, v18, v90
  v_dot2c_f32_bf16 v226, v11, v83
  v_dot2c_f32_bf16 v227, v15, v87
  v_dot2c_f32_bf16 v228, v19, v91
  s_mov_b32 s76, 0xfc00
  LDT v, 8, 60
  v_add_f32 v226, v226, v227
  v_add_f32 v226, v226, v228
  s_nop 1
  v_add_f32_dpp v226, v226, v226 quad_perm:[1,0,3,2] row_mask:0xf bank_mask:0xf
  s_nop 1
  v_add_f32_dpp v226, v226, v226 quad_perm:[2,3,0,1] row_mask:0xf bank_mask:0xf
  s_nop 1
  v_add_f32_dpp v226, v226, v226 row_half_mirror row_mask:0xf bank_mask:0xf
  v_add_f32 v226, s82, v226
  v_max_f32 v232, v128, v226
  v_cmp_gt_f32 vcc, v232, v128
  s_cbranch_vccz Lsk533
  v_sub_f32 v234, v128, v232
  v_mul_f32 v234, s74, v234
  v_exp_f32 v234, v234
  v_mov_b32 v128, v232
  RESC 104, 234
  v_mul_f32 v129, v234, v129
Lsk533:
  v_mul_f32 v233, s74, v128
  v_fma_f32 v235, v226, s74, -v233
  v_exp_f32 v235, v235
  s_nop 0
  v_cvt_pk_bf16_f32 v238, v235, 0
  v_cvt_pk_bf16_f32 v239, 0, v235
  v_add_f32 v129, v129, v239
  s_waitcnt vmcnt(9)
  PV 32, 238, 104
  s_mov_b32 s76, 0x10800
  LDT v, 32, 60
  v_max_f32_dpp v226, v128, v128 row_ror:8 row_mask:0xf bank_mask:0xf
  v_mov_b32 v227, v226
  s_nop 1
  v_permlane16_swap_b32 v226, v227
  v_max_f32 v226, v226, v227
  v_mov_b32 v227, v226
  s_nop 1
  v_permlane32_swap_b32 v226, v227
  v_max_f32 v226, v226, v227
  v_sub_f32 v228, v128, v226
  v_mul_f32 v228, s74, v228
  v_exp_f32 v228, v228
  v_mul_f32 v226, s74, v226
  RESC 104, 228
  v_mul_f32 v129, v228, v129
  s_nop 1
  v_add_f32_dpp v129, v129, v129 row_ror:8 row_mask:0xf bank_mask:0xf
  v_mov_b32 v227, v129
  s_nop 1
  v_permlane16_swap_b32 v129, v227
  v_add_f32 v129, v129, v227
  v_mov_b32 v227, v129
  s_nop 1
  v_permlane32_swap_b32 v129, v227
  v_add_f32 v129, v129, v227
  v_permlane32_swap_b32 v104, v116
  v_permlane32_swap_b32 v105, v117
  v_permlane32_swap_b32 v106, v118
  v_permlane32_swap_b32 v107, v119
  v_permlane32_swap_b32 v108, v120
  v_permlane32_swap_b32 v109, v121
  v_permlane32_swap_b32 v110, v122
  v_permlane32_swap_b32 v111, v123
  v_permlane32_swap_b32 v112, v124
  v_permlane32_swap_b32 v113, v125
  v_permlane32_swap_b32 v114, v126
  v_permlane32_swap_b32 v115, v127
  v_add_f32 v104, v104, v116
  v_add_f32 v105, v105, v117
  v_add_f32 v106, v106, v118
  v_add_f32 v107, v107, v119
  v_add_f32 v108, v108, v120
  v_add_f32 v109, v109, v121
  v_add_f32 v110, v110, v122
  v_add_f32 v111, v111, v123
  v_add_f32 v112, v112, v124
  v_add_f32 v113, v113, v125
  v_add_f32 v114, v114, v126
  v_add_f32 v115, v115, v127
  v_permlane16_swap_b32 v104, v110
  v_permlane16_swap_b32 v105, v111
  v_permlane16_swap_b32 v106, v112
  v_permlane16_swap_b32 v107, v113
  v_permlane16_swap_b32 v108, v114
  v_permlane16_swap_b32 v109, v115
  v_add_f32 v104, v104, v110
  v_add_f32 v105, v105, v111
  v_add_f32 v106, v106, v112
  v_add_f32 v107, v107, v113
  v_add_f32 v108, v108, v114
  v_add_f32 v109, v109, v115
  v_add_f32_dpp v104, v104, v104 row_ror:8 row_mask:0xf bank_mask:0xf
  v_add_f32_dpp v105, v105, v105 row_ror:8 row_mask:0xf bank_mask:0xf
  v_add_f32_dpp v106, v106, v106 row_ror:8 row_mask:0xf bank_mask:0xf
  v_add_f32_dpp v107, v107, v107 row_ror:8 row_mask:0xf bank_mask:0xf
  v_add_f32_dpp v108, v108, v108 row_ror:8 row_mask:0xf bank_mask:0xf
  v_add_f32_dpp v109, v109, v109 row_ror:8 row_mask:0xf bank_mask:0xf
  v_add_u32 v229, 0, v7
  v_lshrrev_b32 v230, 3, v229
  v_and_b32 v229, 7, v229
  v_lshlrev_b32 v230, 6, v230
  v_add_u32 v229, v229, v230
  v_lshl_add_u32 v229, v229, 2, v4
  ds_write_b32 v229, v104
  v_add_u32 v229, 1, v7
  v_lshrrev_b32 v230, 3, v229
  v_and_b32 v229, 7, v229
  v_lshlrev_b32 v230, 6, v230
  v_add_u32 v229, v229, v230
  v_lshl_add_u32 v229, v229, 2, v4
  ds_write_b32 v229, v105
  v_add_u32 v229, 2, v7
  v_lshrrev_b32 v230, 3, v229
  v_and_b32 v229, 7, v229
  v_lshlrev_b32 v230, 6, v230
  v_add_u32 v229, v229, v230
  v_lshl_add_u32 v229, v229, 2, v4
  ds_write_b32 v229, v106
  v_add_u32 v229, 3, v7
  v_lshrrev_b32 v230, 3, v229
  v_and_b32 v229, 7, v229
  v_lshlrev_b32 v230, 6, v230
  v_add_u32 v229, v229, v230
  v_lshl_add_u32 v229, v229, 2, v4
  ds_write_b32 v229, v107
  v_add_u32 v229, 4, v7
  v_lshrrev_b32 v230, 3, v229
  v_and_b32 v229, 7, v229
  v_lshlrev_b32 v230, 6, v230
  v_add_u32 v229, v229, v230
  v_lshl_add_u32 v229, v229, 2, v4
  ds_write_b32 v229, v108
  v_add_u32 v229, 5, v7
  v_lshrrev_b32 v230, 3, v229
  v_and_b32 v229, 7, v229
  v_lshlrev_b32 v230, 6, v230
  v_add_u32 v229, v229, v230
  v_lshl_add_u32 v229, v229, 2, v4
  ds_write_b32 v229, v109
  v_mov_b32 v234, v226
  v_mov_b32 v235, v129
  v_mov_b32 v236, 0
  v_mov_b32 v237, 0
  v_and_b32 v229, 0xffffff1f, v4
  ds_write_b128 v229, v[234:237] offset:768
  s_waitcnt lgkmcnt(0)
  ds_read_b128 v[234:237], v5
  s_waitcnt lgkmcnt(0)
  s_add_u32 s76, s73, 0x954c00
  s_mov_b32 exec_lo, -1
  s_mov_b32 exec_hi, 0x1ffff
  buffer_store_dwordx4 v[234:237], v6, s[64:67], s76 offen sc1
  s_mov_b64 exec, -1
  v_max3_u32 v226, v92, v93, v94
  v_max3_u32 v226, v226, v95, v96
  v_max3_u32 v226, v226, v97, v98
  v_max3_u32 v226, v226, v99, v100
  v_max3_u32 v226, v226, v101, v102
  v_max3_u32 v226, v226, v103, v103
  v_cmp_eq_u32 vcc, -1, v226
  s_cbranch_vccz Lqo534
  s_mov_b32 s75, 0x61a80
Lqr535:
  s_sleep 2
  s_add_u32 s77, s72, 0x15000
  buffer_load_dwordx4 v[92:95], v2, s[64:67], s77 offen sc1
  buffer_load_dwordx4 v[96:99], v2, s[64:67], s77 offen offset:128 sc1
  buffer_load_dwordx4 v[100:103], v2, s[64:67], s77 offen offset:256 sc1
  s_waitcnt vmcnt(0)
  v_max3_u32 v226, v92, v93, v94
  v_max3_u32 v226, v226, v95, v96
  v_max3_u32 v226, v226, v97, v98
  v_max3_u32 v226, v226, v99, v100
  v_max3_u32 v226, v226, v101, v102
  v_max3_u32 v226, v226, v103, v103
  v_cmp_eq_u32 vcc, -1, v226
  s_cbranch_vccz Lqo534
  s_sub_u32 s75, s75, 1
  s_cmp_lg_u32 s75, 0
  s_cbranch_scc1 Lqr535
Lqo534:
  v_mov_b32 v80, v92
  v_mov_b32 v81, v93
  v_mov_b32 v82, v94
  v_mov_b32 v83, v95
  v_mov_b32 v84, v96
  v_mov_b32 v85, v97
  v_mov_b32 v86, v98
  v_mov_b32 v87, v99
  v_mov_b32 v88, v100
  v_mov_b32 v89, v101
  v_mov_b32 v90, v102
  v_mov_b32 v91, v103
  v_mov_b32 v104, 0
  v_mov_b32 v105, 0
  v_mov_b32 v106, 0
  v_mov_b32 v107, 0
  v_mov_b32 v108, 0
  v_mov_b32 v109, 0
  v_mov_b32 v110, 0
  v_mov_b32 v111, 0
  v_mov_b32 v112, 0
  v_mov_b32 v113, 0
  v_mov_b32 v114, 0
  v_mov_b32 v115, 0
  v_mov_b32 v116, 0
  v_mov_b32 v117, 0
  v_mov_b32 v118, 0
  v_mov_b32 v119, 0
  v_mov_b32 v120, 0
  v_mov_b32 v121, 0
  v_mov_b32 v122, 0
  v_mov_b32 v123, 0
  v_mov_b32 v124, 0
  v_mov_b32 v125, 0
  v_mov_b32 v126, 0
  v_mov_b32 v127, 0
  v_mov_b32 v128, 0xf149f2ca
  v_mov_b32 v129, 0
  s_waitcnt vmcnt(10)
  s_waitcnt vmcnt(7)
  QK2 20, 44, 80, 226
  s_mov_b32 s76, 0x11400
  LDT v, 20, 56
  s_mov_b32 s76, 0x12000
  LDT v, 44, 56
  v_add_f32 v226, v226, v227
  v_add_f32 v226, v226, v228
  v_add_f32 v229, v229, v230
  v_add_f32 v229, v229, v231
  v_add_f32_dpp v226, v226, v226 quad_perm:[1,0,3,2] row_mask:0xf bank_mask:0xf
  s_nop 0
  v_add_f32_dpp v229, v229, v229 quad_perm:[1,0,3,2] row_mask:0xf bank_mask:0xf
  v_add_f32_dpp v226, v226, v226 quad_perm:[2,3,0,1] row_mask:0xf bank_mask:0xf
  s_nop 0
  v_add_f32_dpp v229, v229, v229 quad_perm:[2,3,0,1] row_mask:0xf bank_mask:0xf
  v_add_f32_dpp v226, v226, v226 row_half_mirror row_mask:0xf bank_mask:0xf
  s_nop 0
  v_add_f32_dpp v229, v229, v229 row_half_mirror row_mask:0xf bank_mask:0xf
  v_max3_f32 v232, v128, v226, v229
  v_cmp_gt_f32 vcc, v232, v128
  s_cbranch_vccz Lsk536
  v_sub_f32 v234, v128, v232
  v_mul_f32 v234, s74, v234
  v_exp_f32 v234, v234
  v_mov_b32 v128, v232
  RESC 104, 234
  v_mul_f32 v129, v234, v129
Lsk536:
  v_mul_f32 v233, s74, v128
  v_fma_f32 v235, v226, s74, -v233
  v_fma_f32 v236, v229, s74, -v233
  v_exp_f32 v235, v235
  v_exp_f32 v236, v236
  v_cvt_pk_bf16_f32 v238, v235, 0
  v_cvt_pk_bf16_f32 v239, 0, v235
  v_cvt_pk_bf16_f32 v240, v236, 0
  v_cvt_pk_bf16_f32 v241, 0, v236
  v_add_f32 v129, v129, v239
  v_add_f32 v129, v129, v241
  s_waitcnt vmcnt(10)
  PV 8, 238, 104
  s_mov_b32 s76, 0x11400
  LDT v, 8, 60
  s_waitcnt vmcnt(10)
  PV 32, 240, 104
  s_mov_b32 s76, 0x12000
  LDT v, 32, 60
  s_waitcnt vmcnt(9)
  s_waitcnt vmcnt(6)
  QK2 20, 44, 80, 226
  s_mov_b32 s76, 0x12c00
  LDT v, 20, 56
  s_mov_b32 s76, 0x13800
  LDT v, 44, 56
  v_add_f32 v226, v226, v227
  v_add_f32 v226, v226, v228
  v_add_f32 v229, v229, v230
  v_add_f32 v229, v229, v231
  v_add_f32_dpp v226, v226, v226 quad_perm:[1,0,3,2] row_mask:0xf bank_mask:0xf
  s_nop 0
  v_add_f32_dpp v229, v229, v229 quad_perm:[1,0,3,2] row_mask:0xf bank_mask:0xf
  v_add_f32_dpp v226, v226, v226 quad_perm:[2,3,0,1] row_mask:0xf bank_mask:0xf
  s_nop 0
  v_add_f32_dpp v229, v229, v229 quad_perm:[2,3,0,1] row_mask:0xf bank_mask:0xf
  v_add_f32_dpp v226, v226, v226 row_half_mirror row_mask:0xf bank_mask:0xf
  s_nop 0
  v_add_f32_dpp v229, v229, v229 row_half_mirror row_mask:0xf bank_mask:0xf
  v_max3_f32 v232, v128, v226, v229
  v_cmp_gt_f32 vcc, v232, v128
  s_cbranch_vccz Lsk537
  v_sub_f32 v234, v128, v232
  v_mul_f32 v234, s74, v234
  v_exp_f32 v234, v234
  v_mov_b32 v128, v232
  RESC 104, 234
  v_mul_f32 v129, v234, v129
Lsk537:
  v_mul_f32 v233, s74, v128
  v_fma_f32 v235, v226, s74, -v233
  v_fma_f32 v236, v229, s74, -v233
  v_exp_f32 v235, v235
  v_exp_f32 v236, v236
  v_cvt_pk_bf16_f32 v238, v235, 0
  v_cvt_pk_bf16_f32 v239, 0, v235
  v_cvt_pk_bf16_f32 v240, v236, 0
  v_cvt_pk_bf16_f32 v241, 0, v236
  v_add_f32 v129, v129, v239
  v_add_f32 v129, v129, v241
  s_waitcnt vmcnt(9)
  PV 8, 238, 104
  s_mov_b32 s76, 0x12c00
  LDT v, 8, 60
  s_waitcnt vmcnt(9)
  PV 32, 240, 104
  s_mov_b32 s76, 0x13800
  LDT v, 32, 60
  ACR 56, 0
  ACR 68, 12
  QK2 56, 68, 80, 226
  s_mov_b32 s76, 0x14400
  LDT a, 0, 56
  s_mov_b32 s76, 0x15000
  LDT a, 12, 56
  v_add_f32 v226, v226, v227
  v_add_f32 v226, v226, v228
  v_add_f32 v229, v229, v230
  v_add_f32 v229, v229, v231
  v_add_f32_dpp v226, v226, v226 quad_perm:[1,0,3,2] row_mask:0xf bank_mask:0xf
  s_nop 0
  v_add_f32_dpp v229, v229, v229 quad_perm:[1,0,3,2] row_mask:0xf bank_mask:0xf
  v_add_f32_dpp v226, v226, v226 quad_perm:[2,3,0,1] row_mask:0xf bank_mask:0xf
  s_nop 0
  v_add_f32_dpp v229, v229, v229 quad_perm:[2,3,0,1] row_mask:0xf bank_mask:0xf
  v_add_f32_dpp v226, v226, v226 row_half_mirror row_mask:0xf bank_mask:0xf
  s_nop 0
  v_add_f32_dpp v229, v229, v229 row_half_mirror row_mask:0xf bank_mask:0xf
  v_max3_f32 v232, v128, v226, v229
  v_cmp_gt_f32 vcc, v232, v128
  s_cbranch_vccz Lsk538
  v_sub_f32 v234, v128, v232
  v_mul_f32 v234, s74, v234
  v_exp_f32 v234, v234
  v_mov_b32 v128, v232
  RESC 104, 234
  v_mul_f32 v129, v234, v129
Lsk538:
  v_mul_f32 v233, s74, v128
  v_fma_f32 v235, v226, s74, -v233
  v_fma_f32 v236, v229, s74, -v233
  v_exp_f32 v235, v235
  v_exp_f32 v236, v236
  v_cvt_pk_bf16_f32 v238, v235, 0
  v_cvt_pk_bf16_f32 v239, 0, v235
  v_cvt_pk_bf16_f32 v240, v236, 0
  v_cvt_pk_bf16_f32 v241, 0, v236
  v_add_f32 v129, v129, v239
  v_add_f32 v129, v129, v241
  PV 130, 238, 104
  s_mov_b32 s76, 0x14400
  LDT v, 130, 60
  PV 142, 240, 104
  s_mov_b32 s76, 0x15000
  LDT v, 142, 60
  ACR 56, 24
  ACR 68, 36
  QK2 56, 68, 80, 226
  s_mov_b32 s76, 0x15c00
  LDT a, 24, 56
  s_mov_b32 s76, 0x16800
  LDT a, 36, 56
  v_add_f32 v226, v226, v227
  v_add_f32 v226, v226, v228
  v_add_f32 v229, v229, v230
  v_add_f32 v229, v229, v231
  v_add_f32_dpp v226, v226, v226 quad_perm:[1,0,3,2] row_mask:0xf bank_mask:0xf
  s_nop 0
  v_add_f32_dpp v229, v229, v229 quad_perm:[1,0,3,2] row_mask:0xf bank_mask:0xf
  v_add_f32_dpp v226, v226, v226 quad_perm:[2,3,0,1] row_mask:0xf bank_mask:0xf
  s_nop 0
  v_add_f32_dpp v229, v229, v229 quad_perm:[2,3,0,1] row_mask:0xf bank_mask:0xf
  v_add_f32_dpp v226, v226, v226 row_half_mirror row_mask:0xf bank_mask:0xf
  s_nop 0
  v_add_f32_dpp v229, v229, v229 row_half_mirror row_mask:0xf bank_mask:0xf
  v_max3_f32 v232, v128, v226, v229
  v_cmp_gt_f32 vcc, v232, v128
  s_cbranch_vccz Lsk539
  v_sub_f32 v234, v128, v232
  v_mul_f32 v234, s74, v234
  v_exp_f32 v234, v234
  v_mov_b32 v128, v232
  RESC 104, 234
  v_mul_f32 v129, v234, v129
Lsk539:
  v_mul_f32 v233, s74, v128
  v_fma_f32 v235, v226, s74, -v233
  v_fma_f32 v236, v229, s74, -v233
  v_exp_f32 v235, v235
  v_exp_f32 v236, v236
  v_cvt_pk_bf16_f32 v238, v235, 0
  v_cvt_pk_bf16_f32 v239, 0, v235
  v_cvt_pk_bf16_f32 v240, v236, 0
  v_cvt_pk_bf16_f32 v241, 0, v236
  v_add_f32 v129, v129, v239
  v_add_f32 v129, v129, v241
  PV 154, 238, 104
  s_mov_b32 s76, 0x15c00
  LDT v, 154, 60
  PV 166, 240, 104
  s_mov_b32 s76, 0x16800
  LDT v, 166, 60
  ACR 56, 48
  ACR 68, 60
  QK2 56, 68, 80, 226
  s_mov_b32 s76, 0x17400
  LDT a, 48, 56
  s_mov_b32 s76, 0x18000
  LDT a, 60, 56
  v_add_f32 v226, v226, v227
  v_add_f32 v226, v226, v228
  v_add_f32 v229, v229, v230
  v_add_f32 v229, v229, v231
  v_add_f32_dpp v226, v226, v226 quad_perm:[1,0,3,2] row_mask:0xf bank_mask:0xf
  s_nop 0
  v_add_f32_dpp v229, v229, v229 quad_perm:[1,0,3,2] row_mask:0xf bank_mask:0xf
  v_add_f32_dpp v226, v226, v226 quad_perm:[2,3,0,1] row_mask:0xf bank_mask:0xf
  s_nop 0
  v_add_f32_dpp v229, v229, v229 quad_perm:[2,3,0,1] row_mask:0xf bank_mask:0xf
  v_add_f32_dpp v226, v226, v226 row_half_mirror row_mask:0xf bank_mask:0xf
  s_nop 0
  v_add_f32_dpp v229, v229, v229 row_half_mirror row_mask:0xf bank_mask:0xf
  v_max3_f32 v232, v128, v226, v229
  v_cmp_gt_f32 vcc, v232, v128
  s_cbranch_vccz Lsk540
  v_sub_f32 v234, v128, v232
  v_mul_f32 v234, s74, v234
  v_exp_f32 v234, v234
  v_mov_b32 v128, v232
  RESC 104, 234
  v_mul_f32 v129, v234, v129
Lsk540:
  v_mul_f32 v233, s74, v128
  v_fma_f32 v235, v226, s74, -v233
  v_fma_f32 v236, v229, s74, -v233
  v_exp_f32 v235, v235
  v_exp_f32 v236, v236
  v_cvt_pk_bf16_f32 v238, v235, 0
  v_cvt_pk_bf16_f32 v239, 0, v235
  v_cvt_pk_bf16_f32 v240, v236, 0
  v_cvt_pk_bf16_f32 v241, 0, v236
  v_add_f32 v129, v129, v239
  v_add_f32 v129, v129, v241
  PV 178, 238, 104
  s_mov_b32 s76, 0x17400
  LDT v, 178, 60
  PV 190, 240, 104
  s_mov_b32 s76, 0x18000
  LDT v, 190, 60
  ACR 56, 72
  ACR 68, 84
  QK2 56, 68, 80, 226
  s_mov_b32 s76, 0x18c00
  LDT a, 72, 56
  v_add_f32 v226, v226, v227
  v_add_f32 v226, v226, v228
  v_add_f32 v229, v229, v230
  v_add_f32 v229, v229, v231
  v_add_f32_dpp v226, v226, v226 quad_perm:[1,0,3,2] row_mask:0xf bank_mask:0xf
  s_nop 0
  v_add_f32_dpp v229, v229, v229 quad_perm:[1,0,3,2] row_mask:0xf bank_mask:0xf
  v_add_f32_dpp v226, v226, v226 quad_perm:[2,3,0,1] row_mask:0xf bank_mask:0xf
  s_nop 0
  v_add_f32_dpp v229, v229, v229 quad_perm:[2,3,0,1] row_mask:0xf bank_mask:0xf
  v_add_f32_dpp v226, v226, v226 row_half_mirror row_mask:0xf bank_mask:0xf
  s_nop 0
  v_add_f32_dpp v229, v229, v229 row_half_mirror row_mask:0xf bank_mask:0xf
  v_max3_f32 v232, v128, v226, v229
  v_cmp_gt_f32 vcc, v232, v128
  s_cbranch_vccz Lsk541
  v_sub_f32 v234, v128, v232
  v_mul_f32 v234, s74, v234
  v_exp_f32 v234, v234
  v_mov_b32 v128, v232
  RESC 104, 234
  v_mul_f32 v129, v234, v129
Lsk541:
  v_mul_f32 v233, s74, v128
  v_fma_f32 v235, v226, s74, -v233
  v_fma_f32 v236, v229, s74, -v233
  v_exp_f32 v235, v235
  v_exp_f32 v236, v236
  v_cvt_pk_bf16_f32 v238, v235, 0
  v_cvt_pk_bf16_f32 v239, 0, v235
  v_cvt_pk_bf16_f32 v240, v236, 0
  v_cvt_pk_bf16_f32 v241, 0, v236
  v_add_f32 v129, v129, v239
  v_add_f32 v129, v129, v241
  PV 202, 238, 104
  PV 214, 240, 104
  ACR 56, 96
  ACR 68, 108
  QK2 56, 68, 80, 226
  ds_read_b128 v[56:59], v3 offset:0
  ds_read_b128 v[60:63], v3 offset:1024
  ds_read_b128 v[64:67], v3 offset:2048
  ds_read_b128 v[68:71], v3 offset:3072
  ds_read_b128 v[72:75], v3 offset:4096
  ds_read_b128 v[76:79], v3 offset:5120
  v_add_f32 v226, v226, v227
  v_add_f32 v226, v226, v228
  v_add_f32 v229, v229, v230
  v_add_f32 v229, v229, v231
  v_add_f32_dpp v226, v226, v226 quad_perm:[1,0,3,2] row_mask:0xf bank_mask:0xf
  s_nop 0
  v_add_f32_dpp v229, v229, v229 quad_perm:[1,0,3,2] row_mask:0xf bank_mask:0xf
  v_add_f32_dpp v226, v226, v226 quad_perm:[2,3,0,1] row_mask:0xf bank_mask:0xf
  s_nop 0
  v_add_f32_dpp v229, v229, v229 quad_perm:[2,3,0,1] row_mask:0xf bank_mask:0xf
  v_add_f32_dpp v226, v226, v226 row_half_mirror row_mask:0xf bank_mask:0xf
  s_nop 0
  v_add_f32_dpp v229, v229, v229 row_half_mirror row_mask:0xf bank_mask:0xf
  v_max3_f32 v232, v128, v226, v229
  v_cmp_gt_f32 vcc, v232, v128
  s_cbranch_vccz Lsk542
  v_sub_f32 v234, v128, v232
  v_mul_f32 v234, s74, v234
  v_exp_f32 v234, v234
  v_mov_b32 v128, v232
  RESC 104, 234
  v_mul_f32 v129, v234, v129
Lsk542:
  v_mul_f32 v233, s74, v128
  v_fma_f32 v235, v226, s74, -v233
  v_fma_f32 v236, v229, s74, -v233
  v_exp_f32 v235, v235
  v_exp_f32 v236, v236
  v_cvt_pk_bf16_f32 v238, v235, 0
  v_cvt_pk_bf16_f32 v239, 0, v235
  v_cvt_pk_bf16_f32 v240, v236, 0
  v_cvt_pk_bf16_f32 v241, 0, v236
  v_add_f32 v129, v129, v239
  v_add_f32 v129, v129, v241
  s_waitcnt lgkmcnt(3)
  PV 56, 238, 104
  s_waitcnt lgkmcnt(0)
  PV 68, 240, 104
  ACR 56, 120
  ACR 68, 132
  QK2 56, 68, 80, 226
  ds_read_b128 v[56:59], v3 offset:6144
  ds_read_b128 v[60:63], v3 offset:7168
  ds_read_b128 v[64:67], v3 offset:8192
  ds_read_b128 v[68:71], v3 offset:9216
  ds_read_b128 v[72:75], v3 offset:10240
  ds_read_b128 v[76:79], v3 offset:11264
  v_add_f32 v226, v226, v227
  v_add_f32 v226, v226, v228
  v_add_f32 v229, v229, v230
  v_add_f32 v229, v229, v231
  v_add_f32_dpp v226, v226, v226 quad_perm:[1,0,3,2] row_mask:0xf bank_mask:0xf
  s_nop 0
  v_add_f32_dpp v229, v229, v229 quad_perm:[1,0,3,2] row_mask:0xf bank_mask:0xf
  v_add_f32_dpp v226, v226, v226 quad_perm:[2,3,0,1] row_mask:0xf bank_mask:0xf
  s_nop 0
  v_add_f32_dpp v229, v229, v229 quad_perm:[2,3,0,1] row_mask:0xf bank_mask:0xf
  v_add_f32_dpp v226, v226, v226 row_half_mirror row_mask:0xf bank_mask:0xf
  s_nop 0
  v_add_f32_dpp v229, v229, v229 row_half_mirror row_mask:0xf bank_mask:0xf
  v_max3_f32 v232, v128, v226, v229
  v_cmp_gt_f32 vcc, v232, v128
  s_cbranch_vccz Lsk543
  v_sub_f32 v234, v128, v232
  v_mul_f32 v234, s74, v234
  v_exp_f32 v234, v234
  v_mov_b32 v128, v232
  RESC 104, 234
  v_mul_f32 v129, v234, v129
Lsk543:
  v_mul_f32 v233, s74, v128
  v_fma_f32 v235, v226, s74, -v233
  v_fma_f32 v236, v229, s74, -v233
  v_exp_f32 v235, v235
  v_exp_f32 v236, v236
  v_cvt_pk_bf16_f32 v238, v235, 0
  v_cvt_pk_bf16_f32 v239, 0, v235
  v_cvt_pk_bf16_f32 v240, v236, 0
  v_cvt_pk_bf16_f32 v241, 0, v236
  v_add_f32 v129, v129, v239
  v_add_f32 v129, v129, v241
  s_waitcnt lgkmcnt(3)
  PV 56, 238, 104
  s_waitcnt lgkmcnt(0)
  PV 68, 240, 104
  s_waitcnt vmcnt(45)
  s_mov_b32 s76, 0x19800
  LDT v, 202, 56
  s_mov_b32 s76, 0x18c00
  LDT a, 84, 60
  ACR 56, 144
  ACR 68, 156
  QK2 56, 68, 80, 226
  ds_read_b128 v[56:59], v3 offset:12288
  ds_read_b128 v[60:63], v3 offset:13312
  ds_read_b128 v[64:67], v3 offset:14336
  ds_read_b128 v[68:71], v3 offset:15360
  ds_read_b128 v[72:75], v3 offset:16384
  ds_read_b128 v[76:79], v3 offset:17408
  v_add_f32 v226, v226, v227
  v_add_f32 v226, v226, v228
  v_add_f32 v229, v229, v230
  v_add_f32 v229, v229, v231
  v_add_f32_dpp v226, v226, v226 quad_perm:[1,0,3,2] row_mask:0xf bank_mask:0xf
  s_nop 0
  v_add_f32_dpp v229, v229, v229 quad_perm:[1,0,3,2] row_mask:0xf bank_mask:0xf
  v_add_f32_dpp v226, v226, v226 quad_perm:[2,3,0,1] row_mask:0xf bank_mask:0xf
  s_nop 0
  v_add_f32_dpp v229, v229, v229 quad_perm:[2,3,0,1] row_mask:0xf bank_mask:0xf
  v_add_f32_dpp v226, v226, v226 row_half_mirror row_mask:0xf bank_mask:0xf
  s_nop 0
  v_add_f32_dpp v229, v229, v229 row_half_mirror row_mask:0xf bank_mask:0xf
  v_max3_f32 v232, v128, v226, v229
  v_cmp_gt_f32 vcc, v232, v128
  s_cbranch_vccz Lsk544
  v_sub_f32 v234, v128, v232
  v_mul_f32 v234, s74, v234
  v_exp_f32 v234, v234
  v_mov_b32 v128, v232
  RESC 104, 234
  v_mul_f32 v129, v234, v129
Lsk544:
  v_mul_f32 v233, s74, v128
  v_fma_f32 v235, v226, s74, -v233
  v_fma_f32 v236, v229, s74, -v233
  v_exp_f32 v235, v235
  v_exp_f32 v236, v236
  v_cvt_pk_bf16_f32 v238, v235, 0
  v_cvt_pk_bf16_f32 v239, 0, v235
  v_cvt_pk_bf16_f32 v240, v236, 0
  v_cvt_pk_bf16_f32 v241, 0, v236
  v_add_f32 v129, v129, v239
  v_add_f32 v129, v129, v241
  s_waitcnt lgkmcnt(3)
  PV 56, 238, 104
  s_waitcnt lgkmcnt(0)
  PV 68, 240, 104
  s_waitcnt vmcnt(45)
  s_mov_b32 s76, 0x19800
  LDT v, 214, 60
  s_mov_b32 s76, 0x1a400
  LDT a, 96, 56
  ACR 56, 168
  ACR 68, 180
  QK2 56, 68, 80, 226
  ds_read_b128 v[56:59], v3 offset:18432
  ds_read_b128 v[60:63], v3 offset:19456
  ds_read_b128 v[64:67], v3 offset:20480
  ds_read_b128 v[68:71], v3 offset:21504
  ds_read_b128 v[72:75], v3 offset:22528
  ds_read_b128 v[76:79], v3 offset:23552
  v_add_f32 v226, v226, v227
  v_add_f32 v226, v226, v228
  v_add_f32 v229, v229, v230
  v_add_f32 v229, v229, v231
  v_add_f32_dpp v226, v226, v226 quad_perm:[1,0,3,2] row_mask:0xf bank_mask:0xf
  s_nop 0
  v_add_f32_dpp v229, v229, v229 quad_perm:[1,0,3,2] row_mask:0xf bank_mask:0xf
  v_add_f32_dpp v226, v226, v226 quad_perm:[2,3,0,1] row_mask:0xf bank_mask:0xf
  s_nop 0
  v_add_f32_dpp v229, v229, v229 quad_perm:[2,3,0,1] row_mask:0xf bank_mask:0xf
  v_add_f32_dpp v226, v226, v226 row_half_mirror row_mask:0xf bank_mask:0xf
  s_nop 0
  v_add_f32_dpp v229, v229, v229 row_half_mirror row_mask:0xf bank_mask:0xf
  v_max3_f32 v232, v128, v226, v229
  v_cmp_gt_f32 vcc, v232, v128
  s_cbranch_vccz Lsk545
  v_sub_f32 v234, v128, v232
  v_mul_f32 v234, s74, v234
  v_exp_f32 v234, v234
  v_mov_b32 v128, v232
  RESC 104, 234
  v_mul_f32 v129, v234, v129
Lsk545:
  v_mul_f32 v233, s74, v128
  v_fma_f32 v235, v226, s74, -v233
  v_fma_f32 v236, v229, s74, -v233
  v_exp_f32 v235, v235
  v_exp_f32 v236, v236
  v_cvt_pk_bf16_f32 v238, v235, 0
  v_cvt_pk_bf16_f32 v239, 0, v235
  v_cvt_pk_bf16_f32 v240, v236, 0
  v_cvt_pk_bf16_f32 v241, 0, v236
  v_add_f32 v129, v129, v239
  v_add_f32 v129, v129, v241
  s_waitcnt lgkmcnt(3)
  PV 56, 238, 104
  s_waitcnt lgkmcnt(0)
  PV 68, 240, 104
  s_waitcnt vmcnt(45)
  s_mov_b32 s76, 0x1b000
  LDT a, 108, 56
  s_mov_b32 s76, 0x1a400
  LDT a, 120, 60
  s_add_u32 s76, s72, 0x15000
  buffer_load_dwordx4 v[92:95], v2, s[64:67], s76 offen sc1
  buffer_load_dwordx4 v[96:99], v2, s[64:67], s76 offen offset:128 sc1
  buffer_load_dwordx4 v[100:103], v2, s[64:67], s76 offen offset:256 sc1
  ACR 56, 192
  ACR 68, 204
  QK2 56, 68, 80, 226
  ds_read_b128 v[56:59], v3 offset:24576
  ds_read_b128 v[60:63], v3 offset:25600
  ds_read_b128 v[64:67], v3 offset:26624
  ds_read_b128 v[68:71], v3 offset:27648
  ds_read_b128 v[72:75], v3 offset:28672
  ds_read_b128 v[76:79], v3 offset:29696
  v_add_f32 v226, v226, v227
  v_add_f32 v226, v226, v228
  v_add_f32 v229, v229, v230
  v_add_f32 v229, v229, v231
  v_add_f32_dpp v226, v226, v226 quad_perm:[1,0,3,2] row_mask:0xf bank_mask:0xf
  s_nop 0
  v_add_f32_dpp v229, v229, v229 quad_perm:[1,0,3,2] row_mask:0xf bank_mask:0xf
  v_add_f32_dpp v226, v226, v226 quad_perm:[2,3,0,1] row_mask:0xf bank_mask:0xf
  s_nop 0
  v_add_f32_dpp v229, v229, v229 quad_perm:[2,3,0,1] row_mask:0xf bank_mask:0xf
  v_add_f32_dpp v226, v226, v226 row_half_mirror row_mask:0xf bank_mask:0xf
  s_nop 0
  v_add_f32_dpp v229, v229, v229 row_half_mirror row_mask:0xf bank_mask:0xf
  v_max3_f32 v232, v128, v226, v229
  v_cmp_gt_f32 vcc, v232, v128
  s_cbranch_vccz Lsk546
  v_sub_f32 v234, v128, v232
  v_mul_f32 v234, s74, v234
  v_exp_f32 v234, v234
  v_mov_b32 v128, v232
  RESC 104, 234
  v_mul_f32 v129, v234, v129
Lsk546:
  v_mul_f32 v233, s74, v128
  v_fma_f32 v235, v226, s74, -v233
  v_fma_f32 v236, v229, s74, -v233
  v_exp_f32 v235, v235
  v_exp_f32 v236, v236
  v_cvt_pk_bf16_f32 v238, v235, 0
  v_cvt_pk_bf16_f32 v239, 0, v235
  v_cvt_pk_bf16_f32 v240, v236, 0
  v_cvt_pk_bf16_f32 v241, 0, v236
  v_add_f32 v129, v129, v239
  v_add_f32 v129, v129, v241
  s_waitcnt lgkmcnt(3)
  PV 56, 238, 104
  s_waitcnt lgkmcnt(0)
  PV 68, 240, 104
  s_waitcnt vmcnt(48)
  s_mov_b32 s76, 0x1b000
  LDT a, 132, 60
  ACR 56, 216
  ACR 68, 228
  QK2 56, 68, 80, 226
  ds_read_b128 v[56:59], v3 offset:30720
  ds_read_b128 v[60:63], v3 offset:31744
  ds_read_b128 v[64:67], v3 offset:32768
  ds_read_b128 v[68:71], v3 offset:33792
  ds_read_b128 v[72:75], v3 offset:34816
  ds_read_b128 v[76:79], v3 offset:35840
  v_add_f32 v226, v226, v227
  v_add_f32 v226, v226, v228
  v_add_f32 v229, v229, v230
  v_add_f32 v229, v229, v231
  v_add_f32_dpp v226, v226, v226 quad_perm:[1,0,3,2] row_mask:0xf bank_mask:0xf
  s_nop 0
  v_add_f32_dpp v229, v229, v229 quad_perm:[1,0,3,2] row_mask:0xf bank_mask:0xf
  v_add_f32_dpp v226, v226, v226 quad_perm:[2,3,0,1] row_mask:0xf bank_mask:0xf
  s_nop 0
  v_add_f32_dpp v229, v229, v229 quad_perm:[2,3,0,1] row_mask:0xf bank_mask:0xf
  v_add_f32_dpp v226, v226, v226 row_half_mirror row_mask:0xf bank_mask:0xf
  s_nop 0
  v_add_f32_dpp v229, v229, v229 row_half_mirror row_mask:0xf bank_mask:0xf
  v_max3_f32 v232, v128, v226, v229
  v_cmp_gt_f32 vcc, v232, v128
  s_cbranch_vccz Lsk547
  v_sub_f32 v234, v128, v232
  v_mul_f32 v234, s74, v234
  v_exp_f32 v234, v234
  v_mov_b32 v128, v232
  RESC 104, 234
  v_mul_f32 v129, v234, v129
Lsk547:
  v_mul_f32 v233, s74, v128
  v_fma_f32 v235, v226, s74, -v233
  v_fma_f32 v236, v229, s74, -v233
  v_exp_f32 v235, v235
  v_exp_f32 v236, v236
  v_cvt_pk_bf16_f32 v238, v235, 0
  v_cvt_pk_bf16_f32 v239, 0, v235
  v_cvt_pk_bf16_f32 v240, v236, 0
  v_cvt_pk_bf16_f32 v241, 0, v236
  v_add_f32 v129, v129, v239
  v_add_f32 v129, v129, v241
  s_waitcnt lgkmcnt(3)
  PV 56, 238, 104
  s_waitcnt lgkmcnt(0)
  PV 68, 240, 104
  s_waitcnt vmcnt(45)
  s_mov_b32 s76, 0x1bc00
  LDT a, 144, 56
  s_mov_b32 s76, 0x1c800
  LDT a, 156, 56
  ACR 56, 240
  v_dot2_f32_bf16 v226, v56, v80, 0
  v_dot2_f32_bf16 v227, v60, v84, 0
  v_dot2_f32_bf16 v228, v64, v88, 0
  s_nop 0
  v_dot2c_f32_bf16 v226, v57, v81
  v_dot2c_f32_bf16 v227, v61, v85
  v_dot2c_f32_bf16 v228, v65, v89
  v_dot2c_f32_bf16 v226, v58, v82
  v_dot2c_f32_bf16 v227, v62, v86
  v_dot2c_f32_bf16 v228, v66, v90
  v_dot2c_f32_bf16 v226, v59, v83
  v_dot2c_f32_bf16 v227, v63, v87
  v_dot2c_f32_bf16 v228, v67, v91
  ds_read_b128 v[56:59], v3 offset:36864
  ds_read_b128 v[60:63], v3 offset:37888
  ds_read_b128 v[64:67], v3 offset:38912
  v_add_f32 v226, v226, v227
  v_add_f32 v226, v226, v228
  s_nop 1
  v_add_f32_dpp v226, v226, v226 quad_perm:[1,0,3,2] row_mask:0xf bank_mask:0xf
  s_nop 1
  v_add_f32_dpp v226, v226, v226 quad_perm:[2,3,0,1] row_mask:0xf bank_mask:0xf
  s_nop 1
  v_add_f32_dpp v226, v226, v226 row_half_mirror row_mask:0xf bank_mask:0xf
  v_max_f32 v232, v128, v226
  v_cmp_gt_f32 vcc, v232, v128
  s_cbranch_vccz Lsk548
  v_sub_f32 v234, v128, v232
  v_mul_f32 v234, s74, v234
  v_exp_f32 v234, v234
  v_mov_b32 v128, v232
  RESC 104, 234
  v_mul_f32 v129, v234, v129
Lsk548:
  v_mul_f32 v233, s74, v128
  v_fma_f32 v235, v226, s74, -v233
  v_exp_f32 v235, v235
  s_nop 0
  v_cvt_pk_bf16_f32 v238, v235, 0
  v_cvt_pk_bf16_f32 v239, 0, v235
  v_add_f32 v129, v129, v239
  s_waitcnt lgkmcnt(0)
  PV 56, 238, 104
  s_waitcnt vmcnt(45)
  s_mov_b32 s76, 0x1bc00
  LDT a, 168, 60
  s_mov_b32 s76, 0x1c800
  LDT a, 180, 60
  v_max_f32_dpp v226, v128, v128 row_ror:8 row_mask:0xf bank_mask:0xf
  v_mov_b32 v227, v226
  s_nop 1
  v_permlane16_swap_b32 v226, v227
  v_max_f32 v226, v226, v227
  v_mov_b32 v227, v226
  s_nop 1
  v_permlane32_swap_b32 v226, v227
  v_max_f32 v226, v226, v227
  v_sub_f32 v228, v128, v226
  v_mul_f32 v228, s74, v228
  v_exp_f32 v228, v228
  v_mul_f32 v226, s74, v226
  RESC 104, 228
  v_mul_f32 v129, v228, v129
  s_nop 1
  v_add_f32_dpp v129, v129, v129 row_ror:8 row_mask:0xf bank_mask:0xf
  v_mov_b32 v227, v129
  s_nop 1
  v_permlane16_swap_b32 v129, v227
  v_add_f32 v129, v129, v227
  v_mov_b32 v227, v129
  s_nop 1
  v_permlane32_swap_b32 v129, v227
  v_add_f32 v129, v129, v227
  v_permlane32_swap_b32 v104, v116
  v_permlane32_swap_b32 v105, v117
  v_permlane32_swap_b32 v106, v118
  v_permlane32_swap_b32 v107, v119
  v_permlane32_swap_b32 v108, v120
  v_permlane32_swap_b32 v109, v121
  v_permlane32_swap_b32 v110, v122
  v_permlane32_swap_b32 v111, v123
  v_permlane32_swap_b32 v112, v124
  v_permlane32_swap_b32 v113, v125
  v_permlane32_swap_b32 v114, v126
  v_permlane32_swap_b32 v115, v127
  v_add_f32 v104, v104, v116
  v_add_f32 v105, v105, v117
  v_add_f32 v106, v106, v118
  v_add_f32 v107, v107, v119
  v_add_f32 v108, v108, v120
  v_add_f32 v109, v109, v121
  v_add_f32 v110, v110, v122
  v_add_f32 v111, v111, v123
  v_add_f32 v112, v112, v124
  v_add_f32 v113, v113, v125
  v_add_f32 v114, v114, v126
  v_add_f32 v115, v115, v127
  v_permlane16_swap_b32 v104, v110
  v_permlane16_swap_b32 v105, v111
  v_permlane16_swap_b32 v106, v112
  v_permlane16_swap_b32 v107, v113
  v_permlane16_swap_b32 v108, v114
  v_permlane16_swap_b32 v109, v115
  v_add_f32 v104, v104, v110
  v_add_f32 v105, v105, v111
  v_add_f32 v106, v106, v112
  v_add_f32 v107, v107, v113
  v_add_f32 v108, v108, v114
  v_add_f32 v109, v109, v115
  v_add_f32_dpp v104, v104, v104 row_ror:8 row_mask:0xf bank_mask:0xf
  v_add_f32_dpp v105, v105, v105 row_ror:8 row_mask:0xf bank_mask:0xf
  v_add_f32_dpp v106, v106, v106 row_ror:8 row_mask:0xf bank_mask:0xf
  v_add_f32_dpp v107, v107, v107 row_ror:8 row_mask:0xf bank_mask:0xf
  v_add_f32_dpp v108, v108, v108 row_ror:8 row_mask:0xf bank_mask:0xf
  v_add_f32_dpp v109, v109, v109 row_ror:8 row_mask:0xf bank_mask:0xf
  v_add_u32 v229, 0, v7
  v_lshrrev_b32 v230, 3, v229
  v_and_b32 v229, 7, v229
  v_lshlrev_b32 v230, 6, v230
  v_add_u32 v229, v229, v230
  v_lshl_add_u32 v229, v229, 2, v4
  ds_write_b32 v229, v104
  v_add_u32 v229, 1, v7
  v_lshrrev_b32 v230, 3, v229
  v_and_b32 v229, 7, v229
  v_lshlrev_b32 v230, 6, v230
  v_add_u32 v229, v229, v230
  v_lshl_add_u32 v229, v229, 2, v4
  ds_write_b32 v229, v105
  v_add_u32 v229, 2, v7
  v_lshrrev_b32 v230, 3, v229
  v_and_b32 v229, 7, v229
  v_lshlrev_b32 v230, 6, v230
  v_add_u32 v229, v229, v230
  v_lshl_add_u32 v229, v229, 2, v4
  ds_write_b32 v229, v106
  v_add_u32 v229, 3, v7
  v_lshrrev_b32 v230, 3, v229
  v_and_b32 v229, 7, v229
  v_lshlrev_b32 v230, 6, v230
  v_add_u32 v229, v229, v230
  v_lshl_add_u32 v229, v229, 2, v4
  ds_write_b32 v229, v107
  v_add_u32 v229, 4, v7
  v_lshrrev_b32 v230, 3, v229
  v_and_b32 v229, 7, v229
  v_lshlrev_b32 v230, 6, v230
  v_add_u32 v229, v229, v230
  v_lshl_add_u32 v229, v229, 2, v4
  ds_write_b32 v229, v108
  v_add_u32 v229, 5, v7
  v_lshrrev_b32 v230, 3, v229
  v_and_b32 v229, 7, v229
  v_lshlrev_b32 v230, 6, v230
  v_add_u32 v229, v229, v230
  v_lshl_add_u32 v229, v229, 2, v4
  ds_write_b32 v229, v109
  v_mov_b32 v234, v226
  v_mov_b32 v235, v129
  v_mov_b32 v236, 0
  v_mov_b32 v237, 0
  v_and_b32 v229, 0xffffff1f, v4
  ds_write_b128 v229, v[234:237] offset:768
  s_waitcnt lgkmcnt(0)
  ds_read_b128 v[234:237], v5
  s_waitcnt lgkmcnt(0)
  s_add_u32 s76, s73, 0x9f4000
  s_mov_b32 exec_lo, -1
  s_mov_b32 exec_hi, 0x1ffff
  buffer_store_dwordx4 v[234:237], v6, s[64:67], s76 offen sc1
  s_mov_b64 exec, -1
  s_waitcnt vmcnt(16)
  v_max3_u32 v226, v92, v93, v94
  v_max3_u32 v226, v226, v95, v96
  v_max3_u32 v226, v226, v97, v98
  v_max3_u32 v226, v226, v99, v100
  v_max3_u32 v226, v226, v101, v102
  v_max3_u32 v226, v226, v103, v103
  v_cmp_eq_u32 vcc, -1, v226
  s_cbranch_vccz Lqo549
  s_mov_b32 s75, 0x61a80
Lqr550:
  s_sleep 2
  s_add_u32 s77, s72, 0x15000
  buffer_load_dwordx4 v[92:95], v2, s[64:67], s77 offen sc1
  buffer_load_dwordx4 v[96:99], v2, s[64:67], s77 offen offset:128 sc1
  buffer_load_dwordx4 v[100:103], v2, s[64:67], s77 offen offset:256 sc1
  s_waitcnt vmcnt(0)
  v_max3_u32 v226, v92, v93, v94
  v_max3_u32 v226, v226, v95, v96
  v_max3_u32 v226, v226, v97, v98
  v_max3_u32 v226, v226, v99, v100
  v_max3_u32 v226, v226, v101, v102
  v_max3_u32 v226, v226, v103, v103
  v_cmp_eq_u32 vcc, -1, v226
  s_cbranch_vccz Lqo549
  s_sub_u32 s75, s75, 1
  s_cmp_lg_u32 s75, 0
  s_cbranch_scc1 Lqr550
Lqo549:
  v_mov_b32 v80, v92
  v_mov_b32 v81, v93
  v_mov_b32 v82, v94
  v_mov_b32 v83, v95
  v_mov_b32 v84, v96
  v_mov_b32 v85, v97
  v_mov_b32 v86, v98
  v_mov_b32 v87, v99
  v_mov_b32 v88, v100
  v_mov_b32 v89, v101
  v_mov_b32 v90, v102
  v_mov_b32 v91, v103
  v_mov_b32 v104, 0
  v_mov_b32 v105, 0
  v_mov_b32 v106, 0
  v_mov_b32 v107, 0
  v_mov_b32 v108, 0
  v_mov_b32 v109, 0
  v_mov_b32 v110, 0
  v_mov_b32 v111, 0
  v_mov_b32 v112, 0
  v_mov_b32 v113, 0
  v_mov_b32 v114, 0
  v_mov_b32 v115, 0
  v_mov_b32 v116, 0
  v_mov_b32 v117, 0
  v_mov_b32 v118, 0
  v_mov_b32 v119, 0
  v_mov_b32 v120, 0
  v_mov_b32 v121, 0
  v_mov_b32 v122, 0
  v_mov_b32 v123, 0
  v_mov_b32 v124, 0
  v_mov_b32 v125, 0
  v_mov_b32 v126, 0
  v_mov_b32 v127, 0
  v_mov_b32 v128, 0xf149f2ca
  v_mov_b32 v129, 0
  QK2 20, 44, 80, 226
  s_mov_b32 s76, 0x1d400
  LDT v, 20, 56
  s_mov_b32 s76, 0x1d400
  LDT v, 44, 60
  v_add_f32 v226, v226, v227
  v_add_f32 v226, v226, v228
  v_add_f32 v229, v229, v230
  v_add_f32 v229, v229, v231
  v_add_f32_dpp v226, v226, v226 quad_perm:[1,0,3,2] row_mask:0xf bank_mask:0xf
  s_nop 0
  v_add_f32_dpp v229, v229, v229 quad_perm:[1,0,3,2] row_mask:0xf bank_mask:0xf
  v_add_f32_dpp v226, v226, v226 quad_perm:[2,3,0,1] row_mask:0xf bank_mask:0xf
  s_nop 0
  v_add_f32_dpp v229, v229, v229 quad_perm:[2,3,0,1] row_mask:0xf bank_mask:0xf
  v_add_f32_dpp v226, v226, v226 row_half_mirror row_mask:0xf bank_mask:0xf
  s_nop 0
  v_add_f32_dpp v229, v229, v229 row_half_mirror row_mask:0xf bank_mask:0xf
  v_max3_f32 v232, v128, v226, v229
  v_cmp_gt_f32 vcc, v232, v128
  s_cbranch_vccz Lsk551
  v_sub_f32 v234, v128, v232
  v_mul_f32 v234, s74, v234
  v_exp_f32 v234, v234
  v_mov_b32 v128, v232
  RESC 104, 234
  v_mul_f32 v129, v234, v129
Lsk551:
  v_mul_f32 v233, s74, v128
  v_fma_f32 v235, v226, s74, -v233
  v_fma_f32 v236, v229, s74, -v233
  v_exp_f32 v235, v235
  v_exp_f32 v236, v236
  v_cvt_pk_bf16_f32 v238, v235, 0
  v_cvt_pk_bf16_f32 v239, 0, v235
  v_cvt_pk_bf16_f32 v240, v236, 0
  v_cvt_pk_bf16_f32 v241, 0, v236
  v_add_f32 v129, v129, v239
  v_add_f32 v129, v129, v241
  PV 8, 238, 104
  PV 32, 240, 104
  ACR 56, 0
  ACR 68, 12
  QK2 56, 68, 80, 226
  v_add_f32 v226, v226, v227
  v_add_f32 v226, v226, v228
  v_add_f32 v229, v229, v230
  v_add_f32 v229, v229, v231
  v_add_f32_dpp v226, v226, v226 quad_perm:[1,0,3,2] row_mask:0xf bank_mask:0xf
  s_nop 0
  v_add_f32_dpp v229, v229, v229 quad_perm:[1,0,3,2] row_mask:0xf bank_mask:0xf
  v_add_f32_dpp v226, v226, v226 quad_perm:[2,3,0,1] row_mask:0xf bank_mask:0xf
  s_nop 0
  v_add_f32_dpp v229, v229, v229 quad_perm:[2,3,0,1] row_mask:0xf bank_mask:0xf
  v_add_f32_dpp v226, v226, v226 row_half_mirror row_mask:0xf bank_mask:0xf
  s_nop 0
  v_add_f32_dpp v229, v229, v229 row_half_mirror row_mask:0xf bank_mask:0xf
  v_max3_f32 v232, v128, v226, v229
  v_cmp_gt_f32 vcc, v232, v128
  s_cbranch_vccz Lsk552
  v_sub_f32 v234, v128, v232
  v_mul_f32 v234, s74, v234
  v_exp_f32 v234, v234
  v_mov_b32 v128, v232
  RESC 104, 234
  v_mul_f32 v129, v234, v129
Lsk552:
  v_mul_f32 v233, s74, v128
  v_fma_f32 v235, v226, s74, -v233
  v_fma_f32 v236, v229, s74, -v233
  v_exp_f32 v235, v235
  v_exp_f32 v236, v236
  v_cvt_pk_bf16_f32 v238, v235, 0
  v_cvt_pk_bf16_f32 v239, 0, v235
  v_cvt_pk_bf16_f32 v240, v236, 0
  v_cvt_pk_bf16_f32 v241, 0, v236
  v_add_f32 v129, v129, v239
  v_add_f32 v129, v129, v241
  PV 130, 238, 104
  PV 142, 240, 104
  ACR 56, 24
  ACR 68, 36
  QK2 56, 68, 80, 226
  v_add_f32 v226, v226, v227
  v_add_f32 v226, v226, v228
  v_add_f32 v229, v229, v230
  v_add_f32 v229, v229, v231
  v_add_f32_dpp v226, v226, v226 quad_perm:[1,0,3,2] row_mask:0xf bank_mask:0xf
  s_nop 0
  v_add_f32_dpp v229, v229, v229 quad_perm:[1,0,3,2] row_mask:0xf bank_mask:0xf
  v_add_f32_dpp v226, v226, v226 quad_perm:[2,3,0,1] row_mask:0xf bank_mask:0xf
  s_nop 0
  v_add_f32_dpp v229, v229, v229 quad_perm:[2,3,0,1] row_mask:0xf bank_mask:0xf
  v_add_f32_dpp v226, v226, v226 row_half_mirror row_mask:0xf bank_mask:0xf
  s_nop 0
  v_add_f32_dpp v229, v229, v229 row_half_mirror row_mask:0xf bank_mask:0xf
  v_max3_f32 v232, v128, v226, v229
  v_cmp_gt_f32 vcc, v232, v128
  s_cbranch_vccz Lsk553
  v_sub_f32 v234, v128, v232
  v_mul_f32 v234, s74, v234
  v_exp_f32 v234, v234
  v_mov_b32 v128, v232
  RESC 104, 234
  v_mul_f32 v129, v234, v129
Lsk553:
  v_mul_f32 v233, s74, v128
  v_fma_f32 v235, v226, s74, -v233
  v_fma_f32 v236, v229, s74, -v233
  v_exp_f32 v235, v235
  v_exp_f32 v236, v236
  v_cvt_pk_bf16_f32 v238, v235, 0
  v_cvt_pk_bf16_f32 v239, 0, v235
  v_cvt_pk_bf16_f32 v240, v236, 0
  v_cvt_pk_bf16_f32 v241, 0, v236
  v_add_f32 v129, v129, v239
  v_add_f32 v129, v129, v241
  PV 154, 238, 104
  PV 166, 240, 104
  ACR 56, 48
  ACR 68, 60
  QK2 56, 68, 80, 226
  v_add_f32 v226, v226, v227
  v_add_f32 v226, v226, v228
  v_add_f32 v229, v229, v230
  v_add_f32 v229, v229, v231
  v_add_f32_dpp v226, v226, v226 quad_perm:[1,0,3,2] row_mask:0xf bank_mask:0xf
  s_nop 0
  v_add_f32_dpp v229, v229, v229 quad_perm:[1,0,3,2] row_mask:0xf bank_mask:0xf
  v_add_f32_dpp v226, v226, v226 quad_perm:[2,3,0,1] row_mask:0xf bank_mask:0xf
  s_nop 0
  v_add_f32_dpp v229, v229, v229 quad_perm:[2,3,0,1] row_mask:0xf bank_mask:0xf
  v_add_f32_dpp v226, v226, v226 row_half_mirror row_mask:0xf bank_mask:0xf
  s_nop 0
  v_add_f32_dpp v229, v229, v229 row_half_mirror row_mask:0xf bank_mask:0xf
  v_max3_f32 v232, v128, v226, v229
  v_cmp_gt_f32 vcc, v232, v128
  s_cbranch_vccz Lsk554
  v_sub_f32 v234, v128, v232
  v_mul_f32 v234, s74, v234
  v_exp_f32 v234, v234
  v_mov_b32 v128, v232
  RESC 104, 234
  v_mul_f32 v129, v234, v129
Lsk554:
  v_mul_f32 v233, s74, v128
  v_fma_f32 v235, v226, s74, -v233
  v_fma_f32 v236, v229, s74, -v233
  v_exp_f32 v235, v235
  v_exp_f32 v236, v236
  v_cvt_pk_bf16_f32 v238, v235, 0
  v_cvt_pk_bf16_f32 v239, 0, v235
  v_cvt_pk_bf16_f32 v240, v236, 0
  v_cvt_pk_bf16_f32 v241, 0, v236
  v_add_f32 v129, v129, v239
  v_add_f32 v129, v129, v241
  PV 178, 238, 104
  PV 190, 240, 104
  ACR 56, 72
  QK2 56, 202, 80, 226
  v_add_f32 v226, v226, v227
  v_add_f32 v226, v226, v228
  v_add_f32 v229, v229, v230
  v_add_f32 v229, v229, v231
  v_add_f32_dpp v226, v226, v226 quad_perm:[1,0,3,2] row_mask:0xf bank_mask:0xf
  s_nop 0
  v_add_f32_dpp v229, v229, v229 quad_perm:[1,0,3,2] row_mask:0xf bank_mask:0xf
  v_add_f32_dpp v226, v226, v226 quad_perm:[2,3,0,1] row_mask:0xf bank_mask:0xf
  s_nop 0
  v_add_f32_dpp v229, v229, v229 quad_perm:[2,3,0,1] row_mask:0xf bank_mask:0xf
  v_add_f32_dpp v226, v226, v226 row_half_mirror row_mask:0xf bank_mask:0xf
  s_nop 0
  v_add_f32_dpp v229, v229, v229 row_half_mirror row_mask:0xf bank_mask:0xf
  v_max3_f32 v232, v128, v226, v229
  v_cmp_gt_f32 vcc, v232, v128
  s_cbranch_vccz Lsk555
  v_sub_f32 v234, v128, v232
  v_mul_f32 v234, s74, v234
  v_exp_f32 v234, v234
  v_mov_b32 v128, v232
  RESC 104, 234
  v_mul_f32 v129, v234, v129
Lsk555:
  v_mul_f32 v233, s74, v128
  v_fma_f32 v235, v226, s74, -v233
  v_fma_f32 v236, v229, s74, -v233
  v_exp_f32 v235, v235
  v_exp_f32 v236, v236
  v_cvt_pk_bf16_f32 v238, v235, 0
  v_cvt_pk_bf16_f32 v239, 0, v235
  v_cvt_pk_bf16_f32 v240, v236, 0
  v_cvt_pk_bf16_f32 v241, 0, v236
  v_add_f32 v129, v129, v239
  v_add_f32 v129, v129, v241
  ACR 56, 84
  PV 56, 238, 104
  PV 214, 240, 104
  ACR 56, 96
  ACR 68, 108
  QK2 56, 68, 80, 226
  v_add_f32 v226, v226, v227
  v_add_f32 v226, v226, v228
  v_add_f32 v229, v229, v230
  v_add_f32 v229, v229, v231
  v_add_f32_dpp v226, v226, v226 quad_perm:[1,0,3,2] row_mask:0xf bank_mask:0xf
  s_nop 0
  v_add_f32_dpp v229, v229, v229 quad_perm:[1,0,3,2] row_mask:0xf bank_mask:0xf
  v_add_f32_dpp v226, v226, v226 quad_perm:[2,3,0,1] row_mask:0xf bank_mask:0xf
  s_nop 0
  v_add_f32_dpp v229, v229, v229 quad_perm:[2,3,0,1] row_mask:0xf bank_mask:0xf
  v_add_f32_dpp v226, v226, v226 row_half_mirror row_mask:0xf bank_mask:0xf
  s_nop 0
  v_add_f32_dpp v229, v229, v229 row_half_mirror row_mask:0xf bank_mask:0xf
  v_max3_f32 v232, v128, v226, v229
  v_cmp_gt_f32 vcc, v232, v128
  s_cbranch_vccz Lsk556
  v_sub_f32 v234, v128, v232
  v_mul_f32 v234, s74, v234
  v_exp_f32 v234, v234
  v_mov_b32 v128, v232
  RESC 104, 234
  v_mul_f32 v129, v234, v129
Lsk556:
  v_mul_f32 v233, s74, v128
  v_fma_f32 v235, v226, s74, -v233
  v_fma_f32 v236, v229, s74, -v233
  v_exp_f32 v235, v235
  v_exp_f32 v236, v236
  v_cvt_pk_bf16_f32 v238, v235, 0
  v_cvt_pk_bf16_f32 v239, 0, v235
  v_cvt_pk_bf16_f32 v240, v236, 0
  v_cvt_pk_bf16_f32 v241, 0, v236
  v_add_f32 v129, v129, v239
  v_add_f32 v129, v129, v241
  ACR 56, 120
  PV 56, 238, 104
  s_waitcnt vmcnt(19)
  ACR 68, 132
  PV 68, 240, 104
  s_waitcnt vmcnt(16)
  ACR 56, 144
  s_waitcnt vmcnt(13)
  ACR 68, 156
  QK2 56, 68, 80, 226
  v_add_f32 v226, v226, v227
  v_add_f32 v226, v226, v228
  v_add_f32 v229, v229, v230
  v_add_f32 v229, v229, v231
  v_add_f32_dpp v226, v226, v226 quad_perm:[1,0,3,2] row_mask:0xf bank_mask:0xf
  s_nop 0
  v_add_f32_dpp v229, v229, v229 quad_perm:[1,0,3,2] row_mask:0xf bank_mask:0xf
  v_add_f32_dpp v226, v226, v226 quad_perm:[2,3,0,1] row_mask:0xf bank_mask:0xf
  s_nop 0
  v_add_f32_dpp v229, v229, v229 quad_perm:[2,3,0,1] row_mask:0xf bank_mask:0xf
  v_add_f32_dpp v226, v226, v226 row_half_mirror row_mask:0xf bank_mask:0xf
  s_nop 0
  v_add_f32_dpp v229, v229, v229 row_half_mirror row_mask:0xf bank_mask:0xf
  v_max3_f32 v232, v128, v226, v229
  v_cmp_gt_f32 vcc, v232, v128
  s_cbranch_vccz Lsk557
  v_sub_f32 v234, v128, v232
  v_mul_f32 v234, s74, v234
  v_exp_f32 v234, v234
  v_mov_b32 v128, v232
  RESC 104, 234
  v_mul_f32 v129, v234, v129
Lsk557:
  v_mul_f32 v233, s74, v128
  v_fma_f32 v235, v226, s74, -v233
  v_fma_f32 v236, v229, s74, -v233
  v_exp_f32 v235, v235
  v_exp_f32 v236, v236
  v_cvt_pk_bf16_f32 v238, v235, 0
  v_cvt_pk_bf16_f32 v239, 0, v235
  v_cvt_pk_bf16_f32 v240, v236, 0
  v_cvt_pk_bf16_f32 v241, 0, v236
  v_add_f32 v129, v129, v239
  v_add_f32 v129, v129, v241
  s_waitcnt vmcnt(10)
  ACR 56, 168
  PV 56, 238, 104
  s_waitcnt vmcnt(7)
  ACR 68, 180
  PV 68, 240, 104
  s_waitcnt vmcnt(3)
  v_dot2_f32_bf16 v226, v20, v80, 0
  v_dot2_f32_bf16 v227, v24, v84, 0
  v_dot2_f32_bf16 v228, v28, v88, 0
  s_nop 0
  v_dot2c_f32_bf16 v226, v21, v81
  v_dot2c_f32_bf16 v227, v25, v85
  v_dot2c_f32_bf16 v228, v29, v89
  v_dot2c_f32_bf16 v226, v22, v82
  v_dot2c_f32_bf16 v227, v26, v86
  v_dot2c_f32_bf16 v228, v30, v90
  v_dot2c_f32_bf16 v226, v23, v83
  v_dot2c_f32_bf16 v227, v27, v87
  v_dot2c_f32_bf16 v228, v31, v91
  s_nop 1
  v_add_f32 v226, v226, v227
  v_add_f32 v226, v226, v228
  s_nop 1
  v_add_f32_dpp v226, v226, v226 quad_perm:[1,0,3,2] row_mask:0xf bank_mask:0xf
  s_nop 1
  v_add_f32_dpp v226, v226, v226 quad_perm:[2,3,0,1] row_mask:0xf bank_mask:0xf
  s_nop 1
  v_add_f32_dpp v226, v226, v226 row_half_mirror row_mask:0xf bank_mask:0xf
  v_add_f32 v226, s83, v226
  v_max_f32 v232, v128, v226
  v_cmp_gt_f32 vcc, v232, v128
  s_cbranch_vccz Lsk558
  v_sub_f32 v234, v128, v232
  v_mul_f32 v234, s74, v234
  v_exp_f32 v234, v234
  v_mov_b32 v128, v232
  RESC 104, 234
  v_mul_f32 v129, v234, v129
Lsk558:
  v_mul_f32 v233, s74, v128
  v_fma_f32 v235, v226, s74, -v233
  v_exp_f32 v235, v235
  s_nop 0
  v_cvt_pk_bf16_f32 v238, v235, 0
  v_cvt_pk_bf16_f32 v239, 0, v235
  v_add_f32 v129, v129, v239
  s_waitcnt vmcnt(0)
  PV 44, 238, 104
  v_max_f32_dpp v226, v128, v128 row_ror:8 row_mask:0xf bank_mask:0xf
  v_mov_b32 v227, v226
  s_nop 1
  v_permlane16_swap_b32 v226, v227
  v_max_f32 v226, v226, v227
  v_mov_b32 v227, v226
  s_nop 1
  v_permlane32_swap_b32 v226, v227
  v_max_f32 v226, v226, v227
  v_sub_f32 v228, v128, v226
  v_mul_f32 v228, s74, v228
  v_exp_f32 v228, v228
  v_mul_f32 v226, s74, v226
  RESC 104, 228
  v_mul_f32 v129, v228, v129
  s_nop 1
  v_add_f32_dpp v129, v129, v129 row_ror:8 row_mask:0xf bank_mask:0xf
  v_mov_b32 v227, v129
  s_nop 1
  v_permlane16_swap_b32 v129, v227
  v_add_f32 v129, v129, v227
  v_mov_b32 v227, v129
  s_nop 1
  v_permlane32_swap_b32 v129, v227
  v_add_f32 v129, v129, v227
  v_permlane32_swap_b32 v104, v116
  v_permlane32_swap_b32 v105, v117
  v_permlane32_swap_b32 v106, v118
  v_permlane32_swap_b32 v107, v119
  v_permlane32_swap_b32 v108, v120
  v_permlane32_swap_b32 v109, v121
  v_permlane32_swap_b32 v110, v122
  v_permlane32_swap_b32 v111, v123
  v_permlane32_swap_b32 v112, v124
  v_permlane32_swap_b32 v113, v125
  v_permlane32_swap_b32 v114, v126
  v_permlane32_swap_b32 v115, v127
  v_add_f32 v104, v104, v116
  v_add_f32 v105, v105, v117
  v_add_f32 v106, v106, v118
  v_add_f32 v107, v107, v119
  v_add_f32 v108, v108, v120
  v_add_f32 v109, v109, v121
  v_add_f32 v110, v110, v122
  v_add_f32 v111, v111, v123
  v_add_f32 v112, v112, v124
  v_add_f32 v113, v113, v125
  v_add_f32 v114, v114, v126
  v_add_f32 v115, v115, v127
  v_permlane16_swap_b32 v104, v110
  v_permlane16_swap_b32 v105, v111
  v_permlane16_swap_b32 v106, v112
  v_permlane16_swap_b32 v107, v113
  v_permlane16_swap_b32 v108, v114
  v_permlane16_swap_b32 v109, v115
  v_add_f32 v104, v104, v110
  v_add_f32 v105, v105, v111
  v_add_f32 v106, v106, v112
  v_add_f32 v107, v107, v113
  v_add_f32 v108, v108, v114
  v_add_f32 v109, v109, v115
  v_add_f32_dpp v104, v104, v104 row_ror:8 row_mask:0xf bank_mask:0xf
  v_add_f32_dpp v105, v105, v105 row_ror:8 row_mask:0xf bank_mask:0xf
  v_add_f32_dpp v106, v106, v106 row_ror:8 row_mask:0xf bank_mask:0xf
  v_add_f32_dpp v107, v107, v107 row_ror:8 row_mask:0xf bank_mask:0xf
  v_add_f32_dpp v108, v108, v108 row_ror:8 row_mask:0xf bank_mask:0xf
  v_add_f32_dpp v109, v109, v109 row_ror:8 row_mask:0xf bank_mask:0xf
  v_add_u32 v229, 0, v7
  v_lshrrev_b32 v230, 3, v229
  v_and_b32 v229, 7, v229
  v_lshlrev_b32 v230, 6, v230
  v_add_u32 v229, v229, v230
  v_lshl_add_u32 v229, v229, 2, v4
  ds_write_b32 v229, v104
  v_add_u32 v229, 1, v7
  v_lshrrev_b32 v230, 3, v229
  v_and_b32 v229, 7, v229
  v_lshlrev_b32 v230, 6, v230
  v_add_u32 v229, v229, v230
  v_lshl_add_u32 v229, v229, 2, v4
  ds_write_b32 v229, v105
  v_add_u32 v229, 2, v7
  v_lshrrev_b32 v230, 3, v229
  v_and_b32 v229, 7, v229
  v_lshlrev_b32 v230, 6, v230
  v_add_u32 v229, v229, v230
  v_lshl_add_u32 v229, v229, 2, v4
  ds_write_b32 v229, v106
  v_add_u32 v229, 3, v7
  v_lshrrev_b32 v230, 3, v229
  v_and_b32 v229, 7, v229
  v_lshlrev_b32 v230, 6, v230
  v_add_u32 v229, v229, v230
  v_lshl_add_u32 v229, v229, 2, v4
  ds_write_b32 v229, v107
  v_add_u32 v229, 4, v7
  v_lshrrev_b32 v230, 3, v229
  v_and_b32 v229, 7, v229
  v_lshlrev_b32 v230, 6, v230
  v_add_u32 v229, v229, v230
  v_lshl_add_u32 v229, v229, 2, v4
  ds_write_b32 v229, v108
  v_add_u32 v229, 5, v7
  v_lshrrev_b32 v230, 3, v229
  v_and_b32 v229, 7, v229
  v_lshlrev_b32 v230, 6, v230
  v_add_u32 v229, v229, v230
  v_lshl_add_u32 v229, v229, 2, v4
  ds_write_b32 v229, v109
  v_mov_b32 v234, v226
  v_mov_b32 v235, v129
  v_mov_b32 v236, 0
  v_mov_b32 v237, 0
  v_and_b32 v229, 0xffffff1f, v4
  ds_write_b128 v229, v[234:237] offset:768
  s_waitcnt lgkmcnt(0)
  ds_read_b128 v[234:237], v5
  s_waitcnt lgkmcnt(0)
  s_add_u32 s76, s73, 0xa93400
  s_mov_b32 exec_lo, -1
  s_mov_b32 exec_hi, 0x1ffff
  buffer_store_dwordx4 v[234:237], v6, s[64:67], s76 offen sc1
  s_mov_b64 exec, -1
  s_waitcnt vmcnt(0)
  s_endpgm

.section .rodata,"a"
.p2align 6
.amdhsa_kernel interleave_layers__mha_block_cached__glu_gated_geglu__decode_kernel
  .amdhsa_next_free_vgpr 512
  .amdhsa_next_free_sgpr 102
  .amdhsa_accum_offset 256
  .amdhsa_group_segment_fixed_size 0
  .amdhsa_kernarg_size 96
  .amdhsa_user_sgpr_count 2
  .amdhsa_user_sgpr_kernarg_segment_ptr 1
  .amdhsa_system_sgpr_workgroup_id_x 1
.end_amdhsa_kernel
```
